```python
import torch

def _softmax(x, axis=-1):
    return torch.softmax(x, dim=axis)

def _gelu(x):
    return torch.nn.functional.gelu(x, approximate='tanh')

def _silu(x):
    return torch.nn.functional.silu(x)

def _sigmoid(x):
    return torch.sigmoid(x)

def _layernorm(x, axis=-1, eps=1e-05):
    m = x.mean(dim=axis, keepdim=True)
    v = x.var(dim=axis, keepdim=True, unbiased=False)
    return (x - m) / torch.sqrt(v + eps)

def _scatter_add(tgt, idx, src, axis=0):
    return tgt.clone().index_add_(axis, idx, src)

def _segment_sum(src, seg, n):
    out = torch.zeros((n,) + src.shape[1:], dtype=src.dtype)
    return out.index_add_(0, seg, src)

def _pad(x, pw):
    flat = tuple((v for pair in reversed(pw) for v in pair))
    return torch.nn.functional.pad(x, flat)
kernel_name = 'gated_mix__mha_block__mixer_gmlp__prompt'

def setup_inputs():

    _w = lambda a: (lambda t: t.to(torch.bfloat16) if t.is_floating_point() else t)(torch.as_tensor(a))

    def _A_setup():
        B, S, D, H = (1, 2048, 1024, 32)
        return {'x': _w((lambda *s: torch.randn(*s, dtype=torch.bfloat16) * 0.05)(B, S, D)), 'wqkv': _w((lambda *s: torch.randn(*s, dtype=torch.bfloat16) * 0.8)(D, 3 * D)), 'wo': _w((lambda *s: torch.randn(*s, dtype=torch.bfloat16) * 0.1)(D, D))}
    _A_in = _A_setup()

    def _B_setup():
        B, S, D, F = (1, 2048, 1024, 3584)
        Fh = F // 2
        return {'x': _w((lambda *s: torch.randn(*s, dtype=torch.bfloat16) * 0.05)(B, S, D)), 'w_in': _w((lambda *s: torch.randn(*s, dtype=torch.bfloat16) * 0.4)(D, 2 * Fh)), 'w_sp': _w(0.01 * (lambda *s: torch.randn(*s, dtype=torch.bfloat16) * 0.4)(S, S)), 'b_sp': _w(1.0 + 0.01 * (lambda *s: torch.randn(*s, dtype=torch.bfloat16) * 0.05)(S)), 'w_out': _w((lambda *s: torch.randn(*s, dtype=torch.bfloat16) * 0.05)(Fh, D))}
    _B_in = _B_setup()
    return {'A_x': _A_in['x'], 'A_wqkv': _A_in['wqkv'], 'A_wo': _A_in['wo'], 'B_x': _B_in['x'], 'B_w_in': _B_in['w_in'], 'B_w_sp': _B_in['w_sp'], 'B_b_sp': _B_in['b_sp'], 'B_w_out': _B_in['w_out'], 'gate_w': _w((lambda *s: torch.randn(*s, dtype=torch.bfloat16) * 0.05)(1024) * 16.0)}

def reference(A_x, A_wqkv, A_wo, B_x, B_w_in, B_w_sp, B_b_sp, B_w_out, gate_w):

    def _A_ref(x, wqkv, wo):
        B, S, D = x.shape
        H = 32
        Dh = D // H
        qkv = (lambda x, *d: x.permute(*d))((x @ wqkv).reshape(B, S, 3, H, Dh), 2, 0, 3, 1, 4)
        q, k, v = (qkv[0], qkv[1], qkv[2])
        scores = torch.einsum('bhqd,bhkd->bhqk', q, k) * Dh ** (-0.5)
        p = _softmax(scores, axis=-1)
        o = torch.einsum('bhqk,bhkd->bhqd', p, v)
        return (lambda x, *d: x.permute(*d))(o, 0, 2, 1, 3).reshape(B, S, D) @ wo

    def _B_ref(x, w_in, w_sp, b_sp, w_out):
        B, S, D = x.shape
        F = w_in.shape[-1]
        Fh = F // 2
        z = _gelu(torch.einsum('bsd,df->bsf', x, w_in))
        z1 = z[..., :Fh].clone()
        z2 = _layernorm(z[..., Fh:], axis=-1)
        g = torch.einsum('ts,bsf->btf', w_sp, z2) + b_sp[None, :, None]
        return torch.einsum('bsf,fd->bsd', z1 * g, w_out)
    x = A_x
    g = _sigmoid((x * gate_w).sum(-1, keepdims=True))
    a = _A_ref(x, A_wqkv, A_wo)
    b = _B_ref(x, B_w_in, B_w_sp, B_b_sp, B_w_out)
    return g * a + (1 - g) * b
```

```asm
; @launch grid=(256,1,1) block=(256,1,1) lds=163840
.amdgcn_target "amdgcn-amd-amdhsa--gfx950"
.text
.globl gated_mix__mha_block__mixer_gmlp__prompt_kernel
.p2align 8
.type gated_mix__mha_block__mixer_gmlp__prompt_kernel,@function
gated_mix__mha_block__mixer_gmlp__prompt_kernel:
  s_cmp_lt_u32 s2, 256
  s_cbranch_scc1 gated_mix__mha_block__mixer_gmlp__prompt_kernel_go
  s_endpgm
gated_mix__mha_block__mixer_gmlp__prompt_kernel_go:
  s_load_dwordx2 s[8:9], s[0:1], 0
  s_load_dwordx2 s[12:13], s[0:1], 32
  s_load_dwordx2 s[16:17], s[0:1], 8
  s_load_dwordx2 s[4:5], s[0:1], 88
  s_load_dwordx2 s[20:21], s[0:1], 64
  s_load_dwordx2 s[64:65], s[0:1], 8
  s_load_dwordx2 s[68:69], s[0:1], 32
  s_load_dwordx2 s[52:53], s[0:1], 40
  s_load_dwordx2 s[54:55], s[0:1], 56
  s_load_dwordx2 s[56:57], s[0:1], 16
  s_load_dwordx2 s[100:101], s[0:1], 80
  s_getpc_b64 s[76:77]
gated_mix__mha_block__mixer_gmlp__prompt_kernel_pc:
  s_sub_u32 s76, s76, gated_mix__mha_block__mixer_gmlp__prompt_kernel_pc-gated_mix__mha_block__mixer_gmlp__prompt_kernel
  s_subb_u32 s77, s77, 0
  s_lshr_b32 s78, s2, 3
  s_lshl_b32 s78, s78, 12
  v_lshlrev_b32 v244, 4, v0
  v_add_u32 v244, s78, v244
  v_min_u32 v244, code_end-gated_mix__mha_block__mixer_gmlp__prompt_kernel-16, v244
  global_load_dwordx4 a[232:235], v244, s[76:77]
  v_and_b32 v234, 63, v0
  v_lshrrev_b32 v236, 6, v0
  s_and_b32 s24, s2, 7
  v_readfirstlane_b32 s44, v236
  s_lshr_b32 s25, s2, 3
  s_and_b32 s80, s24, 1
  s_lshr_b32 s81, s24, 1
  s_lshl_b32 s80, s80, 2
  s_and_b32 s26, s25, 3
  s_add_u32 s80, s80, s26
  s_lshl_b32 s81, s81, 3
  s_lshr_b32 s26, s25, 2
  s_add_u32 s81, s81, s26
  s_lshl_b32 s45, s24, 2
  s_lshr_b32 s26, s25, 3
  s_add_u32 s45, s45, s26
  s_and_b32 s46, s25, 7
  s_lshr_b32 s47, s24, 1
  s_lshl_b32 s47, s47, 2
  s_and_b32 s26, s25, 3
  s_add_u32 s47, s47, s26
  s_and_b32 s48, s24, 1
  s_lshl_b32 s48, s48, 3
  s_lshr_b32 s26, s25, 2
  s_add_u32 s48, s48, s26
  v_lshlrev_b32 v233, 4, v234
  s_lshl_b32 s24, s80, 8
  s_lshl_b32 s25, s44, 6
  s_add_u32 s24, s24, s25
  v_lshrrev_b32 v236, 3, v234
  v_add_u32 v237, s24, v236
  v_lshlrev_b32 v237, 11, v237
  v_bfe_u32 v238, v234, 4, 1
  v_and_b32 v239, 7, v234
  v_xor_b32 v239, v239, v238
  v_xor_b32 v240, 0, v239
  v_lshl_add_u32 v240, v240, 4, v237
  v_add_u32 v225, 0, v240
  v_xor_b32 v240, 2, v239
  v_lshl_add_u32 v240, v240, 4, v237
  v_add_u32 v226, 15360, v240
  v_xor_b32 v240, 4, v239
  v_lshl_add_u32 v240, v240, 4, v237
  v_add_u32 v227, 30720, v240
  v_xor_b32 v240, 6, v239
  v_lshl_add_u32 v240, v240, 4, v237
  v_add_u32 v228, 46080, v240
  s_lshl_b32 s85, s44, 13
  s_mov_b32 s82, 65536
  s_waitcnt lgkmcnt(0)
  s_mov_b32 s10, 4194304
  s_mov_b32 s11, 0x00020000
  s_lshl_b32 s31, s2, 2
  s_add_u32 s31, s31, s44
  s_lshl_b32 s31, s31, 12
  v_lshlrev_b32 v242, 5, v234
  buffer_load_dwordx4 a[232:235], v242, s[8:11], s31 offen offset:0
  buffer_load_dwordx4 a[232:235], v242, s[8:11], s31 offen offset:2048
  s_add_u32 m0, s85, 0
  s_nop 0
  buffer_load_dwordx4 v225, s[8:11], 0 offen offset:0 lds
  buffer_load_dwordx4 v226, s[8:11], 0 offen offset:1024 lds
  buffer_load_dwordx4 v227, s[8:11], 0 offen offset:2048 lds
  buffer_load_dwordx4 v228, s[8:11], 0 offen offset:3072 lds
  s_add_u32 m0, s85, 4096
  s_nop 0
  buffer_load_dwordx4 v225, s[8:11], s82 offen offset:0 lds
  buffer_load_dwordx4 v226, s[8:11], s82 offen offset:1024 lds
  buffer_load_dwordx4 v227, s[8:11], s82 offen offset:2048 lds
  buffer_load_dwordx4 v228, s[8:11], s82 offen offset:3072 lds
  v_lshrrev_b32 v236, 4, v234
  s_and_b32 s24, s44, 1
  s_lshl_b32 s24, s24, 2
  v_or_b32 v237, s24, v236
  v_bfe_u32 v238, v234, 1, 3
  v_xor_b32 v238, v238, v237
  v_and_b32 v239, 1, v234
  v_lshlrev_b32 v239, 4, v239
  v_lshl_add_u32 v239, v238, 5, v239
  s_lshl_b32 s24, s44, 3
  v_add_u32 v236, s24, v236
  s_mul_i32 s25, s81, 224
  s_and_b32 s26, s81, 1
  s_lshl_b32 s27, s26, 5
  s_sub_u32 s25, s25, s27
  s_mov_b32 s28, 7168
  v_mul_lo_u32 v240, v236, s28
  v_add3_u32 v229, v240, v239, s25
  s_sub_u32 s27, 1, s26
  s_mul_i32 s27, s27, 7
  v_mov_b32 v241, 0x80000000
  v_cmp_eq_u32 vcc, s27, v238
  s_mul_i32 s25, s81, 192
  s_mov_b32 s28, 6144
  v_cndmask_b32 v229, v229, v241, vcc
  v_add_u32 v230, 27648, v229
  v_mul_lo_u32 v240, v236, s28
  v_add3_u32 v231, v240, v239, s25
  v_cmp_lt_u32 vcc, 5, v238
  s_lshl_b32 s85, s44, 13
  s_add_u32 s86, s85, 32768
  v_cndmask_b32 v231, v231, v241, vcc
  v_add_u32 v232, 23552, v231
  s_add_u32 s87, s85, 65536
  s_lshl_b32 s88, s44, 12
  s_add_u32 s88, s88, 98304
  s_lshl_b32 s93, s80, 8
  s_lshl_b32 s31, s81, 3
  s_add_u32 s93, s93, s31
  s_lshl_b32 s31, s44, 1
  s_add_u32 s93, s93, s31
  s_lshl_b32 s31, s93, 11
  v_lshlrev_b32 v242, 5, v234
  s_lshl_b32 s92, s2, 2
  s_add_u32 s92, s92, s44
  s_lshl_b32 s90, s92, 10
  s_mov_b32 s91, s90
  v_add_u32 v252, 786432, v233
  v_add_u32 v253, 917504, v233
  v_add_u32 v254, 1835008, v233
  v_add_u32 v255, 1966080, v233
  s_lshl_b32 s32, s92, 8
  s_add_u32 s32, s32, 44040192
  s_cmp_lt_u32 s92, 80
  s_cselect_b32 s32, s32, 0x70000000
  s_cselect_b32 s94, 6, 99
  v_lshlrev_b32 v243, 2, v234
  v_mov_b32 v245, 0
  s_waitcnt lgkmcnt(0)
  s_mov_b32 s10, 4194304
  s_mov_b32 s11, 0x00020000
  s_mov_b32 s14, 7340032
  s_mov_b32 s15, 0x00020000
  s_mov_b32 s18, 6291456
  s_mov_b32 s19, 0x00020000
  s_mov_b32 s6, 67108864
  s_mov_b32 s7, 0x00020000
  s_mov_b32 s22, 2048
  s_mov_b32 s23, 0x00020000
  s_mov_b32 s66, 6291456
  s_mov_b32 s67, 0x00020000
  s_mov_b32 s70, 7340032
  s_mov_b32 s71, 0x00020000
  s_mov_b32 s82, 0
  s_mov_b32 s83, 0
  s_mov_b32 s84, 0
  s_add_u32 m0, s88, 0
  s_nop 0
  buffer_load_dwordx4 v229, s[12:15], s83 offen lds
  buffer_load_dwordx4 v230, s[12:15], s83 offen offset:1024 lds
  s_add_u32 m0, s88, 2048
  s_nop 0
  buffer_load_dwordx4 v231, s[16:19], s84 offen lds
  buffer_load_dwordx4 v232, s[16:19], s84 offen offset:1024 lds
  s_add_u32 s83, s83, 229376
  s_add_u32 s84, s84, 196608
  s_add_u32 m0, s88, 16384
  s_nop 0
  buffer_load_dwordx4 v229, s[12:15], s83 offen lds
  buffer_load_dwordx4 v230, s[12:15], s83 offen offset:1024 lds
  s_add_u32 m0, s88, 18432
  s_nop 0
  buffer_load_dwordx4 v231, s[16:19], s84 offen lds
  buffer_load_dwordx4 v232, s[16:19], s84 offen offset:1024 lds
  s_add_u32 s83, s83, 229376
  s_add_u32 s84, s84, 196608
  s_mov_b32 s82, 128
  s_add_u32 m0, s86, 0
  s_nop 0
  buffer_load_dwordx4 v225, s[8:11], s82 offen offset:0 lds
  buffer_load_dwordx4 v226, s[8:11], s82 offen offset:1024 lds
  buffer_load_dwordx4 v227, s[8:11], s82 offen offset:2048 lds
  buffer_load_dwordx4 v228, s[8:11], s82 offen offset:3072 lds
  buffer_load_dwordx4 a[232:235], v253, s[68:71], s91 offen
  s_add_u32 m0, s88, 32768
  s_nop 0
  buffer_load_dwordx4 v229, s[12:15], s83 offen lds
  buffer_load_dwordx4 v230, s[12:15], s83 offen offset:1024 lds
  s_add_u32 m0, s88, 34816
  s_nop 0
  buffer_load_dwordx4 v231, s[16:19], s84 offen lds
  buffer_load_dwordx4 v232, s[16:19], s84 offen offset:1024 lds
  s_add_u32 s83, s83, 229376
  s_add_u32 s84, s84, 196608
  s_mov_b32 s82, 65664
  s_add_u32 m0, s86, 4096
  s_nop 0
  buffer_load_dwordx4 v225, s[8:11], s82 offen offset:0 lds
  buffer_load_dwordx4 v226, s[8:11], s82 offen offset:1024 lds
  buffer_load_dwordx4 v227, s[8:11], s82 offen offset:2048 lds
  buffer_load_dwordx4 v228, s[8:11], s82 offen offset:3072 lds
  buffer_load_dwordx4 a[232:235], v254, s[64:67], s90 offen
  v_and_b32 v236, 15, v234
  v_lshrrev_b32 v237, 2, v236
  v_lshlrev_b32 v237, 3, v237
  v_and_b32 v238, 3, v236
  v_add_u32 v237, v237, v238
  v_lshlrev_b32 v237, 7, v237
  v_lshrrev_b32 v238, 1, v236
  v_lshrrev_b32 v239, 4, v234
  v_xor_b32 v239, v239, v238
  v_lshl_add_u32 v223, v239, 4, v237
  v_xor_b32 v224, 64, v223
  v_lshrrev_b32 v236, 4, v234
  v_bfe_u32 v237, v234, 2, 2
  v_and_b32 v238, 1, v236
  v_lshl_or_b32 v238, v238, 2, v237
  v_lshlrev_b32 v239, 12, v236
  v_lshl_add_u32 v239, v237, 8, v239
  v_and_b32 v240, 3, v234
  v_lshl_add_u32 v239, v240, 3, v239
  v_add_u32 v239, 98304, v239
  s_and_b32 s26, s81, 1
  s_add_u32 s27, s26, 0
  v_xor_b32 v240, s27, v238
  v_lshl_add_u32 v208, v240, 5, v239
  s_add_u32 s27, s26, 1
  v_xor_b32 v240, s27, v238
  v_lshl_add_u32 v209, v240, 5, v239
  s_add_u32 s27, s26, 2
  v_xor_b32 v240, s27, v238
  v_lshl_add_u32 v210, v240, 5, v239
  s_add_u32 s27, s26, 3
  v_xor_b32 v240, s27, v238
  v_lshl_add_u32 v211, v240, 5, v239
  s_add_u32 s27, s26, 4
  v_xor_b32 v240, s27, v238
  v_lshl_add_u32 v212, v240, 5, v239
  s_add_u32 s27, s26, 5
  v_xor_b32 v240, s27, v238
  v_lshl_add_u32 v213, v240, 5, v239
  s_add_u32 s27, s26, 6
  v_xor_b32 v240, s27, v238
  v_lshl_add_u32 v214, v240, 5, v239
  v_xor_b32 v240, 0, v238
  v_lshl_add_u32 v215, v240, 5, v239
  v_xor_b32 v240, 1, v238
  v_lshl_add_u32 v216, v240, 5, v239
  v_xor_b32 v240, 2, v238
  v_lshl_add_u32 v217, v240, 5, v239
  v_xor_b32 v240, 3, v238
  v_lshl_add_u32 v218, v240, 5, v239
  v_xor_b32 v240, 4, v238
  v_lshl_add_u32 v219, v240, 5, v239
  v_xor_b32 v240, 5, v238
  v_lshl_add_u32 v220, v240, 5, v239
  v_mov_b32 v0, 0
  v_mov_b32 v1, 0
  v_mov_b32 v2, 0
  v_mov_b32 v3, 0
  v_mov_b32 v4, 0
  v_mov_b32 v5, 0
  v_mov_b32 v6, 0
  v_mov_b32 v7, 0
  v_mov_b32 v8, 0
  v_mov_b32 v9, 0
  v_mov_b32 v10, 0
  v_mov_b32 v11, 0
  v_mov_b32 v12, 0
  v_mov_b32 v13, 0
  v_mov_b32 v14, 0
  v_mov_b32 v15, 0
  v_mov_b32 v16, 0
  v_mov_b32 v17, 0
  v_mov_b32 v18, 0
  v_mov_b32 v19, 0
  v_mov_b32 v20, 0
  v_mov_b32 v21, 0
  v_mov_b32 v22, 0
  v_mov_b32 v23, 0
  v_mov_b32 v24, 0
  v_mov_b32 v25, 0
  v_mov_b32 v26, 0
  v_mov_b32 v27, 0
  v_mov_b32 v28, 0
  v_mov_b32 v29, 0
  v_mov_b32 v30, 0
  v_mov_b32 v31, 0
  v_mov_b32 v32, 0
  v_mov_b32 v33, 0
  v_mov_b32 v34, 0
  v_mov_b32 v35, 0
  v_mov_b32 v36, 0
  v_mov_b32 v37, 0
  v_mov_b32 v38, 0
  v_mov_b32 v39, 0
  v_mov_b32 v40, 0
  v_mov_b32 v41, 0
  v_mov_b32 v42, 0
  v_mov_b32 v43, 0
  v_mov_b32 v44, 0
  v_mov_b32 v45, 0
  v_mov_b32 v46, 0
  v_mov_b32 v47, 0
  v_mov_b32 v48, 0
  v_mov_b32 v49, 0
  v_mov_b32 v50, 0
  v_mov_b32 v51, 0
  v_mov_b32 v52, 0
  v_mov_b32 v53, 0
  v_mov_b32 v54, 0
  v_mov_b32 v55, 0
  v_mov_b32 v56, 0
  v_mov_b32 v57, 0
  v_mov_b32 v58, 0
  v_mov_b32 v59, 0
  v_mov_b32 v60, 0
  v_mov_b32 v61, 0
  v_mov_b32 v62, 0
  v_mov_b32 v63, 0
  v_mov_b32 v64, 0
  v_mov_b32 v65, 0
  v_mov_b32 v66, 0
  v_mov_b32 v67, 0
  v_mov_b32 v68, 0
  v_mov_b32 v69, 0
  v_mov_b32 v70, 0
  v_mov_b32 v71, 0
  v_mov_b32 v72, 0
  v_mov_b32 v73, 0
  v_mov_b32 v74, 0
  v_mov_b32 v75, 0
  v_mov_b32 v76, 0
  v_mov_b32 v77, 0
  v_mov_b32 v78, 0
  v_mov_b32 v79, 0
  v_mov_b32 v80, 0
  v_mov_b32 v81, 0
  v_mov_b32 v82, 0
  v_mov_b32 v83, 0
  v_mov_b32 v84, 0
  v_mov_b32 v85, 0
  v_mov_b32 v86, 0
  v_mov_b32 v87, 0
  v_mov_b32 v88, 0
  v_mov_b32 v89, 0
  v_mov_b32 v90, 0
  v_mov_b32 v91, 0
  v_mov_b32 v92, 0
  v_mov_b32 v93, 0
  v_mov_b32 v94, 0
  v_mov_b32 v95, 0
  v_mov_b32 v96, 0
  v_mov_b32 v97, 0
  v_mov_b32 v98, 0
  v_mov_b32 v99, 0
  v_mov_b32 v100, 0
  v_mov_b32 v101, 0
  v_mov_b32 v102, 0
  v_mov_b32 v103, 0
  v_mov_b32 v104, 0
  v_mov_b32 v105, 0
  v_mov_b32 v106, 0
  v_mov_b32 v107, 0
  v_mov_b32 v108, 0
  v_mov_b32 v109, 0
  v_mov_b32 v110, 0
  v_mov_b32 v111, 0
  v_mov_b32 v112, 0
  v_mov_b32 v113, 0
  v_mov_b32 v114, 0
  v_mov_b32 v115, 0
  v_mov_b32 v116, 0
  v_mov_b32 v117, 0
  v_mov_b32 v118, 0
  v_mov_b32 v119, 0
  v_mov_b32 v120, 0
  v_mov_b32 v121, 0
  v_mov_b32 v122, 0
  v_mov_b32 v123, 0
  v_mov_b32 v124, 0
  v_mov_b32 v125, 0
  v_mov_b32 v126, 0
  v_mov_b32 v127, 0
  v_mov_b32 v128, 0
  v_mov_b32 v129, 0
  v_mov_b32 v130, 0
  v_mov_b32 v131, 0
  v_mov_b32 v132, 0
  v_mov_b32 v133, 0
  v_mov_b32 v134, 0
  v_mov_b32 v135, 0
  v_mov_b32 v136, 0
  v_mov_b32 v137, 0
  v_mov_b32 v138, 0
  v_mov_b32 v139, 0
  v_mov_b32 v140, 0
  v_mov_b32 v141, 0
  v_mov_b32 v142, 0
  v_mov_b32 v143, 0
  v_mov_b32 v144, 0
  v_mov_b32 v145, 0
  v_mov_b32 v146, 0
  v_mov_b32 v147, 0
  v_mov_b32 v148, 0
  v_mov_b32 v149, 0
  v_mov_b32 v150, 0
  v_mov_b32 v151, 0
  v_mov_b32 v152, 0
  v_mov_b32 v153, 0
  v_mov_b32 v154, 0
  v_mov_b32 v155, 0
  v_mov_b32 v156, 0
  v_mov_b32 v157, 0
  v_mov_b32 v158, 0
  v_mov_b32 v159, 0
  v_mov_b32 v160, 0
  v_mov_b32 v161, 0
  v_mov_b32 v162, 0
  v_mov_b32 v163, 0
  v_mov_b32 v164, 0
  v_mov_b32 v165, 0
  v_mov_b32 v166, 0
  v_mov_b32 v167, 0
  v_mov_b32 v168, 0
  v_mov_b32 v169, 0
  v_mov_b32 v170, 0
  v_mov_b32 v171, 0
  v_mov_b32 v172, 0
  v_mov_b32 v173, 0
  v_mov_b32 v174, 0
  v_mov_b32 v175, 0
  v_mov_b32 v176, 0
  v_mov_b32 v177, 0
  v_mov_b32 v178, 0
  v_mov_b32 v179, 0
  v_mov_b32 v180, 0
  v_mov_b32 v181, 0
  v_mov_b32 v182, 0
  v_mov_b32 v183, 0
  v_mov_b32 v184, 0
  v_mov_b32 v185, 0
  v_mov_b32 v186, 0
  v_mov_b32 v187, 0
  v_mov_b32 v188, 0
  v_mov_b32 v189, 0
  v_mov_b32 v190, 0
  v_mov_b32 v191, 0
  v_mov_b32 v192, 0
  v_mov_b32 v193, 0
  v_mov_b32 v194, 0
  v_mov_b32 v195, 0
  v_mov_b32 v196, 0
  v_mov_b32 v197, 0
  v_mov_b32 v198, 0
  v_mov_b32 v199, 0
  v_mov_b32 v200, 0
  v_mov_b32 v201, 0
  v_mov_b32 v202, 0
  v_mov_b32 v203, 0
  v_mov_b32 v204, 0
  v_mov_b32 v205, 0
  v_mov_b32 v206, 0
  v_mov_b32 v207, 0
  s_waitcnt vmcnt(18)
  s_barrier
  v_add_u32 v221, s85, v223
  ds_read_b128 a[0:3], v221 offset:0
  ds_read_b128 a[4:7], v221 offset:512
  ds_read_b128 a[8:11], v221 offset:4096
  ds_read_b128 a[12:15], v221 offset:4608
  ds_read_b64_tr_b16 a[32:33], v208 offset:0
  ds_read_b64_tr_b16 a[34:35], v208 offset:1024
  ds_read_b64_tr_b16 a[36:37], v209 offset:0
  ds_read_b64_tr_b16 a[38:39], v209 offset:1024
  ds_read_b64_tr_b16 a[40:41], v210 offset:0
  ds_read_b64_tr_b16 a[42:43], v210 offset:1024
  ds_read_b64_tr_b16 a[44:45], v211 offset:0
  ds_read_b64_tr_b16 a[46:47], v211 offset:1024
  ds_read_b64_tr_b16 a[48:49], v212 offset:0
  ds_read_b64_tr_b16 a[50:51], v212 offset:1024
  ds_read_b64_tr_b16 a[52:53], v213 offset:0
  ds_read_b64_tr_b16 a[54:55], v213 offset:1024
  ds_read_b64_tr_b16 a[56:57], v214 offset:0
  ds_read_b64_tr_b16 a[58:59], v214 offset:1024
  ds_read_b64_tr_b16 a[60:61], v215 offset:2048
  ds_read_b64_tr_b16 a[62:63], v215 offset:3072
  ds_read_b64_tr_b16 a[64:65], v216 offset:2048
  ds_read_b64_tr_b16 a[66:67], v216 offset:3072
  ds_read_b64_tr_b16 a[68:69], v217 offset:2048
  ds_read_b64_tr_b16 a[70:71], v217 offset:3072
  ds_read_b64_tr_b16 a[72:73], v218 offset:2048
  ds_read_b64_tr_b16 a[74:75], v218 offset:3072
  ds_read_b64_tr_b16 a[76:77], v219 offset:2048
  ds_read_b64_tr_b16 a[78:79], v219 offset:3072
  ds_read_b64_tr_b16 a[80:81], v220 offset:2048
  ds_read_b64_tr_b16 a[82:83], v220 offset:3072
  buffer_store_dword v245, v243, s[4:7], s32 offen sc1
  buffer_load_dwordx4 a[232:235], v252, s[64:67], s90 offen
  s_add_u32 m0, s88, 49152
  s_nop 0
  buffer_load_dwordx4 v229, s[12:15], s83 offen lds
  buffer_load_dwordx4 v230, s[12:15], s83 offen offset:1024 lds
  s_add_u32 m0, s88, 51200
  s_nop 0
  buffer_load_dwordx4 v231, s[16:19], s84 offen lds
  buffer_load_dwordx4 v232, s[16:19], s84 offen offset:1024 lds
  s_add_u32 s83, s83, 229376
  s_add_u32 s84, s84, 196608
  s_mov_b32 s82, 256
  s_add_u32 m0, s87, 0
  s_nop 0
  buffer_load_dwordx4 v225, s[8:11], s82 offen offset:0 lds
  buffer_load_dwordx4 v226, s[8:11], s82 offen offset:1024 lds
  buffer_load_dwordx4 v227, s[8:11], s82 offen offset:2048 lds
  buffer_load_dwordx4 v228, s[8:11], s82 offen offset:3072 lds
  buffer_load_dwordx4 a[232:235], v255, s[68:71], s91 offen
  s_add_u32 s90, s90, 2097152
  s_add_u32 s91, s91, 2097152
  s_mov_b32 s82, 65792
  s_waitcnt vmcnt(24) lgkmcnt(0)
  s_barrier
  s_lshl_b32 s28, s92, 10
  s_add_u32 s29, s28, 4325376
  s_add_u32 s28, s28, 3407872
  s_mov_b32 s79, 0
  s_cmp_lt_u32 s81, 16
  s_cbranch_scc1 gated_mix__mha_block__mixer_gmlp__prompt_kernel_v0
  s_cmp_lt_u32 s81, 21
  s_cbranch_scc1 gated_mix__mha_block__mixer_gmlp__prompt_kernel_v1
  s_cmp_eq_u32 s81, 21
  s_cbranch_scc1 gated_mix__mha_block__mixer_gmlp__prompt_kernel_v2
  s_branch gated_mix__mha_block__mixer_gmlp__prompt_kernel_v3
.p2align 6
gated_mix__mha_block__mixer_gmlp__prompt_kernel_v0:
  s_mov_b32 s89, 7
gated_mix__mha_block__mixer_gmlp__prompt_kernel_v0_loop:
  v_mfma_f32_16x16x32_bf16 v[0:3], a[32:35], a[0:3], v[0:3]
  v_add_u32 v221, s85, v224
  v_mfma_f32_16x16x32_bf16 v[4:7], a[32:35], a[4:7], v[4:7]
  ds_read_b128 a[16:19], v221 offset:0
  v_mfma_f32_16x16x32_bf16 v[8:11], a[32:35], a[8:11], v[8:11]
  ds_read_b128 a[20:23], v221 offset:512
  v_mfma_f32_16x16x32_bf16 v[12:15], a[32:35], a[12:15], v[12:15]
  ds_read_b128 a[24:27], v221 offset:4096
  v_mfma_f32_16x16x32_bf16 v[28:31], a[36:39], a[12:15], v[28:31]
  s_add_u32 m0, s88, 0
  v_mfma_f32_16x16x32_bf16 v[24:27], a[36:39], a[8:11], v[24:27]
  ds_read_b128 a[28:31], v221 offset:4608
  v_mfma_f32_16x16x32_bf16 v[20:23], a[36:39], a[4:7], v[20:23]
  ds_read_b64_tr_b16 a[84:85], v208 offset:16384
  v_mfma_f32_16x16x32_bf16 v[16:19], a[36:39], a[0:3], v[16:19]
  ds_read_b64_tr_b16 a[86:87], v208 offset:17408
  v_mfma_f32_16x16x32_bf16 v[32:35], a[40:43], a[0:3], v[32:35]
  buffer_load_dwordx4 v229, s[12:15], s83 offen lds
  v_mfma_f32_16x16x32_bf16 v[36:39], a[40:43], a[4:7], v[36:39]
  ds_read_b64_tr_b16 a[88:89], v209 offset:16384
  v_mfma_f32_16x16x32_bf16 v[40:43], a[40:43], a[8:11], v[40:43]
  ds_read_b64_tr_b16 a[90:91], v209 offset:17408
  v_mfma_f32_16x16x32_bf16 v[44:47], a[40:43], a[12:15], v[44:47]
  ds_read_b64_tr_b16 a[92:93], v210 offset:16384
  v_mfma_f32_16x16x32_bf16 v[60:63], a[44:47], a[12:15], v[60:63]
  buffer_load_dwordx4 v230, s[12:15], s83 offen offset:1024 lds
  v_mfma_f32_16x16x32_bf16 v[56:59], a[44:47], a[8:11], v[56:59]
  ds_read_b64_tr_b16 a[94:95], v210 offset:17408
  v_mfma_f32_16x16x32_bf16 v[52:55], a[44:47], a[4:7], v[52:55]
  ds_read_b64_tr_b16 a[96:97], v211 offset:16384
  v_mfma_f32_16x16x32_bf16 v[48:51], a[44:47], a[0:3], v[48:51]
  ds_read_b64_tr_b16 a[98:99], v211 offset:17408
  v_mfma_f32_16x16x32_bf16 v[64:67], a[48:51], a[0:3], v[64:67]
  s_add_u32 m0, s88, 2048
  v_mfma_f32_16x16x32_bf16 v[68:71], a[48:51], a[4:7], v[68:71]
  ds_read_b64_tr_b16 a[100:101], v212 offset:16384
  v_mfma_f32_16x16x32_bf16 v[72:75], a[48:51], a[8:11], v[72:75]
  ds_read_b64_tr_b16 a[102:103], v212 offset:17408
  v_mfma_f32_16x16x32_bf16 v[76:79], a[48:51], a[12:15], v[76:79]
  ds_read_b64_tr_b16 a[104:105], v213 offset:16384
  v_mfma_f32_16x16x32_bf16 v[92:95], a[52:55], a[12:15], v[92:95]
  buffer_load_dwordx4 v231, s[16:19], s84 offen lds
  v_mfma_f32_16x16x32_bf16 v[88:91], a[52:55], a[8:11], v[88:91]
  ds_read_b64_tr_b16 a[106:107], v213 offset:17408
  v_mfma_f32_16x16x32_bf16 v[84:87], a[52:55], a[4:7], v[84:87]
  ds_read_b64_tr_b16 a[108:109], v214 offset:16384
  v_mfma_f32_16x16x32_bf16 v[80:83], a[52:55], a[0:3], v[80:83]
  ds_read_b64_tr_b16 a[110:111], v214 offset:17408
  v_mfma_f32_16x16x32_bf16 v[96:99], a[56:59], a[0:3], v[96:99]
  buffer_load_dwordx4 v232, s[16:19], s84 offen offset:1024 lds
  v_mfma_f32_16x16x32_bf16 v[100:103], a[56:59], a[4:7], v[100:103]
  ds_read_b64_tr_b16 a[112:113], v215 offset:18432
  v_mfma_f32_16x16x32_bf16 v[104:107], a[56:59], a[8:11], v[104:107]
  ds_read_b64_tr_b16 a[114:115], v215 offset:19456
  v_mfma_f32_16x16x32_bf16 v[108:111], a[56:59], a[12:15], v[108:111]
  ds_read_b64_tr_b16 a[116:117], v216 offset:18432
  v_mfma_f32_16x16x32_bf16 v[124:127], a[60:63], a[12:15], v[124:127]
  s_add_u32 m0, s87, 4096
  v_mfma_f32_16x16x32_bf16 v[120:123], a[60:63], a[8:11], v[120:123]
  ds_read_b64_tr_b16 a[118:119], v216 offset:19456
  v_mfma_f32_16x16x32_bf16 v[116:119], a[60:63], a[4:7], v[116:119]
  ds_read_b64_tr_b16 a[120:121], v217 offset:18432
  v_mfma_f32_16x16x32_bf16 v[112:115], a[60:63], a[0:3], v[112:115]
  ds_read_b64_tr_b16 a[122:123], v217 offset:19456
  v_mfma_f32_16x16x32_bf16 v[128:131], a[64:67], a[0:3], v[128:131]
  buffer_load_dwordx4 v225, s[8:11], s82 offen offset:0 lds
  v_mfma_f32_16x16x32_bf16 v[132:135], a[64:67], a[4:7], v[132:135]
  ds_read_b64_tr_b16 a[124:125], v218 offset:18432
  v_mfma_f32_16x16x32_bf16 v[136:139], a[64:67], a[8:11], v[136:139]
  ds_read_b64_tr_b16 a[126:127], v218 offset:19456
  v_mfma_f32_16x16x32_bf16 v[140:143], a[64:67], a[12:15], v[140:143]
  ds_read_b64_tr_b16 a[128:129], v219 offset:18432
  v_mfma_f32_16x16x32_bf16 v[156:159], a[68:71], a[12:15], v[156:159]
  buffer_load_dwordx4 v226, s[8:11], s82 offen offset:1024 lds
  v_mfma_f32_16x16x32_bf16 v[152:155], a[68:71], a[8:11], v[152:155]
  ds_read_b64_tr_b16 a[130:131], v219 offset:19456
  v_mfma_f32_16x16x32_bf16 v[148:151], a[68:71], a[4:7], v[148:151]
  ds_read_b64_tr_b16 a[132:133], v220 offset:18432
  v_mfma_f32_16x16x32_bf16 v[144:147], a[68:71], a[0:3], v[144:147]
  ds_read_b64_tr_b16 a[134:135], v220 offset:19456
  v_mfma_f32_16x16x32_bf16 v[160:163], a[72:75], a[0:3], v[160:163]
  buffer_load_dwordx4 v227, s[8:11], s82 offen offset:2048 lds
  v_mfma_f32_16x16x32_bf16 v[164:167], a[72:75], a[4:7], v[164:167]
  buffer_load_dwordx4 v228, s[8:11], s82 offen offset:3072 lds
  v_mfma_f32_16x16x32_bf16 v[168:171], a[72:75], a[8:11], v[168:171]
  buffer_load_dwordx4 a[232:235], v252, s[64:67], s90 offen
  v_mfma_f32_16x16x32_bf16 v[172:175], a[72:75], a[12:15], v[172:175]
  s_add_u32 s83, s83, 229376
  v_mfma_f32_16x16x32_bf16 v[188:191], a[76:79], a[12:15], v[188:191]
  s_add_u32 s84, s84, 196608
  v_mfma_f32_16x16x32_bf16 v[184:187], a[76:79], a[8:11], v[184:187]
  s_sub_u32 s82, s82, 65408
  v_mfma_f32_16x16x32_bf16 v[180:183], a[76:79], a[4:7], v[180:183]
  s_sub_u32 s89, s89, 1
  v_mfma_f32_16x16x32_bf16 v[176:179], a[76:79], a[0:3], v[176:179]
  v_mfma_f32_16x16x32_bf16 v[192:195], a[80:83], a[0:3], v[192:195]
  v_mfma_f32_16x16x32_bf16 v[196:199], a[80:83], a[4:7], v[196:199]
  v_mfma_f32_16x16x32_bf16 v[200:203], a[80:83], a[8:11], v[200:203]
  v_mfma_f32_16x16x32_bf16 v[204:207], a[80:83], a[12:15], v[204:207]
  s_waitcnt vmcnt(19) lgkmcnt(0)
  s_barrier
  v_mfma_f32_16x16x32_bf16 v[0:3], a[84:87], a[16:19], v[0:3]
  v_add_u32 v221, s86, v223
  v_mfma_f32_16x16x32_bf16 v[4:7], a[84:87], a[20:23], v[4:7]
  ds_read_b128 a[0:3], v221 offset:0
  v_mfma_f32_16x16x32_bf16 v[8:11], a[84:87], a[24:27], v[8:11]
  ds_read_b128 a[4:7], v221 offset:512
  v_mfma_f32_16x16x32_bf16 v[12:15], a[84:87], a[28:31], v[12:15]
  ds_read_b128 a[8:11], v221 offset:4096
  v_mfma_f32_16x16x32_bf16 v[28:31], a[88:91], a[28:31], v[28:31]
  s_add_u32 m0, s88, 16384
  v_mfma_f32_16x16x32_bf16 v[24:27], a[88:91], a[24:27], v[24:27]
  ds_read_b128 a[12:15], v221 offset:4608
  v_mfma_f32_16x16x32_bf16 v[20:23], a[88:91], a[20:23], v[20:23]
  ds_read_b64_tr_b16 a[32:33], v208 offset:32768
  v_mfma_f32_16x16x32_bf16 v[16:19], a[88:91], a[16:19], v[16:19]
  ds_read_b64_tr_b16 a[34:35], v208 offset:33792
  v_mfma_f32_16x16x32_bf16 v[32:35], a[92:95], a[16:19], v[32:35]
  buffer_load_dwordx4 v229, s[12:15], s83 offen lds
  v_mfma_f32_16x16x32_bf16 v[36:39], a[92:95], a[20:23], v[36:39]
  ds_read_b64_tr_b16 a[36:37], v209 offset:32768
  v_mfma_f32_16x16x32_bf16 v[40:43], a[92:95], a[24:27], v[40:43]
  ds_read_b64_tr_b16 a[38:39], v209 offset:33792
  v_mfma_f32_16x16x32_bf16 v[44:47], a[92:95], a[28:31], v[44:47]
  ds_read_b64_tr_b16 a[40:41], v210 offset:32768
  v_mfma_f32_16x16x32_bf16 v[60:63], a[96:99], a[28:31], v[60:63]
  buffer_load_dwordx4 v230, s[12:15], s83 offen offset:1024 lds
  v_mfma_f32_16x16x32_bf16 v[56:59], a[96:99], a[24:27], v[56:59]
  ds_read_b64_tr_b16 a[42:43], v210 offset:33792
  v_mfma_f32_16x16x32_bf16 v[52:55], a[96:99], a[20:23], v[52:55]
  ds_read_b64_tr_b16 a[44:45], v211 offset:32768
  v_mfma_f32_16x16x32_bf16 v[48:51], a[96:99], a[16:19], v[48:51]
  ds_read_b64_tr_b16 a[46:47], v211 offset:33792
  v_mfma_f32_16x16x32_bf16 v[64:67], a[100:103], a[16:19], v[64:67]
  s_add_u32 m0, s88, 18432
  v_mfma_f32_16x16x32_bf16 v[68:71], a[100:103], a[20:23], v[68:71]
  ds_read_b64_tr_b16 a[48:49], v212 offset:32768
  v_mfma_f32_16x16x32_bf16 v[72:75], a[100:103], a[24:27], v[72:75]
  ds_read_b64_tr_b16 a[50:51], v212 offset:33792
  v_mfma_f32_16x16x32_bf16 v[76:79], a[100:103], a[28:31], v[76:79]
  ds_read_b64_tr_b16 a[52:53], v213 offset:32768
  v_mfma_f32_16x16x32_bf16 v[92:95], a[104:107], a[28:31], v[92:95]
  buffer_load_dwordx4 v231, s[16:19], s84 offen lds
  v_mfma_f32_16x16x32_bf16 v[88:91], a[104:107], a[24:27], v[88:91]
  ds_read_b64_tr_b16 a[54:55], v213 offset:33792
  v_mfma_f32_16x16x32_bf16 v[84:87], a[104:107], a[20:23], v[84:87]
  ds_read_b64_tr_b16 a[56:57], v214 offset:32768
  v_mfma_f32_16x16x32_bf16 v[80:83], a[104:107], a[16:19], v[80:83]
  ds_read_b64_tr_b16 a[58:59], v214 offset:33792
  v_mfma_f32_16x16x32_bf16 v[96:99], a[108:111], a[16:19], v[96:99]
  buffer_load_dwordx4 v232, s[16:19], s84 offen offset:1024 lds
  v_mfma_f32_16x16x32_bf16 v[100:103], a[108:111], a[20:23], v[100:103]
  ds_read_b64_tr_b16 a[60:61], v215 offset:34816
  v_mfma_f32_16x16x32_bf16 v[104:107], a[108:111], a[24:27], v[104:107]
  ds_read_b64_tr_b16 a[62:63], v215 offset:35840
  v_mfma_f32_16x16x32_bf16 v[108:111], a[108:111], a[28:31], v[108:111]
  ds_read_b64_tr_b16 a[64:65], v216 offset:34816
  v_mfma_f32_16x16x32_bf16 v[124:127], a[112:115], a[28:31], v[124:127]
  s_add_u32 m0, s85, 0
  v_mfma_f32_16x16x32_bf16 v[120:123], a[112:115], a[24:27], v[120:123]
  ds_read_b64_tr_b16 a[66:67], v216 offset:35840
  v_mfma_f32_16x16x32_bf16 v[116:119], a[112:115], a[20:23], v[116:119]
  ds_read_b64_tr_b16 a[68:69], v217 offset:34816
  v_mfma_f32_16x16x32_bf16 v[112:115], a[112:115], a[16:19], v[112:115]
  ds_read_b64_tr_b16 a[70:71], v217 offset:35840
  v_mfma_f32_16x16x32_bf16 v[128:131], a[116:119], a[16:19], v[128:131]
  buffer_load_dwordx4 v225, s[8:11], s82 offen offset:0 lds
  v_mfma_f32_16x16x32_bf16 v[132:135], a[116:119], a[20:23], v[132:135]
  ds_read_b64_tr_b16 a[72:73], v218 offset:34816
  v_mfma_f32_16x16x32_bf16 v[136:139], a[116:119], a[24:27], v[136:139]
  ds_read_b64_tr_b16 a[74:75], v218 offset:35840
  v_mfma_f32_16x16x32_bf16 v[140:143], a[116:119], a[28:31], v[140:143]
  ds_read_b64_tr_b16 a[76:77], v219 offset:34816
  v_mfma_f32_16x16x32_bf16 v[156:159], a[120:123], a[28:31], v[156:159]
  buffer_load_dwordx4 v226, s[8:11], s82 offen offset:1024 lds
  v_mfma_f32_16x16x32_bf16 v[152:155], a[120:123], a[24:27], v[152:155]
  ds_read_b64_tr_b16 a[78:79], v219 offset:35840
  v_mfma_f32_16x16x32_bf16 v[148:151], a[120:123], a[20:23], v[148:151]
  ds_read_b64_tr_b16 a[80:81], v220 offset:34816
  v_mfma_f32_16x16x32_bf16 v[144:147], a[120:123], a[16:19], v[144:147]
  ds_read_b64_tr_b16 a[82:83], v220 offset:35840
  v_mfma_f32_16x16x32_bf16 v[160:163], a[124:127], a[16:19], v[160:163]
  buffer_load_dwordx4 v227, s[8:11], s82 offen offset:2048 lds
  v_mfma_f32_16x16x32_bf16 v[164:167], a[124:127], a[20:23], v[164:167]
  buffer_load_dwordx4 v228, s[8:11], s82 offen offset:3072 lds
  v_mfma_f32_16x16x32_bf16 v[168:171], a[124:127], a[24:27], v[168:171]
  buffer_load_dwordx4 a[232:235], v253, s[68:71], s91 offen
  v_mfma_f32_16x16x32_bf16 v[172:175], a[124:127], a[28:31], v[172:175]
  s_add_u32 s83, s83, 229376
  v_mfma_f32_16x16x32_bf16 v[188:191], a[128:131], a[28:31], v[188:191]
  s_add_u32 s84, s84, 196608
  v_mfma_f32_16x16x32_bf16 v[184:187], a[128:131], a[24:27], v[184:187]
  s_add_u32 s82, s82, 65536
  v_mfma_f32_16x16x32_bf16 v[180:183], a[128:131], a[20:23], v[180:183]
  v_mfma_f32_16x16x32_bf16 v[176:179], a[128:131], a[16:19], v[176:179]
  v_mfma_f32_16x16x32_bf16 v[192:195], a[132:135], a[16:19], v[192:195]
  v_mfma_f32_16x16x32_bf16 v[196:199], a[132:135], a[20:23], v[196:199]
  v_mfma_f32_16x16x32_bf16 v[200:203], a[132:135], a[24:27], v[200:203]
  v_mfma_f32_16x16x32_bf16 v[204:207], a[132:135], a[28:31], v[204:207]
  s_waitcnt vmcnt(19) lgkmcnt(0)
  s_barrier
  v_mfma_f32_16x16x32_bf16 v[0:3], a[32:35], a[0:3], v[0:3]
  v_add_u32 v221, s86, v224
  v_mfma_f32_16x16x32_bf16 v[4:7], a[32:35], a[4:7], v[4:7]
  ds_read_b128 a[16:19], v221 offset:0
  v_mfma_f32_16x16x32_bf16 v[8:11], a[32:35], a[8:11], v[8:11]
  ds_read_b128 a[20:23], v221 offset:512
  v_mfma_f32_16x16x32_bf16 v[12:15], a[32:35], a[12:15], v[12:15]
  ds_read_b128 a[24:27], v221 offset:4096
  v_mfma_f32_16x16x32_bf16 v[28:31], a[36:39], a[12:15], v[28:31]
  s_add_u32 m0, s88, 32768
  v_mfma_f32_16x16x32_bf16 v[24:27], a[36:39], a[8:11], v[24:27]
  ds_read_b128 a[28:31], v221 offset:4608
  v_mfma_f32_16x16x32_bf16 v[20:23], a[36:39], a[4:7], v[20:23]
  ds_read_b64_tr_b16 a[84:85], v208 offset:49152
  v_mfma_f32_16x16x32_bf16 v[16:19], a[36:39], a[0:3], v[16:19]
  ds_read_b64_tr_b16 a[86:87], v208 offset:50176
  v_mfma_f32_16x16x32_bf16 v[32:35], a[40:43], a[0:3], v[32:35]
  buffer_load_dwordx4 v229, s[12:15], s83 offen lds
  v_mfma_f32_16x16x32_bf16 v[36:39], a[40:43], a[4:7], v[36:39]
  ds_read_b64_tr_b16 a[88:89], v209 offset:49152
  v_mfma_f32_16x16x32_bf16 v[40:43], a[40:43], a[8:11], v[40:43]
  ds_read_b64_tr_b16 a[90:91], v209 offset:50176
  v_mfma_f32_16x16x32_bf16 v[44:47], a[40:43], a[12:15], v[44:47]
  ds_read_b64_tr_b16 a[92:93], v210 offset:49152
  v_mfma_f32_16x16x32_bf16 v[60:63], a[44:47], a[12:15], v[60:63]
  buffer_load_dwordx4 v230, s[12:15], s83 offen offset:1024 lds
  v_mfma_f32_16x16x32_bf16 v[56:59], a[44:47], a[8:11], v[56:59]
  ds_read_b64_tr_b16 a[94:95], v210 offset:50176
  v_mfma_f32_16x16x32_bf16 v[52:55], a[44:47], a[4:7], v[52:55]
  ds_read_b64_tr_b16 a[96:97], v211 offset:49152
  v_mfma_f32_16x16x32_bf16 v[48:51], a[44:47], a[0:3], v[48:51]
  ds_read_b64_tr_b16 a[98:99], v211 offset:50176
  v_mfma_f32_16x16x32_bf16 v[64:67], a[48:51], a[0:3], v[64:67]
  s_add_u32 m0, s88, 34816
  v_mfma_f32_16x16x32_bf16 v[68:71], a[48:51], a[4:7], v[68:71]
  ds_read_b64_tr_b16 a[100:101], v212 offset:49152
  v_mfma_f32_16x16x32_bf16 v[72:75], a[48:51], a[8:11], v[72:75]
  ds_read_b64_tr_b16 a[102:103], v212 offset:50176
  v_mfma_f32_16x16x32_bf16 v[76:79], a[48:51], a[12:15], v[76:79]
  ds_read_b64_tr_b16 a[104:105], v213 offset:49152
  v_mfma_f32_16x16x32_bf16 v[92:95], a[52:55], a[12:15], v[92:95]
  buffer_load_dwordx4 v231, s[16:19], s84 offen lds
  v_mfma_f32_16x16x32_bf16 v[88:91], a[52:55], a[8:11], v[88:91]
  ds_read_b64_tr_b16 a[106:107], v213 offset:50176
  v_mfma_f32_16x16x32_bf16 v[84:87], a[52:55], a[4:7], v[84:87]
  ds_read_b64_tr_b16 a[108:109], v214 offset:49152
  v_mfma_f32_16x16x32_bf16 v[80:83], a[52:55], a[0:3], v[80:83]
  ds_read_b64_tr_b16 a[110:111], v214 offset:50176
  v_mfma_f32_16x16x32_bf16 v[96:99], a[56:59], a[0:3], v[96:99]
  buffer_load_dwordx4 v232, s[16:19], s84 offen offset:1024 lds
  v_mfma_f32_16x16x32_bf16 v[100:103], a[56:59], a[4:7], v[100:103]
  ds_read_b64_tr_b16 a[112:113], v215 offset:51200
  v_mfma_f32_16x16x32_bf16 v[104:107], a[56:59], a[8:11], v[104:107]
  ds_read_b64_tr_b16 a[114:115], v215 offset:52224
  v_mfma_f32_16x16x32_bf16 v[108:111], a[56:59], a[12:15], v[108:111]
  ds_read_b64_tr_b16 a[116:117], v216 offset:51200
  v_mfma_f32_16x16x32_bf16 v[124:127], a[60:63], a[12:15], v[124:127]
  s_add_u32 m0, s85, 4096
  v_mfma_f32_16x16x32_bf16 v[120:123], a[60:63], a[8:11], v[120:123]
  ds_read_b64_tr_b16 a[118:119], v216 offset:52224
  v_mfma_f32_16x16x32_bf16 v[116:119], a[60:63], a[4:7], v[116:119]
  ds_read_b64_tr_b16 a[120:121], v217 offset:51200
  v_mfma_f32_16x16x32_bf16 v[112:115], a[60:63], a[0:3], v[112:115]
  ds_read_b64_tr_b16 a[122:123], v217 offset:52224
  v_mfma_f32_16x16x32_bf16 v[128:131], a[64:67], a[0:3], v[128:131]
  buffer_load_dwordx4 v225, s[8:11], s82 offen offset:0 lds
  v_mfma_f32_16x16x32_bf16 v[132:135], a[64:67], a[4:7], v[132:135]
  ds_read_b64_tr_b16 a[124:125], v218 offset:51200
  v_mfma_f32_16x16x32_bf16 v[136:139], a[64:67], a[8:11], v[136:139]
  ds_read_b64_tr_b16 a[126:127], v218 offset:52224
  v_mfma_f32_16x16x32_bf16 v[140:143], a[64:67], a[12:15], v[140:143]
  ds_read_b64_tr_b16 a[128:129], v219 offset:51200
  v_mfma_f32_16x16x32_bf16 v[156:159], a[68:71], a[12:15], v[156:159]
  buffer_load_dwordx4 v226, s[8:11], s82 offen offset:1024 lds
  v_mfma_f32_16x16x32_bf16 v[152:155], a[68:71], a[8:11], v[152:155]
  ds_read_b64_tr_b16 a[130:131], v219 offset:52224
  v_mfma_f32_16x16x32_bf16 v[148:151], a[68:71], a[4:7], v[148:151]
  ds_read_b64_tr_b16 a[132:133], v220 offset:51200
  v_mfma_f32_16x16x32_bf16 v[144:147], a[68:71], a[0:3], v[144:147]
  ds_read_b64_tr_b16 a[134:135], v220 offset:52224
  v_mfma_f32_16x16x32_bf16 v[160:163], a[72:75], a[0:3], v[160:163]
  buffer_load_dwordx4 v227, s[8:11], s82 offen offset:2048 lds
  v_mfma_f32_16x16x32_bf16 v[164:167], a[72:75], a[4:7], v[164:167]
  buffer_load_dwordx4 v228, s[8:11], s82 offen offset:3072 lds
  v_mfma_f32_16x16x32_bf16 v[168:171], a[72:75], a[8:11], v[168:171]
  buffer_load_dwordx4 a[232:235], v254, s[64:67], s90 offen
  v_mfma_f32_16x16x32_bf16 v[172:175], a[72:75], a[12:15], v[172:175]
  s_add_u32 s83, s83, 229376
  v_mfma_f32_16x16x32_bf16 v[188:191], a[76:79], a[12:15], v[188:191]
  s_add_u32 s84, s84, 196608
  v_mfma_f32_16x16x32_bf16 v[184:187], a[76:79], a[8:11], v[184:187]
  s_sub_u32 s82, s82, 65408
  v_mfma_f32_16x16x32_bf16 v[180:183], a[76:79], a[4:7], v[180:183]
  s_add_u32 s90, s90, 2097152
  v_mfma_f32_16x16x32_bf16 v[176:179], a[76:79], a[0:3], v[176:179]
  s_min_u32 s90, s90, s28
  v_mfma_f32_16x16x32_bf16 v[192:195], a[80:83], a[0:3], v[192:195]
  v_mfma_f32_16x16x32_bf16 v[196:199], a[80:83], a[4:7], v[196:199]
  v_mfma_f32_16x16x32_bf16 v[200:203], a[80:83], a[8:11], v[200:203]
  v_mfma_f32_16x16x32_bf16 v[204:207], a[80:83], a[12:15], v[204:207]
  s_waitcnt vmcnt(19) lgkmcnt(0)
  s_barrier
  v_mfma_f32_16x16x32_bf16 v[0:3], a[84:87], a[16:19], v[0:3]
  v_add_u32 v221, s87, v223
  v_mfma_f32_16x16x32_bf16 v[4:7], a[84:87], a[20:23], v[4:7]
  ds_read_b128 a[0:3], v221 offset:0
  v_mfma_f32_16x16x32_bf16 v[8:11], a[84:87], a[24:27], v[8:11]
  ds_read_b128 a[4:7], v221 offset:512
  v_mfma_f32_16x16x32_bf16 v[12:15], a[84:87], a[28:31], v[12:15]
  ds_read_b128 a[8:11], v221 offset:4096
  v_mfma_f32_16x16x32_bf16 v[28:31], a[88:91], a[28:31], v[28:31]
  s_add_u32 m0, s88, 49152
  v_mfma_f32_16x16x32_bf16 v[24:27], a[88:91], a[24:27], v[24:27]
  ds_read_b128 a[12:15], v221 offset:4608
  v_mfma_f32_16x16x32_bf16 v[20:23], a[88:91], a[20:23], v[20:23]
  ds_read_b64_tr_b16 a[32:33], v208 offset:0
  v_mfma_f32_16x16x32_bf16 v[16:19], a[88:91], a[16:19], v[16:19]
  ds_read_b64_tr_b16 a[34:35], v208 offset:1024
  v_mfma_f32_16x16x32_bf16 v[32:35], a[92:95], a[16:19], v[32:35]
  buffer_load_dwordx4 v229, s[12:15], s83 offen lds
  v_mfma_f32_16x16x32_bf16 v[36:39], a[92:95], a[20:23], v[36:39]
  ds_read_b64_tr_b16 a[36:37], v209 offset:0
  v_mfma_f32_16x16x32_bf16 v[40:43], a[92:95], a[24:27], v[40:43]
  ds_read_b64_tr_b16 a[38:39], v209 offset:1024
  v_mfma_f32_16x16x32_bf16 v[44:47], a[92:95], a[28:31], v[44:47]
  ds_read_b64_tr_b16 a[40:41], v210 offset:0
  v_mfma_f32_16x16x32_bf16 v[60:63], a[96:99], a[28:31], v[60:63]
  buffer_load_dwordx4 v230, s[12:15], s83 offen offset:1024 lds
  v_mfma_f32_16x16x32_bf16 v[56:59], a[96:99], a[24:27], v[56:59]
  ds_read_b64_tr_b16 a[42:43], v210 offset:1024
  v_mfma_f32_16x16x32_bf16 v[52:55], a[96:99], a[20:23], v[52:55]
  ds_read_b64_tr_b16 a[44:45], v211 offset:0
  v_mfma_f32_16x16x32_bf16 v[48:51], a[96:99], a[16:19], v[48:51]
  ds_read_b64_tr_b16 a[46:47], v211 offset:1024
  v_mfma_f32_16x16x32_bf16 v[64:67], a[100:103], a[16:19], v[64:67]
  s_add_u32 m0, s88, 51200
  v_mfma_f32_16x16x32_bf16 v[68:71], a[100:103], a[20:23], v[68:71]
  ds_read_b64_tr_b16 a[48:49], v212 offset:0
  v_mfma_f32_16x16x32_bf16 v[72:75], a[100:103], a[24:27], v[72:75]
  ds_read_b64_tr_b16 a[50:51], v212 offset:1024
  v_mfma_f32_16x16x32_bf16 v[76:79], a[100:103], a[28:31], v[76:79]
  ds_read_b64_tr_b16 a[52:53], v213 offset:0
  v_mfma_f32_16x16x32_bf16 v[92:95], a[104:107], a[28:31], v[92:95]
  buffer_load_dwordx4 v231, s[16:19], s84 offen lds
  v_mfma_f32_16x16x32_bf16 v[88:91], a[104:107], a[24:27], v[88:91]
  ds_read_b64_tr_b16 a[54:55], v213 offset:1024
  v_mfma_f32_16x16x32_bf16 v[84:87], a[104:107], a[20:23], v[84:87]
  ds_read_b64_tr_b16 a[56:57], v214 offset:0
  v_mfma_f32_16x16x32_bf16 v[80:83], a[104:107], a[16:19], v[80:83]
  ds_read_b64_tr_b16 a[58:59], v214 offset:1024
  v_mfma_f32_16x16x32_bf16 v[96:99], a[108:111], a[16:19], v[96:99]
  buffer_load_dwordx4 v232, s[16:19], s84 offen offset:1024 lds
  v_mfma_f32_16x16x32_bf16 v[100:103], a[108:111], a[20:23], v[100:103]
  ds_read_b64_tr_b16 a[60:61], v215 offset:2048
  v_mfma_f32_16x16x32_bf16 v[104:107], a[108:111], a[24:27], v[104:107]
  ds_read_b64_tr_b16 a[62:63], v215 offset:3072
  v_mfma_f32_16x16x32_bf16 v[108:111], a[108:111], a[28:31], v[108:111]
  ds_read_b64_tr_b16 a[64:65], v216 offset:2048
  v_mfma_f32_16x16x32_bf16 v[124:127], a[112:115], a[28:31], v[124:127]
  s_add_u32 m0, s86, 0
  v_mfma_f32_16x16x32_bf16 v[120:123], a[112:115], a[24:27], v[120:123]
  ds_read_b64_tr_b16 a[66:67], v216 offset:3072
  v_mfma_f32_16x16x32_bf16 v[116:119], a[112:115], a[20:23], v[116:119]
  ds_read_b64_tr_b16 a[68:69], v217 offset:2048
  v_mfma_f32_16x16x32_bf16 v[112:115], a[112:115], a[16:19], v[112:115]
  ds_read_b64_tr_b16 a[70:71], v217 offset:3072
  v_mfma_f32_16x16x32_bf16 v[128:131], a[116:119], a[16:19], v[128:131]
  buffer_load_dwordx4 v225, s[8:11], s82 offen offset:0 lds
  v_mfma_f32_16x16x32_bf16 v[132:135], a[116:119], a[20:23], v[132:135]
  ds_read_b64_tr_b16 a[72:73], v218 offset:2048
  v_mfma_f32_16x16x32_bf16 v[136:139], a[116:119], a[24:27], v[136:139]
  ds_read_b64_tr_b16 a[74:75], v218 offset:3072
  v_mfma_f32_16x16x32_bf16 v[140:143], a[116:119], a[28:31], v[140:143]
  ds_read_b64_tr_b16 a[76:77], v219 offset:2048
  v_mfma_f32_16x16x32_bf16 v[156:159], a[120:123], a[28:31], v[156:159]
  buffer_load_dwordx4 v226, s[8:11], s82 offen offset:1024 lds
  v_mfma_f32_16x16x32_bf16 v[152:155], a[120:123], a[24:27], v[152:155]
  ds_read_b64_tr_b16 a[78:79], v219 offset:3072
  v_mfma_f32_16x16x32_bf16 v[148:151], a[120:123], a[20:23], v[148:151]
  ds_read_b64_tr_b16 a[80:81], v220 offset:2048
  v_mfma_f32_16x16x32_bf16 v[144:147], a[120:123], a[16:19], v[144:147]
  ds_read_b64_tr_b16 a[82:83], v220 offset:3072
  v_mfma_f32_16x16x32_bf16 v[160:163], a[124:127], a[16:19], v[160:163]
  buffer_load_dwordx4 v227, s[8:11], s82 offen offset:2048 lds
  v_mfma_f32_16x16x32_bf16 v[164:167], a[124:127], a[20:23], v[164:167]
  buffer_load_dwordx4 v228, s[8:11], s82 offen offset:3072 lds
  v_mfma_f32_16x16x32_bf16 v[168:171], a[124:127], a[24:27], v[168:171]
  buffer_load_dwordx4 a[232:235], v255, s[68:71], s91 offen
  v_mfma_f32_16x16x32_bf16 v[172:175], a[124:127], a[28:31], v[172:175]
  s_add_u32 s83, s83, 229376
  v_mfma_f32_16x16x32_bf16 v[188:191], a[128:131], a[28:31], v[188:191]
  s_add_u32 s84, s84, 196608
  v_mfma_f32_16x16x32_bf16 v[184:187], a[128:131], a[24:27], v[184:187]
  s_add_u32 s82, s82, 65536
  v_mfma_f32_16x16x32_bf16 v[180:183], a[128:131], a[20:23], v[180:183]
  s_mov_b32 s24, s87
  v_mfma_f32_16x16x32_bf16 v[176:179], a[128:131], a[16:19], v[176:179]
  s_mov_b32 s87, s86
  v_mfma_f32_16x16x32_bf16 v[192:195], a[132:135], a[16:19], v[192:195]
  s_mov_b32 s86, s85
  v_mfma_f32_16x16x32_bf16 v[196:199], a[132:135], a[20:23], v[196:199]
  s_mov_b32 s85, s24
  v_mfma_f32_16x16x32_bf16 v[200:203], a[132:135], a[24:27], v[200:203]
  s_add_u32 s91, s91, 2097152
  v_mfma_f32_16x16x32_bf16 v[204:207], a[132:135], a[28:31], v[204:207]
  s_min_u32 s91, s91, s29
  s_waitcnt vmcnt(19) lgkmcnt(0)
  s_barrier
  s_cmp_lg_u32 s89, 5
  s_cbranch_scc1 gated_mix__mha_block__mixer_gmlp__prompt_kernel_v0_s5
  s_call_b64 s[24:25], gated_mix__mha_block__mixer_gmlp__prompt_kernel_pfsw1
gated_mix__mha_block__mixer_gmlp__prompt_kernel_v0_s5:
  s_cmp_lg_u32 s89, 3
  s_cbranch_scc1 gated_mix__mha_block__mixer_gmlp__prompt_kernel_v0_s3
  s_call_b64 s[24:25], gated_mix__mha_block__mixer_gmlp__prompt_kernel_pfsw2
gated_mix__mha_block__mixer_gmlp__prompt_kernel_v0_s3:
  s_cmp_lg_u32 s89, s94
  s_cbranch_scc1 gated_mix__mha_block__mixer_gmlp__prompt_kernel_v0_na
  s_call_b64 s[24:25], gated_mix__mha_block__mixer_gmlp__prompt_kernel_arrive
gated_mix__mha_block__mixer_gmlp__prompt_kernel_v0_na:
  s_cmp_lg_u32 s89, 0
  s_cbranch_scc1 gated_mix__mha_block__mixer_gmlp__prompt_kernel_v0_loop
  s_cmp_lg_u32 s44, 0
  s_cbranch_scc1 gated_mix__mha_block__mixer_gmlp__prompt_kernel_v0_ar0
  v_mov_b32 v236, 0
  global_load_dword v237, v236, s[100:101] sc1
gated_mix__mha_block__mixer_gmlp__prompt_kernel_v0_ar0:
  v_mfma_f32_16x16x32_bf16 v[0:3], a[32:35], a[0:3], v[0:3]
  v_add_u32 v221, s85, v224
  v_mfma_f32_16x16x32_bf16 v[4:7], a[32:35], a[4:7], v[4:7]
  ds_read_b128 a[16:19], v221 offset:0
  v_mfma_f32_16x16x32_bf16 v[8:11], a[32:35], a[8:11], v[8:11]
  ds_read_b128 a[20:23], v221 offset:512
  v_mfma_f32_16x16x32_bf16 v[12:15], a[32:35], a[12:15], v[12:15]
  ds_read_b128 a[24:27], v221 offset:4096
  v_mfma_f32_16x16x32_bf16 v[28:31], a[36:39], a[12:15], v[28:31]
  ds_read_b128 a[28:31], v221 offset:4608
  v_mfma_f32_16x16x32_bf16 v[24:27], a[36:39], a[8:11], v[24:27]
  ds_read_b64_tr_b16 a[84:85], v208 offset:16384
  v_mfma_f32_16x16x32_bf16 v[20:23], a[36:39], a[4:7], v[20:23]
  ds_read_b64_tr_b16 a[86:87], v208 offset:17408
  v_mfma_f32_16x16x32_bf16 v[16:19], a[36:39], a[0:3], v[16:19]
  ds_read_b64_tr_b16 a[88:89], v209 offset:16384
  v_mfma_f32_16x16x32_bf16 v[32:35], a[40:43], a[0:3], v[32:35]
  ds_read_b64_tr_b16 a[90:91], v209 offset:17408
  v_mfma_f32_16x16x32_bf16 v[36:39], a[40:43], a[4:7], v[36:39]
  ds_read_b64_tr_b16 a[92:93], v210 offset:16384
  v_mfma_f32_16x16x32_bf16 v[40:43], a[40:43], a[8:11], v[40:43]
  ds_read_b64_tr_b16 a[94:95], v210 offset:17408
  v_mfma_f32_16x16x32_bf16 v[44:47], a[40:43], a[12:15], v[44:47]
  ds_read_b64_tr_b16 a[96:97], v211 offset:16384
  v_mfma_f32_16x16x32_bf16 v[60:63], a[44:47], a[12:15], v[60:63]
  ds_read_b64_tr_b16 a[98:99], v211 offset:17408
  v_mfma_f32_16x16x32_bf16 v[56:59], a[44:47], a[8:11], v[56:59]
  ds_read_b64_tr_b16 a[100:101], v212 offset:16384
  v_mfma_f32_16x16x32_bf16 v[52:55], a[44:47], a[4:7], v[52:55]
  ds_read_b64_tr_b16 a[102:103], v212 offset:17408
  v_mfma_f32_16x16x32_bf16 v[48:51], a[44:47], a[0:3], v[48:51]
  ds_read_b64_tr_b16 a[104:105], v213 offset:16384
  v_mfma_f32_16x16x32_bf16 v[64:67], a[48:51], a[0:3], v[64:67]
  ds_read_b64_tr_b16 a[106:107], v213 offset:17408
  v_mfma_f32_16x16x32_bf16 v[68:71], a[48:51], a[4:7], v[68:71]
  ds_read_b64_tr_b16 a[108:109], v214 offset:16384
  v_mfma_f32_16x16x32_bf16 v[72:75], a[48:51], a[8:11], v[72:75]
  ds_read_b64_tr_b16 a[110:111], v214 offset:17408
  v_mfma_f32_16x16x32_bf16 v[76:79], a[48:51], a[12:15], v[76:79]
  ds_read_b64_tr_b16 a[112:113], v215 offset:18432
  v_mfma_f32_16x16x32_bf16 v[92:95], a[52:55], a[12:15], v[92:95]
  ds_read_b64_tr_b16 a[114:115], v215 offset:19456
  v_mfma_f32_16x16x32_bf16 v[88:91], a[52:55], a[8:11], v[88:91]
  ds_read_b64_tr_b16 a[116:117], v216 offset:18432
  v_mfma_f32_16x16x32_bf16 v[84:87], a[52:55], a[4:7], v[84:87]
  ds_read_b64_tr_b16 a[118:119], v216 offset:19456
  v_mfma_f32_16x16x32_bf16 v[80:83], a[52:55], a[0:3], v[80:83]
  ds_read_b64_tr_b16 a[120:121], v217 offset:18432
  v_mfma_f32_16x16x32_bf16 v[96:99], a[56:59], a[0:3], v[96:99]
  ds_read_b64_tr_b16 a[122:123], v217 offset:19456
  v_mfma_f32_16x16x32_bf16 v[100:103], a[56:59], a[4:7], v[100:103]
  ds_read_b64_tr_b16 a[124:125], v218 offset:18432
  v_mfma_f32_16x16x32_bf16 v[104:107], a[56:59], a[8:11], v[104:107]
  ds_read_b64_tr_b16 a[126:127], v218 offset:19456
  v_mfma_f32_16x16x32_bf16 v[108:111], a[56:59], a[12:15], v[108:111]
  ds_read_b64_tr_b16 a[128:129], v219 offset:18432
  v_mfma_f32_16x16x32_bf16 v[124:127], a[60:63], a[12:15], v[124:127]
  ds_read_b64_tr_b16 a[130:131], v219 offset:19456
  v_mfma_f32_16x16x32_bf16 v[120:123], a[60:63], a[8:11], v[120:123]
  ds_read_b64_tr_b16 a[132:133], v220 offset:18432
  v_mfma_f32_16x16x32_bf16 v[116:119], a[60:63], a[4:7], v[116:119]
  ds_read_b64_tr_b16 a[134:135], v220 offset:19456
  v_mfma_f32_16x16x32_bf16 v[112:115], a[60:63], a[0:3], v[112:115]
  v_lshlrev_b32 v242, 5, v234
  v_mfma_f32_16x16x32_bf16 v[128:131], a[64:67], a[0:3], v[128:131]
  s_lshl_b32 s31, s93, 11
  v_mfma_f32_16x16x32_bf16 v[132:135], a[64:67], a[4:7], v[132:135]
  buffer_load_dwordx4 a[140:143], v242, s[8:11], s31 offen offset:0
  v_mfma_f32_16x16x32_bf16 v[136:139], a[64:67], a[8:11], v[136:139]
  buffer_load_dwordx4 a[144:147], v242, s[8:11], s31 offen offset:16
  v_mfma_f32_16x16x32_bf16 v[140:143], a[64:67], a[12:15], v[140:143]
  buffer_load_dwordx4 a[148:151], v242, s[8:11], s31 offen offset:2048
  v_mfma_f32_16x16x32_bf16 v[156:159], a[68:71], a[12:15], v[156:159]
  buffer_load_dwordx4 a[152:155], v242, s[8:11], s31 offen offset:2064
  v_mfma_f32_16x16x32_bf16 v[152:155], a[68:71], a[8:11], v[152:155]
  buffer_load_dwordx4 a[156:159], v242, s[20:23], 0 offen offset:0
  v_mfma_f32_16x16x32_bf16 v[148:151], a[68:71], a[4:7], v[148:151]
  buffer_load_dwordx4 a[160:163], v242, s[20:23], 0 offen offset:16
  v_mfma_f32_16x16x32_bf16 v[144:147], a[68:71], a[0:3], v[144:147]
  v_mfma_f32_16x16x32_bf16 v[160:163], a[72:75], a[0:3], v[160:163]
  v_mfma_f32_16x16x32_bf16 v[164:167], a[72:75], a[4:7], v[164:167]
  v_mfma_f32_16x16x32_bf16 v[168:171], a[72:75], a[8:11], v[168:171]
  v_mfma_f32_16x16x32_bf16 v[172:175], a[72:75], a[12:15], v[172:175]
  v_mfma_f32_16x16x32_bf16 v[188:191], a[76:79], a[12:15], v[188:191]
  v_mfma_f32_16x16x32_bf16 v[184:187], a[76:79], a[8:11], v[184:187]
  v_mfma_f32_16x16x32_bf16 v[180:183], a[76:79], a[4:7], v[180:183]
  v_mfma_f32_16x16x32_bf16 v[176:179], a[76:79], a[0:3], v[176:179]
  v_mfma_f32_16x16x32_bf16 v[192:195], a[80:83], a[0:3], v[192:195]
  v_mfma_f32_16x16x32_bf16 v[196:199], a[80:83], a[4:7], v[196:199]
  v_mfma_f32_16x16x32_bf16 v[200:203], a[80:83], a[8:11], v[200:203]
  v_mfma_f32_16x16x32_bf16 v[204:207], a[80:83], a[12:15], v[204:207]
  s_waitcnt vmcnt(16) lgkmcnt(0)
  s_barrier
  v_mfma_f32_16x16x32_bf16 v[0:3], a[84:87], a[16:19], v[0:3]
  v_add_u32 v221, s86, v223
  v_mfma_f32_16x16x32_bf16 v[4:7], a[84:87], a[20:23], v[4:7]
  ds_read_b128 a[0:3], v221 offset:0
  v_mfma_f32_16x16x32_bf16 v[8:11], a[84:87], a[24:27], v[8:11]
  ds_read_b128 a[4:7], v221 offset:512
  v_mfma_f32_16x16x32_bf16 v[12:15], a[84:87], a[28:31], v[12:15]
  ds_read_b128 a[8:11], v221 offset:4096
  v_mfma_f32_16x16x32_bf16 v[28:31], a[88:91], a[28:31], v[28:31]
  ds_read_b128 a[12:15], v221 offset:4608
  v_mfma_f32_16x16x32_bf16 v[24:27], a[88:91], a[24:27], v[24:27]
  ds_read_b64_tr_b16 a[32:33], v208 offset:32768
  v_mfma_f32_16x16x32_bf16 v[20:23], a[88:91], a[20:23], v[20:23]
  ds_read_b64_tr_b16 a[34:35], v208 offset:33792
  v_mfma_f32_16x16x32_bf16 v[16:19], a[88:91], a[16:19], v[16:19]
  ds_read_b64_tr_b16 a[36:37], v209 offset:32768
  v_mfma_f32_16x16x32_bf16 v[32:35], a[92:95], a[16:19], v[32:35]
  ds_read_b64_tr_b16 a[38:39], v209 offset:33792
  v_mfma_f32_16x16x32_bf16 v[36:39], a[92:95], a[20:23], v[36:39]
  ds_read_b64_tr_b16 a[40:41], v210 offset:32768
  v_mfma_f32_16x16x32_bf16 v[40:43], a[92:95], a[24:27], v[40:43]
  ds_read_b64_tr_b16 a[42:43], v210 offset:33792
  v_mfma_f32_16x16x32_bf16 v[44:47], a[92:95], a[28:31], v[44:47]
  ds_read_b64_tr_b16 a[44:45], v211 offset:32768
  v_mfma_f32_16x16x32_bf16 v[60:63], a[96:99], a[28:31], v[60:63]
  ds_read_b64_tr_b16 a[46:47], v211 offset:33792
  v_mfma_f32_16x16x32_bf16 v[56:59], a[96:99], a[24:27], v[56:59]
  ds_read_b64_tr_b16 a[48:49], v212 offset:32768
  v_mfma_f32_16x16x32_bf16 v[52:55], a[96:99], a[20:23], v[52:55]
  ds_read_b64_tr_b16 a[50:51], v212 offset:33792
  v_mfma_f32_16x16x32_bf16 v[48:51], a[96:99], a[16:19], v[48:51]
  ds_read_b64_tr_b16 a[52:53], v213 offset:32768
  v_mfma_f32_16x16x32_bf16 v[64:67], a[100:103], a[16:19], v[64:67]
  ds_read_b64_tr_b16 a[54:55], v213 offset:33792
  v_mfma_f32_16x16x32_bf16 v[68:71], a[100:103], a[20:23], v[68:71]
  ds_read_b64_tr_b16 a[56:57], v214 offset:32768
  v_mfma_f32_16x16x32_bf16 v[72:75], a[100:103], a[24:27], v[72:75]
  ds_read_b64_tr_b16 a[58:59], v214 offset:33792
  v_mfma_f32_16x16x32_bf16 v[76:79], a[100:103], a[28:31], v[76:79]
  ds_read_b64_tr_b16 a[60:61], v215 offset:34816
  v_mfma_f32_16x16x32_bf16 v[92:95], a[104:107], a[28:31], v[92:95]
  ds_read_b64_tr_b16 a[62:63], v215 offset:35840
  v_mfma_f32_16x16x32_bf16 v[88:91], a[104:107], a[24:27], v[88:91]
  ds_read_b64_tr_b16 a[64:65], v216 offset:34816
  v_mfma_f32_16x16x32_bf16 v[84:87], a[104:107], a[20:23], v[84:87]
  ds_read_b64_tr_b16 a[66:67], v216 offset:35840
  v_mfma_f32_16x16x32_bf16 v[80:83], a[104:107], a[16:19], v[80:83]
  ds_read_b64_tr_b16 a[68:69], v217 offset:34816
  v_mfma_f32_16x16x32_bf16 v[96:99], a[108:111], a[16:19], v[96:99]
  ds_read_b64_tr_b16 a[70:71], v217 offset:35840
  v_mfma_f32_16x16x32_bf16 v[100:103], a[108:111], a[20:23], v[100:103]
  ds_read_b64_tr_b16 a[72:73], v218 offset:34816
  v_mfma_f32_16x16x32_bf16 v[104:107], a[108:111], a[24:27], v[104:107]
  ds_read_b64_tr_b16 a[74:75], v218 offset:35840
  v_mfma_f32_16x16x32_bf16 v[108:111], a[108:111], a[28:31], v[108:111]
  ds_read_b64_tr_b16 a[76:77], v219 offset:34816
  v_mfma_f32_16x16x32_bf16 v[124:127], a[112:115], a[28:31], v[124:127]
  ds_read_b64_tr_b16 a[78:79], v219 offset:35840
  v_mfma_f32_16x16x32_bf16 v[120:123], a[112:115], a[24:27], v[120:123]
  ds_read_b64_tr_b16 a[80:81], v220 offset:34816
  v_mfma_f32_16x16x32_bf16 v[116:119], a[112:115], a[20:23], v[116:119]
  ds_read_b64_tr_b16 a[82:83], v220 offset:35840
  v_mfma_f32_16x16x32_bf16 v[112:115], a[112:115], a[16:19], v[112:115]
  v_mfma_f32_16x16x32_bf16 v[128:131], a[116:119], a[16:19], v[128:131]
  v_mfma_f32_16x16x32_bf16 v[132:135], a[116:119], a[20:23], v[132:135]
  v_mfma_f32_16x16x32_bf16 v[136:139], a[116:119], a[24:27], v[136:139]
  v_mfma_f32_16x16x32_bf16 v[140:143], a[116:119], a[28:31], v[140:143]
  v_mfma_f32_16x16x32_bf16 v[156:159], a[120:123], a[28:31], v[156:159]
  v_mfma_f32_16x16x32_bf16 v[152:155], a[120:123], a[24:27], v[152:155]
  v_mfma_f32_16x16x32_bf16 v[148:151], a[120:123], a[20:23], v[148:151]
  v_mfma_f32_16x16x32_bf16 v[144:147], a[120:123], a[16:19], v[144:147]
  v_mfma_f32_16x16x32_bf16 v[160:163], a[124:127], a[16:19], v[160:163]
  v_mfma_f32_16x16x32_bf16 v[164:167], a[124:127], a[20:23], v[164:167]
  v_mfma_f32_16x16x32_bf16 v[168:171], a[124:127], a[24:27], v[168:171]
  v_mfma_f32_16x16x32_bf16 v[172:175], a[124:127], a[28:31], v[172:175]
  v_mfma_f32_16x16x32_bf16 v[188:191], a[128:131], a[28:31], v[188:191]
  v_mfma_f32_16x16x32_bf16 v[184:187], a[128:131], a[24:27], v[184:187]
  v_mfma_f32_16x16x32_bf16 v[180:183], a[128:131], a[20:23], v[180:183]
  v_mfma_f32_16x16x32_bf16 v[176:179], a[128:131], a[16:19], v[176:179]
  v_mfma_f32_16x16x32_bf16 v[192:195], a[132:135], a[16:19], v[192:195]
  v_mfma_f32_16x16x32_bf16 v[196:199], a[132:135], a[20:23], v[196:199]
  v_mfma_f32_16x16x32_bf16 v[200:203], a[132:135], a[24:27], v[200:203]
  v_mfma_f32_16x16x32_bf16 v[204:207], a[132:135], a[28:31], v[204:207]
  s_waitcnt vmcnt(0) lgkmcnt(0)
  v_readfirstlane_b32 s26, v237
  s_cmp_lg_u32 s44, 0
  s_cbranch_scc1 gated_mix__mha_block__mixer_gmlp__prompt_kernel_v0_arr
  s_nop 1
  s_cmp_ge_u32 s26, 80
  s_cbranch_scc1 gated_mix__mha_block__mixer_gmlp__prompt_kernel_v0_arr
  s_call_b64 s[24:25], gated_mix__mha_block__mixer_gmlp__prompt_kernel_arrchk
gated_mix__mha_block__mixer_gmlp__prompt_kernel_v0_arr:
  s_barrier
  v_mfma_f32_16x16x32_bf16 v[0:3], a[32:35], a[0:3], v[0:3]
  v_add_u32 v221, s86, v224
  v_mov_b32 v244, 0
  v_mov_b32 v245, 0
  v_accvgpr_read_b32 v247, a156
  v_mfma_f32_16x16x32_bf16 v[4:7], a[32:35], a[4:7], v[4:7]
  ds_read_b128 a[16:19], v221 offset:0
  v_lshlrev_b32 v246, 16, v247
  v_and_b32 v247, 0xffff0000, v247
  v_accvgpr_read_b32 v249, a140
  v_mfma_f32_16x16x32_bf16 v[8:11], a[32:35], a[8:11], v[8:11]
  ds_read_b128 a[20:23], v221 offset:512
  v_lshlrev_b32 v248, 16, v249
  v_and_b32 v249, 0xffff0000, v249
  v_mfma_f32_16x16x32_bf16 v[12:15], a[32:35], a[12:15], v[12:15]
  ds_read_b128 a[24:27], v221 offset:4096
  v_fmac_f32 v244, v246, v248
  v_fmac_f32 v244, v247, v249
  v_mfma_f32_16x16x32_bf16 v[28:31], a[36:39], a[12:15], v[28:31]
  ds_read_b128 a[28:31], v221 offset:4608
  v_accvgpr_read_b32 v249, a148
  v_lshlrev_b32 v248, 16, v249
  v_mfma_f32_16x16x32_bf16 v[24:27], a[36:39], a[8:11], v[24:27]
  ds_read_b64_tr_b16 a[84:85], v208 offset:49152
  v_and_b32 v249, 0xffff0000, v249
  v_fmac_f32 v245, v246, v248
  v_mfma_f32_16x16x32_bf16 v[20:23], a[36:39], a[4:7], v[20:23]
  ds_read_b64_tr_b16 a[86:87], v208 offset:50176
  v_fmac_f32 v245, v247, v249
  v_accvgpr_read_b32 v247, a157
  v_mfma_f32_16x16x32_bf16 v[16:19], a[36:39], a[0:3], v[16:19]
  ds_read_b64_tr_b16 a[88:89], v209 offset:49152
  v_lshlrev_b32 v246, 16, v247
  v_and_b32 v247, 0xffff0000, v247
  v_mfma_f32_16x16x32_bf16 v[32:35], a[40:43], a[0:3], v[32:35]
  ds_read_b64_tr_b16 a[90:91], v209 offset:50176
  v_accvgpr_read_b32 v249, a141
  v_lshlrev_b32 v248, 16, v249
  v_mfma_f32_16x16x32_bf16 v[36:39], a[40:43], a[4:7], v[36:39]
  ds_read_b64_tr_b16 a[92:93], v210 offset:49152
  v_and_b32 v249, 0xffff0000, v249
  v_fmac_f32 v244, v246, v248
  v_mfma_f32_16x16x32_bf16 v[40:43], a[40:43], a[8:11], v[40:43]
  ds_read_b64_tr_b16 a[94:95], v210 offset:50176
  v_fmac_f32 v244, v247, v249
  v_accvgpr_read_b32 v249, a149
  v_mfma_f32_16x16x32_bf16 v[44:47], a[40:43], a[12:15], v[44:47]
  ds_read_b64_tr_b16 a[96:97], v211 offset:49152
  v_lshlrev_b32 v248, 16, v249
  v_and_b32 v249, 0xffff0000, v249
  v_mfma_f32_16x16x32_bf16 v[60:63], a[44:47], a[12:15], v[60:63]
  ds_read_b64_tr_b16 a[98:99], v211 offset:50176
  v_fmac_f32 v245, v246, v248
  v_fmac_f32 v245, v247, v249
  v_mfma_f32_16x16x32_bf16 v[56:59], a[44:47], a[8:11], v[56:59]
  ds_read_b64_tr_b16 a[100:101], v212 offset:49152
  v_accvgpr_read_b32 v247, a158
  v_lshlrev_b32 v246, 16, v247
  v_mfma_f32_16x16x32_bf16 v[52:55], a[44:47], a[4:7], v[52:55]
  ds_read_b64_tr_b16 a[102:103], v212 offset:50176
  v_and_b32 v247, 0xffff0000, v247
  v_accvgpr_read_b32 v249, a142
  v_mfma_f32_16x16x32_bf16 v[48:51], a[44:47], a[0:3], v[48:51]
  ds_read_b64_tr_b16 a[104:105], v213 offset:49152
  v_lshlrev_b32 v248, 16, v249
  v_and_b32 v249, 0xffff0000, v249
  v_mfma_f32_16x16x32_bf16 v[64:67], a[48:51], a[0:3], v[64:67]
  ds_read_b64_tr_b16 a[106:107], v213 offset:50176
  v_fmac_f32 v244, v246, v248
  v_fmac_f32 v244, v247, v249
  v_mfma_f32_16x16x32_bf16 v[68:71], a[48:51], a[4:7], v[68:71]
  ds_read_b64_tr_b16 a[108:109], v214 offset:49152
  v_accvgpr_read_b32 v249, a150
  v_lshlrev_b32 v248, 16, v249
  v_mfma_f32_16x16x32_bf16 v[72:75], a[48:51], a[8:11], v[72:75]
  ds_read_b64_tr_b16 a[110:111], v214 offset:50176
  v_and_b32 v249, 0xffff0000, v249
  v_fmac_f32 v245, v246, v248
  v_mfma_f32_16x16x32_bf16 v[76:79], a[48:51], a[12:15], v[76:79]
  ds_read_b64_tr_b16 a[112:113], v215 offset:51200
  v_fmac_f32 v245, v247, v249
  v_accvgpr_read_b32 v247, a159
  v_mfma_f32_16x16x32_bf16 v[92:95], a[52:55], a[12:15], v[92:95]
  ds_read_b64_tr_b16 a[114:115], v215 offset:52224
  v_lshlrev_b32 v246, 16, v247
  v_and_b32 v247, 0xffff0000, v247
  v_mfma_f32_16x16x32_bf16 v[88:91], a[52:55], a[8:11], v[88:91]
  ds_read_b64_tr_b16 a[116:117], v216 offset:51200
  v_accvgpr_read_b32 v249, a143
  v_lshlrev_b32 v248, 16, v249
  v_mfma_f32_16x16x32_bf16 v[84:87], a[52:55], a[4:7], v[84:87]
  ds_read_b64_tr_b16 a[118:119], v216 offset:52224
  v_and_b32 v249, 0xffff0000, v249
  v_fmac_f32 v244, v246, v248
  v_mfma_f32_16x16x32_bf16 v[80:83], a[52:55], a[0:3], v[80:83]
  ds_read_b64_tr_b16 a[120:121], v217 offset:51200
  v_fmac_f32 v244, v247, v249
  v_accvgpr_read_b32 v249, a151
  v_mfma_f32_16x16x32_bf16 v[96:99], a[56:59], a[0:3], v[96:99]
  ds_read_b64_tr_b16 a[122:123], v217 offset:52224
  v_lshlrev_b32 v248, 16, v249
  v_and_b32 v249, 0xffff0000, v249
  v_mfma_f32_16x16x32_bf16 v[100:103], a[56:59], a[4:7], v[100:103]
  ds_read_b64_tr_b16 a[124:125], v218 offset:51200
  v_fmac_f32 v245, v246, v248
  v_fmac_f32 v245, v247, v249
  v_mfma_f32_16x16x32_bf16 v[104:107], a[56:59], a[8:11], v[104:107]
  ds_read_b64_tr_b16 a[126:127], v218 offset:52224
  v_accvgpr_read_b32 v247, a160
  v_lshlrev_b32 v246, 16, v247
  v_mfma_f32_16x16x32_bf16 v[108:111], a[56:59], a[12:15], v[108:111]
  ds_read_b64_tr_b16 a[128:129], v219 offset:51200
  v_and_b32 v247, 0xffff0000, v247
  v_accvgpr_read_b32 v249, a144
  v_mfma_f32_16x16x32_bf16 v[124:127], a[60:63], a[12:15], v[124:127]
  ds_read_b64_tr_b16 a[130:131], v219 offset:52224
  v_lshlrev_b32 v248, 16, v249
  v_and_b32 v249, 0xffff0000, v249
  v_mfma_f32_16x16x32_bf16 v[120:123], a[60:63], a[8:11], v[120:123]
  ds_read_b64_tr_b16 a[132:133], v220 offset:51200
  v_fmac_f32 v244, v246, v248
  v_fmac_f32 v244, v247, v249
  v_mfma_f32_16x16x32_bf16 v[116:119], a[60:63], a[4:7], v[116:119]
  ds_read_b64_tr_b16 a[134:135], v220 offset:52224
  v_accvgpr_read_b32 v249, a152
  v_lshlrev_b32 v248, 16, v249
  v_mfma_f32_16x16x32_bf16 v[112:115], a[60:63], a[0:3], v[112:115]
  v_and_b32 v249, 0xffff0000, v249
  v_fmac_f32 v245, v246, v248
  v_mfma_f32_16x16x32_bf16 v[128:131], a[64:67], a[0:3], v[128:131]
  v_fmac_f32 v245, v247, v249
  v_accvgpr_read_b32 v247, a161
  v_mfma_f32_16x16x32_bf16 v[132:135], a[64:67], a[4:7], v[132:135]
  v_lshlrev_b32 v246, 16, v247
  v_and_b32 v247, 0xffff0000, v247
  v_mfma_f32_16x16x32_bf16 v[136:139], a[64:67], a[8:11], v[136:139]
  v_accvgpr_read_b32 v249, a145
  v_lshlrev_b32 v248, 16, v249
  v_mfma_f32_16x16x32_bf16 v[140:143], a[64:67], a[12:15], v[140:143]
  v_and_b32 v249, 0xffff0000, v249
  v_fmac_f32 v244, v246, v248
  v_mfma_f32_16x16x32_bf16 v[156:159], a[68:71], a[12:15], v[156:159]
  v_fmac_f32 v244, v247, v249
  v_accvgpr_read_b32 v249, a153
  v_mfma_f32_16x16x32_bf16 v[152:155], a[68:71], a[8:11], v[152:155]
  v_lshlrev_b32 v248, 16, v249
  v_and_b32 v249, 0xffff0000, v249
  v_mfma_f32_16x16x32_bf16 v[148:151], a[68:71], a[4:7], v[148:151]
  v_fmac_f32 v245, v246, v248
  v_fmac_f32 v245, v247, v249
  v_mfma_f32_16x16x32_bf16 v[144:147], a[68:71], a[0:3], v[144:147]
  v_accvgpr_read_b32 v247, a162
  v_lshlrev_b32 v246, 16, v247
  v_mfma_f32_16x16x32_bf16 v[160:163], a[72:75], a[0:3], v[160:163]
  v_and_b32 v247, 0xffff0000, v247
  v_accvgpr_read_b32 v249, a146
  v_mfma_f32_16x16x32_bf16 v[164:167], a[72:75], a[4:7], v[164:167]
  v_lshlrev_b32 v248, 16, v249
  v_and_b32 v249, 0xffff0000, v249
  v_mfma_f32_16x16x32_bf16 v[168:171], a[72:75], a[8:11], v[168:171]
  v_fmac_f32 v244, v246, v248
  v_fmac_f32 v244, v247, v249
  v_mfma_f32_16x16x32_bf16 v[172:175], a[72:75], a[12:15], v[172:175]
  v_accvgpr_read_b32 v249, a154
  v_lshlrev_b32 v248, 16, v249
  v_mfma_f32_16x16x32_bf16 v[188:191], a[76:79], a[12:15], v[188:191]
  v_and_b32 v249, 0xffff0000, v249
  v_fmac_f32 v245, v246, v248
  v_mfma_f32_16x16x32_bf16 v[184:187], a[76:79], a[8:11], v[184:187]
  v_fmac_f32 v245, v247, v249
  v_accvgpr_read_b32 v247, a163
  v_mfma_f32_16x16x32_bf16 v[180:183], a[76:79], a[4:7], v[180:183]
  v_lshlrev_b32 v246, 16, v247
  v_and_b32 v247, 0xffff0000, v247
  v_mfma_f32_16x16x32_bf16 v[176:179], a[76:79], a[0:3], v[176:179]
  v_accvgpr_read_b32 v249, a147
  v_lshlrev_b32 v248, 16, v249
  v_mfma_f32_16x16x32_bf16 v[192:195], a[80:83], a[0:3], v[192:195]
  v_and_b32 v249, 0xffff0000, v249
  v_fmac_f32 v244, v246, v248
  v_mfma_f32_16x16x32_bf16 v[196:199], a[80:83], a[4:7], v[196:199]
  v_fmac_f32 v244, v247, v249
  v_accvgpr_read_b32 v249, a155
  v_mfma_f32_16x16x32_bf16 v[200:203], a[80:83], a[8:11], v[200:203]
  v_lshlrev_b32 v248, 16, v249
  v_and_b32 v249, 0xffff0000, v249
  v_mfma_f32_16x16x32_bf16 v[204:207], a[80:83], a[12:15], v[204:207]
  v_fmac_f32 v245, v246, v248
  v_fmac_f32 v245, v247, v249
  s_waitcnt lgkmcnt(0)
  v_mfma_f32_16x16x32_bf16 v[0:3], a[84:87], a[16:19], v[0:3]
  v_add_f32_dpp v244, v244, v244 row_ror:8 row_mask:0xf bank_mask:0xf
  v_add_f32_dpp v245, v245, v245 row_ror:8 row_mask:0xf bank_mask:0xf
  v_mfma_f32_16x16x32_bf16 v[4:7], a[84:87], a[20:23], v[4:7]
  s_nop 0
  v_mfma_f32_16x16x32_bf16 v[8:11], a[84:87], a[24:27], v[8:11]
  v_add_f32_dpp v244, v244, v244 row_ror:4 row_mask:0xf bank_mask:0xf
  v_add_f32_dpp v245, v245, v245 row_ror:4 row_mask:0xf bank_mask:0xf
  v_mfma_f32_16x16x32_bf16 v[12:15], a[84:87], a[28:31], v[12:15]
  s_nop 0
  v_mfma_f32_16x16x32_bf16 v[28:31], a[88:91], a[28:31], v[28:31]
  v_add_f32_dpp v244, v244, v244 row_ror:2 row_mask:0xf bank_mask:0xf
  v_add_f32_dpp v245, v245, v245 row_ror:2 row_mask:0xf bank_mask:0xf
  v_mfma_f32_16x16x32_bf16 v[24:27], a[88:91], a[24:27], v[24:27]
  s_nop 0
  v_mfma_f32_16x16x32_bf16 v[20:23], a[88:91], a[20:23], v[20:23]
  v_add_f32_dpp v244, v244, v244 row_ror:1 row_mask:0xf bank_mask:0xf
  v_add_f32_dpp v245, v245, v245 row_ror:1 row_mask:0xf bank_mask:0xf
  v_mfma_f32_16x16x32_bf16 v[16:19], a[88:91], a[16:19], v[16:19]
  s_nop 0
  v_mfma_f32_16x16x32_bf16 v[32:35], a[92:95], a[16:19], v[32:35]
  v_readlane_b32 s24, v244, 0
  v_readlane_b32 s25, v244, 16
  v_mfma_f32_16x16x32_bf16 v[36:39], a[92:95], a[20:23], v[36:39]
  v_readlane_b32 s26, v244, 32
  v_readlane_b32 s27, v244, 48
  v_mfma_f32_16x16x32_bf16 v[40:43], a[92:95], a[24:27], v[40:43]
  v_readlane_b32 s28, v245, 0
  v_readlane_b32 s29, v245, 16
  v_mfma_f32_16x16x32_bf16 v[44:47], a[92:95], a[28:31], v[44:47]
  v_readlane_b32 s30, v245, 32
  v_readlane_b32 s31, v245, 48
  v_mfma_f32_16x16x32_bf16 v[60:63], a[96:99], a[28:31], v[60:63]
  v_cmp_eq_u32 vcc, 1, v234
  v_mfma_f32_16x16x32_bf16 v[56:59], a[96:99], a[24:27], v[56:59]
  s_nop 1
  v_mfma_f32_16x16x32_bf16 v[52:55], a[96:99], a[20:23], v[52:55]
  v_mov_b32 v246, s24
  v_mov_b32 v247, s28
  v_mfma_f32_16x16x32_bf16 v[48:51], a[96:99], a[16:19], v[48:51]
  v_add_f32 v246, s25, v246
  v_add_f32 v247, s29, v247
  v_mfma_f32_16x16x32_bf16 v[64:67], a[100:103], a[16:19], v[64:67]
  v_add_f32 v246, s26, v246
  v_add_f32 v247, s30, v247
  v_mfma_f32_16x16x32_bf16 v[68:71], a[100:103], a[20:23], v[68:71]
  v_add_f32 v246, s27, v246
  v_add_f32 v247, s31, v247
  v_mfma_f32_16x16x32_bf16 v[72:75], a[100:103], a[24:27], v[72:75]
  v_cndmask_b32 v246, v246, v247, vcc
  v_mfma_f32_16x16x32_bf16 v[76:79], a[100:103], a[28:31], v[76:79]
  v_mul_f32 v246, 0xbfb8aa3b, v246
  v_mfma_f32_16x16x32_bf16 v[92:95], a[104:107], a[28:31], v[92:95]
  v_exp_f32 v246, v246
  v_mfma_f32_16x16x32_bf16 v[88:91], a[104:107], a[24:27], v[88:91]
  v_lshlrev_b32 v236, 2, v234
  v_mov_b32 v237, 0x80000000
  v_mfma_f32_16x16x32_bf16 v[84:87], a[104:107], a[20:23], v[84:87]
  v_add_f32 v246, 1.0, v246
  v_mfma_f32_16x16x32_bf16 v[80:83], a[104:107], a[16:19], v[80:83]
  v_rcp_f32 v235, v246
  v_mfma_f32_16x16x32_bf16 v[96:99], a[108:111], a[16:19], v[96:99]
  v_cmp_lt_u32 vcc, 1, v234
  v_mfma_f32_16x16x32_bf16 v[100:103], a[108:111], a[20:23], v[100:103]
  s_lshl_b32 s31, s93, 6
  s_add_u32 s31, s31, 42991616
  v_mfma_f32_16x16x32_bf16 v[104:107], a[108:111], a[24:27], v[104:107]
  v_cndmask_b32 v236, v236, v237, vcc
  v_mfma_f32_16x16x32_bf16 v[108:111], a[108:111], a[28:31], v[108:111]
  buffer_store_dword v235, v236, s[4:7], s31 offen sc1
  v_mfma_f32_16x16x32_bf16 v[124:127], a[112:115], a[28:31], v[124:127]
  s_lshl_b32 s32, s80, 3
  v_mfma_f32_16x16x32_bf16 v[120:123], a[112:115], a[24:27], v[120:123]
  s_lshl_b32 s33, s44, 1
  v_mfma_f32_16x16x32_bf16 v[116:119], a[112:115], a[20:23], v[116:119]
  s_add_u32 s32, s32, s33
  v_mfma_f32_16x16x32_bf16 v[112:115], a[112:115], a[16:19], v[112:115]
  v_mov_b32 v254, v234
  v_mfma_f32_16x16x32_bf16 v[128:131], a[116:119], a[16:19], v[128:131]
  v_mov_b32 v255, v233
  v_mfma_f32_16x16x32_bf16 v[132:135], a[116:119], a[20:23], v[132:135]
  v_lshlrev_b32 v253, 2, v234
  v_mfma_f32_16x16x32_bf16 v[136:139], a[116:119], a[24:27], v[136:139]
  v_mov_b32 v252, 1
  v_mfma_f32_16x16x32_bf16 v[140:143], a[116:119], a[28:31], v[140:143]
  v_min_u32 v251, 1, v234
  v_mfma_f32_16x16x32_bf16 v[156:159], a[120:123], a[28:31], v[156:159]
  v_lshlrev_b32 v251, 26, v251
  v_mfma_f32_16x16x32_bf16 v[152:155], a[120:123], a[24:27], v[152:155]
  s_lshl_b32 s51, s81, 3
  v_mfma_f32_16x16x32_bf16 v[148:151], a[120:123], a[20:23], v[148:151]
  s_add_u32 s51, s51, s80
  v_mfma_f32_16x16x32_bf16 v[144:147], a[120:123], a[16:19], v[144:147]
  s_lshl_b32 s51, s51, 2
  v_mfma_f32_16x16x32_bf16 v[160:163], a[124:127], a[16:19], v[160:163]
  s_add_u32 s51, s51, s44
  v_mfma_f32_16x16x32_bf16 v[164:167], a[124:127], a[20:23], v[164:167]
  s_lshl_b32 s51, s51, 2
  v_mfma_f32_16x16x32_bf16 v[168:171], a[124:127], a[24:27], v[168:171]
  s_add_u32 s51, s51, 44052480
  v_mfma_f32_16x16x32_bf16 v[172:175], a[124:127], a[28:31], v[172:175]
  s_mov_b32 s40, 0xbdd2d3e8
  v_mfma_f32_16x16x32_bf16 v[188:191], a[128:131], a[28:31], v[188:191]
  s_mov_b32 s41, 0xbdd2d3e8
  v_mfma_f32_16x16x32_bf16 v[184:187], a[128:131], a[24:27], v[184:187]
  s_mov_b32 s42, 1.0
  v_mfma_f32_16x16x32_bf16 v[180:183], a[128:131], a[20:23], v[180:183]
  s_mov_b32 s43, 1.0
  v_mfma_f32_16x16x32_bf16 v[176:179], a[128:131], a[16:19], v[176:179]
  v_mfma_f32_16x16x32_bf16 v[192:195], a[132:135], a[16:19], v[192:195]
  v_mfma_f32_16x16x32_bf16 v[196:199], a[132:135], a[20:23], v[196:199]
  v_mfma_f32_16x16x32_bf16 v[200:203], a[132:135], a[24:27], v[200:203]
  v_mfma_f32_16x16x32_bf16 v[204:207], a[132:135], a[28:31], v[204:207]
  s_nop 7
  s_mul_i32 s34, s81, 3
  s_add_u32 s34, s34, 0
  s_lshl_b32 s35, s34, 17
  s_lshl_b32 s36, s32, 11
  s_add_u32 s35, s35, s36
  s_cmp_lt_u32 s34, 32
  s_cselect_b32 s38, 0x3e8293ee, 1.0
  s_mov_b32 s39, s38
  v_pk_mul_f32 v[112:113], v[112:113], s[38:39]
  v_pk_mul_f32 v[114:115], v[114:115], s[38:39]
  v_pk_mul_f32 v[128:129], v[128:129], s[38:39]
  v_pk_mul_f32 v[130:131], v[130:131], s[38:39]
  v_cvt_pk_bf16_f32 v212, v112, v113
  v_cvt_pk_bf16_f32 v213, v114, v115
  v_cvt_pk_bf16_f32 v214, v128, v129
  v_cvt_pk_bf16_f32 v215, v130, v131
  buffer_store_dwordx4 v[212:215], v255, s[4:7], s35 offen offset:0 sc1
  v_pk_mul_f32 v[116:117], v[116:117], s[38:39]
  v_pk_mul_f32 v[118:119], v[118:119], s[38:39]
  v_pk_mul_f32 v[132:133], v[132:133], s[38:39]
  v_pk_mul_f32 v[134:135], v[134:135], s[38:39]
  v_cvt_pk_bf16_f32 v216, v116, v117
  v_cvt_pk_bf16_f32 v217, v118, v119
  v_cvt_pk_bf16_f32 v218, v132, v133
  v_cvt_pk_bf16_f32 v219, v134, v135
  buffer_store_dwordx4 v[216:219], v255, s[4:7], s35 offen offset:1024 sc1
  v_pk_mul_f32 v[120:121], v[120:121], s[38:39]
  v_pk_mul_f32 v[122:123], v[122:123], s[38:39]
  v_pk_mul_f32 v[136:137], v[136:137], s[38:39]
  v_pk_mul_f32 v[138:139], v[138:139], s[38:39]
  v_cvt_pk_bf16_f32 v220, v120, v121
  v_cvt_pk_bf16_f32 v221, v122, v123
  v_cvt_pk_bf16_f32 v222, v136, v137
  v_cvt_pk_bf16_f32 v223, v138, v139
  buffer_store_dwordx4 v[220:223], v255, s[4:7], s35 offen offset:2048 sc1
  v_pk_mul_f32 v[124:125], v[124:125], s[38:39]
  v_pk_mul_f32 v[126:127], v[126:127], s[38:39]
  v_pk_mul_f32 v[140:141], v[140:141], s[38:39]
  v_pk_mul_f32 v[142:143], v[142:143], s[38:39]
  v_cvt_pk_bf16_f32 v208, v124, v125
  v_cvt_pk_bf16_f32 v209, v126, v127
  v_cvt_pk_bf16_f32 v210, v140, v141
  v_cvt_pk_bf16_f32 v211, v142, v143
  buffer_store_dwordx4 v[208:211], v255, s[4:7], s35 offen offset:3072 sc1
  s_mul_i32 s34, s81, 3
  s_add_u32 s34, s34, 1
  s_lshl_b32 s35, s34, 17
  s_lshl_b32 s36, s32, 11
  s_add_u32 s35, s35, s36
  s_cmp_lt_u32 s34, 32
  s_cselect_b32 s38, 0x3e8293ee, 1.0
  s_mov_b32 s39, s38
  v_pk_mul_f32 v[144:145], v[144:145], s[38:39]
  v_pk_mul_f32 v[146:147], v[146:147], s[38:39]
  v_pk_mul_f32 v[160:161], v[160:161], s[38:39]
  v_pk_mul_f32 v[162:163], v[162:163], s[38:39]
  v_cvt_pk_bf16_f32 v212, v144, v145
  v_cvt_pk_bf16_f32 v213, v146, v147
  v_cvt_pk_bf16_f32 v214, v160, v161
  v_cvt_pk_bf16_f32 v215, v162, v163
  buffer_store_dwordx4 v[212:215], v255, s[4:7], s35 offen offset:0 sc1
  v_pk_mul_f32 v[148:149], v[148:149], s[38:39]
  v_pk_mul_f32 v[150:151], v[150:151], s[38:39]
  v_pk_mul_f32 v[164:165], v[164:165], s[38:39]
  v_pk_mul_f32 v[166:167], v[166:167], s[38:39]
  v_cvt_pk_bf16_f32 v216, v148, v149
  v_cvt_pk_bf16_f32 v217, v150, v151
  v_cvt_pk_bf16_f32 v218, v164, v165
  v_cvt_pk_bf16_f32 v219, v166, v167
  buffer_store_dwordx4 v[216:219], v255, s[4:7], s35 offen offset:1024 sc1
  v_pk_mul_f32 v[152:153], v[152:153], s[38:39]
  v_pk_mul_f32 v[154:155], v[154:155], s[38:39]
  v_pk_mul_f32 v[168:169], v[168:169], s[38:39]
  v_pk_mul_f32 v[170:171], v[170:171], s[38:39]
  v_cvt_pk_bf16_f32 v220, v152, v153
  v_cvt_pk_bf16_f32 v221, v154, v155
  v_cvt_pk_bf16_f32 v222, v168, v169
  v_cvt_pk_bf16_f32 v223, v170, v171
  buffer_store_dwordx4 v[220:223], v255, s[4:7], s35 offen offset:2048 sc1
  v_pk_mul_f32 v[156:157], v[156:157], s[38:39]
  v_pk_mul_f32 v[158:159], v[158:159], s[38:39]
  v_pk_mul_f32 v[172:173], v[172:173], s[38:39]
  v_pk_mul_f32 v[174:175], v[174:175], s[38:39]
  v_cvt_pk_bf16_f32 v208, v156, v157
  v_cvt_pk_bf16_f32 v209, v158, v159
  v_cvt_pk_bf16_f32 v210, v172, v173
  v_cvt_pk_bf16_f32 v211, v174, v175
  buffer_store_dwordx4 v[208:211], v255, s[4:7], s35 offen offset:3072 sc1
  s_mul_i32 s34, s81, 3
  s_add_u32 s34, s34, 2
  s_lshl_b32 s35, s34, 17
  s_lshl_b32 s36, s32, 11
  s_add_u32 s35, s35, s36
  s_cmp_lt_u32 s34, 32
  s_cselect_b32 s38, 0x3e8293ee, 1.0
  s_mov_b32 s39, s38
  v_pk_mul_f32 v[176:177], v[176:177], s[38:39]
  v_pk_mul_f32 v[178:179], v[178:179], s[38:39]
  v_pk_mul_f32 v[192:193], v[192:193], s[38:39]
  v_pk_mul_f32 v[194:195], v[194:195], s[38:39]
  v_cvt_pk_bf16_f32 v212, v176, v177
  v_cvt_pk_bf16_f32 v213, v178, v179
  v_cvt_pk_bf16_f32 v214, v192, v193
  v_cvt_pk_bf16_f32 v215, v194, v195
  buffer_store_dwordx4 v[212:215], v255, s[4:7], s35 offen offset:0 sc1
  v_pk_mul_f32 v[180:181], v[180:181], s[38:39]
  v_pk_mul_f32 v[182:183], v[182:183], s[38:39]
  v_pk_mul_f32 v[196:197], v[196:197], s[38:39]
  v_pk_mul_f32 v[198:199], v[198:199], s[38:39]
  v_cvt_pk_bf16_f32 v216, v180, v181
  v_cvt_pk_bf16_f32 v217, v182, v183
  v_cvt_pk_bf16_f32 v218, v196, v197
  v_cvt_pk_bf16_f32 v219, v198, v199
  buffer_store_dwordx4 v[216:219], v255, s[4:7], s35 offen offset:1024 sc1
  v_pk_mul_f32 v[184:185], v[184:185], s[38:39]
  v_pk_mul_f32 v[186:187], v[186:187], s[38:39]
  v_pk_mul_f32 v[200:201], v[200:201], s[38:39]
  v_pk_mul_f32 v[202:203], v[202:203], s[38:39]
  v_cvt_pk_bf16_f32 v220, v184, v185
  v_cvt_pk_bf16_f32 v221, v186, v187
  v_cvt_pk_bf16_f32 v222, v200, v201
  v_cvt_pk_bf16_f32 v223, v202, v203
  buffer_store_dwordx4 v[220:223], v255, s[4:7], s35 offen offset:2048 sc1
  v_pk_mul_f32 v[188:189], v[188:189], s[38:39]
  v_pk_mul_f32 v[190:191], v[190:191], s[38:39]
  v_pk_mul_f32 v[204:205], v[204:205], s[38:39]
  v_pk_mul_f32 v[206:207], v[206:207], s[38:39]
  v_cvt_pk_bf16_f32 v208, v188, v189
  v_cvt_pk_bf16_f32 v209, v190, v191
  v_cvt_pk_bf16_f32 v210, v204, v205
  v_cvt_pk_bf16_f32 v211, v206, v207
  buffer_store_dwordx4 v[208:211], v255, s[4:7], s35 offen offset:3072 sc1
  v_mov_b32 v160, 0xc0135761
  v_mov_b32 v161, 0xc0135761
  s_mul_i32 s35, s32, 114688
  s_mul_i32 s36, s81, 7168
  s_add_u32 s35, s35, s36
  s_add_u32 s35, s35, 12582912
  s_lshl_b32 s36, s44, 13
  s_add_u32 s36, s36, 32768
  v_add_u32 v162, s36, v255
  v_pk_mul_f32 v[112:113], v[0:1], v[0:1]
  v_pk_mul_f32 v[114:115], v[2:3], v[2:3]
  v_pk_mul_f32 v[116:117], v[4:5], v[4:5]
  v_pk_mul_f32 v[118:119], v[6:7], v[6:7]
  v_pk_mul_f32 v[120:121], v[8:9], v[8:9]
  v_pk_mul_f32 v[122:123], v[10:11], v[10:11]
  v_pk_mul_f32 v[124:125], v[12:13], v[12:13]
  v_pk_mul_f32 v[126:127], v[14:15], v[14:15]
  v_pk_fma_f32 v[112:113], v[112:113], s[40:41], v[160:161]
  v_pk_fma_f32 v[114:115], v[114:115], s[40:41], v[160:161]
  v_pk_fma_f32 v[116:117], v[116:117], s[40:41], v[160:161]
  v_pk_fma_f32 v[118:119], v[118:119], s[40:41], v[160:161]
  v_pk_fma_f32 v[120:121], v[120:121], s[40:41], v[160:161]
  v_pk_fma_f32 v[122:123], v[122:123], s[40:41], v[160:161]
  v_pk_fma_f32 v[124:125], v[124:125], s[40:41], v[160:161]
  v_pk_fma_f32 v[126:127], v[126:127], s[40:41], v[160:161]
  v_pk_mul_f32 v[112:113], v[112:113], v[0:1]
  v_pk_mul_f32 v[114:115], v[114:115], v[2:3]
  v_pk_mul_f32 v[116:117], v[116:117], v[4:5]
  v_pk_mul_f32 v[118:119], v[118:119], v[6:7]
  v_pk_mul_f32 v[120:121], v[120:121], v[8:9]
  v_pk_mul_f32 v[122:123], v[122:123], v[10:11]
  v_pk_mul_f32 v[124:125], v[124:125], v[12:13]
  v_pk_mul_f32 v[126:127], v[126:127], v[14:15]
  v_exp_f32 v112, v112
  v_exp_f32 v113, v113
  v_exp_f32 v114, v114
  v_exp_f32 v115, v115
  v_exp_f32 v116, v116
  v_exp_f32 v117, v117
  v_exp_f32 v118, v118
  v_exp_f32 v119, v119
  v_exp_f32 v120, v120
  v_exp_f32 v121, v121
  v_exp_f32 v122, v122
  v_exp_f32 v123, v123
  v_exp_f32 v124, v124
  v_exp_f32 v125, v125
  v_exp_f32 v126, v126
  v_exp_f32 v127, v127
  v_pk_add_f32 v[112:113], v[112:113], s[42:43]
  v_pk_add_f32 v[114:115], v[114:115], s[42:43]
  v_pk_add_f32 v[116:117], v[116:117], s[42:43]
  v_pk_add_f32 v[118:119], v[118:119], s[42:43]
  v_pk_add_f32 v[120:121], v[120:121], s[42:43]
  v_pk_add_f32 v[122:123], v[122:123], s[42:43]
  v_pk_add_f32 v[124:125], v[124:125], s[42:43]
  v_pk_add_f32 v[126:127], v[126:127], s[42:43]
  v_rcp_f32 v112, v112
  v_rcp_f32 v113, v113
  v_rcp_f32 v114, v114
  v_rcp_f32 v115, v115
  v_rcp_f32 v116, v116
  v_rcp_f32 v117, v117
  v_rcp_f32 v118, v118
  v_rcp_f32 v119, v119
  v_rcp_f32 v120, v120
  v_rcp_f32 v121, v121
  v_rcp_f32 v122, v122
  v_rcp_f32 v123, v123
  v_rcp_f32 v124, v124
  v_rcp_f32 v125, v125
  v_rcp_f32 v126, v126
  v_rcp_f32 v127, v127
  v_pk_mul_f32 v[0:1], v[0:1], v[112:113]
  v_pk_mul_f32 v[2:3], v[2:3], v[114:115]
  v_pk_mul_f32 v[4:5], v[4:5], v[116:117]
  v_pk_mul_f32 v[6:7], v[6:7], v[118:119]
  v_pk_mul_f32 v[8:9], v[8:9], v[120:121]
  v_pk_mul_f32 v[10:11], v[10:11], v[122:123]
  v_pk_mul_f32 v[12:13], v[12:13], v[124:125]
  v_pk_mul_f32 v[14:15], v[14:15], v[126:127]
  v_cvt_pk_bf16_f32 v212, v0, v1
  v_cvt_pk_bf16_f32 v213, v2, v3
  v_cvt_pk_bf16_f32 v214, v4, v5
  v_cvt_pk_bf16_f32 v215, v6, v7
  ds_write_b128 v162, v[212:215] offset:0
  v_cvt_pk_bf16_f32 v216, v8, v9
  v_cvt_pk_bf16_f32 v217, v10, v11
  v_cvt_pk_bf16_f32 v218, v12, v13
  v_cvt_pk_bf16_f32 v219, v14, v15
  ds_write_b128 v162, v[216:219] offset:32768
  v_pk_mul_f32 v[112:113], v[16:17], v[16:17]
  v_pk_mul_f32 v[114:115], v[18:19], v[18:19]
  v_pk_mul_f32 v[116:117], v[20:21], v[20:21]
  v_pk_mul_f32 v[118:119], v[22:23], v[22:23]
  v_pk_mul_f32 v[120:121], v[24:25], v[24:25]
  v_pk_mul_f32 v[122:123], v[26:27], v[26:27]
  v_pk_mul_f32 v[124:125], v[28:29], v[28:29]
  v_pk_mul_f32 v[126:127], v[30:31], v[30:31]
  v_pk_fma_f32 v[112:113], v[112:113], s[40:41], v[160:161]
  v_pk_fma_f32 v[114:115], v[114:115], s[40:41], v[160:161]
  v_pk_fma_f32 v[116:117], v[116:117], s[40:41], v[160:161]
  v_pk_fma_f32 v[118:119], v[118:119], s[40:41], v[160:161]
  v_pk_fma_f32 v[120:121], v[120:121], s[40:41], v[160:161]
  v_pk_fma_f32 v[122:123], v[122:123], s[40:41], v[160:161]
  v_pk_fma_f32 v[124:125], v[124:125], s[40:41], v[160:161]
  v_pk_fma_f32 v[126:127], v[126:127], s[40:41], v[160:161]
  v_pk_mul_f32 v[112:113], v[112:113], v[16:17]
  v_pk_mul_f32 v[114:115], v[114:115], v[18:19]
  v_pk_mul_f32 v[116:117], v[116:117], v[20:21]
  v_pk_mul_f32 v[118:119], v[118:119], v[22:23]
  v_pk_mul_f32 v[120:121], v[120:121], v[24:25]
  v_pk_mul_f32 v[122:123], v[122:123], v[26:27]
  v_pk_mul_f32 v[124:125], v[124:125], v[28:29]
  v_pk_mul_f32 v[126:127], v[126:127], v[30:31]
  v_exp_f32 v112, v112
  v_exp_f32 v113, v113
  v_exp_f32 v114, v114
  v_exp_f32 v115, v115
  v_exp_f32 v116, v116
  v_exp_f32 v117, v117
  v_exp_f32 v118, v118
  v_exp_f32 v119, v119
  v_exp_f32 v120, v120
  v_exp_f32 v121, v121
  v_exp_f32 v122, v122
  v_exp_f32 v123, v123
  v_exp_f32 v124, v124
  v_exp_f32 v125, v125
  v_exp_f32 v126, v126
  v_exp_f32 v127, v127
  v_pk_add_f32 v[112:113], v[112:113], s[42:43]
  v_pk_add_f32 v[114:115], v[114:115], s[42:43]
  v_pk_add_f32 v[116:117], v[116:117], s[42:43]
  v_pk_add_f32 v[118:119], v[118:119], s[42:43]
  v_pk_add_f32 v[120:121], v[120:121], s[42:43]
  v_pk_add_f32 v[122:123], v[122:123], s[42:43]
  v_pk_add_f32 v[124:125], v[124:125], s[42:43]
  v_pk_add_f32 v[126:127], v[126:127], s[42:43]
  v_rcp_f32 v112, v112
  v_rcp_f32 v113, v113
  v_rcp_f32 v114, v114
  v_rcp_f32 v115, v115
  v_rcp_f32 v116, v116
  v_rcp_f32 v117, v117
  v_rcp_f32 v118, v118
  v_rcp_f32 v119, v119
  v_rcp_f32 v120, v120
  v_rcp_f32 v121, v121
  v_rcp_f32 v122, v122
  v_rcp_f32 v123, v123
  v_rcp_f32 v124, v124
  v_rcp_f32 v125, v125
  v_rcp_f32 v126, v126
  v_rcp_f32 v127, v127
  v_pk_mul_f32 v[16:17], v[16:17], v[112:113]
  v_pk_mul_f32 v[18:19], v[18:19], v[114:115]
  v_pk_mul_f32 v[20:21], v[20:21], v[116:117]
  v_pk_mul_f32 v[22:23], v[22:23], v[118:119]
  v_pk_mul_f32 v[24:25], v[24:25], v[120:121]
  v_pk_mul_f32 v[26:27], v[26:27], v[122:123]
  v_pk_mul_f32 v[28:29], v[28:29], v[124:125]
  v_pk_mul_f32 v[30:31], v[30:31], v[126:127]
  v_cvt_pk_bf16_f32 v220, v16, v17
  v_cvt_pk_bf16_f32 v221, v18, v19
  v_cvt_pk_bf16_f32 v222, v20, v21
  v_cvt_pk_bf16_f32 v223, v22, v23
  ds_write_b128 v162, v[220:223] offset:1024
  v_cvt_pk_bf16_f32 v208, v24, v25
  v_cvt_pk_bf16_f32 v209, v26, v27
  v_cvt_pk_bf16_f32 v210, v28, v29
  v_cvt_pk_bf16_f32 v211, v30, v31
  ds_write_b128 v162, v[208:211] offset:33792
  v_pk_mul_f32 v[112:113], v[32:33], v[32:33]
  v_pk_mul_f32 v[114:115], v[34:35], v[34:35]
  v_pk_mul_f32 v[116:117], v[36:37], v[36:37]
  v_pk_mul_f32 v[118:119], v[38:39], v[38:39]
  v_pk_mul_f32 v[120:121], v[40:41], v[40:41]
  v_pk_mul_f32 v[122:123], v[42:43], v[42:43]
  v_pk_mul_f32 v[124:125], v[44:45], v[44:45]
  v_pk_mul_f32 v[126:127], v[46:47], v[46:47]
  v_pk_fma_f32 v[112:113], v[112:113], s[40:41], v[160:161]
  v_pk_fma_f32 v[114:115], v[114:115], s[40:41], v[160:161]
  v_pk_fma_f32 v[116:117], v[116:117], s[40:41], v[160:161]
  v_pk_fma_f32 v[118:119], v[118:119], s[40:41], v[160:161]
  v_pk_fma_f32 v[120:121], v[120:121], s[40:41], v[160:161]
  v_pk_fma_f32 v[122:123], v[122:123], s[40:41], v[160:161]
  v_pk_fma_f32 v[124:125], v[124:125], s[40:41], v[160:161]
  v_pk_fma_f32 v[126:127], v[126:127], s[40:41], v[160:161]
  v_pk_mul_f32 v[112:113], v[112:113], v[32:33]
  v_pk_mul_f32 v[114:115], v[114:115], v[34:35]
  v_pk_mul_f32 v[116:117], v[116:117], v[36:37]
  v_pk_mul_f32 v[118:119], v[118:119], v[38:39]
  v_pk_mul_f32 v[120:121], v[120:121], v[40:41]
  v_pk_mul_f32 v[122:123], v[122:123], v[42:43]
  v_pk_mul_f32 v[124:125], v[124:125], v[44:45]
  v_pk_mul_f32 v[126:127], v[126:127], v[46:47]
  v_exp_f32 v112, v112
  v_exp_f32 v113, v113
  v_exp_f32 v114, v114
  v_exp_f32 v115, v115
  v_exp_f32 v116, v116
  v_exp_f32 v117, v117
  v_exp_f32 v118, v118
  v_exp_f32 v119, v119
  v_exp_f32 v120, v120
  v_exp_f32 v121, v121
  v_exp_f32 v122, v122
  v_exp_f32 v123, v123
  v_exp_f32 v124, v124
  v_exp_f32 v125, v125
  v_exp_f32 v126, v126
  v_exp_f32 v127, v127
  v_pk_add_f32 v[112:113], v[112:113], s[42:43]
  v_pk_add_f32 v[114:115], v[114:115], s[42:43]
  v_pk_add_f32 v[116:117], v[116:117], s[42:43]
  v_pk_add_f32 v[118:119], v[118:119], s[42:43]
  v_pk_add_f32 v[120:121], v[120:121], s[42:43]
  v_pk_add_f32 v[122:123], v[122:123], s[42:43]
  v_pk_add_f32 v[124:125], v[124:125], s[42:43]
  v_pk_add_f32 v[126:127], v[126:127], s[42:43]
  v_rcp_f32 v112, v112
  v_rcp_f32 v113, v113
  v_rcp_f32 v114, v114
  v_rcp_f32 v115, v115
  v_rcp_f32 v116, v116
  v_rcp_f32 v117, v117
  v_rcp_f32 v118, v118
  v_rcp_f32 v119, v119
  v_rcp_f32 v120, v120
  v_rcp_f32 v121, v121
  v_rcp_f32 v122, v122
  v_rcp_f32 v123, v123
  v_rcp_f32 v124, v124
  v_rcp_f32 v125, v125
  v_rcp_f32 v126, v126
  v_rcp_f32 v127, v127
  v_pk_mul_f32 v[32:33], v[32:33], v[112:113]
  v_pk_mul_f32 v[34:35], v[34:35], v[114:115]
  v_pk_mul_f32 v[36:37], v[36:37], v[116:117]
  v_pk_mul_f32 v[38:39], v[38:39], v[118:119]
  v_pk_mul_f32 v[40:41], v[40:41], v[120:121]
  v_pk_mul_f32 v[42:43], v[42:43], v[122:123]
  v_pk_mul_f32 v[44:45], v[44:45], v[124:125]
  v_pk_mul_f32 v[46:47], v[46:47], v[126:127]
  v_cvt_pk_bf16_f32 v212, v32, v33
  v_cvt_pk_bf16_f32 v213, v34, v35
  v_cvt_pk_bf16_f32 v214, v36, v37
  v_cvt_pk_bf16_f32 v215, v38, v39
  ds_write_b128 v162, v[212:215] offset:2048
  v_cvt_pk_bf16_f32 v216, v40, v41
  v_cvt_pk_bf16_f32 v217, v42, v43
  v_cvt_pk_bf16_f32 v218, v44, v45
  v_cvt_pk_bf16_f32 v219, v46, v47
  ds_write_b128 v162, v[216:219] offset:34816
  s_waitcnt vmcnt(0)
  buffer_store_dword v252, v251, s[4:7], s51 offen sc1
  s_lshl_b32 s51, s80, 5
  s_add_u32 s51, s51, s81
  s_lshl_b32 s51, s51, 2
  s_add_u32 s51, s51, s44
  s_lshl_b32 s51, s51, 2
  s_add_u32 s51, s51, 44056576
  s_lshl_b32 s24, s45, 17
  s_add_u32 s8, s4, s24
  s_addc_u32 s9, s5, 0
  s_add_u32 s8, s8, 4194304
  s_addc_u32 s9, s9, 0
  s_mov_b32 s10, 131072
  s_mov_b32 s11, 0x00020000
  s_add_u32 s12, s4, s24
  s_addc_u32 s13, s5, 0
  s_add_u32 s12, s12, 8387584
  s_addc_u32 s13, s13, 0
  s_mov_b32 s14, 132096
  s_mov_b32 s15, 0x00020000
  s_add_u32 s25, s45, 0
  s_mul_i32 s25, s25, 171
  s_lshr_b32 s25, s25, 9
  s_lshl_b32 s25, s25, 7
  s_add_u32 s26, s45, 32
  s_mul_i32 s26, s26, 171
  s_lshr_b32 s26, s26, 9
  s_lshl_b32 s26, s26, 7
  s_add_u32 s27, s45, 64
  s_mul_i32 s27, s27, 171
  s_lshr_b32 s27, s27, 9
  s_lshl_b32 s27, s27, 7
  v_and_b32 v167, 31, v254
  v_lshlrev_b32 v167, 2, v167
  v_and_b32 v168, 3, v254
  v_mov_b32 v169, s26
  v_mov_b32 v170, s27
  v_cmp_lt_u32 vcc, 31, v254
  s_lshl_b32 s28, s46, 4
  s_add_u32 s28, s28, s25
  v_cndmask_b32 v169, v169, v170, vcc
  v_add_u32 v167, v167, v169
  v_lshl_add_u32 v168, v168, 2, s28
  s_mov_b32 s52, 44052480
  s_cmp_eq_u32 s44, 0
  s_cselect_b32 s52, s52, 0x70000000
  v_pk_mul_f32 v[112:113], v[48:49], v[48:49]
  v_pk_mul_f32 v[114:115], v[50:51], v[50:51]
  v_pk_mul_f32 v[116:117], v[52:53], v[52:53]
  v_pk_mul_f32 v[118:119], v[54:55], v[54:55]
  v_pk_mul_f32 v[120:121], v[56:57], v[56:57]
  v_pk_mul_f32 v[122:123], v[58:59], v[58:59]
  v_pk_mul_f32 v[124:125], v[60:61], v[60:61]
  v_pk_mul_f32 v[126:127], v[62:63], v[62:63]
  v_pk_fma_f32 v[112:113], v[112:113], s[40:41], v[160:161]
  v_pk_fma_f32 v[114:115], v[114:115], s[40:41], v[160:161]
  v_pk_fma_f32 v[116:117], v[116:117], s[40:41], v[160:161]
  v_pk_fma_f32 v[118:119], v[118:119], s[40:41], v[160:161]
  v_pk_fma_f32 v[120:121], v[120:121], s[40:41], v[160:161]
  v_pk_fma_f32 v[122:123], v[122:123], s[40:41], v[160:161]
  v_pk_fma_f32 v[124:125], v[124:125], s[40:41], v[160:161]
  v_pk_fma_f32 v[126:127], v[126:127], s[40:41], v[160:161]
  v_pk_mul_f32 v[112:113], v[112:113], v[48:49]
  v_pk_mul_f32 v[114:115], v[114:115], v[50:51]
  v_pk_mul_f32 v[116:117], v[116:117], v[52:53]
  v_pk_mul_f32 v[118:119], v[118:119], v[54:55]
  v_pk_mul_f32 v[120:121], v[120:121], v[56:57]
  v_pk_mul_f32 v[122:123], v[122:123], v[58:59]
  v_pk_mul_f32 v[124:125], v[124:125], v[60:61]
  v_pk_mul_f32 v[126:127], v[126:127], v[62:63]
  v_exp_f32 v112, v112
  v_exp_f32 v113, v113
  v_exp_f32 v114, v114
  v_exp_f32 v115, v115
  v_exp_f32 v116, v116
  v_exp_f32 v117, v117
  v_exp_f32 v118, v118
  v_exp_f32 v119, v119
  v_exp_f32 v120, v120
  v_exp_f32 v121, v121
  v_exp_f32 v122, v122
  v_exp_f32 v123, v123
  v_exp_f32 v124, v124
  v_exp_f32 v125, v125
  v_exp_f32 v126, v126
  v_exp_f32 v127, v127
  v_pk_add_f32 v[112:113], v[112:113], s[42:43]
  v_pk_add_f32 v[114:115], v[114:115], s[42:43]
  v_pk_add_f32 v[116:117], v[116:117], s[42:43]
  v_pk_add_f32 v[118:119], v[118:119], s[42:43]
  v_pk_add_f32 v[120:121], v[120:121], s[42:43]
  v_pk_add_f32 v[122:123], v[122:123], s[42:43]
  v_pk_add_f32 v[124:125], v[124:125], s[42:43]
  v_pk_add_f32 v[126:127], v[126:127], s[42:43]
  v_rcp_f32 v112, v112
  v_rcp_f32 v113, v113
  v_rcp_f32 v114, v114
  v_rcp_f32 v115, v115
  v_rcp_f32 v116, v116
  v_rcp_f32 v117, v117
  v_rcp_f32 v118, v118
  v_rcp_f32 v119, v119
  v_rcp_f32 v120, v120
  v_rcp_f32 v121, v121
  v_rcp_f32 v122, v122
  v_rcp_f32 v123, v123
  v_rcp_f32 v124, v124
  v_rcp_f32 v125, v125
  v_rcp_f32 v126, v126
  v_rcp_f32 v127, v127
  v_pk_mul_f32 v[48:49], v[48:49], v[112:113]
  v_pk_mul_f32 v[50:51], v[50:51], v[114:115]
  v_pk_mul_f32 v[52:53], v[52:53], v[116:117]
  v_pk_mul_f32 v[54:55], v[54:55], v[118:119]
  v_pk_mul_f32 v[56:57], v[56:57], v[120:121]
  v_pk_mul_f32 v[58:59], v[58:59], v[122:123]
  v_pk_mul_f32 v[60:61], v[60:61], v[124:125]
  v_pk_mul_f32 v[62:63], v[62:63], v[126:127]
  v_cvt_pk_bf16_f32 v220, v48, v49
  v_cvt_pk_bf16_f32 v221, v50, v51
  v_cvt_pk_bf16_f32 v222, v52, v53
  v_cvt_pk_bf16_f32 v223, v54, v55
  ds_write_b128 v162, v[220:223] offset:3072
  v_cvt_pk_bf16_f32 v208, v56, v57
  v_cvt_pk_bf16_f32 v209, v58, v59
  v_cvt_pk_bf16_f32 v210, v60, v61
  v_cvt_pk_bf16_f32 v211, v62, v63
  ds_write_b128 v162, v[208:211] offset:35840
  v_pk_mul_f32 v[112:113], v[64:65], v[64:65]
  v_pk_mul_f32 v[114:115], v[66:67], v[66:67]
  v_pk_mul_f32 v[116:117], v[68:69], v[68:69]
  v_pk_mul_f32 v[118:119], v[70:71], v[70:71]
  v_pk_mul_f32 v[120:121], v[72:73], v[72:73]
  v_pk_mul_f32 v[122:123], v[74:75], v[74:75]
  v_pk_mul_f32 v[124:125], v[76:77], v[76:77]
  v_pk_mul_f32 v[126:127], v[78:79], v[78:79]
  v_pk_fma_f32 v[112:113], v[112:113], s[40:41], v[160:161]
  v_pk_fma_f32 v[114:115], v[114:115], s[40:41], v[160:161]
  v_pk_fma_f32 v[116:117], v[116:117], s[40:41], v[160:161]
  v_pk_fma_f32 v[118:119], v[118:119], s[40:41], v[160:161]
  v_pk_fma_f32 v[120:121], v[120:121], s[40:41], v[160:161]
  v_pk_fma_f32 v[122:123], v[122:123], s[40:41], v[160:161]
  v_pk_fma_f32 v[124:125], v[124:125], s[40:41], v[160:161]
  v_pk_fma_f32 v[126:127], v[126:127], s[40:41], v[160:161]
  v_pk_mul_f32 v[112:113], v[112:113], v[64:65]
  v_pk_mul_f32 v[114:115], v[114:115], v[66:67]
  v_pk_mul_f32 v[116:117], v[116:117], v[68:69]
  v_pk_mul_f32 v[118:119], v[118:119], v[70:71]
  v_pk_mul_f32 v[120:121], v[120:121], v[72:73]
  v_pk_mul_f32 v[122:123], v[122:123], v[74:75]
  v_pk_mul_f32 v[124:125], v[124:125], v[76:77]
  v_pk_mul_f32 v[126:127], v[126:127], v[78:79]
  v_exp_f32 v112, v112
  v_exp_f32 v113, v113
  v_exp_f32 v114, v114
  v_exp_f32 v115, v115
  v_exp_f32 v116, v116
  v_exp_f32 v117, v117
  v_exp_f32 v118, v118
  v_exp_f32 v119, v119
  v_exp_f32 v120, v120
  v_exp_f32 v121, v121
  v_exp_f32 v122, v122
  v_exp_f32 v123, v123
  v_exp_f32 v124, v124
  v_exp_f32 v125, v125
  v_exp_f32 v126, v126
  v_exp_f32 v127, v127
  v_pk_add_f32 v[112:113], v[112:113], s[42:43]
  v_pk_add_f32 v[114:115], v[114:115], s[42:43]
  v_pk_add_f32 v[116:117], v[116:117], s[42:43]
  v_pk_add_f32 v[118:119], v[118:119], s[42:43]
  v_pk_add_f32 v[120:121], v[120:121], s[42:43]
  v_pk_add_f32 v[122:123], v[122:123], s[42:43]
  v_pk_add_f32 v[124:125], v[124:125], s[42:43]
  v_pk_add_f32 v[126:127], v[126:127], s[42:43]
  v_rcp_f32 v112, v112
  v_rcp_f32 v113, v113
  v_rcp_f32 v114, v114
  v_rcp_f32 v115, v115
  v_rcp_f32 v116, v116
  v_rcp_f32 v117, v117
  v_rcp_f32 v118, v118
  v_rcp_f32 v119, v119
  v_rcp_f32 v120, v120
  v_rcp_f32 v121, v121
  v_rcp_f32 v122, v122
  v_rcp_f32 v123, v123
  v_rcp_f32 v124, v124
  v_rcp_f32 v125, v125
  v_rcp_f32 v126, v126
  v_rcp_f32 v127, v127
  v_pk_mul_f32 v[64:65], v[64:65], v[112:113]
  v_pk_mul_f32 v[66:67], v[66:67], v[114:115]
  v_pk_mul_f32 v[68:69], v[68:69], v[116:117]
  v_pk_mul_f32 v[70:71], v[70:71], v[118:119]
  v_pk_mul_f32 v[72:73], v[72:73], v[120:121]
  v_pk_mul_f32 v[74:75], v[74:75], v[122:123]
  v_pk_mul_f32 v[76:77], v[76:77], v[124:125]
  v_pk_mul_f32 v[78:79], v[78:79], v[126:127]
  v_cvt_pk_bf16_f32 v212, v64, v65
  v_cvt_pk_bf16_f32 v213, v66, v67
  v_cvt_pk_bf16_f32 v214, v68, v69
  v_cvt_pk_bf16_f32 v215, v70, v71
  ds_write_b128 v162, v[212:215] offset:4096
  v_cvt_pk_bf16_f32 v216, v72, v73
  v_cvt_pk_bf16_f32 v217, v74, v75
  v_cvt_pk_bf16_f32 v218, v76, v77
  v_cvt_pk_bf16_f32 v219, v78, v79
  ds_write_b128 v162, v[216:219] offset:36864
  buffer_load_dword v164, v167, s[4:7], s52 offen sc1
  buffer_load_dword v165, v168, s[4:7], s52 offen sc1
  v_pk_mul_f32 v[112:113], v[80:81], v[80:81]
  v_pk_mul_f32 v[114:115], v[82:83], v[82:83]
  v_pk_mul_f32 v[116:117], v[84:85], v[84:85]
  v_pk_mul_f32 v[118:119], v[86:87], v[86:87]
  v_pk_mul_f32 v[120:121], v[88:89], v[88:89]
  v_pk_mul_f32 v[122:123], v[90:91], v[90:91]
  v_pk_mul_f32 v[124:125], v[92:93], v[92:93]
  v_pk_mul_f32 v[126:127], v[94:95], v[94:95]
  v_pk_fma_f32 v[112:113], v[112:113], s[40:41], v[160:161]
  v_pk_fma_f32 v[114:115], v[114:115], s[40:41], v[160:161]
  v_pk_fma_f32 v[116:117], v[116:117], s[40:41], v[160:161]
  v_pk_fma_f32 v[118:119], v[118:119], s[40:41], v[160:161]
  v_pk_fma_f32 v[120:121], v[120:121], s[40:41], v[160:161]
  v_pk_fma_f32 v[122:123], v[122:123], s[40:41], v[160:161]
  v_pk_fma_f32 v[124:125], v[124:125], s[40:41], v[160:161]
  v_pk_fma_f32 v[126:127], v[126:127], s[40:41], v[160:161]
  v_pk_mul_f32 v[112:113], v[112:113], v[80:81]
  v_pk_mul_f32 v[114:115], v[114:115], v[82:83]
  v_pk_mul_f32 v[116:117], v[116:117], v[84:85]
  v_pk_mul_f32 v[118:119], v[118:119], v[86:87]
  v_pk_mul_f32 v[120:121], v[120:121], v[88:89]
  v_pk_mul_f32 v[122:123], v[122:123], v[90:91]
  v_pk_mul_f32 v[124:125], v[124:125], v[92:93]
  v_pk_mul_f32 v[126:127], v[126:127], v[94:95]
  v_exp_f32 v112, v112
  v_exp_f32 v113, v113
  v_exp_f32 v114, v114
  v_exp_f32 v115, v115
  v_exp_f32 v116, v116
  v_exp_f32 v117, v117
  v_exp_f32 v118, v118
  v_exp_f32 v119, v119
  v_exp_f32 v120, v120
  v_exp_f32 v121, v121
  v_exp_f32 v122, v122
  v_exp_f32 v123, v123
  v_exp_f32 v124, v124
  v_exp_f32 v125, v125
  v_exp_f32 v126, v126
  v_exp_f32 v127, v127
  v_pk_add_f32 v[112:113], v[112:113], s[42:43]
  v_pk_add_f32 v[114:115], v[114:115], s[42:43]
  v_pk_add_f32 v[116:117], v[116:117], s[42:43]
  v_pk_add_f32 v[118:119], v[118:119], s[42:43]
  v_pk_add_f32 v[120:121], v[120:121], s[42:43]
  v_pk_add_f32 v[122:123], v[122:123], s[42:43]
  v_pk_add_f32 v[124:125], v[124:125], s[42:43]
  v_pk_add_f32 v[126:127], v[126:127], s[42:43]
  v_rcp_f32 v112, v112
  v_rcp_f32 v113, v113
  v_rcp_f32 v114, v114
  v_rcp_f32 v115, v115
  v_rcp_f32 v116, v116
  v_rcp_f32 v117, v117
  v_rcp_f32 v118, v118
  v_rcp_f32 v119, v119
  v_rcp_f32 v120, v120
  v_rcp_f32 v121, v121
  v_rcp_f32 v122, v122
  v_rcp_f32 v123, v123
  v_rcp_f32 v124, v124
  v_rcp_f32 v125, v125
  v_rcp_f32 v126, v126
  v_rcp_f32 v127, v127
  v_pk_mul_f32 v[80:81], v[80:81], v[112:113]
  v_pk_mul_f32 v[82:83], v[82:83], v[114:115]
  v_pk_mul_f32 v[84:85], v[84:85], v[116:117]
  v_pk_mul_f32 v[86:87], v[86:87], v[118:119]
  v_pk_mul_f32 v[88:89], v[88:89], v[120:121]
  v_pk_mul_f32 v[90:91], v[90:91], v[122:123]
  v_pk_mul_f32 v[92:93], v[92:93], v[124:125]
  v_pk_mul_f32 v[94:95], v[94:95], v[126:127]
  v_cvt_pk_bf16_f32 v220, v80, v81
  v_cvt_pk_bf16_f32 v221, v82, v83
  v_cvt_pk_bf16_f32 v222, v84, v85
  v_cvt_pk_bf16_f32 v223, v86, v87
  ds_write_b128 v162, v[220:223] offset:5120
  v_cvt_pk_bf16_f32 v208, v88, v89
  v_cvt_pk_bf16_f32 v209, v90, v91
  v_cvt_pk_bf16_f32 v210, v92, v93
  v_cvt_pk_bf16_f32 v211, v94, v95
  ds_write_b128 v162, v[208:211] offset:37888
  v_pk_mul_f32 v[112:113], v[96:97], v[96:97]
  v_pk_mul_f32 v[114:115], v[98:99], v[98:99]
  v_pk_mul_f32 v[116:117], v[100:101], v[100:101]
  v_pk_mul_f32 v[118:119], v[102:103], v[102:103]
  v_pk_mul_f32 v[120:121], v[104:105], v[104:105]
  v_pk_mul_f32 v[122:123], v[106:107], v[106:107]
  v_pk_mul_f32 v[124:125], v[108:109], v[108:109]
  v_pk_mul_f32 v[126:127], v[110:111], v[110:111]
  v_pk_fma_f32 v[112:113], v[112:113], s[40:41], v[160:161]
  v_pk_fma_f32 v[114:115], v[114:115], s[40:41], v[160:161]
  v_pk_fma_f32 v[116:117], v[116:117], s[40:41], v[160:161]
  v_pk_fma_f32 v[118:119], v[118:119], s[40:41], v[160:161]
  v_pk_fma_f32 v[120:121], v[120:121], s[40:41], v[160:161]
  v_pk_fma_f32 v[122:123], v[122:123], s[40:41], v[160:161]
  v_pk_fma_f32 v[124:125], v[124:125], s[40:41], v[160:161]
  v_pk_fma_f32 v[126:127], v[126:127], s[40:41], v[160:161]
  v_pk_mul_f32 v[112:113], v[112:113], v[96:97]
  v_pk_mul_f32 v[114:115], v[114:115], v[98:99]
  v_pk_mul_f32 v[116:117], v[116:117], v[100:101]
  v_pk_mul_f32 v[118:119], v[118:119], v[102:103]
  v_pk_mul_f32 v[120:121], v[120:121], v[104:105]
  v_pk_mul_f32 v[122:123], v[122:123], v[106:107]
  v_pk_mul_f32 v[124:125], v[124:125], v[108:109]
  v_pk_mul_f32 v[126:127], v[126:127], v[110:111]
  v_exp_f32 v112, v112
  v_exp_f32 v113, v113
  v_exp_f32 v114, v114
  v_exp_f32 v115, v115
  v_exp_f32 v116, v116
  v_exp_f32 v117, v117
  v_exp_f32 v118, v118
  v_exp_f32 v119, v119
  v_exp_f32 v120, v120
  v_exp_f32 v121, v121
  v_exp_f32 v122, v122
  v_exp_f32 v123, v123
  v_exp_f32 v124, v124
  v_exp_f32 v125, v125
  v_exp_f32 v126, v126
  v_exp_f32 v127, v127
  v_pk_add_f32 v[112:113], v[112:113], s[42:43]
  v_pk_add_f32 v[114:115], v[114:115], s[42:43]
  v_pk_add_f32 v[116:117], v[116:117], s[42:43]
  v_pk_add_f32 v[118:119], v[118:119], s[42:43]
  v_pk_add_f32 v[120:121], v[120:121], s[42:43]
  v_pk_add_f32 v[122:123], v[122:123], s[42:43]
  v_pk_add_f32 v[124:125], v[124:125], s[42:43]
  v_pk_add_f32 v[126:127], v[126:127], s[42:43]
  v_rcp_f32 v112, v112
  v_rcp_f32 v113, v113
  v_rcp_f32 v114, v114
  v_rcp_f32 v115, v115
  v_rcp_f32 v116, v116
  v_rcp_f32 v117, v117
  v_rcp_f32 v118, v118
  v_rcp_f32 v119, v119
  v_rcp_f32 v120, v120
  v_rcp_f32 v121, v121
  v_rcp_f32 v122, v122
  v_rcp_f32 v123, v123
  v_rcp_f32 v124, v124
  v_rcp_f32 v125, v125
  v_rcp_f32 v126, v126
  v_rcp_f32 v127, v127
  v_pk_mul_f32 v[96:97], v[96:97], v[112:113]
  v_pk_mul_f32 v[98:99], v[98:99], v[114:115]
  v_pk_mul_f32 v[100:101], v[100:101], v[116:117]
  v_pk_mul_f32 v[102:103], v[102:103], v[118:119]
  v_pk_mul_f32 v[104:105], v[104:105], v[120:121]
  v_pk_mul_f32 v[106:107], v[106:107], v[122:123]
  v_pk_mul_f32 v[108:109], v[108:109], v[124:125]
  v_pk_mul_f32 v[110:111], v[110:111], v[126:127]
  v_cvt_pk_bf16_f32 v212, v96, v97
  v_cvt_pk_bf16_f32 v213, v98, v99
  v_cvt_pk_bf16_f32 v214, v100, v101
  v_cvt_pk_bf16_f32 v215, v102, v103
  ds_write_b128 v162, v[212:215] offset:6144
  v_cvt_pk_bf16_f32 v216, v104, v105
  v_cvt_pk_bf16_f32 v217, v106, v107
  v_cvt_pk_bf16_f32 v218, v108, v109
  v_cvt_pk_bf16_f32 v219, v110, v111
  ds_write_b128 v162, v[216:219] offset:38912
  s_lshl_b32 s87, s32, 8
  s_lshl_b32 s37, s81, 14
  s_add_u32 s87, s87, s37
  s_add_u32 s87, s87, 1879048192
  s_mov_b32 s82, s35
  s_waitcnt vmcnt(0) lgkmcnt(0)
  s_branch gated_mix__mha_block__mixer_gmlp__prompt_kernel_p2
.p2align 6
gated_mix__mha_block__mixer_gmlp__prompt_kernel_v1:
  s_mov_b32 s89, 7
gated_mix__mha_block__mixer_gmlp__prompt_kernel_v1_loop:
  v_mfma_f32_16x16x32_bf16 v[0:3], a[0:3], a[32:35], v[0:3]
  v_add_u32 v221, s85, v224
  v_mfma_f32_16x16x32_bf16 v[4:7], a[4:7], a[32:35], v[4:7]
  ds_read_b128 a[16:19], v221 offset:0
  v_mfma_f32_16x16x32_bf16 v[8:11], a[8:11], a[32:35], v[8:11]
  ds_read_b128 a[20:23], v221 offset:512
  v_mfma_f32_16x16x32_bf16 v[12:15], a[12:15], a[32:35], v[12:15]
  ds_read_b128 a[24:27], v221 offset:4096
  v_mfma_f32_16x16x32_bf16 v[28:31], a[12:15], a[36:39], v[28:31]
  s_add_u32 m0, s88, 0
  v_mfma_f32_16x16x32_bf16 v[24:27], a[8:11], a[36:39], v[24:27]
  ds_read_b128 a[28:31], v221 offset:4608
  v_mfma_f32_16x16x32_bf16 v[20:23], a[4:7], a[36:39], v[20:23]
  ds_read_b64_tr_b16 a[84:85], v208 offset:16384
  v_mfma_f32_16x16x32_bf16 v[16:19], a[0:3], a[36:39], v[16:19]
  ds_read_b64_tr_b16 a[86:87], v208 offset:17408
  v_mfma_f32_16x16x32_bf16 v[32:35], a[0:3], a[40:43], v[32:35]
  buffer_load_dwordx4 v229, s[12:15], s83 offen lds
  v_mfma_f32_16x16x32_bf16 v[36:39], a[4:7], a[40:43], v[36:39]
  ds_read_b64_tr_b16 a[88:89], v209 offset:16384
  v_mfma_f32_16x16x32_bf16 v[40:43], a[8:11], a[40:43], v[40:43]
  ds_read_b64_tr_b16 a[90:91], v209 offset:17408
  v_mfma_f32_16x16x32_bf16 v[44:47], a[12:15], a[40:43], v[44:47]
  ds_read_b64_tr_b16 a[92:93], v210 offset:16384
  v_mfma_f32_16x16x32_bf16 v[60:63], a[12:15], a[44:47], v[60:63]
  buffer_load_dwordx4 v230, s[12:15], s83 offen offset:1024 lds
  v_mfma_f32_16x16x32_bf16 v[56:59], a[8:11], a[44:47], v[56:59]
  ds_read_b64_tr_b16 a[94:95], v210 offset:17408
  v_mfma_f32_16x16x32_bf16 v[52:55], a[4:7], a[44:47], v[52:55]
  ds_read_b64_tr_b16 a[96:97], v211 offset:16384
  v_mfma_f32_16x16x32_bf16 v[48:51], a[0:3], a[44:47], v[48:51]
  ds_read_b64_tr_b16 a[98:99], v211 offset:17408
  v_mfma_f32_16x16x32_bf16 v[64:67], a[0:3], a[48:51], v[64:67]
  s_add_u32 m0, s88, 2048
  v_mfma_f32_16x16x32_bf16 v[68:71], a[4:7], a[48:51], v[68:71]
  ds_read_b64_tr_b16 a[100:101], v212 offset:16384
  v_mfma_f32_16x16x32_bf16 v[72:75], a[8:11], a[48:51], v[72:75]
  ds_read_b64_tr_b16 a[102:103], v212 offset:17408
  v_mfma_f32_16x16x32_bf16 v[76:79], a[12:15], a[48:51], v[76:79]
  ds_read_b64_tr_b16 a[104:105], v213 offset:16384
  v_mfma_f32_16x16x32_bf16 v[92:95], a[12:15], a[52:55], v[92:95]
  buffer_load_dwordx4 v231, s[16:19], s84 offen lds
  v_mfma_f32_16x16x32_bf16 v[88:91], a[8:11], a[52:55], v[88:91]
  ds_read_b64_tr_b16 a[106:107], v213 offset:17408
  v_mfma_f32_16x16x32_bf16 v[84:87], a[4:7], a[52:55], v[84:87]
  ds_read_b64_tr_b16 a[108:109], v214 offset:16384
  v_mfma_f32_16x16x32_bf16 v[80:83], a[0:3], a[52:55], v[80:83]
  ds_read_b64_tr_b16 a[110:111], v214 offset:17408
  v_mfma_f32_16x16x32_bf16 v[96:99], a[0:3], a[56:59], v[96:99]
  buffer_load_dwordx4 v232, s[16:19], s84 offen offset:1024 lds
  v_mfma_f32_16x16x32_bf16 v[100:103], a[4:7], a[56:59], v[100:103]
  ds_read_b64_tr_b16 a[112:113], v215 offset:18432
  v_mfma_f32_16x16x32_bf16 v[104:107], a[8:11], a[56:59], v[104:107]
  ds_read_b64_tr_b16 a[114:115], v215 offset:19456
  v_mfma_f32_16x16x32_bf16 v[108:111], a[12:15], a[56:59], v[108:111]
  ds_read_b64_tr_b16 a[116:117], v216 offset:18432
  v_mfma_f32_16x16x32_bf16 v[124:127], a[60:63], a[12:15], v[124:127]
  s_add_u32 m0, s87, 4096
  v_mfma_f32_16x16x32_bf16 v[120:123], a[60:63], a[8:11], v[120:123]
  ds_read_b64_tr_b16 a[118:119], v216 offset:19456
  v_mfma_f32_16x16x32_bf16 v[116:119], a[60:63], a[4:7], v[116:119]
  ds_read_b64_tr_b16 a[120:121], v217 offset:18432
  v_mfma_f32_16x16x32_bf16 v[112:115], a[60:63], a[0:3], v[112:115]
  ds_read_b64_tr_b16 a[122:123], v217 offset:19456
  v_mfma_f32_16x16x32_bf16 v[128:131], a[64:67], a[0:3], v[128:131]
  buffer_load_dwordx4 v225, s[8:11], s82 offen offset:0 lds
  v_mfma_f32_16x16x32_bf16 v[132:135], a[64:67], a[4:7], v[132:135]
  ds_read_b64_tr_b16 a[124:125], v218 offset:18432
  v_mfma_f32_16x16x32_bf16 v[136:139], a[64:67], a[8:11], v[136:139]
  ds_read_b64_tr_b16 a[126:127], v218 offset:19456
  v_mfma_f32_16x16x32_bf16 v[140:143], a[64:67], a[12:15], v[140:143]
  ds_read_b64_tr_b16 a[128:129], v219 offset:18432
  v_mfma_f32_16x16x32_bf16 v[156:159], a[68:71], a[12:15], v[156:159]
  buffer_load_dwordx4 v226, s[8:11], s82 offen offset:1024 lds
  v_mfma_f32_16x16x32_bf16 v[152:155], a[68:71], a[8:11], v[152:155]
  ds_read_b64_tr_b16 a[130:131], v219 offset:19456
  v_mfma_f32_16x16x32_bf16 v[148:151], a[68:71], a[4:7], v[148:151]
  ds_read_b64_tr_b16 a[132:133], v220 offset:18432
  v_mfma_f32_16x16x32_bf16 v[144:147], a[68:71], a[0:3], v[144:147]
  ds_read_b64_tr_b16 a[134:135], v220 offset:19456
  v_mfma_f32_16x16x32_bf16 v[160:163], a[72:75], a[0:3], v[160:163]
  buffer_load_dwordx4 v227, s[8:11], s82 offen offset:2048 lds
  v_mfma_f32_16x16x32_bf16 v[164:167], a[72:75], a[4:7], v[164:167]
  buffer_load_dwordx4 v228, s[8:11], s82 offen offset:3072 lds
  v_mfma_f32_16x16x32_bf16 v[168:171], a[72:75], a[8:11], v[168:171]
  buffer_load_dwordx4 a[232:235], v252, s[64:67], s90 offen
  v_mfma_f32_16x16x32_bf16 v[172:175], a[72:75], a[12:15], v[172:175]
  s_add_u32 s83, s83, 229376
  v_mfma_f32_16x16x32_bf16 v[188:191], a[76:79], a[12:15], v[188:191]
  s_add_u32 s84, s84, 196608
  v_mfma_f32_16x16x32_bf16 v[184:187], a[76:79], a[8:11], v[184:187]
  s_sub_u32 s82, s82, 65408
  v_mfma_f32_16x16x32_bf16 v[180:183], a[76:79], a[4:7], v[180:183]
  s_sub_u32 s89, s89, 1
  v_mfma_f32_16x16x32_bf16 v[176:179], a[76:79], a[0:3], v[176:179]
  v_mfma_f32_16x16x32_bf16 v[192:195], a[80:83], a[0:3], v[192:195]
  v_mfma_f32_16x16x32_bf16 v[196:199], a[80:83], a[4:7], v[196:199]
  v_mfma_f32_16x16x32_bf16 v[200:203], a[80:83], a[8:11], v[200:203]
  v_mfma_f32_16x16x32_bf16 v[204:207], a[80:83], a[12:15], v[204:207]
  s_waitcnt vmcnt(19) lgkmcnt(0)
  s_barrier
  v_mfma_f32_16x16x32_bf16 v[0:3], a[16:19], a[84:87], v[0:3]
  v_add_u32 v221, s86, v223
  v_mfma_f32_16x16x32_bf16 v[4:7], a[20:23], a[84:87], v[4:7]
  ds_read_b128 a[0:3], v221 offset:0
  v_mfma_f32_16x16x32_bf16 v[8:11], a[24:27], a[84:87], v[8:11]
  ds_read_b128 a[4:7], v221 offset:512
  v_mfma_f32_16x16x32_bf16 v[12:15], a[28:31], a[84:87], v[12:15]
  ds_read_b128 a[8:11], v221 offset:4096
  v_mfma_f32_16x16x32_bf16 v[28:31], a[28:31], a[88:91], v[28:31]
  s_add_u32 m0, s88, 16384
  v_mfma_f32_16x16x32_bf16 v[24:27], a[24:27], a[88:91], v[24:27]
  ds_read_b128 a[12:15], v221 offset:4608
  v_mfma_f32_16x16x32_bf16 v[20:23], a[20:23], a[88:91], v[20:23]
  ds_read_b64_tr_b16 a[32:33], v208 offset:32768
  v_mfma_f32_16x16x32_bf16 v[16:19], a[16:19], a[88:91], v[16:19]
  ds_read_b64_tr_b16 a[34:35], v208 offset:33792
  v_mfma_f32_16x16x32_bf16 v[32:35], a[16:19], a[92:95], v[32:35]
  buffer_load_dwordx4 v229, s[12:15], s83 offen lds
  v_mfma_f32_16x16x32_bf16 v[36:39], a[20:23], a[92:95], v[36:39]
  ds_read_b64_tr_b16 a[36:37], v209 offset:32768
  v_mfma_f32_16x16x32_bf16 v[40:43], a[24:27], a[92:95], v[40:43]
  ds_read_b64_tr_b16 a[38:39], v209 offset:33792
  v_mfma_f32_16x16x32_bf16 v[44:47], a[28:31], a[92:95], v[44:47]
  ds_read_b64_tr_b16 a[40:41], v210 offset:32768
  v_mfma_f32_16x16x32_bf16 v[60:63], a[28:31], a[96:99], v[60:63]
  buffer_load_dwordx4 v230, s[12:15], s83 offen offset:1024 lds
  v_mfma_f32_16x16x32_bf16 v[56:59], a[24:27], a[96:99], v[56:59]
  ds_read_b64_tr_b16 a[42:43], v210 offset:33792
  v_mfma_f32_16x16x32_bf16 v[52:55], a[20:23], a[96:99], v[52:55]
  ds_read_b64_tr_b16 a[44:45], v211 offset:32768
  v_mfma_f32_16x16x32_bf16 v[48:51], a[16:19], a[96:99], v[48:51]
  ds_read_b64_tr_b16 a[46:47], v211 offset:33792
  v_mfma_f32_16x16x32_bf16 v[64:67], a[16:19], a[100:103], v[64:67]
  s_add_u32 m0, s88, 18432
  v_mfma_f32_16x16x32_bf16 v[68:71], a[20:23], a[100:103], v[68:71]
  ds_read_b64_tr_b16 a[48:49], v212 offset:32768
  v_mfma_f32_16x16x32_bf16 v[72:75], a[24:27], a[100:103], v[72:75]
  ds_read_b64_tr_b16 a[50:51], v212 offset:33792
  v_mfma_f32_16x16x32_bf16 v[76:79], a[28:31], a[100:103], v[76:79]
  ds_read_b64_tr_b16 a[52:53], v213 offset:32768
  v_mfma_f32_16x16x32_bf16 v[92:95], a[28:31], a[104:107], v[92:95]
  buffer_load_dwordx4 v231, s[16:19], s84 offen lds
  v_mfma_f32_16x16x32_bf16 v[88:91], a[24:27], a[104:107], v[88:91]
  ds_read_b64_tr_b16 a[54:55], v213 offset:33792
  v_mfma_f32_16x16x32_bf16 v[84:87], a[20:23], a[104:107], v[84:87]
  ds_read_b64_tr_b16 a[56:57], v214 offset:32768
  v_mfma_f32_16x16x32_bf16 v[80:83], a[16:19], a[104:107], v[80:83]
  ds_read_b64_tr_b16 a[58:59], v214 offset:33792
  v_mfma_f32_16x16x32_bf16 v[96:99], a[16:19], a[108:111], v[96:99]
  buffer_load_dwordx4 v232, s[16:19], s84 offen offset:1024 lds
  v_mfma_f32_16x16x32_bf16 v[100:103], a[20:23], a[108:111], v[100:103]
  ds_read_b64_tr_b16 a[60:61], v215 offset:34816
  v_mfma_f32_16x16x32_bf16 v[104:107], a[24:27], a[108:111], v[104:107]
  ds_read_b64_tr_b16 a[62:63], v215 offset:35840
  v_mfma_f32_16x16x32_bf16 v[108:111], a[28:31], a[108:111], v[108:111]
  ds_read_b64_tr_b16 a[64:65], v216 offset:34816
  v_mfma_f32_16x16x32_bf16 v[124:127], a[112:115], a[28:31], v[124:127]
  s_add_u32 m0, s85, 0
  v_mfma_f32_16x16x32_bf16 v[120:123], a[112:115], a[24:27], v[120:123]
  ds_read_b64_tr_b16 a[66:67], v216 offset:35840
  v_mfma_f32_16x16x32_bf16 v[116:119], a[112:115], a[20:23], v[116:119]
  ds_read_b64_tr_b16 a[68:69], v217 offset:34816
  v_mfma_f32_16x16x32_bf16 v[112:115], a[112:115], a[16:19], v[112:115]
  ds_read_b64_tr_b16 a[70:71], v217 offset:35840
  v_mfma_f32_16x16x32_bf16 v[128:131], a[116:119], a[16:19], v[128:131]
  buffer_load_dwordx4 v225, s[8:11], s82 offen offset:0 lds
  v_mfma_f32_16x16x32_bf16 v[132:135], a[116:119], a[20:23], v[132:135]
  ds_read_b64_tr_b16 a[72:73], v218 offset:34816
  v_mfma_f32_16x16x32_bf16 v[136:139], a[116:119], a[24:27], v[136:139]
  ds_read_b64_tr_b16 a[74:75], v218 offset:35840
  v_mfma_f32_16x16x32_bf16 v[140:143], a[116:119], a[28:31], v[140:143]
  ds_read_b64_tr_b16 a[76:77], v219 offset:34816
  v_mfma_f32_16x16x32_bf16 v[156:159], a[120:123], a[28:31], v[156:159]
  buffer_load_dwordx4 v226, s[8:11], s82 offen offset:1024 lds
  v_mfma_f32_16x16x32_bf16 v[152:155], a[120:123], a[24:27], v[152:155]
  ds_read_b64_tr_b16 a[78:79], v219 offset:35840
  v_mfma_f32_16x16x32_bf16 v[148:151], a[120:123], a[20:23], v[148:151]
  ds_read_b64_tr_b16 a[80:81], v220 offset:34816
  v_mfma_f32_16x16x32_bf16 v[144:147], a[120:123], a[16:19], v[144:147]
  ds_read_b64_tr_b16 a[82:83], v220 offset:35840
  v_mfma_f32_16x16x32_bf16 v[160:163], a[124:127], a[16:19], v[160:163]
  buffer_load_dwordx4 v227, s[8:11], s82 offen offset:2048 lds
  v_mfma_f32_16x16x32_bf16 v[164:167], a[124:127], a[20:23], v[164:167]
  buffer_load_dwordx4 v228, s[8:11], s82 offen offset:3072 lds
  v_mfma_f32_16x16x32_bf16 v[168:171], a[124:127], a[24:27], v[168:171]
  buffer_load_dwordx4 a[232:235], v253, s[68:71], s91 offen
  v_mfma_f32_16x16x32_bf16 v[172:175], a[124:127], a[28:31], v[172:175]
  s_add_u32 s83, s83, 229376
  v_mfma_f32_16x16x32_bf16 v[188:191], a[128:131], a[28:31], v[188:191]
  s_add_u32 s84, s84, 196608
  v_mfma_f32_16x16x32_bf16 v[184:187], a[128:131], a[24:27], v[184:187]
  s_add_u32 s82, s82, 65536
  v_mfma_f32_16x16x32_bf16 v[180:183], a[128:131], a[20:23], v[180:183]
  v_mfma_f32_16x16x32_bf16 v[176:179], a[128:131], a[16:19], v[176:179]
  v_mfma_f32_16x16x32_bf16 v[192:195], a[132:135], a[16:19], v[192:195]
  v_mfma_f32_16x16x32_bf16 v[196:199], a[132:135], a[20:23], v[196:199]
  v_mfma_f32_16x16x32_bf16 v[200:203], a[132:135], a[24:27], v[200:203]
  v_mfma_f32_16x16x32_bf16 v[204:207], a[132:135], a[28:31], v[204:207]
  s_waitcnt vmcnt(19) lgkmcnt(0)
  s_barrier
  v_mfma_f32_16x16x32_bf16 v[0:3], a[0:3], a[32:35], v[0:3]
  v_add_u32 v221, s86, v224
  v_mfma_f32_16x16x32_bf16 v[4:7], a[4:7], a[32:35], v[4:7]
  ds_read_b128 a[16:19], v221 offset:0
  v_mfma_f32_16x16x32_bf16 v[8:11], a[8:11], a[32:35], v[8:11]
  ds_read_b128 a[20:23], v221 offset:512
  v_mfma_f32_16x16x32_bf16 v[12:15], a[12:15], a[32:35], v[12:15]
  ds_read_b128 a[24:27], v221 offset:4096
  v_mfma_f32_16x16x32_bf16 v[28:31], a[12:15], a[36:39], v[28:31]
  s_add_u32 m0, s88, 32768
  v_mfma_f32_16x16x32_bf16 v[24:27], a[8:11], a[36:39], v[24:27]
  ds_read_b128 a[28:31], v221 offset:4608
  v_mfma_f32_16x16x32_bf16 v[20:23], a[4:7], a[36:39], v[20:23]
  ds_read_b64_tr_b16 a[84:85], v208 offset:49152
  v_mfma_f32_16x16x32_bf16 v[16:19], a[0:3], a[36:39], v[16:19]
  ds_read_b64_tr_b16 a[86:87], v208 offset:50176
  v_mfma_f32_16x16x32_bf16 v[32:35], a[0:3], a[40:43], v[32:35]
  buffer_load_dwordx4 v229, s[12:15], s83 offen lds
  v_mfma_f32_16x16x32_bf16 v[36:39], a[4:7], a[40:43], v[36:39]
  ds_read_b64_tr_b16 a[88:89], v209 offset:49152
  v_mfma_f32_16x16x32_bf16 v[40:43], a[8:11], a[40:43], v[40:43]
  ds_read_b64_tr_b16 a[90:91], v209 offset:50176
  v_mfma_f32_16x16x32_bf16 v[44:47], a[12:15], a[40:43], v[44:47]
  ds_read_b64_tr_b16 a[92:93], v210 offset:49152
  v_mfma_f32_16x16x32_bf16 v[60:63], a[12:15], a[44:47], v[60:63]
  buffer_load_dwordx4 v230, s[12:15], s83 offen offset:1024 lds
  v_mfma_f32_16x16x32_bf16 v[56:59], a[8:11], a[44:47], v[56:59]
  ds_read_b64_tr_b16 a[94:95], v210 offset:50176
  v_mfma_f32_16x16x32_bf16 v[52:55], a[4:7], a[44:47], v[52:55]
  ds_read_b64_tr_b16 a[96:97], v211 offset:49152
  v_mfma_f32_16x16x32_bf16 v[48:51], a[0:3], a[44:47], v[48:51]
  ds_read_b64_tr_b16 a[98:99], v211 offset:50176
  v_mfma_f32_16x16x32_bf16 v[64:67], a[0:3], a[48:51], v[64:67]
  s_add_u32 m0, s88, 34816
  v_mfma_f32_16x16x32_bf16 v[68:71], a[4:7], a[48:51], v[68:71]
  ds_read_b64_tr_b16 a[100:101], v212 offset:49152
  v_mfma_f32_16x16x32_bf16 v[72:75], a[8:11], a[48:51], v[72:75]
  ds_read_b64_tr_b16 a[102:103], v212 offset:50176
  v_mfma_f32_16x16x32_bf16 v[76:79], a[12:15], a[48:51], v[76:79]
  ds_read_b64_tr_b16 a[104:105], v213 offset:49152
  v_mfma_f32_16x16x32_bf16 v[92:95], a[12:15], a[52:55], v[92:95]
  buffer_load_dwordx4 v231, s[16:19], s84 offen lds
  v_mfma_f32_16x16x32_bf16 v[88:91], a[8:11], a[52:55], v[88:91]
  ds_read_b64_tr_b16 a[106:107], v213 offset:50176
  v_mfma_f32_16x16x32_bf16 v[84:87], a[4:7], a[52:55], v[84:87]
  ds_read_b64_tr_b16 a[108:109], v214 offset:49152
  v_mfma_f32_16x16x32_bf16 v[80:83], a[0:3], a[52:55], v[80:83]
  ds_read_b64_tr_b16 a[110:111], v214 offset:50176
  v_mfma_f32_16x16x32_bf16 v[96:99], a[0:3], a[56:59], v[96:99]
  buffer_load_dwordx4 v232, s[16:19], s84 offen offset:1024 lds
  v_mfma_f32_16x16x32_bf16 v[100:103], a[4:7], a[56:59], v[100:103]
  ds_read_b64_tr_b16 a[112:113], v215 offset:51200
  v_mfma_f32_16x16x32_bf16 v[104:107], a[8:11], a[56:59], v[104:107]
  ds_read_b64_tr_b16 a[114:115], v215 offset:52224
  v_mfma_f32_16x16x32_bf16 v[108:111], a[12:15], a[56:59], v[108:111]
  ds_read_b64_tr_b16 a[116:117], v216 offset:51200
  v_mfma_f32_16x16x32_bf16 v[124:127], a[60:63], a[12:15], v[124:127]
  s_add_u32 m0, s85, 4096
  v_mfma_f32_16x16x32_bf16 v[120:123], a[60:63], a[8:11], v[120:123]
  ds_read_b64_tr_b16 a[118:119], v216 offset:52224
  v_mfma_f32_16x16x32_bf16 v[116:119], a[60:63], a[4:7], v[116:119]
  ds_read_b64_tr_b16 a[120:121], v217 offset:51200
  v_mfma_f32_16x16x32_bf16 v[112:115], a[60:63], a[0:3], v[112:115]
  ds_read_b64_tr_b16 a[122:123], v217 offset:52224
  v_mfma_f32_16x16x32_bf16 v[128:131], a[64:67], a[0:3], v[128:131]
  buffer_load_dwordx4 v225, s[8:11], s82 offen offset:0 lds
  v_mfma_f32_16x16x32_bf16 v[132:135], a[64:67], a[4:7], v[132:135]
  ds_read_b64_tr_b16 a[124:125], v218 offset:51200
  v_mfma_f32_16x16x32_bf16 v[136:139], a[64:67], a[8:11], v[136:139]
  ds_read_b64_tr_b16 a[126:127], v218 offset:52224
  v_mfma_f32_16x16x32_bf16 v[140:143], a[64:67], a[12:15], v[140:143]
  ds_read_b64_tr_b16 a[128:129], v219 offset:51200
  v_mfma_f32_16x16x32_bf16 v[156:159], a[68:71], a[12:15], v[156:159]
  buffer_load_dwordx4 v226, s[8:11], s82 offen offset:1024 lds
  v_mfma_f32_16x16x32_bf16 v[152:155], a[68:71], a[8:11], v[152:155]
  ds_read_b64_tr_b16 a[130:131], v219 offset:52224
  v_mfma_f32_16x16x32_bf16 v[148:151], a[68:71], a[4:7], v[148:151]
  ds_read_b64_tr_b16 a[132:133], v220 offset:51200
  v_mfma_f32_16x16x32_bf16 v[144:147], a[68:71], a[0:3], v[144:147]
  ds_read_b64_tr_b16 a[134:135], v220 offset:52224
  v_mfma_f32_16x16x32_bf16 v[160:163], a[72:75], a[0:3], v[160:163]
  buffer_load_dwordx4 v227, s[8:11], s82 offen offset:2048 lds
  v_mfma_f32_16x16x32_bf16 v[164:167], a[72:75], a[4:7], v[164:167]
  buffer_load_dwordx4 v228, s[8:11], s82 offen offset:3072 lds
  v_mfma_f32_16x16x32_bf16 v[168:171], a[72:75], a[8:11], v[168:171]
  buffer_load_dwordx4 a[232:235], v254, s[64:67], s90 offen
  v_mfma_f32_16x16x32_bf16 v[172:175], a[72:75], a[12:15], v[172:175]
  s_add_u32 s83, s83, 229376
  v_mfma_f32_16x16x32_bf16 v[188:191], a[76:79], a[12:15], v[188:191]
  s_add_u32 s84, s84, 196608
  v_mfma_f32_16x16x32_bf16 v[184:187], a[76:79], a[8:11], v[184:187]
  s_sub_u32 s82, s82, 65408
  v_mfma_f32_16x16x32_bf16 v[180:183], a[76:79], a[4:7], v[180:183]
  s_add_u32 s90, s90, 2097152
  v_mfma_f32_16x16x32_bf16 v[176:179], a[76:79], a[0:3], v[176:179]
  s_min_u32 s90, s90, s28
  v_mfma_f32_16x16x32_bf16 v[192:195], a[80:83], a[0:3], v[192:195]
  v_mfma_f32_16x16x32_bf16 v[196:199], a[80:83], a[4:7], v[196:199]
  v_mfma_f32_16x16x32_bf16 v[200:203], a[80:83], a[8:11], v[200:203]
  v_mfma_f32_16x16x32_bf16 v[204:207], a[80:83], a[12:15], v[204:207]
  s_waitcnt vmcnt(19) lgkmcnt(0)
  s_barrier
  v_mfma_f32_16x16x32_bf16 v[0:3], a[16:19], a[84:87], v[0:3]
  v_add_u32 v221, s87, v223
  v_mfma_f32_16x16x32_bf16 v[4:7], a[20:23], a[84:87], v[4:7]
  ds_read_b128 a[0:3], v221 offset:0
  v_mfma_f32_16x16x32_bf16 v[8:11], a[24:27], a[84:87], v[8:11]
  ds_read_b128 a[4:7], v221 offset:512
  v_mfma_f32_16x16x32_bf16 v[12:15], a[28:31], a[84:87], v[12:15]
  ds_read_b128 a[8:11], v221 offset:4096
  v_mfma_f32_16x16x32_bf16 v[28:31], a[28:31], a[88:91], v[28:31]
  s_add_u32 m0, s88, 49152
  v_mfma_f32_16x16x32_bf16 v[24:27], a[24:27], a[88:91], v[24:27]
  ds_read_b128 a[12:15], v221 offset:4608
  v_mfma_f32_16x16x32_bf16 v[20:23], a[20:23], a[88:91], v[20:23]
  ds_read_b64_tr_b16 a[32:33], v208 offset:0
  v_mfma_f32_16x16x32_bf16 v[16:19], a[16:19], a[88:91], v[16:19]
  ds_read_b64_tr_b16 a[34:35], v208 offset:1024
  v_mfma_f32_16x16x32_bf16 v[32:35], a[16:19], a[92:95], v[32:35]
  buffer_load_dwordx4 v229, s[12:15], s83 offen lds
  v_mfma_f32_16x16x32_bf16 v[36:39], a[20:23], a[92:95], v[36:39]
  ds_read_b64_tr_b16 a[36:37], v209 offset:0
  v_mfma_f32_16x16x32_bf16 v[40:43], a[24:27], a[92:95], v[40:43]
  ds_read_b64_tr_b16 a[38:39], v209 offset:1024
  v_mfma_f32_16x16x32_bf16 v[44:47], a[28:31], a[92:95], v[44:47]
  ds_read_b64_tr_b16 a[40:41], v210 offset:0
  v_mfma_f32_16x16x32_bf16 v[60:63], a[28:31], a[96:99], v[60:63]
  buffer_load_dwordx4 v230, s[12:15], s83 offen offset:1024 lds
  v_mfma_f32_16x16x32_bf16 v[56:59], a[24:27], a[96:99], v[56:59]
  ds_read_b64_tr_b16 a[42:43], v210 offset:1024
  v_mfma_f32_16x16x32_bf16 v[52:55], a[20:23], a[96:99], v[52:55]
  ds_read_b64_tr_b16 a[44:45], v211 offset:0
  v_mfma_f32_16x16x32_bf16 v[48:51], a[16:19], a[96:99], v[48:51]
  ds_read_b64_tr_b16 a[46:47], v211 offset:1024
  v_mfma_f32_16x16x32_bf16 v[64:67], a[16:19], a[100:103], v[64:67]
  s_add_u32 m0, s88, 51200
  v_mfma_f32_16x16x32_bf16 v[68:71], a[20:23], a[100:103], v[68:71]
  ds_read_b64_tr_b16 a[48:49], v212 offset:0
  v_mfma_f32_16x16x32_bf16 v[72:75], a[24:27], a[100:103], v[72:75]
  ds_read_b64_tr_b16 a[50:51], v212 offset:1024
  v_mfma_f32_16x16x32_bf16 v[76:79], a[28:31], a[100:103], v[76:79]
  ds_read_b64_tr_b16 a[52:53], v213 offset:0
  v_mfma_f32_16x16x32_bf16 v[92:95], a[28:31], a[104:107], v[92:95]
  buffer_load_dwordx4 v231, s[16:19], s84 offen lds
  v_mfma_f32_16x16x32_bf16 v[88:91], a[24:27], a[104:107], v[88:91]
  ds_read_b64_tr_b16 a[54:55], v213 offset:1024
  v_mfma_f32_16x16x32_bf16 v[84:87], a[20:23], a[104:107], v[84:87]
  ds_read_b64_tr_b16 a[56:57], v214 offset:0
  v_mfma_f32_16x16x32_bf16 v[80:83], a[16:19], a[104:107], v[80:83]
  ds_read_b64_tr_b16 a[58:59], v214 offset:1024
  v_mfma_f32_16x16x32_bf16 v[96:99], a[16:19], a[108:111], v[96:99]
  buffer_load_dwordx4 v232, s[16:19], s84 offen offset:1024 lds
  v_mfma_f32_16x16x32_bf16 v[100:103], a[20:23], a[108:111], v[100:103]
  ds_read_b64_tr_b16 a[60:61], v215 offset:2048
  v_mfma_f32_16x16x32_bf16 v[104:107], a[24:27], a[108:111], v[104:107]
  ds_read_b64_tr_b16 a[62:63], v215 offset:3072
  v_mfma_f32_16x16x32_bf16 v[108:111], a[28:31], a[108:111], v[108:111]
  ds_read_b64_tr_b16 a[64:65], v216 offset:2048
  v_mfma_f32_16x16x32_bf16 v[124:127], a[112:115], a[28:31], v[124:127]
  s_add_u32 m0, s86, 0
  v_mfma_f32_16x16x32_bf16 v[120:123], a[112:115], a[24:27], v[120:123]
  ds_read_b64_tr_b16 a[66:67], v216 offset:3072
  v_mfma_f32_16x16x32_bf16 v[116:119], a[112:115], a[20:23], v[116:119]
  ds_read_b64_tr_b16 a[68:69], v217 offset:2048
  v_mfma_f32_16x16x32_bf16 v[112:115], a[112:115], a[16:19], v[112:115]
  ds_read_b64_tr_b16 a[70:71], v217 offset:3072
  v_mfma_f32_16x16x32_bf16 v[128:131], a[116:119], a[16:19], v[128:131]
  buffer_load_dwordx4 v225, s[8:11], s82 offen offset:0 lds
  v_mfma_f32_16x16x32_bf16 v[132:135], a[116:119], a[20:23], v[132:135]
  ds_read_b64_tr_b16 a[72:73], v218 offset:2048
  v_mfma_f32_16x16x32_bf16 v[136:139], a[116:119], a[24:27], v[136:139]
  ds_read_b64_tr_b16 a[74:75], v218 offset:3072
  v_mfma_f32_16x16x32_bf16 v[140:143], a[116:119], a[28:31], v[140:143]
  ds_read_b64_tr_b16 a[76:77], v219 offset:2048
  v_mfma_f32_16x16x32_bf16 v[156:159], a[120:123], a[28:31], v[156:159]
  buffer_load_dwordx4 v226, s[8:11], s82 offen offset:1024 lds
  v_mfma_f32_16x16x32_bf16 v[152:155], a[120:123], a[24:27], v[152:155]
  ds_read_b64_tr_b16 a[78:79], v219 offset:3072
  v_mfma_f32_16x16x32_bf16 v[148:151], a[120:123], a[20:23], v[148:151]
  ds_read_b64_tr_b16 a[80:81], v220 offset:2048
  v_mfma_f32_16x16x32_bf16 v[144:147], a[120:123], a[16:19], v[144:147]
  ds_read_b64_tr_b16 a[82:83], v220 offset:3072
  v_mfma_f32_16x16x32_bf16 v[160:163], a[124:127], a[16:19], v[160:163]
  buffer_load_dwordx4 v227, s[8:11], s82 offen offset:2048 lds
  v_mfma_f32_16x16x32_bf16 v[164:167], a[124:127], a[20:23], v[164:167]
  buffer_load_dwordx4 v228, s[8:11], s82 offen offset:3072 lds
  v_mfma_f32_16x16x32_bf16 v[168:171], a[124:127], a[24:27], v[168:171]
  buffer_load_dwordx4 a[232:235], v255, s[68:71], s91 offen
  v_mfma_f32_16x16x32_bf16 v[172:175], a[124:127], a[28:31], v[172:175]
  s_add_u32 s83, s83, 229376
  v_mfma_f32_16x16x32_bf16 v[188:191], a[128:131], a[28:31], v[188:191]
  s_add_u32 s84, s84, 196608
  v_mfma_f32_16x16x32_bf16 v[184:187], a[128:131], a[24:27], v[184:187]
  s_add_u32 s82, s82, 65536
  v_mfma_f32_16x16x32_bf16 v[180:183], a[128:131], a[20:23], v[180:183]
  s_mov_b32 s24, s87
  v_mfma_f32_16x16x32_bf16 v[176:179], a[128:131], a[16:19], v[176:179]
  s_mov_b32 s87, s86
  v_mfma_f32_16x16x32_bf16 v[192:195], a[132:135], a[16:19], v[192:195]
  s_mov_b32 s86, s85
  v_mfma_f32_16x16x32_bf16 v[196:199], a[132:135], a[20:23], v[196:199]
  s_mov_b32 s85, s24
  v_mfma_f32_16x16x32_bf16 v[200:203], a[132:135], a[24:27], v[200:203]
  s_add_u32 s91, s91, 2097152
  v_mfma_f32_16x16x32_bf16 v[204:207], a[132:135], a[28:31], v[204:207]
  s_min_u32 s91, s91, s29
  s_waitcnt vmcnt(19) lgkmcnt(0)
  s_barrier
  s_cmp_lg_u32 s89, 5
  s_cbranch_scc1 gated_mix__mha_block__mixer_gmlp__prompt_kernel_v1_s5
  s_call_b64 s[24:25], gated_mix__mha_block__mixer_gmlp__prompt_kernel_pfsw1
gated_mix__mha_block__mixer_gmlp__prompt_kernel_v1_s5:
  s_cmp_lg_u32 s89, 3
  s_cbranch_scc1 gated_mix__mha_block__mixer_gmlp__prompt_kernel_v1_s3
  s_call_b64 s[24:25], gated_mix__mha_block__mixer_gmlp__prompt_kernel_pfsw2
gated_mix__mha_block__mixer_gmlp__prompt_kernel_v1_s3:
  s_cmp_lg_u32 s89, s94
  s_cbranch_scc1 gated_mix__mha_block__mixer_gmlp__prompt_kernel_v1_na
  s_call_b64 s[24:25], gated_mix__mha_block__mixer_gmlp__prompt_kernel_arrive
gated_mix__mha_block__mixer_gmlp__prompt_kernel_v1_na:
  s_cmp_lg_u32 s89, 0
  s_cbranch_scc1 gated_mix__mha_block__mixer_gmlp__prompt_kernel_v1_loop
  s_cmp_lg_u32 s44, 0
  s_cbranch_scc1 gated_mix__mha_block__mixer_gmlp__prompt_kernel_v1_ar0
  v_mov_b32 v236, 0
  global_load_dword v237, v236, s[100:101] sc1
gated_mix__mha_block__mixer_gmlp__prompt_kernel_v1_ar0:
  v_mfma_f32_16x16x32_bf16 v[0:3], a[0:3], a[32:35], v[0:3]
  v_add_u32 v221, s85, v224
  v_mfma_f32_16x16x32_bf16 v[4:7], a[4:7], a[32:35], v[4:7]
  ds_read_b128 a[16:19], v221 offset:0
  v_mfma_f32_16x16x32_bf16 v[8:11], a[8:11], a[32:35], v[8:11]
  ds_read_b128 a[20:23], v221 offset:512
  v_mfma_f32_16x16x32_bf16 v[12:15], a[12:15], a[32:35], v[12:15]
  ds_read_b128 a[24:27], v221 offset:4096
  v_mfma_f32_16x16x32_bf16 v[28:31], a[12:15], a[36:39], v[28:31]
  ds_read_b128 a[28:31], v221 offset:4608
  v_mfma_f32_16x16x32_bf16 v[24:27], a[8:11], a[36:39], v[24:27]
  ds_read_b64_tr_b16 a[84:85], v208 offset:16384
  v_mfma_f32_16x16x32_bf16 v[20:23], a[4:7], a[36:39], v[20:23]
  ds_read_b64_tr_b16 a[86:87], v208 offset:17408
  v_mfma_f32_16x16x32_bf16 v[16:19], a[0:3], a[36:39], v[16:19]
  ds_read_b64_tr_b16 a[88:89], v209 offset:16384
  v_mfma_f32_16x16x32_bf16 v[32:35], a[0:3], a[40:43], v[32:35]
  ds_read_b64_tr_b16 a[90:91], v209 offset:17408
  v_mfma_f32_16x16x32_bf16 v[36:39], a[4:7], a[40:43], v[36:39]
  ds_read_b64_tr_b16 a[92:93], v210 offset:16384
  v_mfma_f32_16x16x32_bf16 v[40:43], a[8:11], a[40:43], v[40:43]
  ds_read_b64_tr_b16 a[94:95], v210 offset:17408
  v_mfma_f32_16x16x32_bf16 v[44:47], a[12:15], a[40:43], v[44:47]
  ds_read_b64_tr_b16 a[96:97], v211 offset:16384
  v_mfma_f32_16x16x32_bf16 v[60:63], a[12:15], a[44:47], v[60:63]
  ds_read_b64_tr_b16 a[98:99], v211 offset:17408
  v_mfma_f32_16x16x32_bf16 v[56:59], a[8:11], a[44:47], v[56:59]
  ds_read_b64_tr_b16 a[100:101], v212 offset:16384
  v_mfma_f32_16x16x32_bf16 v[52:55], a[4:7], a[44:47], v[52:55]
  ds_read_b64_tr_b16 a[102:103], v212 offset:17408
  v_mfma_f32_16x16x32_bf16 v[48:51], a[0:3], a[44:47], v[48:51]
  ds_read_b64_tr_b16 a[104:105], v213 offset:16384
  v_mfma_f32_16x16x32_bf16 v[64:67], a[0:3], a[48:51], v[64:67]
  ds_read_b64_tr_b16 a[106:107], v213 offset:17408
  v_mfma_f32_16x16x32_bf16 v[68:71], a[4:7], a[48:51], v[68:71]
  ds_read_b64_tr_b16 a[108:109], v214 offset:16384
  v_mfma_f32_16x16x32_bf16 v[72:75], a[8:11], a[48:51], v[72:75]
  ds_read_b64_tr_b16 a[110:111], v214 offset:17408
  v_mfma_f32_16x16x32_bf16 v[76:79], a[12:15], a[48:51], v[76:79]
  ds_read_b64_tr_b16 a[112:113], v215 offset:18432
  v_mfma_f32_16x16x32_bf16 v[92:95], a[12:15], a[52:55], v[92:95]
  ds_read_b64_tr_b16 a[114:115], v215 offset:19456
  v_mfma_f32_16x16x32_bf16 v[88:91], a[8:11], a[52:55], v[88:91]
  ds_read_b64_tr_b16 a[116:117], v216 offset:18432
  v_mfma_f32_16x16x32_bf16 v[84:87], a[4:7], a[52:55], v[84:87]
  ds_read_b64_tr_b16 a[118:119], v216 offset:19456
  v_mfma_f32_16x16x32_bf16 v[80:83], a[0:3], a[52:55], v[80:83]
  ds_read_b64_tr_b16 a[120:121], v217 offset:18432
  v_mfma_f32_16x16x32_bf16 v[96:99], a[0:3], a[56:59], v[96:99]
  ds_read_b64_tr_b16 a[122:123], v217 offset:19456
  v_mfma_f32_16x16x32_bf16 v[100:103], a[4:7], a[56:59], v[100:103]
  ds_read_b64_tr_b16 a[124:125], v218 offset:18432
  v_mfma_f32_16x16x32_bf16 v[104:107], a[8:11], a[56:59], v[104:107]
  ds_read_b64_tr_b16 a[126:127], v218 offset:19456
  v_mfma_f32_16x16x32_bf16 v[108:111], a[12:15], a[56:59], v[108:111]
  ds_read_b64_tr_b16 a[128:129], v219 offset:18432
  v_mfma_f32_16x16x32_bf16 v[124:127], a[60:63], a[12:15], v[124:127]
  ds_read_b64_tr_b16 a[130:131], v219 offset:19456
  v_mfma_f32_16x16x32_bf16 v[120:123], a[60:63], a[8:11], v[120:123]
  ds_read_b64_tr_b16 a[132:133], v220 offset:18432
  v_mfma_f32_16x16x32_bf16 v[116:119], a[60:63], a[4:7], v[116:119]
  ds_read_b64_tr_b16 a[134:135], v220 offset:19456
  v_mfma_f32_16x16x32_bf16 v[112:115], a[60:63], a[0:3], v[112:115]
  v_lshlrev_b32 v242, 5, v234
  v_mfma_f32_16x16x32_bf16 v[128:131], a[64:67], a[0:3], v[128:131]
  s_lshl_b32 s31, s93, 11
  v_mfma_f32_16x16x32_bf16 v[132:135], a[64:67], a[4:7], v[132:135]
  buffer_load_dwordx4 a[140:143], v242, s[8:11], s31 offen offset:0
  v_mfma_f32_16x16x32_bf16 v[136:139], a[64:67], a[8:11], v[136:139]
  buffer_load_dwordx4 a[144:147], v242, s[8:11], s31 offen offset:16
  v_mfma_f32_16x16x32_bf16 v[140:143], a[64:67], a[12:15], v[140:143]
  buffer_load_dwordx4 a[148:151], v242, s[8:11], s31 offen offset:2048
  v_mfma_f32_16x16x32_bf16 v[156:159], a[68:71], a[12:15], v[156:159]
  buffer_load_dwordx4 a[152:155], v242, s[8:11], s31 offen offset:2064
  v_mfma_f32_16x16x32_bf16 v[152:155], a[68:71], a[8:11], v[152:155]
  buffer_load_dwordx4 a[156:159], v242, s[20:23], 0 offen offset:0
  v_mfma_f32_16x16x32_bf16 v[148:151], a[68:71], a[4:7], v[148:151]
  buffer_load_dwordx4 a[160:163], v242, s[20:23], 0 offen offset:16
  v_mfma_f32_16x16x32_bf16 v[144:147], a[68:71], a[0:3], v[144:147]
  v_mfma_f32_16x16x32_bf16 v[160:163], a[72:75], a[0:3], v[160:163]
  v_mfma_f32_16x16x32_bf16 v[164:167], a[72:75], a[4:7], v[164:167]
  v_mfma_f32_16x16x32_bf16 v[168:171], a[72:75], a[8:11], v[168:171]
  v_mfma_f32_16x16x32_bf16 v[172:175], a[72:75], a[12:15], v[172:175]
  v_mfma_f32_16x16x32_bf16 v[188:191], a[76:79], a[12:15], v[188:191]
  v_mfma_f32_16x16x32_bf16 v[184:187], a[76:79], a[8:11], v[184:187]
  v_mfma_f32_16x16x32_bf16 v[180:183], a[76:79], a[4:7], v[180:183]
  v_mfma_f32_16x16x32_bf16 v[176:179], a[76:79], a[0:3], v[176:179]
  v_mfma_f32_16x16x32_bf16 v[192:195], a[80:83], a[0:3], v[192:195]
  v_mfma_f32_16x16x32_bf16 v[196:199], a[80:83], a[4:7], v[196:199]
  v_mfma_f32_16x16x32_bf16 v[200:203], a[80:83], a[8:11], v[200:203]
  v_mfma_f32_16x16x32_bf16 v[204:207], a[80:83], a[12:15], v[204:207]
  s_waitcnt vmcnt(16) lgkmcnt(0)
  s_barrier
  v_mfma_f32_16x16x32_bf16 v[0:3], a[16:19], a[84:87], v[0:3]
  v_add_u32 v221, s86, v223
  v_mfma_f32_16x16x32_bf16 v[4:7], a[20:23], a[84:87], v[4:7]
  ds_read_b128 a[0:3], v221 offset:0
  v_mfma_f32_16x16x32_bf16 v[8:11], a[24:27], a[84:87], v[8:11]
  ds_read_b128 a[4:7], v221 offset:512
  v_mfma_f32_16x16x32_bf16 v[12:15], a[28:31], a[84:87], v[12:15]
  ds_read_b128 a[8:11], v221 offset:4096
  v_mfma_f32_16x16x32_bf16 v[28:31], a[28:31], a[88:91], v[28:31]
  ds_read_b128 a[12:15], v221 offset:4608
  v_mfma_f32_16x16x32_bf16 v[24:27], a[24:27], a[88:91], v[24:27]
  ds_read_b64_tr_b16 a[32:33], v208 offset:32768
  v_mfma_f32_16x16x32_bf16 v[20:23], a[20:23], a[88:91], v[20:23]
  ds_read_b64_tr_b16 a[34:35], v208 offset:33792
  v_mfma_f32_16x16x32_bf16 v[16:19], a[16:19], a[88:91], v[16:19]
  ds_read_b64_tr_b16 a[36:37], v209 offset:32768
  v_mfma_f32_16x16x32_bf16 v[32:35], a[16:19], a[92:95], v[32:35]
  ds_read_b64_tr_b16 a[38:39], v209 offset:33792
  v_mfma_f32_16x16x32_bf16 v[36:39], a[20:23], a[92:95], v[36:39]
  ds_read_b64_tr_b16 a[40:41], v210 offset:32768
  v_mfma_f32_16x16x32_bf16 v[40:43], a[24:27], a[92:95], v[40:43]
  ds_read_b64_tr_b16 a[42:43], v210 offset:33792
  v_mfma_f32_16x16x32_bf16 v[44:47], a[28:31], a[92:95], v[44:47]
  ds_read_b64_tr_b16 a[44:45], v211 offset:32768
  v_mfma_f32_16x16x32_bf16 v[60:63], a[28:31], a[96:99], v[60:63]
  ds_read_b64_tr_b16 a[46:47], v211 offset:33792
  v_mfma_f32_16x16x32_bf16 v[56:59], a[24:27], a[96:99], v[56:59]
  ds_read_b64_tr_b16 a[48:49], v212 offset:32768
  v_mfma_f32_16x16x32_bf16 v[52:55], a[20:23], a[96:99], v[52:55]
  ds_read_b64_tr_b16 a[50:51], v212 offset:33792
  v_mfma_f32_16x16x32_bf16 v[48:51], a[16:19], a[96:99], v[48:51]
  ds_read_b64_tr_b16 a[52:53], v213 offset:32768
  v_mfma_f32_16x16x32_bf16 v[64:67], a[16:19], a[100:103], v[64:67]
  ds_read_b64_tr_b16 a[54:55], v213 offset:33792
  v_mfma_f32_16x16x32_bf16 v[68:71], a[20:23], a[100:103], v[68:71]
  ds_read_b64_tr_b16 a[56:57], v214 offset:32768
  v_mfma_f32_16x16x32_bf16 v[72:75], a[24:27], a[100:103], v[72:75]
  ds_read_b64_tr_b16 a[58:59], v214 offset:33792
  v_mfma_f32_16x16x32_bf16 v[76:79], a[28:31], a[100:103], v[76:79]
  ds_read_b64_tr_b16 a[60:61], v215 offset:34816
  v_mfma_f32_16x16x32_bf16 v[92:95], a[28:31], a[104:107], v[92:95]
  ds_read_b64_tr_b16 a[62:63], v215 offset:35840
  v_mfma_f32_16x16x32_bf16 v[88:91], a[24:27], a[104:107], v[88:91]
  ds_read_b64_tr_b16 a[64:65], v216 offset:34816
  v_mfma_f32_16x16x32_bf16 v[84:87], a[20:23], a[104:107], v[84:87]
  ds_read_b64_tr_b16 a[66:67], v216 offset:35840
  v_mfma_f32_16x16x32_bf16 v[80:83], a[16:19], a[104:107], v[80:83]
  ds_read_b64_tr_b16 a[68:69], v217 offset:34816
  v_mfma_f32_16x16x32_bf16 v[96:99], a[16:19], a[108:111], v[96:99]
  ds_read_b64_tr_b16 a[70:71], v217 offset:35840
  v_mfma_f32_16x16x32_bf16 v[100:103], a[20:23], a[108:111], v[100:103]
  ds_read_b64_tr_b16 a[72:73], v218 offset:34816
  v_mfma_f32_16x16x32_bf16 v[104:107], a[24:27], a[108:111], v[104:107]
  ds_read_b64_tr_b16 a[74:75], v218 offset:35840
  v_mfma_f32_16x16x32_bf16 v[108:111], a[28:31], a[108:111], v[108:111]
  ds_read_b64_tr_b16 a[76:77], v219 offset:34816
  v_mfma_f32_16x16x32_bf16 v[124:127], a[112:115], a[28:31], v[124:127]
  ds_read_b64_tr_b16 a[78:79], v219 offset:35840
  v_mfma_f32_16x16x32_bf16 v[120:123], a[112:115], a[24:27], v[120:123]
  ds_read_b64_tr_b16 a[80:81], v220 offset:34816
  v_mfma_f32_16x16x32_bf16 v[116:119], a[112:115], a[20:23], v[116:119]
  ds_read_b64_tr_b16 a[82:83], v220 offset:35840
  v_mfma_f32_16x16x32_bf16 v[112:115], a[112:115], a[16:19], v[112:115]
  v_mfma_f32_16x16x32_bf16 v[128:131], a[116:119], a[16:19], v[128:131]
  v_mfma_f32_16x16x32_bf16 v[132:135], a[116:119], a[20:23], v[132:135]
  v_mfma_f32_16x16x32_bf16 v[136:139], a[116:119], a[24:27], v[136:139]
  v_mfma_f32_16x16x32_bf16 v[140:143], a[116:119], a[28:31], v[140:143]
  v_mfma_f32_16x16x32_bf16 v[156:159], a[120:123], a[28:31], v[156:159]
  v_mfma_f32_16x16x32_bf16 v[152:155], a[120:123], a[24:27], v[152:155]
  v_mfma_f32_16x16x32_bf16 v[148:151], a[120:123], a[20:23], v[148:151]
  v_mfma_f32_16x16x32_bf16 v[144:147], a[120:123], a[16:19], v[144:147]
  v_mfma_f32_16x16x32_bf16 v[160:163], a[124:127], a[16:19], v[160:163]
  v_mfma_f32_16x16x32_bf16 v[164:167], a[124:127], a[20:23], v[164:167]
  v_mfma_f32_16x16x32_bf16 v[168:171], a[124:127], a[24:27], v[168:171]
  v_mfma_f32_16x16x32_bf16 v[172:175], a[124:127], a[28:31], v[172:175]
  v_mfma_f32_16x16x32_bf16 v[188:191], a[128:131], a[28:31], v[188:191]
  v_mfma_f32_16x16x32_bf16 v[184:187], a[128:131], a[24:27], v[184:187]
  v_mfma_f32_16x16x32_bf16 v[180:183], a[128:131], a[20:23], v[180:183]
  v_mfma_f32_16x16x32_bf16 v[176:179], a[128:131], a[16:19], v[176:179]
  v_mfma_f32_16x16x32_bf16 v[192:195], a[132:135], a[16:19], v[192:195]
  v_mfma_f32_16x16x32_bf16 v[196:199], a[132:135], a[20:23], v[196:199]
  v_mfma_f32_16x16x32_bf16 v[200:203], a[132:135], a[24:27], v[200:203]
  v_mfma_f32_16x16x32_bf16 v[204:207], a[132:135], a[28:31], v[204:207]
  s_waitcnt vmcnt(0) lgkmcnt(0)
  v_readfirstlane_b32 s26, v237
  s_cmp_lg_u32 s44, 0
  s_cbranch_scc1 gated_mix__mha_block__mixer_gmlp__prompt_kernel_v1_arr
  s_nop 1
  s_cmp_ge_u32 s26, 80
  s_cbranch_scc1 gated_mix__mha_block__mixer_gmlp__prompt_kernel_v1_arr
  s_call_b64 s[24:25], gated_mix__mha_block__mixer_gmlp__prompt_kernel_arrchk
gated_mix__mha_block__mixer_gmlp__prompt_kernel_v1_arr:
  s_barrier
  v_mfma_f32_16x16x32_bf16 v[0:3], a[0:3], a[32:35], v[0:3]
  v_add_u32 v221, s86, v224
  v_mov_b32 v244, 0
  v_mov_b32 v245, 0
  v_accvgpr_read_b32 v247, a156
  v_mfma_f32_16x16x32_bf16 v[4:7], a[4:7], a[32:35], v[4:7]
  ds_read_b128 a[16:19], v221 offset:0
  v_lshlrev_b32 v246, 16, v247
  v_and_b32 v247, 0xffff0000, v247
  v_accvgpr_read_b32 v249, a140
  v_mfma_f32_16x16x32_bf16 v[8:11], a[8:11], a[32:35], v[8:11]
  ds_read_b128 a[20:23], v221 offset:512
  v_lshlrev_b32 v248, 16, v249
  v_and_b32 v249, 0xffff0000, v249
  v_mfma_f32_16x16x32_bf16 v[12:15], a[12:15], a[32:35], v[12:15]
  ds_read_b128 a[24:27], v221 offset:4096
  v_fmac_f32 v244, v246, v248
  v_fmac_f32 v244, v247, v249
  v_mfma_f32_16x16x32_bf16 v[28:31], a[12:15], a[36:39], v[28:31]
  ds_read_b128 a[28:31], v221 offset:4608
  v_accvgpr_read_b32 v249, a148
  v_lshlrev_b32 v248, 16, v249
  v_mfma_f32_16x16x32_bf16 v[24:27], a[8:11], a[36:39], v[24:27]
  ds_read_b64_tr_b16 a[84:85], v208 offset:49152
  v_and_b32 v249, 0xffff0000, v249
  v_fmac_f32 v245, v246, v248
  v_mfma_f32_16x16x32_bf16 v[20:23], a[4:7], a[36:39], v[20:23]
  ds_read_b64_tr_b16 a[86:87], v208 offset:50176
  v_fmac_f32 v245, v247, v249
  v_accvgpr_read_b32 v247, a157
  v_mfma_f32_16x16x32_bf16 v[16:19], a[0:3], a[36:39], v[16:19]
  ds_read_b64_tr_b16 a[88:89], v209 offset:49152
  v_lshlrev_b32 v246, 16, v247
  v_and_b32 v247, 0xffff0000, v247
  v_mfma_f32_16x16x32_bf16 v[32:35], a[0:3], a[40:43], v[32:35]
  ds_read_b64_tr_b16 a[90:91], v209 offset:50176
  v_accvgpr_read_b32 v249, a141
  v_lshlrev_b32 v248, 16, v249
  v_mfma_f32_16x16x32_bf16 v[36:39], a[4:7], a[40:43], v[36:39]
  ds_read_b64_tr_b16 a[92:93], v210 offset:49152
  v_and_b32 v249, 0xffff0000, v249
  v_fmac_f32 v244, v246, v248
  v_mfma_f32_16x16x32_bf16 v[40:43], a[8:11], a[40:43], v[40:43]
  ds_read_b64_tr_b16 a[94:95], v210 offset:50176
  v_fmac_f32 v244, v247, v249
  v_accvgpr_read_b32 v249, a149
  v_mfma_f32_16x16x32_bf16 v[44:47], a[12:15], a[40:43], v[44:47]
  ds_read_b64_tr_b16 a[96:97], v211 offset:49152
  v_lshlrev_b32 v248, 16, v249
  v_and_b32 v249, 0xffff0000, v249
  v_mfma_f32_16x16x32_bf16 v[60:63], a[12:15], a[44:47], v[60:63]
  ds_read_b64_tr_b16 a[98:99], v211 offset:50176
  v_fmac_f32 v245, v246, v248
  v_fmac_f32 v245, v247, v249
  v_mfma_f32_16x16x32_bf16 v[56:59], a[8:11], a[44:47], v[56:59]
  ds_read_b64_tr_b16 a[100:101], v212 offset:49152
  v_accvgpr_read_b32 v247, a158
  v_lshlrev_b32 v246, 16, v247
  v_mfma_f32_16x16x32_bf16 v[52:55], a[4:7], a[44:47], v[52:55]
  ds_read_b64_tr_b16 a[102:103], v212 offset:50176
  v_and_b32 v247, 0xffff0000, v247
  v_accvgpr_read_b32 v249, a142
  v_mfma_f32_16x16x32_bf16 v[48:51], a[0:3], a[44:47], v[48:51]
  ds_read_b64_tr_b16 a[104:105], v213 offset:49152
  v_lshlrev_b32 v248, 16, v249
  v_and_b32 v249, 0xffff0000, v249
  v_mfma_f32_16x16x32_bf16 v[64:67], a[0:3], a[48:51], v[64:67]
  ds_read_b64_tr_b16 a[106:107], v213 offset:50176
  v_fmac_f32 v244, v246, v248
  v_fmac_f32 v244, v247, v249
  v_mfma_f32_16x16x32_bf16 v[68:71], a[4:7], a[48:51], v[68:71]
  ds_read_b64_tr_b16 a[108:109], v214 offset:49152
  v_accvgpr_read_b32 v249, a150
  v_lshlrev_b32 v248, 16, v249
  v_mfma_f32_16x16x32_bf16 v[72:75], a[8:11], a[48:51], v[72:75]
  ds_read_b64_tr_b16 a[110:111], v214 offset:50176
  v_and_b32 v249, 0xffff0000, v249
  v_fmac_f32 v245, v246, v248
  v_mfma_f32_16x16x32_bf16 v[76:79], a[12:15], a[48:51], v[76:79]
  ds_read_b64_tr_b16 a[112:113], v215 offset:51200
  v_fmac_f32 v245, v247, v249
  v_accvgpr_read_b32 v247, a159
  v_mfma_f32_16x16x32_bf16 v[92:95], a[12:15], a[52:55], v[92:95]
  ds_read_b64_tr_b16 a[114:115], v215 offset:52224
  v_lshlrev_b32 v246, 16, v247
  v_and_b32 v247, 0xffff0000, v247
  v_mfma_f32_16x16x32_bf16 v[88:91], a[8:11], a[52:55], v[88:91]
  ds_read_b64_tr_b16 a[116:117], v216 offset:51200
  v_accvgpr_read_b32 v249, a143
  v_lshlrev_b32 v248, 16, v249
  v_mfma_f32_16x16x32_bf16 v[84:87], a[4:7], a[52:55], v[84:87]
  ds_read_b64_tr_b16 a[118:119], v216 offset:52224
  v_and_b32 v249, 0xffff0000, v249
  v_fmac_f32 v244, v246, v248
  v_mfma_f32_16x16x32_bf16 v[80:83], a[0:3], a[52:55], v[80:83]
  ds_read_b64_tr_b16 a[120:121], v217 offset:51200
  v_fmac_f32 v244, v247, v249
  v_accvgpr_read_b32 v249, a151
  v_mfma_f32_16x16x32_bf16 v[96:99], a[0:3], a[56:59], v[96:99]
  ds_read_b64_tr_b16 a[122:123], v217 offset:52224
  v_lshlrev_b32 v248, 16, v249
  v_and_b32 v249, 0xffff0000, v249
  v_mfma_f32_16x16x32_bf16 v[100:103], a[4:7], a[56:59], v[100:103]
  ds_read_b64_tr_b16 a[124:125], v218 offset:51200
  v_fmac_f32 v245, v246, v248
  v_fmac_f32 v245, v247, v249
  v_mfma_f32_16x16x32_bf16 v[104:107], a[8:11], a[56:59], v[104:107]
  ds_read_b64_tr_b16 a[126:127], v218 offset:52224
  v_accvgpr_read_b32 v247, a160
  v_lshlrev_b32 v246, 16, v247
  v_mfma_f32_16x16x32_bf16 v[108:111], a[12:15], a[56:59], v[108:111]
  ds_read_b64_tr_b16 a[128:129], v219 offset:51200
  v_and_b32 v247, 0xffff0000, v247
  v_accvgpr_read_b32 v249, a144
  v_mfma_f32_16x16x32_bf16 v[124:127], a[60:63], a[12:15], v[124:127]
  ds_read_b64_tr_b16 a[130:131], v219 offset:52224
  v_lshlrev_b32 v248, 16, v249
  v_and_b32 v249, 0xffff0000, v249
  v_mfma_f32_16x16x32_bf16 v[120:123], a[60:63], a[8:11], v[120:123]
  ds_read_b64_tr_b16 a[132:133], v220 offset:51200
  v_fmac_f32 v244, v246, v248
  v_fmac_f32 v244, v247, v249
  v_mfma_f32_16x16x32_bf16 v[116:119], a[60:63], a[4:7], v[116:119]
  ds_read_b64_tr_b16 a[134:135], v220 offset:52224
  v_accvgpr_read_b32 v249, a152
  v_lshlrev_b32 v248, 16, v249
  v_mfma_f32_16x16x32_bf16 v[112:115], a[60:63], a[0:3], v[112:115]
  v_and_b32 v249, 0xffff0000, v249
  v_fmac_f32 v245, v246, v248
  v_mfma_f32_16x16x32_bf16 v[128:131], a[64:67], a[0:3], v[128:131]
  v_fmac_f32 v245, v247, v249
  v_accvgpr_read_b32 v247, a161
  v_mfma_f32_16x16x32_bf16 v[132:135], a[64:67], a[4:7], v[132:135]
  v_lshlrev_b32 v246, 16, v247
  v_and_b32 v247, 0xffff0000, v247
  v_mfma_f32_16x16x32_bf16 v[136:139], a[64:67], a[8:11], v[136:139]
  v_accvgpr_read_b32 v249, a145
  v_lshlrev_b32 v248, 16, v249
  v_mfma_f32_16x16x32_bf16 v[140:143], a[64:67], a[12:15], v[140:143]
  v_and_b32 v249, 0xffff0000, v249
  v_fmac_f32 v244, v246, v248
  v_mfma_f32_16x16x32_bf16 v[156:159], a[68:71], a[12:15], v[156:159]
  v_fmac_f32 v244, v247, v249
  v_accvgpr_read_b32 v249, a153
  v_mfma_f32_16x16x32_bf16 v[152:155], a[68:71], a[8:11], v[152:155]
  v_lshlrev_b32 v248, 16, v249
  v_and_b32 v249, 0xffff0000, v249
  v_mfma_f32_16x16x32_bf16 v[148:151], a[68:71], a[4:7], v[148:151]
  v_fmac_f32 v245, v246, v248
  v_fmac_f32 v245, v247, v249
  v_mfma_f32_16x16x32_bf16 v[144:147], a[68:71], a[0:3], v[144:147]
  v_accvgpr_read_b32 v247, a162
  v_lshlrev_b32 v246, 16, v247
  v_mfma_f32_16x16x32_bf16 v[160:163], a[72:75], a[0:3], v[160:163]
  v_and_b32 v247, 0xffff0000, v247
  v_accvgpr_read_b32 v249, a146
  v_mfma_f32_16x16x32_bf16 v[164:167], a[72:75], a[4:7], v[164:167]
  v_lshlrev_b32 v248, 16, v249
  v_and_b32 v249, 0xffff0000, v249
  v_mfma_f32_16x16x32_bf16 v[168:171], a[72:75], a[8:11], v[168:171]
  v_fmac_f32 v244, v246, v248
  v_fmac_f32 v244, v247, v249
  v_mfma_f32_16x16x32_bf16 v[172:175], a[72:75], a[12:15], v[172:175]
  v_accvgpr_read_b32 v249, a154
  v_lshlrev_b32 v248, 16, v249
  v_mfma_f32_16x16x32_bf16 v[188:191], a[76:79], a[12:15], v[188:191]
  v_and_b32 v249, 0xffff0000, v249
  v_fmac_f32 v245, v246, v248
  v_mfma_f32_16x16x32_bf16 v[184:187], a[76:79], a[8:11], v[184:187]
  v_fmac_f32 v245, v247, v249
  v_accvgpr_read_b32 v247, a163
  v_mfma_f32_16x16x32_bf16 v[180:183], a[76:79], a[4:7], v[180:183]
  v_lshlrev_b32 v246, 16, v247
  v_and_b32 v247, 0xffff0000, v247
  v_mfma_f32_16x16x32_bf16 v[176:179], a[76:79], a[0:3], v[176:179]
  v_accvgpr_read_b32 v249, a147
  v_lshlrev_b32 v248, 16, v249
  v_mfma_f32_16x16x32_bf16 v[192:195], a[80:83], a[0:3], v[192:195]
  v_and_b32 v249, 0xffff0000, v249
  v_fmac_f32 v244, v246, v248
  v_mfma_f32_16x16x32_bf16 v[196:199], a[80:83], a[4:7], v[196:199]
  v_fmac_f32 v244, v247, v249
  v_accvgpr_read_b32 v249, a155
  v_mfma_f32_16x16x32_bf16 v[200:203], a[80:83], a[8:11], v[200:203]
  v_lshlrev_b32 v248, 16, v249
  v_and_b32 v249, 0xffff0000, v249
  v_mfma_f32_16x16x32_bf16 v[204:207], a[80:83], a[12:15], v[204:207]
  v_fmac_f32 v245, v246, v248
  v_fmac_f32 v245, v247, v249
  s_waitcnt lgkmcnt(0)
  v_mfma_f32_16x16x32_bf16 v[0:3], a[16:19], a[84:87], v[0:3]
  v_add_f32_dpp v244, v244, v244 row_ror:8 row_mask:0xf bank_mask:0xf
  v_add_f32_dpp v245, v245, v245 row_ror:8 row_mask:0xf bank_mask:0xf
  v_mfma_f32_16x16x32_bf16 v[4:7], a[20:23], a[84:87], v[4:7]
  s_nop 0
  v_mfma_f32_16x16x32_bf16 v[8:11], a[24:27], a[84:87], v[8:11]
  v_add_f32_dpp v244, v244, v244 row_ror:4 row_mask:0xf bank_mask:0xf
  v_add_f32_dpp v245, v245, v245 row_ror:4 row_mask:0xf bank_mask:0xf
  v_mfma_f32_16x16x32_bf16 v[12:15], a[28:31], a[84:87], v[12:15]
  s_nop 0
  v_mfma_f32_16x16x32_bf16 v[28:31], a[28:31], a[88:91], v[28:31]
  v_add_f32_dpp v244, v244, v244 row_ror:2 row_mask:0xf bank_mask:0xf
  v_add_f32_dpp v245, v245, v245 row_ror:2 row_mask:0xf bank_mask:0xf
  v_mfma_f32_16x16x32_bf16 v[24:27], a[24:27], a[88:91], v[24:27]
  s_nop 0
  v_mfma_f32_16x16x32_bf16 v[20:23], a[20:23], a[88:91], v[20:23]
  v_add_f32_dpp v244, v244, v244 row_ror:1 row_mask:0xf bank_mask:0xf
  v_add_f32_dpp v245, v245, v245 row_ror:1 row_mask:0xf bank_mask:0xf
  v_mfma_f32_16x16x32_bf16 v[16:19], a[16:19], a[88:91], v[16:19]
  s_nop 0
  v_mfma_f32_16x16x32_bf16 v[32:35], a[16:19], a[92:95], v[32:35]
  v_readlane_b32 s24, v244, 0
  v_readlane_b32 s25, v244, 16
  v_mfma_f32_16x16x32_bf16 v[36:39], a[20:23], a[92:95], v[36:39]
  v_readlane_b32 s26, v244, 32
  v_readlane_b32 s27, v244, 48
  v_mfma_f32_16x16x32_bf16 v[40:43], a[24:27], a[92:95], v[40:43]
  v_readlane_b32 s28, v245, 0
  v_readlane_b32 s29, v245, 16
  v_mfma_f32_16x16x32_bf16 v[44:47], a[28:31], a[92:95], v[44:47]
  v_readlane_b32 s30, v245, 32
  v_readlane_b32 s31, v245, 48
  v_mfma_f32_16x16x32_bf16 v[60:63], a[28:31], a[96:99], v[60:63]
  v_cmp_eq_u32 vcc, 1, v234
  v_mfma_f32_16x16x32_bf16 v[56:59], a[24:27], a[96:99], v[56:59]
  s_nop 1
  v_mfma_f32_16x16x32_bf16 v[52:55], a[20:23], a[96:99], v[52:55]
  v_mov_b32 v246, s24
  v_mov_b32 v247, s28
  v_mfma_f32_16x16x32_bf16 v[48:51], a[16:19], a[96:99], v[48:51]
  v_add_f32 v246, s25, v246
  v_add_f32 v247, s29, v247
  v_mfma_f32_16x16x32_bf16 v[64:67], a[16:19], a[100:103], v[64:67]
  v_add_f32 v246, s26, v246
  v_add_f32 v247, s30, v247
  v_mfma_f32_16x16x32_bf16 v[68:71], a[20:23], a[100:103], v[68:71]
  v_add_f32 v246, s27, v246
  v_add_f32 v247, s31, v247
  v_mfma_f32_16x16x32_bf16 v[72:75], a[24:27], a[100:103], v[72:75]
  v_cndmask_b32 v246, v246, v247, vcc
  v_mfma_f32_16x16x32_bf16 v[76:79], a[28:31], a[100:103], v[76:79]
  v_mul_f32 v246, 0xbfb8aa3b, v246
  v_mfma_f32_16x16x32_bf16 v[92:95], a[28:31], a[104:107], v[92:95]
  v_exp_f32 v246, v246
  v_mfma_f32_16x16x32_bf16 v[88:91], a[24:27], a[104:107], v[88:91]
  v_lshlrev_b32 v236, 2, v234
  v_mov_b32 v237, 0x80000000
  v_mfma_f32_16x16x32_bf16 v[84:87], a[20:23], a[104:107], v[84:87]
  v_add_f32 v246, 1.0, v246
  v_mfma_f32_16x16x32_bf16 v[80:83], a[16:19], a[104:107], v[80:83]
  v_rcp_f32 v235, v246
  v_mfma_f32_16x16x32_bf16 v[96:99], a[16:19], a[108:111], v[96:99]
  v_cmp_lt_u32 vcc, 1, v234
  v_mfma_f32_16x16x32_bf16 v[100:103], a[20:23], a[108:111], v[100:103]
  s_lshl_b32 s31, s93, 6
  s_add_u32 s31, s31, 42991616
  v_mfma_f32_16x16x32_bf16 v[104:107], a[24:27], a[108:111], v[104:107]
  v_cndmask_b32 v236, v236, v237, vcc
  v_mfma_f32_16x16x32_bf16 v[108:111], a[28:31], a[108:111], v[108:111]
  buffer_store_dword v235, v236, s[4:7], s31 offen sc1
  v_mfma_f32_16x16x32_bf16 v[124:127], a[112:115], a[28:31], v[124:127]
  s_lshl_b32 s32, s80, 3
  v_mfma_f32_16x16x32_bf16 v[120:123], a[112:115], a[24:27], v[120:123]
  s_lshl_b32 s33, s44, 1
  v_mfma_f32_16x16x32_bf16 v[116:119], a[112:115], a[20:23], v[116:119]
  s_add_u32 s32, s32, s33
  v_mfma_f32_16x16x32_bf16 v[112:115], a[112:115], a[16:19], v[112:115]
  v_mov_b32 v254, v234
  v_mfma_f32_16x16x32_bf16 v[128:131], a[116:119], a[16:19], v[128:131]
  v_mov_b32 v255, v233
  v_mfma_f32_16x16x32_bf16 v[132:135], a[116:119], a[20:23], v[132:135]
  v_lshlrev_b32 v253, 2, v234
  v_mfma_f32_16x16x32_bf16 v[136:139], a[116:119], a[24:27], v[136:139]
  v_mov_b32 v252, 1
  v_mfma_f32_16x16x32_bf16 v[140:143], a[116:119], a[28:31], v[140:143]
  v_min_u32 v251, 1, v234
  v_mfma_f32_16x16x32_bf16 v[156:159], a[120:123], a[28:31], v[156:159]
  v_lshlrev_b32 v251, 26, v251
  v_mfma_f32_16x16x32_bf16 v[152:155], a[120:123], a[24:27], v[152:155]
  s_lshl_b32 s51, s81, 3
  v_mfma_f32_16x16x32_bf16 v[148:151], a[120:123], a[20:23], v[148:151]
  s_add_u32 s51, s51, s80
  v_mfma_f32_16x16x32_bf16 v[144:147], a[120:123], a[16:19], v[144:147]
  s_lshl_b32 s51, s51, 2
  v_mfma_f32_16x16x32_bf16 v[160:163], a[124:127], a[16:19], v[160:163]
  s_add_u32 s51, s51, s44
  v_mfma_f32_16x16x32_bf16 v[164:167], a[124:127], a[20:23], v[164:167]
  s_lshl_b32 s51, s51, 2
  v_mfma_f32_16x16x32_bf16 v[168:171], a[124:127], a[24:27], v[168:171]
  s_add_u32 s51, s51, 44052480
  v_mfma_f32_16x16x32_bf16 v[172:175], a[124:127], a[28:31], v[172:175]
  s_mov_b32 s40, 0xbdd2d3e8
  v_mfma_f32_16x16x32_bf16 v[188:191], a[128:131], a[28:31], v[188:191]
  s_mov_b32 s41, 0xbdd2d3e8
  v_mfma_f32_16x16x32_bf16 v[184:187], a[128:131], a[24:27], v[184:187]
  s_mov_b32 s42, 1.0
  v_mfma_f32_16x16x32_bf16 v[180:183], a[128:131], a[20:23], v[180:183]
  s_mov_b32 s43, 1.0
  v_mfma_f32_16x16x32_bf16 v[176:179], a[128:131], a[16:19], v[176:179]
  v_mfma_f32_16x16x32_bf16 v[192:195], a[132:135], a[16:19], v[192:195]
  v_mfma_f32_16x16x32_bf16 v[196:199], a[132:135], a[20:23], v[196:199]
  v_mfma_f32_16x16x32_bf16 v[200:203], a[132:135], a[24:27], v[200:203]
  v_mfma_f32_16x16x32_bf16 v[204:207], a[132:135], a[28:31], v[204:207]
  s_nop 7
  s_mul_i32 s34, s81, 3
  s_add_u32 s34, s34, 0
  s_lshl_b32 s35, s34, 17
  s_lshl_b32 s36, s32, 11
  s_add_u32 s35, s35, s36
  s_cmp_lt_u32 s34, 32
  s_cselect_b32 s38, 0x3e8293ee, 1.0
  s_mov_b32 s39, s38
  v_cvt_pk_bf16_f32 v212, v112, v113
  v_cvt_pk_bf16_f32 v213, v114, v115
  v_cvt_pk_bf16_f32 v214, v128, v129
  v_cvt_pk_bf16_f32 v215, v130, v131
  buffer_store_dwordx4 v[212:215], v255, s[4:7], s35 offen offset:0 sc1
  v_cvt_pk_bf16_f32 v216, v116, v117
  v_cvt_pk_bf16_f32 v217, v118, v119
  v_cvt_pk_bf16_f32 v218, v132, v133
  v_cvt_pk_bf16_f32 v219, v134, v135
  buffer_store_dwordx4 v[216:219], v255, s[4:7], s35 offen offset:1024 sc1
  v_cvt_pk_bf16_f32 v220, v120, v121
  v_cvt_pk_bf16_f32 v221, v122, v123
  v_cvt_pk_bf16_f32 v222, v136, v137
  v_cvt_pk_bf16_f32 v223, v138, v139
  buffer_store_dwordx4 v[220:223], v255, s[4:7], s35 offen offset:2048 sc1
  v_cvt_pk_bf16_f32 v208, v124, v125
  v_cvt_pk_bf16_f32 v209, v126, v127
  v_cvt_pk_bf16_f32 v210, v140, v141
  v_cvt_pk_bf16_f32 v211, v142, v143
  buffer_store_dwordx4 v[208:211], v255, s[4:7], s35 offen offset:3072 sc1
  s_mul_i32 s34, s81, 3
  s_add_u32 s34, s34, 1
  s_lshl_b32 s35, s34, 17
  s_lshl_b32 s36, s32, 11
  s_add_u32 s35, s35, s36
  s_cmp_lt_u32 s34, 32
  s_cselect_b32 s38, 0x3e8293ee, 1.0
  s_mov_b32 s39, s38
  v_cvt_pk_bf16_f32 v212, v144, v145
  v_cvt_pk_bf16_f32 v213, v146, v147
  v_cvt_pk_bf16_f32 v214, v160, v161
  v_cvt_pk_bf16_f32 v215, v162, v163
  buffer_store_dwordx4 v[212:215], v255, s[4:7], s35 offen offset:0 sc1
  v_cvt_pk_bf16_f32 v216, v148, v149
  v_cvt_pk_bf16_f32 v217, v150, v151
  v_cvt_pk_bf16_f32 v218, v164, v165
  v_cvt_pk_bf16_f32 v219, v166, v167
  buffer_store_dwordx4 v[216:219], v255, s[4:7], s35 offen offset:1024 sc1
  v_cvt_pk_bf16_f32 v220, v152, v153
  v_cvt_pk_bf16_f32 v221, v154, v155
  v_cvt_pk_bf16_f32 v222, v168, v169
  v_cvt_pk_bf16_f32 v223, v170, v171
  buffer_store_dwordx4 v[220:223], v255, s[4:7], s35 offen offset:2048 sc1
  v_cvt_pk_bf16_f32 v208, v156, v157
  v_cvt_pk_bf16_f32 v209, v158, v159
  v_cvt_pk_bf16_f32 v210, v172, v173
  v_cvt_pk_bf16_f32 v211, v174, v175
  buffer_store_dwordx4 v[208:211], v255, s[4:7], s35 offen offset:3072 sc1
  s_mul_i32 s34, s81, 3
  s_add_u32 s34, s34, 2
  s_lshl_b32 s35, s34, 17
  s_lshl_b32 s36, s32, 11
  s_add_u32 s35, s35, s36
  s_cmp_lt_u32 s34, 32
  s_cselect_b32 s38, 0x3e8293ee, 1.0
  s_mov_b32 s39, s38
  v_cvt_pk_bf16_f32 v212, v176, v177
  v_cvt_pk_bf16_f32 v213, v178, v179
  v_cvt_pk_bf16_f32 v214, v192, v193
  v_cvt_pk_bf16_f32 v215, v194, v195
  buffer_store_dwordx4 v[212:215], v255, s[4:7], s35 offen offset:0 sc1
  v_cvt_pk_bf16_f32 v216, v180, v181
  v_cvt_pk_bf16_f32 v217, v182, v183
  v_cvt_pk_bf16_f32 v218, v196, v197
  v_cvt_pk_bf16_f32 v219, v198, v199
  buffer_store_dwordx4 v[216:219], v255, s[4:7], s35 offen offset:1024 sc1
  v_cvt_pk_bf16_f32 v220, v184, v185
  v_cvt_pk_bf16_f32 v221, v186, v187
  v_cvt_pk_bf16_f32 v222, v200, v201
  v_cvt_pk_bf16_f32 v223, v202, v203
  buffer_store_dwordx4 v[220:223], v255, s[4:7], s35 offen offset:2048 sc1
  v_cvt_pk_bf16_f32 v208, v188, v189
  v_cvt_pk_bf16_f32 v209, v190, v191
  v_cvt_pk_bf16_f32 v210, v204, v205
  v_cvt_pk_bf16_f32 v211, v206, v207
  buffer_store_dwordx4 v[208:211], v255, s[4:7], s35 offen offset:3072 sc1
  s_branch gated_mix__mha_block__mixer_gmlp__prompt_kernel_z2ep
.p2align 6
gated_mix__mha_block__mixer_gmlp__prompt_kernel_v2:
  s_mov_b32 s89, 7
gated_mix__mha_block__mixer_gmlp__prompt_kernel_v2_loop:
  v_mfma_f32_16x16x32_bf16 v[0:3], a[0:3], a[32:35], v[0:3]
  v_add_u32 v221, s85, v224
  v_mfma_f32_16x16x32_bf16 v[4:7], a[4:7], a[32:35], v[4:7]
  ds_read_b128 a[16:19], v221 offset:0
  v_mfma_f32_16x16x32_bf16 v[8:11], a[8:11], a[32:35], v[8:11]
  ds_read_b128 a[20:23], v221 offset:512
  v_mfma_f32_16x16x32_bf16 v[12:15], a[12:15], a[32:35], v[12:15]
  ds_read_b128 a[24:27], v221 offset:4096
  v_mfma_f32_16x16x32_bf16 v[28:31], a[12:15], a[36:39], v[28:31]
  s_add_u32 m0, s88, 0
  v_mfma_f32_16x16x32_bf16 v[24:27], a[8:11], a[36:39], v[24:27]
  ds_read_b128 a[28:31], v221 offset:4608
  v_mfma_f32_16x16x32_bf16 v[20:23], a[4:7], a[36:39], v[20:23]
  ds_read_b64_tr_b16 a[84:85], v208 offset:16384
  v_mfma_f32_16x16x32_bf16 v[16:19], a[0:3], a[36:39], v[16:19]
  ds_read_b64_tr_b16 a[86:87], v208 offset:17408
  v_mfma_f32_16x16x32_bf16 v[32:35], a[0:3], a[40:43], v[32:35]
  buffer_load_dwordx4 v229, s[12:15], s83 offen lds
  v_mfma_f32_16x16x32_bf16 v[36:39], a[4:7], a[40:43], v[36:39]
  ds_read_b64_tr_b16 a[88:89], v209 offset:16384
  v_mfma_f32_16x16x32_bf16 v[40:43], a[8:11], a[40:43], v[40:43]
  ds_read_b64_tr_b16 a[90:91], v209 offset:17408
  v_mfma_f32_16x16x32_bf16 v[44:47], a[12:15], a[40:43], v[44:47]
  ds_read_b64_tr_b16 a[92:93], v210 offset:16384
  v_mfma_f32_16x16x32_bf16 v[60:63], a[12:15], a[44:47], v[60:63]
  buffer_load_dwordx4 v230, s[12:15], s83 offen offset:1024 lds
  v_mfma_f32_16x16x32_bf16 v[56:59], a[8:11], a[44:47], v[56:59]
  ds_read_b64_tr_b16 a[94:95], v210 offset:17408
  v_mfma_f32_16x16x32_bf16 v[52:55], a[4:7], a[44:47], v[52:55]
  ds_read_b64_tr_b16 a[96:97], v211 offset:16384
  v_mfma_f32_16x16x32_bf16 v[48:51], a[0:3], a[44:47], v[48:51]
  ds_read_b64_tr_b16 a[98:99], v211 offset:17408
  v_mfma_f32_16x16x32_bf16 v[64:67], a[0:3], a[48:51], v[64:67]
  s_add_u32 m0, s88, 2048
  v_mfma_f32_16x16x32_bf16 v[68:71], a[4:7], a[48:51], v[68:71]
  ds_read_b64_tr_b16 a[100:101], v212 offset:16384
  v_mfma_f32_16x16x32_bf16 v[72:75], a[8:11], a[48:51], v[72:75]
  ds_read_b64_tr_b16 a[102:103], v212 offset:17408
  v_mfma_f32_16x16x32_bf16 v[76:79], a[12:15], a[48:51], v[76:79]
  ds_read_b64_tr_b16 a[104:105], v213 offset:16384
  v_mfma_f32_16x16x32_bf16 v[92:95], a[12:15], a[52:55], v[92:95]
  buffer_load_dwordx4 v231, s[16:19], s84 offen lds
  v_mfma_f32_16x16x32_bf16 v[88:91], a[8:11], a[52:55], v[88:91]
  ds_read_b64_tr_b16 a[106:107], v213 offset:17408
  v_mfma_f32_16x16x32_bf16 v[84:87], a[4:7], a[52:55], v[84:87]
  ds_read_b64_tr_b16 a[108:109], v214 offset:16384
  v_mfma_f32_16x16x32_bf16 v[80:83], a[0:3], a[52:55], v[80:83]
  ds_read_b64_tr_b16 a[110:111], v214 offset:17408
  v_mfma_f32_16x16x32_bf16 v[96:99], a[0:3], a[56:59], v[96:99]
  buffer_load_dwordx4 v232, s[16:19], s84 offen offset:1024 lds
  v_mfma_f32_16x16x32_bf16 v[100:103], a[4:7], a[56:59], v[100:103]
  ds_read_b64_tr_b16 a[112:113], v215 offset:18432
  v_mfma_f32_16x16x32_bf16 v[104:107], a[8:11], a[56:59], v[104:107]
  ds_read_b64_tr_b16 a[114:115], v215 offset:19456
  v_mfma_f32_16x16x32_bf16 v[108:111], a[12:15], a[56:59], v[108:111]
  ds_read_b64_tr_b16 a[116:117], v216 offset:18432
  v_mfma_f32_16x16x32_bf16 v[124:127], a[60:63], a[12:15], v[124:127]
  s_add_u32 m0, s87, 4096
  v_mfma_f32_16x16x32_bf16 v[120:123], a[60:63], a[8:11], v[120:123]
  ds_read_b64_tr_b16 a[118:119], v216 offset:19456
  v_mfma_f32_16x16x32_bf16 v[116:119], a[60:63], a[4:7], v[116:119]
  ds_read_b64_tr_b16 a[120:121], v217 offset:18432
  v_mfma_f32_16x16x32_bf16 v[112:115], a[60:63], a[0:3], v[112:115]
  ds_read_b64_tr_b16 a[122:123], v217 offset:19456
  v_mfma_f32_16x16x32_bf16 v[128:131], a[64:67], a[0:3], v[128:131]
  buffer_load_dwordx4 v225, s[8:11], s82 offen offset:0 lds
  v_mfma_f32_16x16x32_bf16 v[132:135], a[64:67], a[4:7], v[132:135]
  ds_read_b64_tr_b16 a[124:125], v218 offset:18432
  v_mfma_f32_16x16x32_bf16 v[136:139], a[64:67], a[8:11], v[136:139]
  ds_read_b64_tr_b16 a[126:127], v218 offset:19456
  v_mfma_f32_16x16x32_bf16 v[140:143], a[64:67], a[12:15], v[140:143]
  ds_read_b64_tr_b16 a[128:129], v219 offset:18432
  v_mfma_f32_16x16x32_bf16 v[156:159], a[12:15], a[68:71], v[156:159]
  buffer_load_dwordx4 v226, s[8:11], s82 offen offset:1024 lds
  v_mfma_f32_16x16x32_bf16 v[152:155], a[8:11], a[68:71], v[152:155]
  ds_read_b64_tr_b16 a[130:131], v219 offset:19456
  v_mfma_f32_16x16x32_bf16 v[148:151], a[4:7], a[68:71], v[148:151]
  ds_read_b64_tr_b16 a[132:133], v220 offset:18432
  v_mfma_f32_16x16x32_bf16 v[144:147], a[0:3], a[68:71], v[144:147]
  ds_read_b64_tr_b16 a[134:135], v220 offset:19456
  v_mfma_f32_16x16x32_bf16 v[160:163], a[0:3], a[72:75], v[160:163]
  buffer_load_dwordx4 v227, s[8:11], s82 offen offset:2048 lds
  v_mfma_f32_16x16x32_bf16 v[164:167], a[4:7], a[72:75], v[164:167]
  buffer_load_dwordx4 v228, s[8:11], s82 offen offset:3072 lds
  v_mfma_f32_16x16x32_bf16 v[168:171], a[8:11], a[72:75], v[168:171]
  buffer_load_dwordx4 a[232:235], v252, s[64:67], s90 offen
  v_mfma_f32_16x16x32_bf16 v[172:175], a[12:15], a[72:75], v[172:175]
  s_add_u32 s83, s83, 229376
  v_mfma_f32_16x16x32_bf16 v[188:191], a[12:15], a[76:79], v[188:191]
  s_add_u32 s84, s84, 196608
  v_mfma_f32_16x16x32_bf16 v[184:187], a[8:11], a[76:79], v[184:187]
  s_sub_u32 s82, s82, 65408
  v_mfma_f32_16x16x32_bf16 v[180:183], a[4:7], a[76:79], v[180:183]
  s_sub_u32 s89, s89, 1
  v_mfma_f32_16x16x32_bf16 v[176:179], a[0:3], a[76:79], v[176:179]
  v_mfma_f32_16x16x32_bf16 v[192:195], a[0:3], a[80:83], v[192:195]
  v_mfma_f32_16x16x32_bf16 v[196:199], a[4:7], a[80:83], v[196:199]
  v_mfma_f32_16x16x32_bf16 v[200:203], a[8:11], a[80:83], v[200:203]
  v_mfma_f32_16x16x32_bf16 v[204:207], a[12:15], a[80:83], v[204:207]
  s_waitcnt vmcnt(19) lgkmcnt(0)
  s_barrier
  v_mfma_f32_16x16x32_bf16 v[0:3], a[16:19], a[84:87], v[0:3]
  v_add_u32 v221, s86, v223
  v_mfma_f32_16x16x32_bf16 v[4:7], a[20:23], a[84:87], v[4:7]
  ds_read_b128 a[0:3], v221 offset:0
  v_mfma_f32_16x16x32_bf16 v[8:11], a[24:27], a[84:87], v[8:11]
  ds_read_b128 a[4:7], v221 offset:512
  v_mfma_f32_16x16x32_bf16 v[12:15], a[28:31], a[84:87], v[12:15]
  ds_read_b128 a[8:11], v221 offset:4096
  v_mfma_f32_16x16x32_bf16 v[28:31], a[28:31], a[88:91], v[28:31]
  s_add_u32 m0, s88, 16384
  v_mfma_f32_16x16x32_bf16 v[24:27], a[24:27], a[88:91], v[24:27]
  ds_read_b128 a[12:15], v221 offset:4608
  v_mfma_f32_16x16x32_bf16 v[20:23], a[20:23], a[88:91], v[20:23]
  ds_read_b64_tr_b16 a[32:33], v208 offset:32768
  v_mfma_f32_16x16x32_bf16 v[16:19], a[16:19], a[88:91], v[16:19]
  ds_read_b64_tr_b16 a[34:35], v208 offset:33792
  v_mfma_f32_16x16x32_bf16 v[32:35], a[16:19], a[92:95], v[32:35]
  buffer_load_dwordx4 v229, s[12:15], s83 offen lds
  v_mfma_f32_16x16x32_bf16 v[36:39], a[20:23], a[92:95], v[36:39]
  ds_read_b64_tr_b16 a[36:37], v209 offset:32768
  v_mfma_f32_16x16x32_bf16 v[40:43], a[24:27], a[92:95], v[40:43]
  ds_read_b64_tr_b16 a[38:39], v209 offset:33792
  v_mfma_f32_16x16x32_bf16 v[44:47], a[28:31], a[92:95], v[44:47]
  ds_read_b64_tr_b16 a[40:41], v210 offset:32768
  v_mfma_f32_16x16x32_bf16 v[60:63], a[28:31], a[96:99], v[60:63]
  buffer_load_dwordx4 v230, s[12:15], s83 offen offset:1024 lds
  v_mfma_f32_16x16x32_bf16 v[56:59], a[24:27], a[96:99], v[56:59]
  ds_read_b64_tr_b16 a[42:43], v210 offset:33792
  v_mfma_f32_16x16x32_bf16 v[52:55], a[20:23], a[96:99], v[52:55]
  ds_read_b64_tr_b16 a[44:45], v211 offset:32768
  v_mfma_f32_16x16x32_bf16 v[48:51], a[16:19], a[96:99], v[48:51]
  ds_read_b64_tr_b16 a[46:47], v211 offset:33792
  v_mfma_f32_16x16x32_bf16 v[64:67], a[16:19], a[100:103], v[64:67]
  s_add_u32 m0, s88, 18432
  v_mfma_f32_16x16x32_bf16 v[68:71], a[20:23], a[100:103], v[68:71]
  ds_read_b64_tr_b16 a[48:49], v212 offset:32768
  v_mfma_f32_16x16x32_bf16 v[72:75], a[24:27], a[100:103], v[72:75]
  ds_read_b64_tr_b16 a[50:51], v212 offset:33792
  v_mfma_f32_16x16x32_bf16 v[76:79], a[28:31], a[100:103], v[76:79]
  ds_read_b64_tr_b16 a[52:53], v213 offset:32768
  v_mfma_f32_16x16x32_bf16 v[92:95], a[28:31], a[104:107], v[92:95]
  buffer_load_dwordx4 v231, s[16:19], s84 offen lds
  v_mfma_f32_16x16x32_bf16 v[88:91], a[24:27], a[104:107], v[88:91]
  ds_read_b64_tr_b16 a[54:55], v213 offset:33792
  v_mfma_f32_16x16x32_bf16 v[84:87], a[20:23], a[104:107], v[84:87]
  ds_read_b64_tr_b16 a[56:57], v214 offset:32768
  v_mfma_f32_16x16x32_bf16 v[80:83], a[16:19], a[104:107], v[80:83]
  ds_read_b64_tr_b16 a[58:59], v214 offset:33792
  v_mfma_f32_16x16x32_bf16 v[96:99], a[16:19], a[108:111], v[96:99]
  buffer_load_dwordx4 v232, s[16:19], s84 offen offset:1024 lds
  v_mfma_f32_16x16x32_bf16 v[100:103], a[20:23], a[108:111], v[100:103]
  ds_read_b64_tr_b16 a[60:61], v215 offset:34816
  v_mfma_f32_16x16x32_bf16 v[104:107], a[24:27], a[108:111], v[104:107]
  ds_read_b64_tr_b16 a[62:63], v215 offset:35840
  v_mfma_f32_16x16x32_bf16 v[108:111], a[28:31], a[108:111], v[108:111]
  ds_read_b64_tr_b16 a[64:65], v216 offset:34816
  v_mfma_f32_16x16x32_bf16 v[124:127], a[112:115], a[28:31], v[124:127]
  s_add_u32 m0, s85, 0
  v_mfma_f32_16x16x32_bf16 v[120:123], a[112:115], a[24:27], v[120:123]
  ds_read_b64_tr_b16 a[66:67], v216 offset:35840
  v_mfma_f32_16x16x32_bf16 v[116:119], a[112:115], a[20:23], v[116:119]
  ds_read_b64_tr_b16 a[68:69], v217 offset:34816
  v_mfma_f32_16x16x32_bf16 v[112:115], a[112:115], a[16:19], v[112:115]
  ds_read_b64_tr_b16 a[70:71], v217 offset:35840
  v_mfma_f32_16x16x32_bf16 v[128:131], a[116:119], a[16:19], v[128:131]
  buffer_load_dwordx4 v225, s[8:11], s82 offen offset:0 lds
  v_mfma_f32_16x16x32_bf16 v[132:135], a[116:119], a[20:23], v[132:135]
  ds_read_b64_tr_b16 a[72:73], v218 offset:34816
  v_mfma_f32_16x16x32_bf16 v[136:139], a[116:119], a[24:27], v[136:139]
  ds_read_b64_tr_b16 a[74:75], v218 offset:35840
  v_mfma_f32_16x16x32_bf16 v[140:143], a[116:119], a[28:31], v[140:143]
  ds_read_b64_tr_b16 a[76:77], v219 offset:34816
  v_mfma_f32_16x16x32_bf16 v[156:159], a[28:31], a[120:123], v[156:159]
  buffer_load_dwordx4 v226, s[8:11], s82 offen offset:1024 lds
  v_mfma_f32_16x16x32_bf16 v[152:155], a[24:27], a[120:123], v[152:155]
  ds_read_b64_tr_b16 a[78:79], v219 offset:35840
  v_mfma_f32_16x16x32_bf16 v[148:151], a[20:23], a[120:123], v[148:151]
  ds_read_b64_tr_b16 a[80:81], v220 offset:34816
  v_mfma_f32_16x16x32_bf16 v[144:147], a[16:19], a[120:123], v[144:147]
  ds_read_b64_tr_b16 a[82:83], v220 offset:35840
  v_mfma_f32_16x16x32_bf16 v[160:163], a[16:19], a[124:127], v[160:163]
  buffer_load_dwordx4 v227, s[8:11], s82 offen offset:2048 lds
  v_mfma_f32_16x16x32_bf16 v[164:167], a[20:23], a[124:127], v[164:167]
  buffer_load_dwordx4 v228, s[8:11], s82 offen offset:3072 lds
  v_mfma_f32_16x16x32_bf16 v[168:171], a[24:27], a[124:127], v[168:171]
  buffer_load_dwordx4 a[232:235], v253, s[68:71], s91 offen
  v_mfma_f32_16x16x32_bf16 v[172:175], a[28:31], a[124:127], v[172:175]
  s_add_u32 s83, s83, 229376
  v_mfma_f32_16x16x32_bf16 v[188:191], a[28:31], a[128:131], v[188:191]
  s_add_u32 s84, s84, 196608
  v_mfma_f32_16x16x32_bf16 v[184:187], a[24:27], a[128:131], v[184:187]
  s_add_u32 s82, s82, 65536
  v_mfma_f32_16x16x32_bf16 v[180:183], a[20:23], a[128:131], v[180:183]
  v_mfma_f32_16x16x32_bf16 v[176:179], a[16:19], a[128:131], v[176:179]
  v_mfma_f32_16x16x32_bf16 v[192:195], a[16:19], a[132:135], v[192:195]
  v_mfma_f32_16x16x32_bf16 v[196:199], a[20:23], a[132:135], v[196:199]
  v_mfma_f32_16x16x32_bf16 v[200:203], a[24:27], a[132:135], v[200:203]
  v_mfma_f32_16x16x32_bf16 v[204:207], a[28:31], a[132:135], v[204:207]
  s_waitcnt vmcnt(19) lgkmcnt(0)
  s_barrier
  v_mfma_f32_16x16x32_bf16 v[0:3], a[0:3], a[32:35], v[0:3]
  v_add_u32 v221, s86, v224
  v_mfma_f32_16x16x32_bf16 v[4:7], a[4:7], a[32:35], v[4:7]
  ds_read_b128 a[16:19], v221 offset:0
  v_mfma_f32_16x16x32_bf16 v[8:11], a[8:11], a[32:35], v[8:11]
  ds_read_b128 a[20:23], v221 offset:512
  v_mfma_f32_16x16x32_bf16 v[12:15], a[12:15], a[32:35], v[12:15]
  ds_read_b128 a[24:27], v221 offset:4096
  v_mfma_f32_16x16x32_bf16 v[28:31], a[12:15], a[36:39], v[28:31]
  s_add_u32 m0, s88, 32768
  v_mfma_f32_16x16x32_bf16 v[24:27], a[8:11], a[36:39], v[24:27]
  ds_read_b128 a[28:31], v221 offset:4608
  v_mfma_f32_16x16x32_bf16 v[20:23], a[4:7], a[36:39], v[20:23]
  ds_read_b64_tr_b16 a[84:85], v208 offset:49152
  v_mfma_f32_16x16x32_bf16 v[16:19], a[0:3], a[36:39], v[16:19]
  ds_read_b64_tr_b16 a[86:87], v208 offset:50176
  v_mfma_f32_16x16x32_bf16 v[32:35], a[0:3], a[40:43], v[32:35]
  buffer_load_dwordx4 v229, s[12:15], s83 offen lds
  v_mfma_f32_16x16x32_bf16 v[36:39], a[4:7], a[40:43], v[36:39]
  ds_read_b64_tr_b16 a[88:89], v209 offset:49152
  v_mfma_f32_16x16x32_bf16 v[40:43], a[8:11], a[40:43], v[40:43]
  ds_read_b64_tr_b16 a[90:91], v209 offset:50176
  v_mfma_f32_16x16x32_bf16 v[44:47], a[12:15], a[40:43], v[44:47]
  ds_read_b64_tr_b16 a[92:93], v210 offset:49152
  v_mfma_f32_16x16x32_bf16 v[60:63], a[12:15], a[44:47], v[60:63]
  buffer_load_dwordx4 v230, s[12:15], s83 offen offset:1024 lds
  v_mfma_f32_16x16x32_bf16 v[56:59], a[8:11], a[44:47], v[56:59]
  ds_read_b64_tr_b16 a[94:95], v210 offset:50176
  v_mfma_f32_16x16x32_bf16 v[52:55], a[4:7], a[44:47], v[52:55]
  ds_read_b64_tr_b16 a[96:97], v211 offset:49152
  v_mfma_f32_16x16x32_bf16 v[48:51], a[0:3], a[44:47], v[48:51]
  ds_read_b64_tr_b16 a[98:99], v211 offset:50176
  v_mfma_f32_16x16x32_bf16 v[64:67], a[0:3], a[48:51], v[64:67]
  s_add_u32 m0, s88, 34816
  v_mfma_f32_16x16x32_bf16 v[68:71], a[4:7], a[48:51], v[68:71]
  ds_read_b64_tr_b16 a[100:101], v212 offset:49152
  v_mfma_f32_16x16x32_bf16 v[72:75], a[8:11], a[48:51], v[72:75]
  ds_read_b64_tr_b16 a[102:103], v212 offset:50176
  v_mfma_f32_16x16x32_bf16 v[76:79], a[12:15], a[48:51], v[76:79]
  ds_read_b64_tr_b16 a[104:105], v213 offset:49152
  v_mfma_f32_16x16x32_bf16 v[92:95], a[12:15], a[52:55], v[92:95]
  buffer_load_dwordx4 v231, s[16:19], s84 offen lds
  v_mfma_f32_16x16x32_bf16 v[88:91], a[8:11], a[52:55], v[88:91]
  ds_read_b64_tr_b16 a[106:107], v213 offset:50176
  v_mfma_f32_16x16x32_bf16 v[84:87], a[4:7], a[52:55], v[84:87]
  ds_read_b64_tr_b16 a[108:109], v214 offset:49152
  v_mfma_f32_16x16x32_bf16 v[80:83], a[0:3], a[52:55], v[80:83]
  ds_read_b64_tr_b16 a[110:111], v214 offset:50176
  v_mfma_f32_16x16x32_bf16 v[96:99], a[0:3], a[56:59], v[96:99]
  buffer_load_dwordx4 v232, s[16:19], s84 offen offset:1024 lds
  v_mfma_f32_16x16x32_bf16 v[100:103], a[4:7], a[56:59], v[100:103]
  ds_read_b64_tr_b16 a[112:113], v215 offset:51200
  v_mfma_f32_16x16x32_bf16 v[104:107], a[8:11], a[56:59], v[104:107]
  ds_read_b64_tr_b16 a[114:115], v215 offset:52224
  v_mfma_f32_16x16x32_bf16 v[108:111], a[12:15], a[56:59], v[108:111]
  ds_read_b64_tr_b16 a[116:117], v216 offset:51200
  v_mfma_f32_16x16x32_bf16 v[124:127], a[60:63], a[12:15], v[124:127]
  s_add_u32 m0, s85, 4096
  v_mfma_f32_16x16x32_bf16 v[120:123], a[60:63], a[8:11], v[120:123]
  ds_read_b64_tr_b16 a[118:119], v216 offset:52224
  v_mfma_f32_16x16x32_bf16 v[116:119], a[60:63], a[4:7], v[116:119]
  ds_read_b64_tr_b16 a[120:121], v217 offset:51200
  v_mfma_f32_16x16x32_bf16 v[112:115], a[60:63], a[0:3], v[112:115]
  ds_read_b64_tr_b16 a[122:123], v217 offset:52224
  v_mfma_f32_16x16x32_bf16 v[128:131], a[64:67], a[0:3], v[128:131]
  buffer_load_dwordx4 v225, s[8:11], s82 offen offset:0 lds
  v_mfma_f32_16x16x32_bf16 v[132:135], a[64:67], a[4:7], v[132:135]
  ds_read_b64_tr_b16 a[124:125], v218 offset:51200
  v_mfma_f32_16x16x32_bf16 v[136:139], a[64:67], a[8:11], v[136:139]
  ds_read_b64_tr_b16 a[126:127], v218 offset:52224
  v_mfma_f32_16x16x32_bf16 v[140:143], a[64:67], a[12:15], v[140:143]
  ds_read_b64_tr_b16 a[128:129], v219 offset:51200
  v_mfma_f32_16x16x32_bf16 v[156:159], a[12:15], a[68:71], v[156:159]
  buffer_load_dwordx4 v226, s[8:11], s82 offen offset:1024 lds
  v_mfma_f32_16x16x32_bf16 v[152:155], a[8:11], a[68:71], v[152:155]
  ds_read_b64_tr_b16 a[130:131], v219 offset:52224
  v_mfma_f32_16x16x32_bf16 v[148:151], a[4:7], a[68:71], v[148:151]
  ds_read_b64_tr_b16 a[132:133], v220 offset:51200
  v_mfma_f32_16x16x32_bf16 v[144:147], a[0:3], a[68:71], v[144:147]
  ds_read_b64_tr_b16 a[134:135], v220 offset:52224
  v_mfma_f32_16x16x32_bf16 v[160:163], a[0:3], a[72:75], v[160:163]
  buffer_load_dwordx4 v227, s[8:11], s82 offen offset:2048 lds
  v_mfma_f32_16x16x32_bf16 v[164:167], a[4:7], a[72:75], v[164:167]
  buffer_load_dwordx4 v228, s[8:11], s82 offen offset:3072 lds
  v_mfma_f32_16x16x32_bf16 v[168:171], a[8:11], a[72:75], v[168:171]
  buffer_load_dwordx4 a[232:235], v254, s[64:67], s90 offen
  v_mfma_f32_16x16x32_bf16 v[172:175], a[12:15], a[72:75], v[172:175]
  s_add_u32 s83, s83, 229376
  v_mfma_f32_16x16x32_bf16 v[188:191], a[12:15], a[76:79], v[188:191]
  s_add_u32 s84, s84, 196608
  v_mfma_f32_16x16x32_bf16 v[184:187], a[8:11], a[76:79], v[184:187]
  s_sub_u32 s82, s82, 65408
  v_mfma_f32_16x16x32_bf16 v[180:183], a[4:7], a[76:79], v[180:183]
  s_add_u32 s90, s90, 2097152
  v_mfma_f32_16x16x32_bf16 v[176:179], a[0:3], a[76:79], v[176:179]
  s_min_u32 s90, s90, s28
  v_mfma_f32_16x16x32_bf16 v[192:195], a[0:3], a[80:83], v[192:195]
  v_mfma_f32_16x16x32_bf16 v[196:199], a[4:7], a[80:83], v[196:199]
  v_mfma_f32_16x16x32_bf16 v[200:203], a[8:11], a[80:83], v[200:203]
  v_mfma_f32_16x16x32_bf16 v[204:207], a[12:15], a[80:83], v[204:207]
  s_waitcnt vmcnt(19) lgkmcnt(0)
  s_barrier
  v_mfma_f32_16x16x32_bf16 v[0:3], a[16:19], a[84:87], v[0:3]
  v_add_u32 v221, s87, v223
  v_mfma_f32_16x16x32_bf16 v[4:7], a[20:23], a[84:87], v[4:7]
  ds_read_b128 a[0:3], v221 offset:0
  v_mfma_f32_16x16x32_bf16 v[8:11], a[24:27], a[84:87], v[8:11]
  ds_read_b128 a[4:7], v221 offset:512
  v_mfma_f32_16x16x32_bf16 v[12:15], a[28:31], a[84:87], v[12:15]
  ds_read_b128 a[8:11], v221 offset:4096
  v_mfma_f32_16x16x32_bf16 v[28:31], a[28:31], a[88:91], v[28:31]
  s_add_u32 m0, s88, 49152
  v_mfma_f32_16x16x32_bf16 v[24:27], a[24:27], a[88:91], v[24:27]
  ds_read_b128 a[12:15], v221 offset:4608
  v_mfma_f32_16x16x32_bf16 v[20:23], a[20:23], a[88:91], v[20:23]
  ds_read_b64_tr_b16 a[32:33], v208 offset:0
  v_mfma_f32_16x16x32_bf16 v[16:19], a[16:19], a[88:91], v[16:19]
  ds_read_b64_tr_b16 a[34:35], v208 offset:1024
  v_mfma_f32_16x16x32_bf16 v[32:35], a[16:19], a[92:95], v[32:35]
  buffer_load_dwordx4 v229, s[12:15], s83 offen lds
  v_mfma_f32_16x16x32_bf16 v[36:39], a[20:23], a[92:95], v[36:39]
  ds_read_b64_tr_b16 a[36:37], v209 offset:0
  v_mfma_f32_16x16x32_bf16 v[40:43], a[24:27], a[92:95], v[40:43]
  ds_read_b64_tr_b16 a[38:39], v209 offset:1024
  v_mfma_f32_16x16x32_bf16 v[44:47], a[28:31], a[92:95], v[44:47]
  ds_read_b64_tr_b16 a[40:41], v210 offset:0
  v_mfma_f32_16x16x32_bf16 v[60:63], a[28:31], a[96:99], v[60:63]
  buffer_load_dwordx4 v230, s[12:15], s83 offen offset:1024 lds
  v_mfma_f32_16x16x32_bf16 v[56:59], a[24:27], a[96:99], v[56:59]
  ds_read_b64_tr_b16 a[42:43], v210 offset:1024
  v_mfma_f32_16x16x32_bf16 v[52:55], a[20:23], a[96:99], v[52:55]
  ds_read_b64_tr_b16 a[44:45], v211 offset:0
  v_mfma_f32_16x16x32_bf16 v[48:51], a[16:19], a[96:99], v[48:51]
  ds_read_b64_tr_b16 a[46:47], v211 offset:1024
  v_mfma_f32_16x16x32_bf16 v[64:67], a[16:19], a[100:103], v[64:67]
  s_add_u32 m0, s88, 51200
  v_mfma_f32_16x16x32_bf16 v[68:71], a[20:23], a[100:103], v[68:71]
  ds_read_b64_tr_b16 a[48:49], v212 offset:0
  v_mfma_f32_16x16x32_bf16 v[72:75], a[24:27], a[100:103], v[72:75]
  ds_read_b64_tr_b16 a[50:51], v212 offset:1024
  v_mfma_f32_16x16x32_bf16 v[76:79], a[28:31], a[100:103], v[76:79]
  ds_read_b64_tr_b16 a[52:53], v213 offset:0
  v_mfma_f32_16x16x32_bf16 v[92:95], a[28:31], a[104:107], v[92:95]
  buffer_load_dwordx4 v231, s[16:19], s84 offen lds
  v_mfma_f32_16x16x32_bf16 v[88:91], a[24:27], a[104:107], v[88:91]
  ds_read_b64_tr_b16 a[54:55], v213 offset:1024
  v_mfma_f32_16x16x32_bf16 v[84:87], a[20:23], a[104:107], v[84:87]
  ds_read_b64_tr_b16 a[56:57], v214 offset:0
  v_mfma_f32_16x16x32_bf16 v[80:83], a[16:19], a[104:107], v[80:83]
  ds_read_b64_tr_b16 a[58:59], v214 offset:1024
  v_mfma_f32_16x16x32_bf16 v[96:99], a[16:19], a[108:111], v[96:99]
  buffer_load_dwordx4 v232, s[16:19], s84 offen offset:1024 lds
  v_mfma_f32_16x16x32_bf16 v[100:103], a[20:23], a[108:111], v[100:103]
  ds_read_b64_tr_b16 a[60:61], v215 offset:2048
  v_mfma_f32_16x16x32_bf16 v[104:107], a[24:27], a[108:111], v[104:107]
  ds_read_b64_tr_b16 a[62:63], v215 offset:3072
  v_mfma_f32_16x16x32_bf16 v[108:111], a[28:31], a[108:111], v[108:111]
  ds_read_b64_tr_b16 a[64:65], v216 offset:2048
  v_mfma_f32_16x16x32_bf16 v[124:127], a[112:115], a[28:31], v[124:127]
  s_add_u32 m0, s86, 0
  v_mfma_f32_16x16x32_bf16 v[120:123], a[112:115], a[24:27], v[120:123]
  ds_read_b64_tr_b16 a[66:67], v216 offset:3072
  v_mfma_f32_16x16x32_bf16 v[116:119], a[112:115], a[20:23], v[116:119]
  ds_read_b64_tr_b16 a[68:69], v217 offset:2048
  v_mfma_f32_16x16x32_bf16 v[112:115], a[112:115], a[16:19], v[112:115]
  ds_read_b64_tr_b16 a[70:71], v217 offset:3072
  v_mfma_f32_16x16x32_bf16 v[128:131], a[116:119], a[16:19], v[128:131]
  buffer_load_dwordx4 v225, s[8:11], s82 offen offset:0 lds
  v_mfma_f32_16x16x32_bf16 v[132:135], a[116:119], a[20:23], v[132:135]
  ds_read_b64_tr_b16 a[72:73], v218 offset:2048
  v_mfma_f32_16x16x32_bf16 v[136:139], a[116:119], a[24:27], v[136:139]
  ds_read_b64_tr_b16 a[74:75], v218 offset:3072
  v_mfma_f32_16x16x32_bf16 v[140:143], a[116:119], a[28:31], v[140:143]
  ds_read_b64_tr_b16 a[76:77], v219 offset:2048
  v_mfma_f32_16x16x32_bf16 v[156:159], a[28:31], a[120:123], v[156:159]
  buffer_load_dwordx4 v226, s[8:11], s82 offen offset:1024 lds
  v_mfma_f32_16x16x32_bf16 v[152:155], a[24:27], a[120:123], v[152:155]
  ds_read_b64_tr_b16 a[78:79], v219 offset:3072
  v_mfma_f32_16x16x32_bf16 v[148:151], a[20:23], a[120:123], v[148:151]
  ds_read_b64_tr_b16 a[80:81], v220 offset:2048
  v_mfma_f32_16x16x32_bf16 v[144:147], a[16:19], a[120:123], v[144:147]
  ds_read_b64_tr_b16 a[82:83], v220 offset:3072
  v_mfma_f32_16x16x32_bf16 v[160:163], a[16:19], a[124:127], v[160:163]
  buffer_load_dwordx4 v227, s[8:11], s82 offen offset:2048 lds
  v_mfma_f32_16x16x32_bf16 v[164:167], a[20:23], a[124:127], v[164:167]
  buffer_load_dwordx4 v228, s[8:11], s82 offen offset:3072 lds
  v_mfma_f32_16x16x32_bf16 v[168:171], a[24:27], a[124:127], v[168:171]
  buffer_load_dwordx4 a[232:235], v255, s[68:71], s91 offen
  v_mfma_f32_16x16x32_bf16 v[172:175], a[28:31], a[124:127], v[172:175]
  s_add_u32 s83, s83, 229376
  v_mfma_f32_16x16x32_bf16 v[188:191], a[28:31], a[128:131], v[188:191]
  s_add_u32 s84, s84, 196608
  v_mfma_f32_16x16x32_bf16 v[184:187], a[24:27], a[128:131], v[184:187]
  s_add_u32 s82, s82, 65536
  v_mfma_f32_16x16x32_bf16 v[180:183], a[20:23], a[128:131], v[180:183]
  s_mov_b32 s24, s87
  v_mfma_f32_16x16x32_bf16 v[176:179], a[16:19], a[128:131], v[176:179]
  s_mov_b32 s87, s86
  v_mfma_f32_16x16x32_bf16 v[192:195], a[16:19], a[132:135], v[192:195]
  s_mov_b32 s86, s85
  v_mfma_f32_16x16x32_bf16 v[196:199], a[20:23], a[132:135], v[196:199]
  s_mov_b32 s85, s24
  v_mfma_f32_16x16x32_bf16 v[200:203], a[24:27], a[132:135], v[200:203]
  s_add_u32 s91, s91, 2097152
  v_mfma_f32_16x16x32_bf16 v[204:207], a[28:31], a[132:135], v[204:207]
  s_min_u32 s91, s91, s29
  s_waitcnt vmcnt(19) lgkmcnt(0)
  s_barrier
  s_cmp_lg_u32 s89, 5
  s_cbranch_scc1 gated_mix__mha_block__mixer_gmlp__prompt_kernel_v2_s5
  s_call_b64 s[24:25], gated_mix__mha_block__mixer_gmlp__prompt_kernel_pfsw1
gated_mix__mha_block__mixer_gmlp__prompt_kernel_v2_s5:
  s_cmp_lg_u32 s89, 3
  s_cbranch_scc1 gated_mix__mha_block__mixer_gmlp__prompt_kernel_v2_s3
  s_call_b64 s[24:25], gated_mix__mha_block__mixer_gmlp__prompt_kernel_pfsw2
gated_mix__mha_block__mixer_gmlp__prompt_kernel_v2_s3:
  s_cmp_lg_u32 s89, s94
  s_cbranch_scc1 gated_mix__mha_block__mixer_gmlp__prompt_kernel_v2_na
  s_call_b64 s[24:25], gated_mix__mha_block__mixer_gmlp__prompt_kernel_arrive
gated_mix__mha_block__mixer_gmlp__prompt_kernel_v2_na:
  s_cmp_lg_u32 s89, 0
  s_cbranch_scc1 gated_mix__mha_block__mixer_gmlp__prompt_kernel_v2_loop
  s_cmp_lg_u32 s44, 0
  s_cbranch_scc1 gated_mix__mha_block__mixer_gmlp__prompt_kernel_v2_ar0
  v_mov_b32 v236, 0
  global_load_dword v237, v236, s[100:101] sc1
gated_mix__mha_block__mixer_gmlp__prompt_kernel_v2_ar0:
  v_mfma_f32_16x16x32_bf16 v[0:3], a[0:3], a[32:35], v[0:3]
  v_add_u32 v221, s85, v224
  v_mfma_f32_16x16x32_bf16 v[4:7], a[4:7], a[32:35], v[4:7]
  ds_read_b128 a[16:19], v221 offset:0
  v_mfma_f32_16x16x32_bf16 v[8:11], a[8:11], a[32:35], v[8:11]
  ds_read_b128 a[20:23], v221 offset:512
  v_mfma_f32_16x16x32_bf16 v[12:15], a[12:15], a[32:35], v[12:15]
  ds_read_b128 a[24:27], v221 offset:4096
  v_mfma_f32_16x16x32_bf16 v[28:31], a[12:15], a[36:39], v[28:31]
  ds_read_b128 a[28:31], v221 offset:4608
  v_mfma_f32_16x16x32_bf16 v[24:27], a[8:11], a[36:39], v[24:27]
  ds_read_b64_tr_b16 a[84:85], v208 offset:16384
  v_mfma_f32_16x16x32_bf16 v[20:23], a[4:7], a[36:39], v[20:23]
  ds_read_b64_tr_b16 a[86:87], v208 offset:17408
  v_mfma_f32_16x16x32_bf16 v[16:19], a[0:3], a[36:39], v[16:19]
  ds_read_b64_tr_b16 a[88:89], v209 offset:16384
  v_mfma_f32_16x16x32_bf16 v[32:35], a[0:3], a[40:43], v[32:35]
  ds_read_b64_tr_b16 a[90:91], v209 offset:17408
  v_mfma_f32_16x16x32_bf16 v[36:39], a[4:7], a[40:43], v[36:39]
  ds_read_b64_tr_b16 a[92:93], v210 offset:16384
  v_mfma_f32_16x16x32_bf16 v[40:43], a[8:11], a[40:43], v[40:43]
  ds_read_b64_tr_b16 a[94:95], v210 offset:17408
  v_mfma_f32_16x16x32_bf16 v[44:47], a[12:15], a[40:43], v[44:47]
  ds_read_b64_tr_b16 a[96:97], v211 offset:16384
  v_mfma_f32_16x16x32_bf16 v[60:63], a[12:15], a[44:47], v[60:63]
  ds_read_b64_tr_b16 a[98:99], v211 offset:17408
  v_mfma_f32_16x16x32_bf16 v[56:59], a[8:11], a[44:47], v[56:59]
  ds_read_b64_tr_b16 a[100:101], v212 offset:16384
  v_mfma_f32_16x16x32_bf16 v[52:55], a[4:7], a[44:47], v[52:55]
  ds_read_b64_tr_b16 a[102:103], v212 offset:17408
  v_mfma_f32_16x16x32_bf16 v[48:51], a[0:3], a[44:47], v[48:51]
  ds_read_b64_tr_b16 a[104:105], v213 offset:16384
  v_mfma_f32_16x16x32_bf16 v[64:67], a[0:3], a[48:51], v[64:67]
  ds_read_b64_tr_b16 a[106:107], v213 offset:17408
  v_mfma_f32_16x16x32_bf16 v[68:71], a[4:7], a[48:51], v[68:71]
  ds_read_b64_tr_b16 a[108:109], v214 offset:16384
  v_mfma_f32_16x16x32_bf16 v[72:75], a[8:11], a[48:51], v[72:75]
  ds_read_b64_tr_b16 a[110:111], v214 offset:17408
  v_mfma_f32_16x16x32_bf16 v[76:79], a[12:15], a[48:51], v[76:79]
  ds_read_b64_tr_b16 a[112:113], v215 offset:18432
  v_mfma_f32_16x16x32_bf16 v[92:95], a[12:15], a[52:55], v[92:95]
  ds_read_b64_tr_b16 a[114:115], v215 offset:19456
  v_mfma_f32_16x16x32_bf16 v[88:91], a[8:11], a[52:55], v[88:91]
  ds_read_b64_tr_b16 a[116:117], v216 offset:18432
  v_mfma_f32_16x16x32_bf16 v[84:87], a[4:7], a[52:55], v[84:87]
  ds_read_b64_tr_b16 a[118:119], v216 offset:19456
  v_mfma_f32_16x16x32_bf16 v[80:83], a[0:3], a[52:55], v[80:83]
  ds_read_b64_tr_b16 a[120:121], v217 offset:18432
  v_mfma_f32_16x16x32_bf16 v[96:99], a[0:3], a[56:59], v[96:99]
  ds_read_b64_tr_b16 a[122:123], v217 offset:19456
  v_mfma_f32_16x16x32_bf16 v[100:103], a[4:7], a[56:59], v[100:103]
  ds_read_b64_tr_b16 a[124:125], v218 offset:18432
  v_mfma_f32_16x16x32_bf16 v[104:107], a[8:11], a[56:59], v[104:107]
  ds_read_b64_tr_b16 a[126:127], v218 offset:19456
  v_mfma_f32_16x16x32_bf16 v[108:111], a[12:15], a[56:59], v[108:111]
  ds_read_b64_tr_b16 a[128:129], v219 offset:18432
  v_mfma_f32_16x16x32_bf16 v[124:127], a[60:63], a[12:15], v[124:127]
  ds_read_b64_tr_b16 a[130:131], v219 offset:19456
  v_mfma_f32_16x16x32_bf16 v[120:123], a[60:63], a[8:11], v[120:123]
  ds_read_b64_tr_b16 a[132:133], v220 offset:18432
  v_mfma_f32_16x16x32_bf16 v[116:119], a[60:63], a[4:7], v[116:119]
  ds_read_b64_tr_b16 a[134:135], v220 offset:19456
  v_mfma_f32_16x16x32_bf16 v[112:115], a[60:63], a[0:3], v[112:115]
  v_lshlrev_b32 v242, 5, v234
  v_mfma_f32_16x16x32_bf16 v[128:131], a[64:67], a[0:3], v[128:131]
  s_lshl_b32 s31, s93, 11
  v_mfma_f32_16x16x32_bf16 v[132:135], a[64:67], a[4:7], v[132:135]
  buffer_load_dwordx4 a[140:143], v242, s[8:11], s31 offen offset:0
  v_mfma_f32_16x16x32_bf16 v[136:139], a[64:67], a[8:11], v[136:139]
  buffer_load_dwordx4 a[144:147], v242, s[8:11], s31 offen offset:16
  v_mfma_f32_16x16x32_bf16 v[140:143], a[64:67], a[12:15], v[140:143]
  buffer_load_dwordx4 a[148:151], v242, s[8:11], s31 offen offset:2048
  v_mfma_f32_16x16x32_bf16 v[156:159], a[12:15], a[68:71], v[156:159]
  buffer_load_dwordx4 a[152:155], v242, s[8:11], s31 offen offset:2064
  v_mfma_f32_16x16x32_bf16 v[152:155], a[8:11], a[68:71], v[152:155]
  buffer_load_dwordx4 a[156:159], v242, s[20:23], 0 offen offset:0
  v_mfma_f32_16x16x32_bf16 v[148:151], a[4:7], a[68:71], v[148:151]
  buffer_load_dwordx4 a[160:163], v242, s[20:23], 0 offen offset:16
  v_mfma_f32_16x16x32_bf16 v[144:147], a[0:3], a[68:71], v[144:147]
  v_mfma_f32_16x16x32_bf16 v[160:163], a[0:3], a[72:75], v[160:163]
  v_mfma_f32_16x16x32_bf16 v[164:167], a[4:7], a[72:75], v[164:167]
  v_mfma_f32_16x16x32_bf16 v[168:171], a[8:11], a[72:75], v[168:171]
  v_mfma_f32_16x16x32_bf16 v[172:175], a[12:15], a[72:75], v[172:175]
  v_mfma_f32_16x16x32_bf16 v[188:191], a[12:15], a[76:79], v[188:191]
  v_mfma_f32_16x16x32_bf16 v[184:187], a[8:11], a[76:79], v[184:187]
  v_mfma_f32_16x16x32_bf16 v[180:183], a[4:7], a[76:79], v[180:183]
  v_mfma_f32_16x16x32_bf16 v[176:179], a[0:3], a[76:79], v[176:179]
  v_mfma_f32_16x16x32_bf16 v[192:195], a[0:3], a[80:83], v[192:195]
  v_mfma_f32_16x16x32_bf16 v[196:199], a[4:7], a[80:83], v[196:199]
  v_mfma_f32_16x16x32_bf16 v[200:203], a[8:11], a[80:83], v[200:203]
  v_mfma_f32_16x16x32_bf16 v[204:207], a[12:15], a[80:83], v[204:207]
  s_waitcnt vmcnt(16) lgkmcnt(0)
  s_barrier
  v_mfma_f32_16x16x32_bf16 v[0:3], a[16:19], a[84:87], v[0:3]
  v_add_u32 v221, s86, v223
  v_mfma_f32_16x16x32_bf16 v[4:7], a[20:23], a[84:87], v[4:7]
  ds_read_b128 a[0:3], v221 offset:0
  v_mfma_f32_16x16x32_bf16 v[8:11], a[24:27], a[84:87], v[8:11]
  ds_read_b128 a[4:7], v221 offset:512
  v_mfma_f32_16x16x32_bf16 v[12:15], a[28:31], a[84:87], v[12:15]
  ds_read_b128 a[8:11], v221 offset:4096
  v_mfma_f32_16x16x32_bf16 v[28:31], a[28:31], a[88:91], v[28:31]
  ds_read_b128 a[12:15], v221 offset:4608
  v_mfma_f32_16x16x32_bf16 v[24:27], a[24:27], a[88:91], v[24:27]
  ds_read_b64_tr_b16 a[32:33], v208 offset:32768
  v_mfma_f32_16x16x32_bf16 v[20:23], a[20:23], a[88:91], v[20:23]
  ds_read_b64_tr_b16 a[34:35], v208 offset:33792
  v_mfma_f32_16x16x32_bf16 v[16:19], a[16:19], a[88:91], v[16:19]
  ds_read_b64_tr_b16 a[36:37], v209 offset:32768
  v_mfma_f32_16x16x32_bf16 v[32:35], a[16:19], a[92:95], v[32:35]
  ds_read_b64_tr_b16 a[38:39], v209 offset:33792
  v_mfma_f32_16x16x32_bf16 v[36:39], a[20:23], a[92:95], v[36:39]
  ds_read_b64_tr_b16 a[40:41], v210 offset:32768
  v_mfma_f32_16x16x32_bf16 v[40:43], a[24:27], a[92:95], v[40:43]
  ds_read_b64_tr_b16 a[42:43], v210 offset:33792
  v_mfma_f32_16x16x32_bf16 v[44:47], a[28:31], a[92:95], v[44:47]
  ds_read_b64_tr_b16 a[44:45], v211 offset:32768
  v_mfma_f32_16x16x32_bf16 v[60:63], a[28:31], a[96:99], v[60:63]
  ds_read_b64_tr_b16 a[46:47], v211 offset:33792
  v_mfma_f32_16x16x32_bf16 v[56:59], a[24:27], a[96:99], v[56:59]
  ds_read_b64_tr_b16 a[48:49], v212 offset:32768
  v_mfma_f32_16x16x32_bf16 v[52:55], a[20:23], a[96:99], v[52:55]
  ds_read_b64_tr_b16 a[50:51], v212 offset:33792
  v_mfma_f32_16x16x32_bf16 v[48:51], a[16:19], a[96:99], v[48:51]
  ds_read_b64_tr_b16 a[52:53], v213 offset:32768
  v_mfma_f32_16x16x32_bf16 v[64:67], a[16:19], a[100:103], v[64:67]
  ds_read_b64_tr_b16 a[54:55], v213 offset:33792
  v_mfma_f32_16x16x32_bf16 v[68:71], a[20:23], a[100:103], v[68:71]
  ds_read_b64_tr_b16 a[56:57], v214 offset:32768
  v_mfma_f32_16x16x32_bf16 v[72:75], a[24:27], a[100:103], v[72:75]
  ds_read_b64_tr_b16 a[58:59], v214 offset:33792
  v_mfma_f32_16x16x32_bf16 v[76:79], a[28:31], a[100:103], v[76:79]
  ds_read_b64_tr_b16 a[60:61], v215 offset:34816
  v_mfma_f32_16x16x32_bf16 v[92:95], a[28:31], a[104:107], v[92:95]
  ds_read_b64_tr_b16 a[62:63], v215 offset:35840
  v_mfma_f32_16x16x32_bf16 v[88:91], a[24:27], a[104:107], v[88:91]
  ds_read_b64_tr_b16 a[64:65], v216 offset:34816
  v_mfma_f32_16x16x32_bf16 v[84:87], a[20:23], a[104:107], v[84:87]
  ds_read_b64_tr_b16 a[66:67], v216 offset:35840
  v_mfma_f32_16x16x32_bf16 v[80:83], a[16:19], a[104:107], v[80:83]
  ds_read_b64_tr_b16 a[68:69], v217 offset:34816
  v_mfma_f32_16x16x32_bf16 v[96:99], a[16:19], a[108:111], v[96:99]
  ds_read_b64_tr_b16 a[70:71], v217 offset:35840
  v_mfma_f32_16x16x32_bf16 v[100:103], a[20:23], a[108:111], v[100:103]
  ds_read_b64_tr_b16 a[72:73], v218 offset:34816
  v_mfma_f32_16x16x32_bf16 v[104:107], a[24:27], a[108:111], v[104:107]
  ds_read_b64_tr_b16 a[74:75], v218 offset:35840
  v_mfma_f32_16x16x32_bf16 v[108:111], a[28:31], a[108:111], v[108:111]
  ds_read_b64_tr_b16 a[76:77], v219 offset:34816
  v_mfma_f32_16x16x32_bf16 v[124:127], a[112:115], a[28:31], v[124:127]
  ds_read_b64_tr_b16 a[78:79], v219 offset:35840
  v_mfma_f32_16x16x32_bf16 v[120:123], a[112:115], a[24:27], v[120:123]
  ds_read_b64_tr_b16 a[80:81], v220 offset:34816
  v_mfma_f32_16x16x32_bf16 v[116:119], a[112:115], a[20:23], v[116:119]
  ds_read_b64_tr_b16 a[82:83], v220 offset:35840
  v_mfma_f32_16x16x32_bf16 v[112:115], a[112:115], a[16:19], v[112:115]
  v_mfma_f32_16x16x32_bf16 v[128:131], a[116:119], a[16:19], v[128:131]
  v_mfma_f32_16x16x32_bf16 v[132:135], a[116:119], a[20:23], v[132:135]
  v_mfma_f32_16x16x32_bf16 v[136:139], a[116:119], a[24:27], v[136:139]
  v_mfma_f32_16x16x32_bf16 v[140:143], a[116:119], a[28:31], v[140:143]
  v_mfma_f32_16x16x32_bf16 v[156:159], a[28:31], a[120:123], v[156:159]
  v_mfma_f32_16x16x32_bf16 v[152:155], a[24:27], a[120:123], v[152:155]
  v_mfma_f32_16x16x32_bf16 v[148:151], a[20:23], a[120:123], v[148:151]
  v_mfma_f32_16x16x32_bf16 v[144:147], a[16:19], a[120:123], v[144:147]
  v_mfma_f32_16x16x32_bf16 v[160:163], a[16:19], a[124:127], v[160:163]
  v_mfma_f32_16x16x32_bf16 v[164:167], a[20:23], a[124:127], v[164:167]
  v_mfma_f32_16x16x32_bf16 v[168:171], a[24:27], a[124:127], v[168:171]
  v_mfma_f32_16x16x32_bf16 v[172:175], a[28:31], a[124:127], v[172:175]
  v_mfma_f32_16x16x32_bf16 v[188:191], a[28:31], a[128:131], v[188:191]
  v_mfma_f32_16x16x32_bf16 v[184:187], a[24:27], a[128:131], v[184:187]
  v_mfma_f32_16x16x32_bf16 v[180:183], a[20:23], a[128:131], v[180:183]
  v_mfma_f32_16x16x32_bf16 v[176:179], a[16:19], a[128:131], v[176:179]
  v_mfma_f32_16x16x32_bf16 v[192:195], a[16:19], a[132:135], v[192:195]
  v_mfma_f32_16x16x32_bf16 v[196:199], a[20:23], a[132:135], v[196:199]
  v_mfma_f32_16x16x32_bf16 v[200:203], a[24:27], a[132:135], v[200:203]
  v_mfma_f32_16x16x32_bf16 v[204:207], a[28:31], a[132:135], v[204:207]
  s_waitcnt vmcnt(0) lgkmcnt(0)
  v_readfirstlane_b32 s26, v237
  s_cmp_lg_u32 s44, 0
  s_cbranch_scc1 gated_mix__mha_block__mixer_gmlp__prompt_kernel_v2_arr
  s_nop 1
  s_cmp_ge_u32 s26, 80
  s_cbranch_scc1 gated_mix__mha_block__mixer_gmlp__prompt_kernel_v2_arr
  s_call_b64 s[24:25], gated_mix__mha_block__mixer_gmlp__prompt_kernel_arrchk
gated_mix__mha_block__mixer_gmlp__prompt_kernel_v2_arr:
  s_barrier
  v_mfma_f32_16x16x32_bf16 v[0:3], a[0:3], a[32:35], v[0:3]
  v_add_u32 v221, s86, v224
  v_mov_b32 v244, 0
  v_mov_b32 v245, 0
  v_accvgpr_read_b32 v247, a156
  v_mfma_f32_16x16x32_bf16 v[4:7], a[4:7], a[32:35], v[4:7]
  ds_read_b128 a[16:19], v221 offset:0
  v_lshlrev_b32 v246, 16, v247
  v_and_b32 v247, 0xffff0000, v247
  v_accvgpr_read_b32 v249, a140
  v_mfma_f32_16x16x32_bf16 v[8:11], a[8:11], a[32:35], v[8:11]
  ds_read_b128 a[20:23], v221 offset:512
  v_lshlrev_b32 v248, 16, v249
  v_and_b32 v249, 0xffff0000, v249
  v_mfma_f32_16x16x32_bf16 v[12:15], a[12:15], a[32:35], v[12:15]
  ds_read_b128 a[24:27], v221 offset:4096
  v_fmac_f32 v244, v246, v248
  v_fmac_f32 v244, v247, v249
  v_mfma_f32_16x16x32_bf16 v[28:31], a[12:15], a[36:39], v[28:31]
  ds_read_b128 a[28:31], v221 offset:4608
  v_accvgpr_read_b32 v249, a148
  v_lshlrev_b32 v248, 16, v249
  v_mfma_f32_16x16x32_bf16 v[24:27], a[8:11], a[36:39], v[24:27]
  ds_read_b64_tr_b16 a[84:85], v208 offset:49152
  v_and_b32 v249, 0xffff0000, v249
  v_fmac_f32 v245, v246, v248
  v_mfma_f32_16x16x32_bf16 v[20:23], a[4:7], a[36:39], v[20:23]
  ds_read_b64_tr_b16 a[86:87], v208 offset:50176
  v_fmac_f32 v245, v247, v249
  v_accvgpr_read_b32 v247, a157
  v_mfma_f32_16x16x32_bf16 v[16:19], a[0:3], a[36:39], v[16:19]
  ds_read_b64_tr_b16 a[88:89], v209 offset:49152
  v_lshlrev_b32 v246, 16, v247
  v_and_b32 v247, 0xffff0000, v247
  v_mfma_f32_16x16x32_bf16 v[32:35], a[0:3], a[40:43], v[32:35]
  ds_read_b64_tr_b16 a[90:91], v209 offset:50176
  v_accvgpr_read_b32 v249, a141
  v_lshlrev_b32 v248, 16, v249
  v_mfma_f32_16x16x32_bf16 v[36:39], a[4:7], a[40:43], v[36:39]
  ds_read_b64_tr_b16 a[92:93], v210 offset:49152
  v_and_b32 v249, 0xffff0000, v249
  v_fmac_f32 v244, v246, v248
  v_mfma_f32_16x16x32_bf16 v[40:43], a[8:11], a[40:43], v[40:43]
  ds_read_b64_tr_b16 a[94:95], v210 offset:50176
  v_fmac_f32 v244, v247, v249
  v_accvgpr_read_b32 v249, a149
  v_mfma_f32_16x16x32_bf16 v[44:47], a[12:15], a[40:43], v[44:47]
  ds_read_b64_tr_b16 a[96:97], v211 offset:49152
  v_lshlrev_b32 v248, 16, v249
  v_and_b32 v249, 0xffff0000, v249
  v_mfma_f32_16x16x32_bf16 v[60:63], a[12:15], a[44:47], v[60:63]
  ds_read_b64_tr_b16 a[98:99], v211 offset:50176
  v_fmac_f32 v245, v246, v248
  v_fmac_f32 v245, v247, v249
  v_mfma_f32_16x16x32_bf16 v[56:59], a[8:11], a[44:47], v[56:59]
  ds_read_b64_tr_b16 a[100:101], v212 offset:49152
  v_accvgpr_read_b32 v247, a158
  v_lshlrev_b32 v246, 16, v247
  v_mfma_f32_16x16x32_bf16 v[52:55], a[4:7], a[44:47], v[52:55]
  ds_read_b64_tr_b16 a[102:103], v212 offset:50176
  v_and_b32 v247, 0xffff0000, v247
  v_accvgpr_read_b32 v249, a142
  v_mfma_f32_16x16x32_bf16 v[48:51], a[0:3], a[44:47], v[48:51]
  ds_read_b64_tr_b16 a[104:105], v213 offset:49152
  v_lshlrev_b32 v248, 16, v249
  v_and_b32 v249, 0xffff0000, v249
  v_mfma_f32_16x16x32_bf16 v[64:67], a[0:3], a[48:51], v[64:67]
  ds_read_b64_tr_b16 a[106:107], v213 offset:50176
  v_fmac_f32 v244, v246, v248
  v_fmac_f32 v244, v247, v249
  v_mfma_f32_16x16x32_bf16 v[68:71], a[4:7], a[48:51], v[68:71]
  ds_read_b64_tr_b16 a[108:109], v214 offset:49152
  v_accvgpr_read_b32 v249, a150
  v_lshlrev_b32 v248, 16, v249
  v_mfma_f32_16x16x32_bf16 v[72:75], a[8:11], a[48:51], v[72:75]
  ds_read_b64_tr_b16 a[110:111], v214 offset:50176
  v_and_b32 v249, 0xffff0000, v249
  v_fmac_f32 v245, v246, v248
  v_mfma_f32_16x16x32_bf16 v[76:79], a[12:15], a[48:51], v[76:79]
  ds_read_b64_tr_b16 a[112:113], v215 offset:51200
  v_fmac_f32 v245, v247, v249
  v_accvgpr_read_b32 v247, a159
  v_mfma_f32_16x16x32_bf16 v[92:95], a[12:15], a[52:55], v[92:95]
  ds_read_b64_tr_b16 a[114:115], v215 offset:52224
  v_lshlrev_b32 v246, 16, v247
  v_and_b32 v247, 0xffff0000, v247
  v_mfma_f32_16x16x32_bf16 v[88:91], a[8:11], a[52:55], v[88:91]
  ds_read_b64_tr_b16 a[116:117], v216 offset:51200
  v_accvgpr_read_b32 v249, a143
  v_lshlrev_b32 v248, 16, v249
  v_mfma_f32_16x16x32_bf16 v[84:87], a[4:7], a[52:55], v[84:87]
  ds_read_b64_tr_b16 a[118:119], v216 offset:52224
  v_and_b32 v249, 0xffff0000, v249
  v_fmac_f32 v244, v246, v248
  v_mfma_f32_16x16x32_bf16 v[80:83], a[0:3], a[52:55], v[80:83]
  ds_read_b64_tr_b16 a[120:121], v217 offset:51200
  v_fmac_f32 v244, v247, v249
  v_accvgpr_read_b32 v249, a151
  v_mfma_f32_16x16x32_bf16 v[96:99], a[0:3], a[56:59], v[96:99]
  ds_read_b64_tr_b16 a[122:123], v217 offset:52224
  v_lshlrev_b32 v248, 16, v249
  v_and_b32 v249, 0xffff0000, v249
  v_mfma_f32_16x16x32_bf16 v[100:103], a[4:7], a[56:59], v[100:103]
  ds_read_b64_tr_b16 a[124:125], v218 offset:51200
  v_fmac_f32 v245, v246, v248
  v_fmac_f32 v245, v247, v249
  v_mfma_f32_16x16x32_bf16 v[104:107], a[8:11], a[56:59], v[104:107]
  ds_read_b64_tr_b16 a[126:127], v218 offset:52224
  v_accvgpr_read_b32 v247, a160
  v_lshlrev_b32 v246, 16, v247
  v_mfma_f32_16x16x32_bf16 v[108:111], a[12:15], a[56:59], v[108:111]
  ds_read_b64_tr_b16 a[128:129], v219 offset:51200
  v_and_b32 v247, 0xffff0000, v247
  v_accvgpr_read_b32 v249, a144
  v_mfma_f32_16x16x32_bf16 v[124:127], a[60:63], a[12:15], v[124:127]
  ds_read_b64_tr_b16 a[130:131], v219 offset:52224
  v_lshlrev_b32 v248, 16, v249
  v_and_b32 v249, 0xffff0000, v249
  v_mfma_f32_16x16x32_bf16 v[120:123], a[60:63], a[8:11], v[120:123]
  ds_read_b64_tr_b16 a[132:133], v220 offset:51200
  v_fmac_f32 v244, v246, v248
  v_fmac_f32 v244, v247, v249
  v_mfma_f32_16x16x32_bf16 v[116:119], a[60:63], a[4:7], v[116:119]
  ds_read_b64_tr_b16 a[134:135], v220 offset:52224
  v_accvgpr_read_b32 v249, a152
  v_lshlrev_b32 v248, 16, v249
  v_mfma_f32_16x16x32_bf16 v[112:115], a[60:63], a[0:3], v[112:115]
  v_and_b32 v249, 0xffff0000, v249
  v_fmac_f32 v245, v246, v248
  v_mfma_f32_16x16x32_bf16 v[128:131], a[64:67], a[0:3], v[128:131]
  v_fmac_f32 v245, v247, v249
  v_accvgpr_read_b32 v247, a161
  v_mfma_f32_16x16x32_bf16 v[132:135], a[64:67], a[4:7], v[132:135]
  v_lshlrev_b32 v246, 16, v247
  v_and_b32 v247, 0xffff0000, v247
  v_mfma_f32_16x16x32_bf16 v[136:139], a[64:67], a[8:11], v[136:139]
  v_accvgpr_read_b32 v249, a145
  v_lshlrev_b32 v248, 16, v249
  v_mfma_f32_16x16x32_bf16 v[140:143], a[64:67], a[12:15], v[140:143]
  v_and_b32 v249, 0xffff0000, v249
  v_fmac_f32 v244, v246, v248
  v_mfma_f32_16x16x32_bf16 v[156:159], a[12:15], a[68:71], v[156:159]
  v_fmac_f32 v244, v247, v249
  v_accvgpr_read_b32 v249, a153
  v_mfma_f32_16x16x32_bf16 v[152:155], a[8:11], a[68:71], v[152:155]
  v_lshlrev_b32 v248, 16, v249
  v_and_b32 v249, 0xffff0000, v249
  v_mfma_f32_16x16x32_bf16 v[148:151], a[4:7], a[68:71], v[148:151]
  v_fmac_f32 v245, v246, v248
  v_fmac_f32 v245, v247, v249
  v_mfma_f32_16x16x32_bf16 v[144:147], a[0:3], a[68:71], v[144:147]
  v_accvgpr_read_b32 v247, a162
  v_lshlrev_b32 v246, 16, v247
  v_mfma_f32_16x16x32_bf16 v[160:163], a[0:3], a[72:75], v[160:163]
  v_and_b32 v247, 0xffff0000, v247
  v_accvgpr_read_b32 v249, a146
  v_mfma_f32_16x16x32_bf16 v[164:167], a[4:7], a[72:75], v[164:167]
  v_lshlrev_b32 v248, 16, v249
  v_and_b32 v249, 0xffff0000, v249
  v_mfma_f32_16x16x32_bf16 v[168:171], a[8:11], a[72:75], v[168:171]
  v_fmac_f32 v244, v246, v248
  v_fmac_f32 v244, v247, v249
  v_mfma_f32_16x16x32_bf16 v[172:175], a[12:15], a[72:75], v[172:175]
  v_accvgpr_read_b32 v249, a154
  v_lshlrev_b32 v248, 16, v249
  v_mfma_f32_16x16x32_bf16 v[188:191], a[12:15], a[76:79], v[188:191]
  v_and_b32 v249, 0xffff0000, v249
  v_fmac_f32 v245, v246, v248
  v_mfma_f32_16x16x32_bf16 v[184:187], a[8:11], a[76:79], v[184:187]
  v_fmac_f32 v245, v247, v249
  v_accvgpr_read_b32 v247, a163
  v_mfma_f32_16x16x32_bf16 v[180:183], a[4:7], a[76:79], v[180:183]
  v_lshlrev_b32 v246, 16, v247
  v_and_b32 v247, 0xffff0000, v247
  v_mfma_f32_16x16x32_bf16 v[176:179], a[0:3], a[76:79], v[176:179]
  v_accvgpr_read_b32 v249, a147
  v_lshlrev_b32 v248, 16, v249
  v_mfma_f32_16x16x32_bf16 v[192:195], a[0:3], a[80:83], v[192:195]
  v_and_b32 v249, 0xffff0000, v249
  v_fmac_f32 v244, v246, v248
  v_mfma_f32_16x16x32_bf16 v[196:199], a[4:7], a[80:83], v[196:199]
  v_fmac_f32 v244, v247, v249
  v_accvgpr_read_b32 v249, a155
  v_mfma_f32_16x16x32_bf16 v[200:203], a[8:11], a[80:83], v[200:203]
  v_lshlrev_b32 v248, 16, v249
  v_and_b32 v249, 0xffff0000, v249
  v_mfma_f32_16x16x32_bf16 v[204:207], a[12:15], a[80:83], v[204:207]
  v_fmac_f32 v245, v246, v248
  v_fmac_f32 v245, v247, v249
  s_waitcnt lgkmcnt(0)
  v_mfma_f32_16x16x32_bf16 v[0:3], a[16:19], a[84:87], v[0:3]
  v_add_f32_dpp v244, v244, v244 row_ror:8 row_mask:0xf bank_mask:0xf
  v_add_f32_dpp v245, v245, v245 row_ror:8 row_mask:0xf bank_mask:0xf
  v_mfma_f32_16x16x32_bf16 v[4:7], a[20:23], a[84:87], v[4:7]
  s_nop 0
  v_mfma_f32_16x16x32_bf16 v[8:11], a[24:27], a[84:87], v[8:11]
  v_add_f32_dpp v244, v244, v244 row_ror:4 row_mask:0xf bank_mask:0xf
  v_add_f32_dpp v245, v245, v245 row_ror:4 row_mask:0xf bank_mask:0xf
  v_mfma_f32_16x16x32_bf16 v[12:15], a[28:31], a[84:87], v[12:15]
  s_nop 0
  v_mfma_f32_16x16x32_bf16 v[28:31], a[28:31], a[88:91], v[28:31]
  v_add_f32_dpp v244, v244, v244 row_ror:2 row_mask:0xf bank_mask:0xf
  v_add_f32_dpp v245, v245, v245 row_ror:2 row_mask:0xf bank_mask:0xf
  v_mfma_f32_16x16x32_bf16 v[24:27], a[24:27], a[88:91], v[24:27]
  s_nop 0
  v_mfma_f32_16x16x32_bf16 v[20:23], a[20:23], a[88:91], v[20:23]
  v_add_f32_dpp v244, v244, v244 row_ror:1 row_mask:0xf bank_mask:0xf
  v_add_f32_dpp v245, v245, v245 row_ror:1 row_mask:0xf bank_mask:0xf
  v_mfma_f32_16x16x32_bf16 v[16:19], a[16:19], a[88:91], v[16:19]
  s_nop 0
  v_mfma_f32_16x16x32_bf16 v[32:35], a[16:19], a[92:95], v[32:35]
  v_readlane_b32 s24, v244, 0
  v_readlane_b32 s25, v244, 16
  v_mfma_f32_16x16x32_bf16 v[36:39], a[20:23], a[92:95], v[36:39]
  v_readlane_b32 s26, v244, 32
  v_readlane_b32 s27, v244, 48
  v_mfma_f32_16x16x32_bf16 v[40:43], a[24:27], a[92:95], v[40:43]
  v_readlane_b32 s28, v245, 0
  v_readlane_b32 s29, v245, 16
  v_mfma_f32_16x16x32_bf16 v[44:47], a[28:31], a[92:95], v[44:47]
  v_readlane_b32 s30, v245, 32
  v_readlane_b32 s31, v245, 48
  v_mfma_f32_16x16x32_bf16 v[60:63], a[28:31], a[96:99], v[60:63]
  v_cmp_eq_u32 vcc, 1, v234
  v_mfma_f32_16x16x32_bf16 v[56:59], a[24:27], a[96:99], v[56:59]
  s_nop 1
  v_mfma_f32_16x16x32_bf16 v[52:55], a[20:23], a[96:99], v[52:55]
  v_mov_b32 v246, s24
  v_mov_b32 v247, s28
  v_mfma_f32_16x16x32_bf16 v[48:51], a[16:19], a[96:99], v[48:51]
  v_add_f32 v246, s25, v246
  v_add_f32 v247, s29, v247
  v_mfma_f32_16x16x32_bf16 v[64:67], a[16:19], a[100:103], v[64:67]
  v_add_f32 v246, s26, v246
  v_add_f32 v247, s30, v247
  v_mfma_f32_16x16x32_bf16 v[68:71], a[20:23], a[100:103], v[68:71]
  v_add_f32 v246, s27, v246
  v_add_f32 v247, s31, v247
  v_mfma_f32_16x16x32_bf16 v[72:75], a[24:27], a[100:103], v[72:75]
  v_cndmask_b32 v246, v246, v247, vcc
  v_mfma_f32_16x16x32_bf16 v[76:79], a[28:31], a[100:103], v[76:79]
  v_mul_f32 v246, 0xbfb8aa3b, v246
  v_mfma_f32_16x16x32_bf16 v[92:95], a[28:31], a[104:107], v[92:95]
  v_exp_f32 v246, v246
  v_mfma_f32_16x16x32_bf16 v[88:91], a[24:27], a[104:107], v[88:91]
  v_lshlrev_b32 v236, 2, v234
  v_mov_b32 v237, 0x80000000
  v_mfma_f32_16x16x32_bf16 v[84:87], a[20:23], a[104:107], v[84:87]
  v_add_f32 v246, 1.0, v246
  v_mfma_f32_16x16x32_bf16 v[80:83], a[16:19], a[104:107], v[80:83]
  v_rcp_f32 v235, v246
  v_mfma_f32_16x16x32_bf16 v[96:99], a[16:19], a[108:111], v[96:99]
  v_cmp_lt_u32 vcc, 1, v234
  v_mfma_f32_16x16x32_bf16 v[100:103], a[20:23], a[108:111], v[100:103]
  s_lshl_b32 s31, s93, 6
  s_add_u32 s31, s31, 42991616
  v_mfma_f32_16x16x32_bf16 v[104:107], a[24:27], a[108:111], v[104:107]
  v_cndmask_b32 v236, v236, v237, vcc
  v_mfma_f32_16x16x32_bf16 v[108:111], a[28:31], a[108:111], v[108:111]
  buffer_store_dword v235, v236, s[4:7], s31 offen sc1
  v_mfma_f32_16x16x32_bf16 v[124:127], a[112:115], a[28:31], v[124:127]
  s_lshl_b32 s32, s80, 3
  v_mfma_f32_16x16x32_bf16 v[120:123], a[112:115], a[24:27], v[120:123]
  s_lshl_b32 s33, s44, 1
  v_mfma_f32_16x16x32_bf16 v[116:119], a[112:115], a[20:23], v[116:119]
  s_add_u32 s32, s32, s33
  v_mfma_f32_16x16x32_bf16 v[112:115], a[112:115], a[16:19], v[112:115]
  v_mov_b32 v254, v234
  v_mfma_f32_16x16x32_bf16 v[128:131], a[116:119], a[16:19], v[128:131]
  v_mov_b32 v255, v233
  v_mfma_f32_16x16x32_bf16 v[132:135], a[116:119], a[20:23], v[132:135]
  v_lshlrev_b32 v253, 2, v234
  v_mfma_f32_16x16x32_bf16 v[136:139], a[116:119], a[24:27], v[136:139]
  v_mov_b32 v252, 1
  v_mfma_f32_16x16x32_bf16 v[140:143], a[116:119], a[28:31], v[140:143]
  v_min_u32 v251, 1, v234
  v_mfma_f32_16x16x32_bf16 v[156:159], a[28:31], a[120:123], v[156:159]
  v_lshlrev_b32 v251, 26, v251
  v_mfma_f32_16x16x32_bf16 v[152:155], a[24:27], a[120:123], v[152:155]
  s_lshl_b32 s51, s81, 3
  v_mfma_f32_16x16x32_bf16 v[148:151], a[20:23], a[120:123], v[148:151]
  s_add_u32 s51, s51, s80
  v_mfma_f32_16x16x32_bf16 v[144:147], a[16:19], a[120:123], v[144:147]
  s_lshl_b32 s51, s51, 2
  v_mfma_f32_16x16x32_bf16 v[160:163], a[16:19], a[124:127], v[160:163]
  s_add_u32 s51, s51, s44
  v_mfma_f32_16x16x32_bf16 v[164:167], a[20:23], a[124:127], v[164:167]
  s_lshl_b32 s51, s51, 2
  v_mfma_f32_16x16x32_bf16 v[168:171], a[24:27], a[124:127], v[168:171]
  s_add_u32 s51, s51, 44052480
  v_mfma_f32_16x16x32_bf16 v[172:175], a[28:31], a[124:127], v[172:175]
  s_mov_b32 s40, 0xbdd2d3e8
  v_mfma_f32_16x16x32_bf16 v[188:191], a[28:31], a[128:131], v[188:191]
  s_mov_b32 s41, 0xbdd2d3e8
  v_mfma_f32_16x16x32_bf16 v[184:187], a[24:27], a[128:131], v[184:187]
  s_mov_b32 s42, 1.0
  v_mfma_f32_16x16x32_bf16 v[180:183], a[20:23], a[128:131], v[180:183]
  s_mov_b32 s43, 1.0
  v_mfma_f32_16x16x32_bf16 v[176:179], a[16:19], a[128:131], v[176:179]
  v_mfma_f32_16x16x32_bf16 v[192:195], a[16:19], a[132:135], v[192:195]
  v_mfma_f32_16x16x32_bf16 v[196:199], a[20:23], a[132:135], v[196:199]
  v_mfma_f32_16x16x32_bf16 v[200:203], a[24:27], a[132:135], v[200:203]
  v_mfma_f32_16x16x32_bf16 v[204:207], a[28:31], a[132:135], v[204:207]
  s_nop 7
  s_mul_i32 s34, s81, 3
  s_add_u32 s34, s34, 0
  s_lshl_b32 s35, s34, 17
  s_lshl_b32 s36, s32, 11
  s_add_u32 s35, s35, s36
  s_cmp_lt_u32 s34, 32
  s_cselect_b32 s38, 0x3e8293ee, 1.0
  s_mov_b32 s39, s38
  v_cvt_pk_bf16_f32 v212, v112, v113
  v_cvt_pk_bf16_f32 v213, v114, v115
  v_cvt_pk_bf16_f32 v214, v128, v129
  v_cvt_pk_bf16_f32 v215, v130, v131
  buffer_store_dwordx4 v[212:215], v255, s[4:7], s35 offen offset:0 sc1
  v_cvt_pk_bf16_f32 v216, v116, v117
  v_cvt_pk_bf16_f32 v217, v118, v119
  v_cvt_pk_bf16_f32 v218, v132, v133
  v_cvt_pk_bf16_f32 v219, v134, v135
  buffer_store_dwordx4 v[216:219], v255, s[4:7], s35 offen offset:1024 sc1
  v_cvt_pk_bf16_f32 v220, v120, v121
  v_cvt_pk_bf16_f32 v221, v122, v123
  v_cvt_pk_bf16_f32 v222, v136, v137
  v_cvt_pk_bf16_f32 v223, v138, v139
  buffer_store_dwordx4 v[220:223], v255, s[4:7], s35 offen offset:2048 sc1
  v_cvt_pk_bf16_f32 v208, v124, v125
  v_cvt_pk_bf16_f32 v209, v126, v127
  v_cvt_pk_bf16_f32 v210, v140, v141
  v_cvt_pk_bf16_f32 v211, v142, v143
  buffer_store_dwordx4 v[208:211], v255, s[4:7], s35 offen offset:3072 sc1
  s_mul_i32 s34, s81, 3
  s_add_u32 s34, s34, 1
  s_lshl_b32 s35, s34, 17
  s_lshl_b32 s36, s32, 11
  s_add_u32 s35, s35, s36
  v_cvt_pk_bf16_f32 v212, v144, v145
  v_cvt_pk_bf16_f32 v213, v146, v147
  v_cvt_pk_bf16_f32 v214, v148, v149
  v_cvt_pk_bf16_f32 v215, v150, v151
  buffer_store_dwordx4 v[212:215], v255, s[4:7], s35 offen offset:0 sc1
  v_cvt_pk_bf16_f32 v216, v160, v161
  v_cvt_pk_bf16_f32 v217, v162, v163
  v_cvt_pk_bf16_f32 v218, v164, v165
  v_cvt_pk_bf16_f32 v219, v166, v167
  buffer_store_dwordx4 v[216:219], v255, s[4:7], s35 offen offset:1024 sc1
  v_cvt_pk_bf16_f32 v220, v152, v153
  v_cvt_pk_bf16_f32 v221, v154, v155
  v_cvt_pk_bf16_f32 v222, v156, v157
  v_cvt_pk_bf16_f32 v223, v158, v159
  buffer_store_dwordx4 v[220:223], v255, s[4:7], s35 offen offset:2048 sc1
  v_cvt_pk_bf16_f32 v208, v168, v169
  v_cvt_pk_bf16_f32 v209, v170, v171
  v_cvt_pk_bf16_f32 v210, v172, v173
  v_cvt_pk_bf16_f32 v211, v174, v175
  buffer_store_dwordx4 v[208:211], v255, s[4:7], s35 offen offset:3072 sc1
  s_mul_i32 s34, s81, 3
  s_add_u32 s34, s34, 2
  s_lshl_b32 s35, s34, 17
  s_lshl_b32 s36, s32, 11
  s_add_u32 s35, s35, s36
  v_cvt_pk_bf16_f32 v212, v176, v177
  v_cvt_pk_bf16_f32 v213, v178, v179
  v_cvt_pk_bf16_f32 v214, v180, v181
  v_cvt_pk_bf16_f32 v215, v182, v183
  buffer_store_dwordx4 v[212:215], v255, s[4:7], s35 offen offset:0 sc1
  v_cvt_pk_bf16_f32 v216, v192, v193
  v_cvt_pk_bf16_f32 v217, v194, v195
  v_cvt_pk_bf16_f32 v218, v196, v197
  v_cvt_pk_bf16_f32 v219, v198, v199
  buffer_store_dwordx4 v[216:219], v255, s[4:7], s35 offen offset:1024 sc1
  v_cvt_pk_bf16_f32 v220, v184, v185
  v_cvt_pk_bf16_f32 v221, v186, v187
  v_cvt_pk_bf16_f32 v222, v188, v189
  v_cvt_pk_bf16_f32 v223, v190, v191
  buffer_store_dwordx4 v[220:223], v255, s[4:7], s35 offen offset:2048 sc1
  v_cvt_pk_bf16_f32 v208, v200, v201
  v_cvt_pk_bf16_f32 v209, v202, v203
  v_cvt_pk_bf16_f32 v210, v204, v205
  v_cvt_pk_bf16_f32 v211, v206, v207
  buffer_store_dwordx4 v[208:211], v255, s[4:7], s35 offen offset:3072 sc1
  s_branch gated_mix__mha_block__mixer_gmlp__prompt_kernel_z2ep
.p2align 6
gated_mix__mha_block__mixer_gmlp__prompt_kernel_v3:
  s_mov_b32 s89, 7
gated_mix__mha_block__mixer_gmlp__prompt_kernel_v3_loop:
  v_mfma_f32_16x16x32_bf16 v[0:3], a[0:3], a[32:35], v[0:3]
  v_add_u32 v221, s85, v224
  v_mfma_f32_16x16x32_bf16 v[4:7], a[4:7], a[32:35], v[4:7]
  ds_read_b128 a[16:19], v221 offset:0
  v_mfma_f32_16x16x32_bf16 v[8:11], a[8:11], a[32:35], v[8:11]
  ds_read_b128 a[20:23], v221 offset:512
  v_mfma_f32_16x16x32_bf16 v[12:15], a[12:15], a[32:35], v[12:15]
  ds_read_b128 a[24:27], v221 offset:4096
  v_mfma_f32_16x16x32_bf16 v[28:31], a[12:15], a[36:39], v[28:31]
  s_add_u32 m0, s88, 0
  v_mfma_f32_16x16x32_bf16 v[24:27], a[8:11], a[36:39], v[24:27]
  ds_read_b128 a[28:31], v221 offset:4608
  v_mfma_f32_16x16x32_bf16 v[20:23], a[4:7], a[36:39], v[20:23]
  ds_read_b64_tr_b16 a[84:85], v208 offset:16384
  v_mfma_f32_16x16x32_bf16 v[16:19], a[0:3], a[36:39], v[16:19]
  ds_read_b64_tr_b16 a[86:87], v208 offset:17408
  v_mfma_f32_16x16x32_bf16 v[32:35], a[0:3], a[40:43], v[32:35]
  buffer_load_dwordx4 v229, s[12:15], s83 offen lds
  v_mfma_f32_16x16x32_bf16 v[36:39], a[4:7], a[40:43], v[36:39]
  ds_read_b64_tr_b16 a[88:89], v209 offset:16384
  v_mfma_f32_16x16x32_bf16 v[40:43], a[8:11], a[40:43], v[40:43]
  ds_read_b64_tr_b16 a[90:91], v209 offset:17408
  v_mfma_f32_16x16x32_bf16 v[44:47], a[12:15], a[40:43], v[44:47]
  ds_read_b64_tr_b16 a[92:93], v210 offset:16384
  v_mfma_f32_16x16x32_bf16 v[60:63], a[12:15], a[44:47], v[60:63]
  buffer_load_dwordx4 v230, s[12:15], s83 offen offset:1024 lds
  v_mfma_f32_16x16x32_bf16 v[56:59], a[8:11], a[44:47], v[56:59]
  ds_read_b64_tr_b16 a[94:95], v210 offset:17408
  v_mfma_f32_16x16x32_bf16 v[52:55], a[4:7], a[44:47], v[52:55]
  ds_read_b64_tr_b16 a[96:97], v211 offset:16384
  v_mfma_f32_16x16x32_bf16 v[48:51], a[0:3], a[44:47], v[48:51]
  ds_read_b64_tr_b16 a[98:99], v211 offset:17408
  v_mfma_f32_16x16x32_bf16 v[64:67], a[0:3], a[48:51], v[64:67]
  s_add_u32 m0, s88, 2048
  v_mfma_f32_16x16x32_bf16 v[68:71], a[4:7], a[48:51], v[68:71]
  ds_read_b64_tr_b16 a[100:101], v212 offset:16384
  v_mfma_f32_16x16x32_bf16 v[72:75], a[8:11], a[48:51], v[72:75]
  ds_read_b64_tr_b16 a[102:103], v212 offset:17408
  v_mfma_f32_16x16x32_bf16 v[76:79], a[12:15], a[48:51], v[76:79]
  ds_read_b64_tr_b16 a[104:105], v213 offset:16384
  v_mfma_f32_16x16x32_bf16 v[92:95], a[12:15], a[52:55], v[92:95]
  buffer_load_dwordx4 v231, s[16:19], s84 offen lds
  v_mfma_f32_16x16x32_bf16 v[88:91], a[8:11], a[52:55], v[88:91]
  ds_read_b64_tr_b16 a[106:107], v213 offset:17408
  v_mfma_f32_16x16x32_bf16 v[84:87], a[4:7], a[52:55], v[84:87]
  ds_read_b64_tr_b16 a[108:109], v214 offset:16384
  v_mfma_f32_16x16x32_bf16 v[80:83], a[0:3], a[52:55], v[80:83]
  ds_read_b64_tr_b16 a[110:111], v214 offset:17408
  v_mfma_f32_16x16x32_bf16 v[96:99], a[0:3], a[56:59], v[96:99]
  buffer_load_dwordx4 v232, s[16:19], s84 offen offset:1024 lds
  v_mfma_f32_16x16x32_bf16 v[100:103], a[4:7], a[56:59], v[100:103]
  ds_read_b64_tr_b16 a[112:113], v215 offset:18432
  v_mfma_f32_16x16x32_bf16 v[104:107], a[8:11], a[56:59], v[104:107]
  ds_read_b64_tr_b16 a[114:115], v215 offset:19456
  v_mfma_f32_16x16x32_bf16 v[108:111], a[12:15], a[56:59], v[108:111]
  ds_read_b64_tr_b16 a[116:117], v216 offset:18432
  v_mfma_f32_16x16x32_bf16 v[124:127], a[12:15], a[60:63], v[124:127]
  s_add_u32 m0, s87, 4096
  v_mfma_f32_16x16x32_bf16 v[120:123], a[8:11], a[60:63], v[120:123]
  ds_read_b64_tr_b16 a[118:119], v216 offset:19456
  v_mfma_f32_16x16x32_bf16 v[116:119], a[4:7], a[60:63], v[116:119]
  ds_read_b64_tr_b16 a[120:121], v217 offset:18432
  v_mfma_f32_16x16x32_bf16 v[112:115], a[0:3], a[60:63], v[112:115]
  ds_read_b64_tr_b16 a[122:123], v217 offset:19456
  v_mfma_f32_16x16x32_bf16 v[128:131], a[0:3], a[64:67], v[128:131]
  buffer_load_dwordx4 v225, s[8:11], s82 offen offset:0 lds
  v_mfma_f32_16x16x32_bf16 v[132:135], a[4:7], a[64:67], v[132:135]
  ds_read_b64_tr_b16 a[124:125], v218 offset:18432
  v_mfma_f32_16x16x32_bf16 v[136:139], a[8:11], a[64:67], v[136:139]
  ds_read_b64_tr_b16 a[126:127], v218 offset:19456
  v_mfma_f32_16x16x32_bf16 v[140:143], a[12:15], a[64:67], v[140:143]
  ds_read_b64_tr_b16 a[128:129], v219 offset:18432
  v_mfma_f32_16x16x32_bf16 v[156:159], a[12:15], a[68:71], v[156:159]
  buffer_load_dwordx4 v226, s[8:11], s82 offen offset:1024 lds
  v_mfma_f32_16x16x32_bf16 v[152:155], a[8:11], a[68:71], v[152:155]
  ds_read_b64_tr_b16 a[130:131], v219 offset:19456
  v_mfma_f32_16x16x32_bf16 v[148:151], a[4:7], a[68:71], v[148:151]
  ds_read_b64_tr_b16 a[132:133], v220 offset:18432
  v_mfma_f32_16x16x32_bf16 v[144:147], a[0:3], a[68:71], v[144:147]
  ds_read_b64_tr_b16 a[134:135], v220 offset:19456
  v_mfma_f32_16x16x32_bf16 v[160:163], a[0:3], a[72:75], v[160:163]
  buffer_load_dwordx4 v227, s[8:11], s82 offen offset:2048 lds
  v_mfma_f32_16x16x32_bf16 v[164:167], a[4:7], a[72:75], v[164:167]
  buffer_load_dwordx4 v228, s[8:11], s82 offen offset:3072 lds
  v_mfma_f32_16x16x32_bf16 v[168:171], a[8:11], a[72:75], v[168:171]
  buffer_load_dwordx4 a[232:235], v252, s[64:67], s90 offen
  v_mfma_f32_16x16x32_bf16 v[172:175], a[12:15], a[72:75], v[172:175]
  s_add_u32 s83, s83, 229376
  v_mfma_f32_16x16x32_bf16 v[188:191], a[12:15], a[76:79], v[188:191]
  s_add_u32 s84, s84, 196608
  v_mfma_f32_16x16x32_bf16 v[184:187], a[8:11], a[76:79], v[184:187]
  s_sub_u32 s82, s82, 65408
  v_mfma_f32_16x16x32_bf16 v[180:183], a[4:7], a[76:79], v[180:183]
  s_sub_u32 s89, s89, 1
  v_mfma_f32_16x16x32_bf16 v[176:179], a[0:3], a[76:79], v[176:179]
  v_mfma_f32_16x16x32_bf16 v[192:195], a[0:3], a[80:83], v[192:195]
  v_mfma_f32_16x16x32_bf16 v[196:199], a[4:7], a[80:83], v[196:199]
  v_mfma_f32_16x16x32_bf16 v[200:203], a[8:11], a[80:83], v[200:203]
  v_mfma_f32_16x16x32_bf16 v[204:207], a[12:15], a[80:83], v[204:207]
  s_waitcnt vmcnt(19) lgkmcnt(0)
  s_barrier
  v_mfma_f32_16x16x32_bf16 v[0:3], a[16:19], a[84:87], v[0:3]
  v_add_u32 v221, s86, v223
  v_mfma_f32_16x16x32_bf16 v[4:7], a[20:23], a[84:87], v[4:7]
  ds_read_b128 a[0:3], v221 offset:0
  v_mfma_f32_16x16x32_bf16 v[8:11], a[24:27], a[84:87], v[8:11]
  ds_read_b128 a[4:7], v221 offset:512
  v_mfma_f32_16x16x32_bf16 v[12:15], a[28:31], a[84:87], v[12:15]
  ds_read_b128 a[8:11], v221 offset:4096
  v_mfma_f32_16x16x32_bf16 v[28:31], a[28:31], a[88:91], v[28:31]
  s_add_u32 m0, s88, 16384
  v_mfma_f32_16x16x32_bf16 v[24:27], a[24:27], a[88:91], v[24:27]
  ds_read_b128 a[12:15], v221 offset:4608
  v_mfma_f32_16x16x32_bf16 v[20:23], a[20:23], a[88:91], v[20:23]
  ds_read_b64_tr_b16 a[32:33], v208 offset:32768
  v_mfma_f32_16x16x32_bf16 v[16:19], a[16:19], a[88:91], v[16:19]
  ds_read_b64_tr_b16 a[34:35], v208 offset:33792
  v_mfma_f32_16x16x32_bf16 v[32:35], a[16:19], a[92:95], v[32:35]
  buffer_load_dwordx4 v229, s[12:15], s83 offen lds
  v_mfma_f32_16x16x32_bf16 v[36:39], a[20:23], a[92:95], v[36:39]
  ds_read_b64_tr_b16 a[36:37], v209 offset:32768
  v_mfma_f32_16x16x32_bf16 v[40:43], a[24:27], a[92:95], v[40:43]
  ds_read_b64_tr_b16 a[38:39], v209 offset:33792
  v_mfma_f32_16x16x32_bf16 v[44:47], a[28:31], a[92:95], v[44:47]
  ds_read_b64_tr_b16 a[40:41], v210 offset:32768
  v_mfma_f32_16x16x32_bf16 v[60:63], a[28:31], a[96:99], v[60:63]
  buffer_load_dwordx4 v230, s[12:15], s83 offen offset:1024 lds
  v_mfma_f32_16x16x32_bf16 v[56:59], a[24:27], a[96:99], v[56:59]
  ds_read_b64_tr_b16 a[42:43], v210 offset:33792
  v_mfma_f32_16x16x32_bf16 v[52:55], a[20:23], a[96:99], v[52:55]
  ds_read_b64_tr_b16 a[44:45], v211 offset:32768
  v_mfma_f32_16x16x32_bf16 v[48:51], a[16:19], a[96:99], v[48:51]
  ds_read_b64_tr_b16 a[46:47], v211 offset:33792
  v_mfma_f32_16x16x32_bf16 v[64:67], a[16:19], a[100:103], v[64:67]
  s_add_u32 m0, s88, 18432
  v_mfma_f32_16x16x32_bf16 v[68:71], a[20:23], a[100:103], v[68:71]
  ds_read_b64_tr_b16 a[48:49], v212 offset:32768
  v_mfma_f32_16x16x32_bf16 v[72:75], a[24:27], a[100:103], v[72:75]
  ds_read_b64_tr_b16 a[50:51], v212 offset:33792
  v_mfma_f32_16x16x32_bf16 v[76:79], a[28:31], a[100:103], v[76:79]
  ds_read_b64_tr_b16 a[52:53], v213 offset:32768
  v_mfma_f32_16x16x32_bf16 v[92:95], a[28:31], a[104:107], v[92:95]
  buffer_load_dwordx4 v231, s[16:19], s84 offen lds
  v_mfma_f32_16x16x32_bf16 v[88:91], a[24:27], a[104:107], v[88:91]
  ds_read_b64_tr_b16 a[54:55], v213 offset:33792
  v_mfma_f32_16x16x32_bf16 v[84:87], a[20:23], a[104:107], v[84:87]
  ds_read_b64_tr_b16 a[56:57], v214 offset:32768
  v_mfma_f32_16x16x32_bf16 v[80:83], a[16:19], a[104:107], v[80:83]
  ds_read_b64_tr_b16 a[58:59], v214 offset:33792
  v_mfma_f32_16x16x32_bf16 v[96:99], a[16:19], a[108:111], v[96:99]
  buffer_load_dwordx4 v232, s[16:19], s84 offen offset:1024 lds
  v_mfma_f32_16x16x32_bf16 v[100:103], a[20:23], a[108:111], v[100:103]
  ds_read_b64_tr_b16 a[60:61], v215 offset:34816
  v_mfma_f32_16x16x32_bf16 v[104:107], a[24:27], a[108:111], v[104:107]
  ds_read_b64_tr_b16 a[62:63], v215 offset:35840
  v_mfma_f32_16x16x32_bf16 v[108:111], a[28:31], a[108:111], v[108:111]
  ds_read_b64_tr_b16 a[64:65], v216 offset:34816
  v_mfma_f32_16x16x32_bf16 v[124:127], a[28:31], a[112:115], v[124:127]
  s_add_u32 m0, s85, 0
  v_mfma_f32_16x16x32_bf16 v[120:123], a[24:27], a[112:115], v[120:123]
  ds_read_b64_tr_b16 a[66:67], v216 offset:35840
  v_mfma_f32_16x16x32_bf16 v[116:119], a[20:23], a[112:115], v[116:119]
  ds_read_b64_tr_b16 a[68:69], v217 offset:34816
  v_mfma_f32_16x16x32_bf16 v[112:115], a[16:19], a[112:115], v[112:115]
  ds_read_b64_tr_b16 a[70:71], v217 offset:35840
  v_mfma_f32_16x16x32_bf16 v[128:131], a[16:19], a[116:119], v[128:131]
  buffer_load_dwordx4 v225, s[8:11], s82 offen offset:0 lds
  v_mfma_f32_16x16x32_bf16 v[132:135], a[20:23], a[116:119], v[132:135]
  ds_read_b64_tr_b16 a[72:73], v218 offset:34816
  v_mfma_f32_16x16x32_bf16 v[136:139], a[24:27], a[116:119], v[136:139]
  ds_read_b64_tr_b16 a[74:75], v218 offset:35840
  v_mfma_f32_16x16x32_bf16 v[140:143], a[28:31], a[116:119], v[140:143]
  ds_read_b64_tr_b16 a[76:77], v219 offset:34816
  v_mfma_f32_16x16x32_bf16 v[156:159], a[28:31], a[120:123], v[156:159]
  buffer_load_dwordx4 v226, s[8:11], s82 offen offset:1024 lds
  v_mfma_f32_16x16x32_bf16 v[152:155], a[24:27], a[120:123], v[152:155]
  ds_read_b64_tr_b16 a[78:79], v219 offset:35840
  v_mfma_f32_16x16x32_bf16 v[148:151], a[20:23], a[120:123], v[148:151]
  ds_read_b64_tr_b16 a[80:81], v220 offset:34816
  v_mfma_f32_16x16x32_bf16 v[144:147], a[16:19], a[120:123], v[144:147]
  ds_read_b64_tr_b16 a[82:83], v220 offset:35840
  v_mfma_f32_16x16x32_bf16 v[160:163], a[16:19], a[124:127], v[160:163]
  buffer_load_dwordx4 v227, s[8:11], s82 offen offset:2048 lds
  v_mfma_f32_16x16x32_bf16 v[164:167], a[20:23], a[124:127], v[164:167]
  buffer_load_dwordx4 v228, s[8:11], s82 offen offset:3072 lds
  v_mfma_f32_16x16x32_bf16 v[168:171], a[24:27], a[124:127], v[168:171]
  buffer_load_dwordx4 a[232:235], v253, s[68:71], s91 offen
  v_mfma_f32_16x16x32_bf16 v[172:175], a[28:31], a[124:127], v[172:175]
  s_add_u32 s83, s83, 229376
  v_mfma_f32_16x16x32_bf16 v[188:191], a[28:31], a[128:131], v[188:191]
  s_add_u32 s84, s84, 196608
  v_mfma_f32_16x16x32_bf16 v[184:187], a[24:27], a[128:131], v[184:187]
  s_add_u32 s82, s82, 65536
  v_mfma_f32_16x16x32_bf16 v[180:183], a[20:23], a[128:131], v[180:183]
  v_mfma_f32_16x16x32_bf16 v[176:179], a[16:19], a[128:131], v[176:179]
  v_mfma_f32_16x16x32_bf16 v[192:195], a[16:19], a[132:135], v[192:195]
  v_mfma_f32_16x16x32_bf16 v[196:199], a[20:23], a[132:135], v[196:199]
  v_mfma_f32_16x16x32_bf16 v[200:203], a[24:27], a[132:135], v[200:203]
  v_mfma_f32_16x16x32_bf16 v[204:207], a[28:31], a[132:135], v[204:207]
  s_waitcnt vmcnt(19) lgkmcnt(0)
  s_barrier
  v_mfma_f32_16x16x32_bf16 v[0:3], a[0:3], a[32:35], v[0:3]
  v_add_u32 v221, s86, v224
  v_mfma_f32_16x16x32_bf16 v[4:7], a[4:7], a[32:35], v[4:7]
  ds_read_b128 a[16:19], v221 offset:0
  v_mfma_f32_16x16x32_bf16 v[8:11], a[8:11], a[32:35], v[8:11]
  ds_read_b128 a[20:23], v221 offset:512
  v_mfma_f32_16x16x32_bf16 v[12:15], a[12:15], a[32:35], v[12:15]
  ds_read_b128 a[24:27], v221 offset:4096
  v_mfma_f32_16x16x32_bf16 v[28:31], a[12:15], a[36:39], v[28:31]
  s_add_u32 m0, s88, 32768
  v_mfma_f32_16x16x32_bf16 v[24:27], a[8:11], a[36:39], v[24:27]
  ds_read_b128 a[28:31], v221 offset:4608
  v_mfma_f32_16x16x32_bf16 v[20:23], a[4:7], a[36:39], v[20:23]
  ds_read_b64_tr_b16 a[84:85], v208 offset:49152
  v_mfma_f32_16x16x32_bf16 v[16:19], a[0:3], a[36:39], v[16:19]
  ds_read_b64_tr_b16 a[86:87], v208 offset:50176
  v_mfma_f32_16x16x32_bf16 v[32:35], a[0:3], a[40:43], v[32:35]
  buffer_load_dwordx4 v229, s[12:15], s83 offen lds
  v_mfma_f32_16x16x32_bf16 v[36:39], a[4:7], a[40:43], v[36:39]
  ds_read_b64_tr_b16 a[88:89], v209 offset:49152
  v_mfma_f32_16x16x32_bf16 v[40:43], a[8:11], a[40:43], v[40:43]
  ds_read_b64_tr_b16 a[90:91], v209 offset:50176
  v_mfma_f32_16x16x32_bf16 v[44:47], a[12:15], a[40:43], v[44:47]
  ds_read_b64_tr_b16 a[92:93], v210 offset:49152
  v_mfma_f32_16x16x32_bf16 v[60:63], a[12:15], a[44:47], v[60:63]
  buffer_load_dwordx4 v230, s[12:15], s83 offen offset:1024 lds
  v_mfma_f32_16x16x32_bf16 v[56:59], a[8:11], a[44:47], v[56:59]
  ds_read_b64_tr_b16 a[94:95], v210 offset:50176
  v_mfma_f32_16x16x32_bf16 v[52:55], a[4:7], a[44:47], v[52:55]
  ds_read_b64_tr_b16 a[96:97], v211 offset:49152
  v_mfma_f32_16x16x32_bf16 v[48:51], a[0:3], a[44:47], v[48:51]
  ds_read_b64_tr_b16 a[98:99], v211 offset:50176
  v_mfma_f32_16x16x32_bf16 v[64:67], a[0:3], a[48:51], v[64:67]
  s_add_u32 m0, s88, 34816
  v_mfma_f32_16x16x32_bf16 v[68:71], a[4:7], a[48:51], v[68:71]
  ds_read_b64_tr_b16 a[100:101], v212 offset:49152
  v_mfma_f32_16x16x32_bf16 v[72:75], a[8:11], a[48:51], v[72:75]
  ds_read_b64_tr_b16 a[102:103], v212 offset:50176
  v_mfma_f32_16x16x32_bf16 v[76:79], a[12:15], a[48:51], v[76:79]
  ds_read_b64_tr_b16 a[104:105], v213 offset:49152
  v_mfma_f32_16x16x32_bf16 v[92:95], a[12:15], a[52:55], v[92:95]
  buffer_load_dwordx4 v231, s[16:19], s84 offen lds
  v_mfma_f32_16x16x32_bf16 v[88:91], a[8:11], a[52:55], v[88:91]
  ds_read_b64_tr_b16 a[106:107], v213 offset:50176
  v_mfma_f32_16x16x32_bf16 v[84:87], a[4:7], a[52:55], v[84:87]
  ds_read_b64_tr_b16 a[108:109], v214 offset:49152
  v_mfma_f32_16x16x32_bf16 v[80:83], a[0:3], a[52:55], v[80:83]
  ds_read_b64_tr_b16 a[110:111], v214 offset:50176
  v_mfma_f32_16x16x32_bf16 v[96:99], a[0:3], a[56:59], v[96:99]
  buffer_load_dwordx4 v232, s[16:19], s84 offen offset:1024 lds
  v_mfma_f32_16x16x32_bf16 v[100:103], a[4:7], a[56:59], v[100:103]
  ds_read_b64_tr_b16 a[112:113], v215 offset:51200
  v_mfma_f32_16x16x32_bf16 v[104:107], a[8:11], a[56:59], v[104:107]
  ds_read_b64_tr_b16 a[114:115], v215 offset:52224
  v_mfma_f32_16x16x32_bf16 v[108:111], a[12:15], a[56:59], v[108:111]
  ds_read_b64_tr_b16 a[116:117], v216 offset:51200
  v_mfma_f32_16x16x32_bf16 v[124:127], a[12:15], a[60:63], v[124:127]
  s_add_u32 m0, s85, 4096
  v_mfma_f32_16x16x32_bf16 v[120:123], a[8:11], a[60:63], v[120:123]
  ds_read_b64_tr_b16 a[118:119], v216 offset:52224
  v_mfma_f32_16x16x32_bf16 v[116:119], a[4:7], a[60:63], v[116:119]
  ds_read_b64_tr_b16 a[120:121], v217 offset:51200
  v_mfma_f32_16x16x32_bf16 v[112:115], a[0:3], a[60:63], v[112:115]
  ds_read_b64_tr_b16 a[122:123], v217 offset:52224
  v_mfma_f32_16x16x32_bf16 v[128:131], a[0:3], a[64:67], v[128:131]
  buffer_load_dwordx4 v225, s[8:11], s82 offen offset:0 lds
  v_mfma_f32_16x16x32_bf16 v[132:135], a[4:7], a[64:67], v[132:135]
  ds_read_b64_tr_b16 a[124:125], v218 offset:51200
  v_mfma_f32_16x16x32_bf16 v[136:139], a[8:11], a[64:67], v[136:139]
  ds_read_b64_tr_b16 a[126:127], v218 offset:52224
  v_mfma_f32_16x16x32_bf16 v[140:143], a[12:15], a[64:67], v[140:143]
  ds_read_b64_tr_b16 a[128:129], v219 offset:51200
  v_mfma_f32_16x16x32_bf16 v[156:159], a[12:15], a[68:71], v[156:159]
  buffer_load_dwordx4 v226, s[8:11], s82 offen offset:1024 lds
  v_mfma_f32_16x16x32_bf16 v[152:155], a[8:11], a[68:71], v[152:155]
  ds_read_b64_tr_b16 a[130:131], v219 offset:52224
  v_mfma_f32_16x16x32_bf16 v[148:151], a[4:7], a[68:71], v[148:151]
  ds_read_b64_tr_b16 a[132:133], v220 offset:51200
  v_mfma_f32_16x16x32_bf16 v[144:147], a[0:3], a[68:71], v[144:147]
  ds_read_b64_tr_b16 a[134:135], v220 offset:52224
  v_mfma_f32_16x16x32_bf16 v[160:163], a[0:3], a[72:75], v[160:163]
  buffer_load_dwordx4 v227, s[8:11], s82 offen offset:2048 lds
  v_mfma_f32_16x16x32_bf16 v[164:167], a[4:7], a[72:75], v[164:167]
  buffer_load_dwordx4 v228, s[8:11], s82 offen offset:3072 lds
  v_mfma_f32_16x16x32_bf16 v[168:171], a[8:11], a[72:75], v[168:171]
  buffer_load_dwordx4 a[232:235], v254, s[64:67], s90 offen
  v_mfma_f32_16x16x32_bf16 v[172:175], a[12:15], a[72:75], v[172:175]
  s_add_u32 s83, s83, 229376
  v_mfma_f32_16x16x32_bf16 v[188:191], a[12:15], a[76:79], v[188:191]
  s_add_u32 s84, s84, 196608
  v_mfma_f32_16x16x32_bf16 v[184:187], a[8:11], a[76:79], v[184:187]
  s_sub_u32 s82, s82, 65408
  v_mfma_f32_16x16x32_bf16 v[180:183], a[4:7], a[76:79], v[180:183]
  s_add_u32 s90, s90, 2097152
  v_mfma_f32_16x16x32_bf16 v[176:179], a[0:3], a[76:79], v[176:179]
  s_min_u32 s90, s90, s28
  v_mfma_f32_16x16x32_bf16 v[192:195], a[0:3], a[80:83], v[192:195]
  v_mfma_f32_16x16x32_bf16 v[196:199], a[4:7], a[80:83], v[196:199]
  v_mfma_f32_16x16x32_bf16 v[200:203], a[8:11], a[80:83], v[200:203]
  v_mfma_f32_16x16x32_bf16 v[204:207], a[12:15], a[80:83], v[204:207]
  s_waitcnt vmcnt(19) lgkmcnt(0)
  s_barrier
  v_mfma_f32_16x16x32_bf16 v[0:3], a[16:19], a[84:87], v[0:3]
  v_add_u32 v221, s87, v223
  v_mfma_f32_16x16x32_bf16 v[4:7], a[20:23], a[84:87], v[4:7]
  ds_read_b128 a[0:3], v221 offset:0
  v_mfma_f32_16x16x32_bf16 v[8:11], a[24:27], a[84:87], v[8:11]
  ds_read_b128 a[4:7], v221 offset:512
  v_mfma_f32_16x16x32_bf16 v[12:15], a[28:31], a[84:87], v[12:15]
  ds_read_b128 a[8:11], v221 offset:4096
  v_mfma_f32_16x16x32_bf16 v[28:31], a[28:31], a[88:91], v[28:31]
  s_add_u32 m0, s88, 49152
  v_mfma_f32_16x16x32_bf16 v[24:27], a[24:27], a[88:91], v[24:27]
  ds_read_b128 a[12:15], v221 offset:4608
  v_mfma_f32_16x16x32_bf16 v[20:23], a[20:23], a[88:91], v[20:23]
  ds_read_b64_tr_b16 a[32:33], v208 offset:0
  v_mfma_f32_16x16x32_bf16 v[16:19], a[16:19], a[88:91], v[16:19]
  ds_read_b64_tr_b16 a[34:35], v208 offset:1024
  v_mfma_f32_16x16x32_bf16 v[32:35], a[16:19], a[92:95], v[32:35]
  buffer_load_dwordx4 v229, s[12:15], s83 offen lds
  v_mfma_f32_16x16x32_bf16 v[36:39], a[20:23], a[92:95], v[36:39]
  ds_read_b64_tr_b16 a[36:37], v209 offset:0
  v_mfma_f32_16x16x32_bf16 v[40:43], a[24:27], a[92:95], v[40:43]
  ds_read_b64_tr_b16 a[38:39], v209 offset:1024
  v_mfma_f32_16x16x32_bf16 v[44:47], a[28:31], a[92:95], v[44:47]
  ds_read_b64_tr_b16 a[40:41], v210 offset:0
  v_mfma_f32_16x16x32_bf16 v[60:63], a[28:31], a[96:99], v[60:63]
  buffer_load_dwordx4 v230, s[12:15], s83 offen offset:1024 lds
  v_mfma_f32_16x16x32_bf16 v[56:59], a[24:27], a[96:99], v[56:59]
  ds_read_b64_tr_b16 a[42:43], v210 offset:1024
  v_mfma_f32_16x16x32_bf16 v[52:55], a[20:23], a[96:99], v[52:55]
  ds_read_b64_tr_b16 a[44:45], v211 offset:0
  v_mfma_f32_16x16x32_bf16 v[48:51], a[16:19], a[96:99], v[48:51]
  ds_read_b64_tr_b16 a[46:47], v211 offset:1024
  v_mfma_f32_16x16x32_bf16 v[64:67], a[16:19], a[100:103], v[64:67]
  s_add_u32 m0, s88, 51200
  v_mfma_f32_16x16x32_bf16 v[68:71], a[20:23], a[100:103], v[68:71]
  ds_read_b64_tr_b16 a[48:49], v212 offset:0
  v_mfma_f32_16x16x32_bf16 v[72:75], a[24:27], a[100:103], v[72:75]
  ds_read_b64_tr_b16 a[50:51], v212 offset:1024
  v_mfma_f32_16x16x32_bf16 v[76:79], a[28:31], a[100:103], v[76:79]
  ds_read_b64_tr_b16 a[52:53], v213 offset:0
  v_mfma_f32_16x16x32_bf16 v[92:95], a[28:31], a[104:107], v[92:95]
  buffer_load_dwordx4 v231, s[16:19], s84 offen lds
  v_mfma_f32_16x16x32_bf16 v[88:91], a[24:27], a[104:107], v[88:91]
  ds_read_b64_tr_b16 a[54:55], v213 offset:1024
  v_mfma_f32_16x16x32_bf16 v[84:87], a[20:23], a[104:107], v[84:87]
  ds_read_b64_tr_b16 a[56:57], v214 offset:0
  v_mfma_f32_16x16x32_bf16 v[80:83], a[16:19], a[104:107], v[80:83]
  ds_read_b64_tr_b16 a[58:59], v214 offset:1024
  v_mfma_f32_16x16x32_bf16 v[96:99], a[16:19], a[108:111], v[96:99]
  buffer_load_dwordx4 v232, s[16:19], s84 offen offset:1024 lds
  v_mfma_f32_16x16x32_bf16 v[100:103], a[20:23], a[108:111], v[100:103]
  ds_read_b64_tr_b16 a[60:61], v215 offset:2048
  v_mfma_f32_16x16x32_bf16 v[104:107], a[24:27], a[108:111], v[104:107]
  ds_read_b64_tr_b16 a[62:63], v215 offset:3072
  v_mfma_f32_16x16x32_bf16 v[108:111], a[28:31], a[108:111], v[108:111]
  ds_read_b64_tr_b16 a[64:65], v216 offset:2048
  v_mfma_f32_16x16x32_bf16 v[124:127], a[28:31], a[112:115], v[124:127]
  s_add_u32 m0, s86, 0
  v_mfma_f32_16x16x32_bf16 v[120:123], a[24:27], a[112:115], v[120:123]
  ds_read_b64_tr_b16 a[66:67], v216 offset:3072
  v_mfma_f32_16x16x32_bf16 v[116:119], a[20:23], a[112:115], v[116:119]
  ds_read_b64_tr_b16 a[68:69], v217 offset:2048
  v_mfma_f32_16x16x32_bf16 v[112:115], a[16:19], a[112:115], v[112:115]
  ds_read_b64_tr_b16 a[70:71], v217 offset:3072
  v_mfma_f32_16x16x32_bf16 v[128:131], a[16:19], a[116:119], v[128:131]
  buffer_load_dwordx4 v225, s[8:11], s82 offen offset:0 lds
  v_mfma_f32_16x16x32_bf16 v[132:135], a[20:23], a[116:119], v[132:135]
  ds_read_b64_tr_b16 a[72:73], v218 offset:2048
  v_mfma_f32_16x16x32_bf16 v[136:139], a[24:27], a[116:119], v[136:139]
  ds_read_b64_tr_b16 a[74:75], v218 offset:3072
  v_mfma_f32_16x16x32_bf16 v[140:143], a[28:31], a[116:119], v[140:143]
  ds_read_b64_tr_b16 a[76:77], v219 offset:2048
  v_mfma_f32_16x16x32_bf16 v[156:159], a[28:31], a[120:123], v[156:159]
  buffer_load_dwordx4 v226, s[8:11], s82 offen offset:1024 lds
  v_mfma_f32_16x16x32_bf16 v[152:155], a[24:27], a[120:123], v[152:155]
  ds_read_b64_tr_b16 a[78:79], v219 offset:3072
  v_mfma_f32_16x16x32_bf16 v[148:151], a[20:23], a[120:123], v[148:151]
  ds_read_b64_tr_b16 a[80:81], v220 offset:2048
  v_mfma_f32_16x16x32_bf16 v[144:147], a[16:19], a[120:123], v[144:147]
  ds_read_b64_tr_b16 a[82:83], v220 offset:3072
  v_mfma_f32_16x16x32_bf16 v[160:163], a[16:19], a[124:127], v[160:163]
  buffer_load_dwordx4 v227, s[8:11], s82 offen offset:2048 lds
  v_mfma_f32_16x16x32_bf16 v[164:167], a[20:23], a[124:127], v[164:167]
  buffer_load_dwordx4 v228, s[8:11], s82 offen offset:3072 lds
  v_mfma_f32_16x16x32_bf16 v[168:171], a[24:27], a[124:127], v[168:171]
  buffer_load_dwordx4 a[232:235], v255, s[68:71], s91 offen
  v_mfma_f32_16x16x32_bf16 v[172:175], a[28:31], a[124:127], v[172:175]
  s_add_u32 s83, s83, 229376
  v_mfma_f32_16x16x32_bf16 v[188:191], a[28:31], a[128:131], v[188:191]
  s_add_u32 s84, s84, 196608
  v_mfma_f32_16x16x32_bf16 v[184:187], a[24:27], a[128:131], v[184:187]
  s_add_u32 s82, s82, 65536
  v_mfma_f32_16x16x32_bf16 v[180:183], a[20:23], a[128:131], v[180:183]
  s_mov_b32 s24, s87
  v_mfma_f32_16x16x32_bf16 v[176:179], a[16:19], a[128:131], v[176:179]
  s_mov_b32 s87, s86
  v_mfma_f32_16x16x32_bf16 v[192:195], a[16:19], a[132:135], v[192:195]
  s_mov_b32 s86, s85
  v_mfma_f32_16x16x32_bf16 v[196:199], a[20:23], a[132:135], v[196:199]
  s_mov_b32 s85, s24
  v_mfma_f32_16x16x32_bf16 v[200:203], a[24:27], a[132:135], v[200:203]
  s_add_u32 s91, s91, 2097152
  v_mfma_f32_16x16x32_bf16 v[204:207], a[28:31], a[132:135], v[204:207]
  s_min_u32 s91, s91, s29
  s_waitcnt vmcnt(19) lgkmcnt(0)
  s_barrier
  s_cmp_lg_u32 s89, 5
  s_cbranch_scc1 gated_mix__mha_block__mixer_gmlp__prompt_kernel_v3_s5
  s_call_b64 s[24:25], gated_mix__mha_block__mixer_gmlp__prompt_kernel_pfsw1
gated_mix__mha_block__mixer_gmlp__prompt_kernel_v3_s5:
  s_cmp_lg_u32 s89, 3
  s_cbranch_scc1 gated_mix__mha_block__mixer_gmlp__prompt_kernel_v3_s3
  s_call_b64 s[24:25], gated_mix__mha_block__mixer_gmlp__prompt_kernel_pfsw2
gated_mix__mha_block__mixer_gmlp__prompt_kernel_v3_s3:
  s_cmp_lg_u32 s89, s94
  s_cbranch_scc1 gated_mix__mha_block__mixer_gmlp__prompt_kernel_v3_na
  s_call_b64 s[24:25], gated_mix__mha_block__mixer_gmlp__prompt_kernel_arrive
gated_mix__mha_block__mixer_gmlp__prompt_kernel_v3_na:
  s_cmp_lg_u32 s89, 0
  s_cbranch_scc1 gated_mix__mha_block__mixer_gmlp__prompt_kernel_v3_loop
  s_cmp_lg_u32 s44, 0
  s_cbranch_scc1 gated_mix__mha_block__mixer_gmlp__prompt_kernel_v3_ar0
  v_mov_b32 v236, 0
  global_load_dword v237, v236, s[100:101] sc1
gated_mix__mha_block__mixer_gmlp__prompt_kernel_v3_ar0:
  v_mfma_f32_16x16x32_bf16 v[0:3], a[0:3], a[32:35], v[0:3]
  v_add_u32 v221, s85, v224
  v_mfma_f32_16x16x32_bf16 v[4:7], a[4:7], a[32:35], v[4:7]
  ds_read_b128 a[16:19], v221 offset:0
  v_mfma_f32_16x16x32_bf16 v[8:11], a[8:11], a[32:35], v[8:11]
  ds_read_b128 a[20:23], v221 offset:512
  v_mfma_f32_16x16x32_bf16 v[12:15], a[12:15], a[32:35], v[12:15]
  ds_read_b128 a[24:27], v221 offset:4096
  v_mfma_f32_16x16x32_bf16 v[28:31], a[12:15], a[36:39], v[28:31]
  ds_read_b128 a[28:31], v221 offset:4608
  v_mfma_f32_16x16x32_bf16 v[24:27], a[8:11], a[36:39], v[24:27]
  ds_read_b64_tr_b16 a[84:85], v208 offset:16384
  v_mfma_f32_16x16x32_bf16 v[20:23], a[4:7], a[36:39], v[20:23]
  ds_read_b64_tr_b16 a[86:87], v208 offset:17408
  v_mfma_f32_16x16x32_bf16 v[16:19], a[0:3], a[36:39], v[16:19]
  ds_read_b64_tr_b16 a[88:89], v209 offset:16384
  v_mfma_f32_16x16x32_bf16 v[32:35], a[0:3], a[40:43], v[32:35]
  ds_read_b64_tr_b16 a[90:91], v209 offset:17408
  v_mfma_f32_16x16x32_bf16 v[36:39], a[4:7], a[40:43], v[36:39]
  ds_read_b64_tr_b16 a[92:93], v210 offset:16384
  v_mfma_f32_16x16x32_bf16 v[40:43], a[8:11], a[40:43], v[40:43]
  ds_read_b64_tr_b16 a[94:95], v210 offset:17408
  v_mfma_f32_16x16x32_bf16 v[44:47], a[12:15], a[40:43], v[44:47]
  ds_read_b64_tr_b16 a[96:97], v211 offset:16384
  v_mfma_f32_16x16x32_bf16 v[60:63], a[12:15], a[44:47], v[60:63]
  ds_read_b64_tr_b16 a[98:99], v211 offset:17408
  v_mfma_f32_16x16x32_bf16 v[56:59], a[8:11], a[44:47], v[56:59]
  ds_read_b64_tr_b16 a[100:101], v212 offset:16384
  v_mfma_f32_16x16x32_bf16 v[52:55], a[4:7], a[44:47], v[52:55]
  ds_read_b64_tr_b16 a[102:103], v212 offset:17408
  v_mfma_f32_16x16x32_bf16 v[48:51], a[0:3], a[44:47], v[48:51]
  ds_read_b64_tr_b16 a[104:105], v213 offset:16384
  v_mfma_f32_16x16x32_bf16 v[64:67], a[0:3], a[48:51], v[64:67]
  ds_read_b64_tr_b16 a[106:107], v213 offset:17408
  v_mfma_f32_16x16x32_bf16 v[68:71], a[4:7], a[48:51], v[68:71]
  ds_read_b64_tr_b16 a[108:109], v214 offset:16384
  v_mfma_f32_16x16x32_bf16 v[72:75], a[8:11], a[48:51], v[72:75]
  ds_read_b64_tr_b16 a[110:111], v214 offset:17408
  v_mfma_f32_16x16x32_bf16 v[76:79], a[12:15], a[48:51], v[76:79]
  ds_read_b64_tr_b16 a[112:113], v215 offset:18432
  v_mfma_f32_16x16x32_bf16 v[92:95], a[12:15], a[52:55], v[92:95]
  ds_read_b64_tr_b16 a[114:115], v215 offset:19456
  v_mfma_f32_16x16x32_bf16 v[88:91], a[8:11], a[52:55], v[88:91]
  ds_read_b64_tr_b16 a[116:117], v216 offset:18432
  v_mfma_f32_16x16x32_bf16 v[84:87], a[4:7], a[52:55], v[84:87]
  ds_read_b64_tr_b16 a[118:119], v216 offset:19456
  v_mfma_f32_16x16x32_bf16 v[80:83], a[0:3], a[52:55], v[80:83]
  ds_read_b64_tr_b16 a[120:121], v217 offset:18432
  v_mfma_f32_16x16x32_bf16 v[96:99], a[0:3], a[56:59], v[96:99]
  ds_read_b64_tr_b16 a[122:123], v217 offset:19456
  v_mfma_f32_16x16x32_bf16 v[100:103], a[4:7], a[56:59], v[100:103]
  ds_read_b64_tr_b16 a[124:125], v218 offset:18432
  v_mfma_f32_16x16x32_bf16 v[104:107], a[8:11], a[56:59], v[104:107]
  ds_read_b64_tr_b16 a[126:127], v218 offset:19456
  v_mfma_f32_16x16x32_bf16 v[108:111], a[12:15], a[56:59], v[108:111]
  ds_read_b64_tr_b16 a[128:129], v219 offset:18432
  v_mfma_f32_16x16x32_bf16 v[124:127], a[12:15], a[60:63], v[124:127]
  ds_read_b64_tr_b16 a[130:131], v219 offset:19456
  v_mfma_f32_16x16x32_bf16 v[120:123], a[8:11], a[60:63], v[120:123]
  ds_read_b64_tr_b16 a[132:133], v220 offset:18432
  v_mfma_f32_16x16x32_bf16 v[116:119], a[4:7], a[60:63], v[116:119]
  ds_read_b64_tr_b16 a[134:135], v220 offset:19456
  v_mfma_f32_16x16x32_bf16 v[112:115], a[0:3], a[60:63], v[112:115]
  v_lshlrev_b32 v242, 5, v234
  v_mfma_f32_16x16x32_bf16 v[128:131], a[0:3], a[64:67], v[128:131]
  s_lshl_b32 s31, s93, 11
  v_mfma_f32_16x16x32_bf16 v[132:135], a[4:7], a[64:67], v[132:135]
  buffer_load_dwordx4 a[140:143], v242, s[8:11], s31 offen offset:0
  v_mfma_f32_16x16x32_bf16 v[136:139], a[8:11], a[64:67], v[136:139]
  buffer_load_dwordx4 a[144:147], v242, s[8:11], s31 offen offset:16
  v_mfma_f32_16x16x32_bf16 v[140:143], a[12:15], a[64:67], v[140:143]
  buffer_load_dwordx4 a[148:151], v242, s[8:11], s31 offen offset:2048
  v_mfma_f32_16x16x32_bf16 v[156:159], a[12:15], a[68:71], v[156:159]
  buffer_load_dwordx4 a[152:155], v242, s[8:11], s31 offen offset:2064
  v_mfma_f32_16x16x32_bf16 v[152:155], a[8:11], a[68:71], v[152:155]
  buffer_load_dwordx4 a[156:159], v242, s[20:23], 0 offen offset:0
  v_mfma_f32_16x16x32_bf16 v[148:151], a[4:7], a[68:71], v[148:151]
  buffer_load_dwordx4 a[160:163], v242, s[20:23], 0 offen offset:16
  v_mfma_f32_16x16x32_bf16 v[144:147], a[0:3], a[68:71], v[144:147]
  v_mfma_f32_16x16x32_bf16 v[160:163], a[0:3], a[72:75], v[160:163]
  v_mfma_f32_16x16x32_bf16 v[164:167], a[4:7], a[72:75], v[164:167]
  v_mfma_f32_16x16x32_bf16 v[168:171], a[8:11], a[72:75], v[168:171]
  v_mfma_f32_16x16x32_bf16 v[172:175], a[12:15], a[72:75], v[172:175]
  v_mfma_f32_16x16x32_bf16 v[188:191], a[12:15], a[76:79], v[188:191]
  v_mfma_f32_16x16x32_bf16 v[184:187], a[8:11], a[76:79], v[184:187]
  v_mfma_f32_16x16x32_bf16 v[180:183], a[4:7], a[76:79], v[180:183]
  v_mfma_f32_16x16x32_bf16 v[176:179], a[0:3], a[76:79], v[176:179]
  v_mfma_f32_16x16x32_bf16 v[192:195], a[0:3], a[80:83], v[192:195]
  v_mfma_f32_16x16x32_bf16 v[196:199], a[4:7], a[80:83], v[196:199]
  v_mfma_f32_16x16x32_bf16 v[200:203], a[8:11], a[80:83], v[200:203]
  v_mfma_f32_16x16x32_bf16 v[204:207], a[12:15], a[80:83], v[204:207]
  s_waitcnt vmcnt(16) lgkmcnt(0)
  s_barrier
  v_mfma_f32_16x16x32_bf16 v[0:3], a[16:19], a[84:87], v[0:3]
  v_add_u32 v221, s86, v223
  v_mfma_f32_16x16x32_bf16 v[4:7], a[20:23], a[84:87], v[4:7]
  ds_read_b128 a[0:3], v221 offset:0
  v_mfma_f32_16x16x32_bf16 v[8:11], a[24:27], a[84:87], v[8:11]
  ds_read_b128 a[4:7], v221 offset:512
  v_mfma_f32_16x16x32_bf16 v[12:15], a[28:31], a[84:87], v[12:15]
  ds_read_b128 a[8:11], v221 offset:4096
  v_mfma_f32_16x16x32_bf16 v[28:31], a[28:31], a[88:91], v[28:31]
  ds_read_b128 a[12:15], v221 offset:4608
  v_mfma_f32_16x16x32_bf16 v[24:27], a[24:27], a[88:91], v[24:27]
  ds_read_b64_tr_b16 a[32:33], v208 offset:32768
  v_mfma_f32_16x16x32_bf16 v[20:23], a[20:23], a[88:91], v[20:23]
  ds_read_b64_tr_b16 a[34:35], v208 offset:33792
  v_mfma_f32_16x16x32_bf16 v[16:19], a[16:19], a[88:91], v[16:19]
  ds_read_b64_tr_b16 a[36:37], v209 offset:32768
  v_mfma_f32_16x16x32_bf16 v[32:35], a[16:19], a[92:95], v[32:35]
  ds_read_b64_tr_b16 a[38:39], v209 offset:33792
  v_mfma_f32_16x16x32_bf16 v[36:39], a[20:23], a[92:95], v[36:39]
  ds_read_b64_tr_b16 a[40:41], v210 offset:32768
  v_mfma_f32_16x16x32_bf16 v[40:43], a[24:27], a[92:95], v[40:43]
  ds_read_b64_tr_b16 a[42:43], v210 offset:33792
  v_mfma_f32_16x16x32_bf16 v[44:47], a[28:31], a[92:95], v[44:47]
  ds_read_b64_tr_b16 a[44:45], v211 offset:32768
  v_mfma_f32_16x16x32_bf16 v[60:63], a[28:31], a[96:99], v[60:63]
  ds_read_b64_tr_b16 a[46:47], v211 offset:33792
  v_mfma_f32_16x16x32_bf16 v[56:59], a[24:27], a[96:99], v[56:59]
  ds_read_b64_tr_b16 a[48:49], v212 offset:32768
  v_mfma_f32_16x16x32_bf16 v[52:55], a[20:23], a[96:99], v[52:55]
  ds_read_b64_tr_b16 a[50:51], v212 offset:33792
  v_mfma_f32_16x16x32_bf16 v[48:51], a[16:19], a[96:99], v[48:51]
  ds_read_b64_tr_b16 a[52:53], v213 offset:32768
  v_mfma_f32_16x16x32_bf16 v[64:67], a[16:19], a[100:103], v[64:67]
  ds_read_b64_tr_b16 a[54:55], v213 offset:33792
  v_mfma_f32_16x16x32_bf16 v[68:71], a[20:23], a[100:103], v[68:71]
  ds_read_b64_tr_b16 a[56:57], v214 offset:32768
  v_mfma_f32_16x16x32_bf16 v[72:75], a[24:27], a[100:103], v[72:75]
  ds_read_b64_tr_b16 a[58:59], v214 offset:33792
  v_mfma_f32_16x16x32_bf16 v[76:79], a[28:31], a[100:103], v[76:79]
  ds_read_b64_tr_b16 a[60:61], v215 offset:34816
  v_mfma_f32_16x16x32_bf16 v[92:95], a[28:31], a[104:107], v[92:95]
  ds_read_b64_tr_b16 a[62:63], v215 offset:35840
  v_mfma_f32_16x16x32_bf16 v[88:91], a[24:27], a[104:107], v[88:91]
  ds_read_b64_tr_b16 a[64:65], v216 offset:34816
  v_mfma_f32_16x16x32_bf16 v[84:87], a[20:23], a[104:107], v[84:87]
  ds_read_b64_tr_b16 a[66:67], v216 offset:35840
  v_mfma_f32_16x16x32_bf16 v[80:83], a[16:19], a[104:107], v[80:83]
  ds_read_b64_tr_b16 a[68:69], v217 offset:34816
  v_mfma_f32_16x16x32_bf16 v[96:99], a[16:19], a[108:111], v[96:99]
  ds_read_b64_tr_b16 a[70:71], v217 offset:35840
  v_mfma_f32_16x16x32_bf16 v[100:103], a[20:23], a[108:111], v[100:103]
  ds_read_b64_tr_b16 a[72:73], v218 offset:34816
  v_mfma_f32_16x16x32_bf16 v[104:107], a[24:27], a[108:111], v[104:107]
  ds_read_b64_tr_b16 a[74:75], v218 offset:35840
  v_mfma_f32_16x16x32_bf16 v[108:111], a[28:31], a[108:111], v[108:111]
  ds_read_b64_tr_b16 a[76:77], v219 offset:34816
  v_mfma_f32_16x16x32_bf16 v[124:127], a[28:31], a[112:115], v[124:127]
  ds_read_b64_tr_b16 a[78:79], v219 offset:35840
  v_mfma_f32_16x16x32_bf16 v[120:123], a[24:27], a[112:115], v[120:123]
  ds_read_b64_tr_b16 a[80:81], v220 offset:34816
  v_mfma_f32_16x16x32_bf16 v[116:119], a[20:23], a[112:115], v[116:119]
  ds_read_b64_tr_b16 a[82:83], v220 offset:35840
  v_mfma_f32_16x16x32_bf16 v[112:115], a[16:19], a[112:115], v[112:115]
  v_mfma_f32_16x16x32_bf16 v[128:131], a[16:19], a[116:119], v[128:131]
  v_mfma_f32_16x16x32_bf16 v[132:135], a[20:23], a[116:119], v[132:135]
  v_mfma_f32_16x16x32_bf16 v[136:139], a[24:27], a[116:119], v[136:139]
  v_mfma_f32_16x16x32_bf16 v[140:143], a[28:31], a[116:119], v[140:143]
  v_mfma_f32_16x16x32_bf16 v[156:159], a[28:31], a[120:123], v[156:159]
  v_mfma_f32_16x16x32_bf16 v[152:155], a[24:27], a[120:123], v[152:155]
  v_mfma_f32_16x16x32_bf16 v[148:151], a[20:23], a[120:123], v[148:151]
  v_mfma_f32_16x16x32_bf16 v[144:147], a[16:19], a[120:123], v[144:147]
  v_mfma_f32_16x16x32_bf16 v[160:163], a[16:19], a[124:127], v[160:163]
  v_mfma_f32_16x16x32_bf16 v[164:167], a[20:23], a[124:127], v[164:167]
  v_mfma_f32_16x16x32_bf16 v[168:171], a[24:27], a[124:127], v[168:171]
  v_mfma_f32_16x16x32_bf16 v[172:175], a[28:31], a[124:127], v[172:175]
  v_mfma_f32_16x16x32_bf16 v[188:191], a[28:31], a[128:131], v[188:191]
  v_mfma_f32_16x16x32_bf16 v[184:187], a[24:27], a[128:131], v[184:187]
  v_mfma_f32_16x16x32_bf16 v[180:183], a[20:23], a[128:131], v[180:183]
  v_mfma_f32_16x16x32_bf16 v[176:179], a[16:19], a[128:131], v[176:179]
  v_mfma_f32_16x16x32_bf16 v[192:195], a[16:19], a[132:135], v[192:195]
  v_mfma_f32_16x16x32_bf16 v[196:199], a[20:23], a[132:135], v[196:199]
  v_mfma_f32_16x16x32_bf16 v[200:203], a[24:27], a[132:135], v[200:203]
  v_mfma_f32_16x16x32_bf16 v[204:207], a[28:31], a[132:135], v[204:207]
  s_waitcnt vmcnt(0) lgkmcnt(0)
  v_readfirstlane_b32 s26, v237
  s_cmp_lg_u32 s44, 0
  s_cbranch_scc1 gated_mix__mha_block__mixer_gmlp__prompt_kernel_v3_arr
  s_nop 1
  s_cmp_ge_u32 s26, 80
  s_cbranch_scc1 gated_mix__mha_block__mixer_gmlp__prompt_kernel_v3_arr
  s_call_b64 s[24:25], gated_mix__mha_block__mixer_gmlp__prompt_kernel_arrchk
gated_mix__mha_block__mixer_gmlp__prompt_kernel_v3_arr:
  s_barrier
  v_mfma_f32_16x16x32_bf16 v[0:3], a[0:3], a[32:35], v[0:3]
  v_add_u32 v221, s86, v224
  v_mov_b32 v244, 0
  v_mov_b32 v245, 0
  v_accvgpr_read_b32 v247, a156
  v_mfma_f32_16x16x32_bf16 v[4:7], a[4:7], a[32:35], v[4:7]
  ds_read_b128 a[16:19], v221 offset:0
  v_lshlrev_b32 v246, 16, v247
  v_and_b32 v247, 0xffff0000, v247
  v_accvgpr_read_b32 v249, a140
  v_mfma_f32_16x16x32_bf16 v[8:11], a[8:11], a[32:35], v[8:11]
  ds_read_b128 a[20:23], v221 offset:512
  v_lshlrev_b32 v248, 16, v249
  v_and_b32 v249, 0xffff0000, v249
  v_mfma_f32_16x16x32_bf16 v[12:15], a[12:15], a[32:35], v[12:15]
  ds_read_b128 a[24:27], v221 offset:4096
  v_fmac_f32 v244, v246, v248
  v_fmac_f32 v244, v247, v249
  v_mfma_f32_16x16x32_bf16 v[28:31], a[12:15], a[36:39], v[28:31]
  ds_read_b128 a[28:31], v221 offset:4608
  v_accvgpr_read_b32 v249, a148
  v_lshlrev_b32 v248, 16, v249
  v_mfma_f32_16x16x32_bf16 v[24:27], a[8:11], a[36:39], v[24:27]
  ds_read_b64_tr_b16 a[84:85], v208 offset:49152
  v_and_b32 v249, 0xffff0000, v249
  v_fmac_f32 v245, v246, v248
  v_mfma_f32_16x16x32_bf16 v[20:23], a[4:7], a[36:39], v[20:23]
  ds_read_b64_tr_b16 a[86:87], v208 offset:50176
  v_fmac_f32 v245, v247, v249
  v_accvgpr_read_b32 v247, a157
  v_mfma_f32_16x16x32_bf16 v[16:19], a[0:3], a[36:39], v[16:19]
  ds_read_b64_tr_b16 a[88:89], v209 offset:49152
  v_lshlrev_b32 v246, 16, v247
  v_and_b32 v247, 0xffff0000, v247
  v_mfma_f32_16x16x32_bf16 v[32:35], a[0:3], a[40:43], v[32:35]
  ds_read_b64_tr_b16 a[90:91], v209 offset:50176
  v_accvgpr_read_b32 v249, a141
  v_lshlrev_b32 v248, 16, v249
  v_mfma_f32_16x16x32_bf16 v[36:39], a[4:7], a[40:43], v[36:39]
  ds_read_b64_tr_b16 a[92:93], v210 offset:49152
  v_and_b32 v249, 0xffff0000, v249
  v_fmac_f32 v244, v246, v248
  v_mfma_f32_16x16x32_bf16 v[40:43], a[8:11], a[40:43], v[40:43]
  ds_read_b64_tr_b16 a[94:95], v210 offset:50176
  v_fmac_f32 v244, v247, v249
  v_accvgpr_read_b32 v249, a149
  v_mfma_f32_16x16x32_bf16 v[44:47], a[12:15], a[40:43], v[44:47]
  ds_read_b64_tr_b16 a[96:97], v211 offset:49152
  v_lshlrev_b32 v248, 16, v249
  v_and_b32 v249, 0xffff0000, v249
  v_mfma_f32_16x16x32_bf16 v[60:63], a[12:15], a[44:47], v[60:63]
  ds_read_b64_tr_b16 a[98:99], v211 offset:50176
  v_fmac_f32 v245, v246, v248
  v_fmac_f32 v245, v247, v249
  v_mfma_f32_16x16x32_bf16 v[56:59], a[8:11], a[44:47], v[56:59]
  ds_read_b64_tr_b16 a[100:101], v212 offset:49152
  v_accvgpr_read_b32 v247, a158
  v_lshlrev_b32 v246, 16, v247
  v_mfma_f32_16x16x32_bf16 v[52:55], a[4:7], a[44:47], v[52:55]
  ds_read_b64_tr_b16 a[102:103], v212 offset:50176
  v_and_b32 v247, 0xffff0000, v247
  v_accvgpr_read_b32 v249, a142
  v_mfma_f32_16x16x32_bf16 v[48:51], a[0:3], a[44:47], v[48:51]
  ds_read_b64_tr_b16 a[104:105], v213 offset:49152
  v_lshlrev_b32 v248, 16, v249
  v_and_b32 v249, 0xffff0000, v249
  v_mfma_f32_16x16x32_bf16 v[64:67], a[0:3], a[48:51], v[64:67]
  ds_read_b64_tr_b16 a[106:107], v213 offset:50176
  v_fmac_f32 v244, v246, v248
  v_fmac_f32 v244, v247, v249
  v_mfma_f32_16x16x32_bf16 v[68:71], a[4:7], a[48:51], v[68:71]
  ds_read_b64_tr_b16 a[108:109], v214 offset:49152
  v_accvgpr_read_b32 v249, a150
  v_lshlrev_b32 v248, 16, v249
  v_mfma_f32_16x16x32_bf16 v[72:75], a[8:11], a[48:51], v[72:75]
  ds_read_b64_tr_b16 a[110:111], v214 offset:50176
  v_and_b32 v249, 0xffff0000, v249
  v_fmac_f32 v245, v246, v248
  v_mfma_f32_16x16x32_bf16 v[76:79], a[12:15], a[48:51], v[76:79]
  ds_read_b64_tr_b16 a[112:113], v215 offset:51200
  v_fmac_f32 v245, v247, v249
  v_accvgpr_read_b32 v247, a159
  v_mfma_f32_16x16x32_bf16 v[92:95], a[12:15], a[52:55], v[92:95]
  ds_read_b64_tr_b16 a[114:115], v215 offset:52224
  v_lshlrev_b32 v246, 16, v247
  v_and_b32 v247, 0xffff0000, v247
  v_mfma_f32_16x16x32_bf16 v[88:91], a[8:11], a[52:55], v[88:91]
  ds_read_b64_tr_b16 a[116:117], v216 offset:51200
  v_accvgpr_read_b32 v249, a143
  v_lshlrev_b32 v248, 16, v249
  v_mfma_f32_16x16x32_bf16 v[84:87], a[4:7], a[52:55], v[84:87]
  ds_read_b64_tr_b16 a[118:119], v216 offset:52224
  v_and_b32 v249, 0xffff0000, v249
  v_fmac_f32 v244, v246, v248
  v_mfma_f32_16x16x32_bf16 v[80:83], a[0:3], a[52:55], v[80:83]
  ds_read_b64_tr_b16 a[120:121], v217 offset:51200
  v_fmac_f32 v244, v247, v249
  v_accvgpr_read_b32 v249, a151
  v_mfma_f32_16x16x32_bf16 v[96:99], a[0:3], a[56:59], v[96:99]
  ds_read_b64_tr_b16 a[122:123], v217 offset:52224
  v_lshlrev_b32 v248, 16, v249
  v_and_b32 v249, 0xffff0000, v249
  v_mfma_f32_16x16x32_bf16 v[100:103], a[4:7], a[56:59], v[100:103]
  ds_read_b64_tr_b16 a[124:125], v218 offset:51200
  v_fmac_f32 v245, v246, v248
  v_fmac_f32 v245, v247, v249
  v_mfma_f32_16x16x32_bf16 v[104:107], a[8:11], a[56:59], v[104:107]
  ds_read_b64_tr_b16 a[126:127], v218 offset:52224
  v_accvgpr_read_b32 v247, a160
  v_lshlrev_b32 v246, 16, v247
  v_mfma_f32_16x16x32_bf16 v[108:111], a[12:15], a[56:59], v[108:111]
  ds_read_b64_tr_b16 a[128:129], v219 offset:51200
  v_and_b32 v247, 0xffff0000, v247
  v_accvgpr_read_b32 v249, a144
  v_mfma_f32_16x16x32_bf16 v[124:127], a[12:15], a[60:63], v[124:127]
  ds_read_b64_tr_b16 a[130:131], v219 offset:52224
  v_lshlrev_b32 v248, 16, v249
  v_and_b32 v249, 0xffff0000, v249
  v_mfma_f32_16x16x32_bf16 v[120:123], a[8:11], a[60:63], v[120:123]
  ds_read_b64_tr_b16 a[132:133], v220 offset:51200
  v_fmac_f32 v244, v246, v248
  v_fmac_f32 v244, v247, v249
  v_mfma_f32_16x16x32_bf16 v[116:119], a[4:7], a[60:63], v[116:119]
  ds_read_b64_tr_b16 a[134:135], v220 offset:52224
  v_accvgpr_read_b32 v249, a152
  v_lshlrev_b32 v248, 16, v249
  v_mfma_f32_16x16x32_bf16 v[112:115], a[0:3], a[60:63], v[112:115]
  v_and_b32 v249, 0xffff0000, v249
  v_fmac_f32 v245, v246, v248
  v_mfma_f32_16x16x32_bf16 v[128:131], a[0:3], a[64:67], v[128:131]
  v_fmac_f32 v245, v247, v249
  v_accvgpr_read_b32 v247, a161
  v_mfma_f32_16x16x32_bf16 v[132:135], a[4:7], a[64:67], v[132:135]
  v_lshlrev_b32 v246, 16, v247
  v_and_b32 v247, 0xffff0000, v247
  v_mfma_f32_16x16x32_bf16 v[136:139], a[8:11], a[64:67], v[136:139]
  v_accvgpr_read_b32 v249, a145
  v_lshlrev_b32 v248, 16, v249
  v_mfma_f32_16x16x32_bf16 v[140:143], a[12:15], a[64:67], v[140:143]
  v_and_b32 v249, 0xffff0000, v249
  v_fmac_f32 v244, v246, v248
  v_mfma_f32_16x16x32_bf16 v[156:159], a[12:15], a[68:71], v[156:159]
  v_fmac_f32 v244, v247, v249
  v_accvgpr_read_b32 v249, a153
  v_mfma_f32_16x16x32_bf16 v[152:155], a[8:11], a[68:71], v[152:155]
  v_lshlrev_b32 v248, 16, v249
  v_and_b32 v249, 0xffff0000, v249
  v_mfma_f32_16x16x32_bf16 v[148:151], a[4:7], a[68:71], v[148:151]
  v_fmac_f32 v245, v246, v248
  v_fmac_f32 v245, v247, v249
  v_mfma_f32_16x16x32_bf16 v[144:147], a[0:3], a[68:71], v[144:147]
  v_accvgpr_read_b32 v247, a162
  v_lshlrev_b32 v246, 16, v247
  v_mfma_f32_16x16x32_bf16 v[160:163], a[0:3], a[72:75], v[160:163]
  v_and_b32 v247, 0xffff0000, v247
  v_accvgpr_read_b32 v249, a146
  v_mfma_f32_16x16x32_bf16 v[164:167], a[4:7], a[72:75], v[164:167]
  v_lshlrev_b32 v248, 16, v249
  v_and_b32 v249, 0xffff0000, v249
  v_mfma_f32_16x16x32_bf16 v[168:171], a[8:11], a[72:75], v[168:171]
  v_fmac_f32 v244, v246, v248
  v_fmac_f32 v244, v247, v249
  v_mfma_f32_16x16x32_bf16 v[172:175], a[12:15], a[72:75], v[172:175]
  v_accvgpr_read_b32 v249, a154
  v_lshlrev_b32 v248, 16, v249
  v_mfma_f32_16x16x32_bf16 v[188:191], a[12:15], a[76:79], v[188:191]
  v_and_b32 v249, 0xffff0000, v249
  v_fmac_f32 v245, v246, v248
  v_mfma_f32_16x16x32_bf16 v[184:187], a[8:11], a[76:79], v[184:187]
  v_fmac_f32 v245, v247, v249
  v_accvgpr_read_b32 v247, a163
  v_mfma_f32_16x16x32_bf16 v[180:183], a[4:7], a[76:79], v[180:183]
  v_lshlrev_b32 v246, 16, v247
  v_and_b32 v247, 0xffff0000, v247
  v_mfma_f32_16x16x32_bf16 v[176:179], a[0:3], a[76:79], v[176:179]
  v_accvgpr_read_b32 v249, a147
  v_lshlrev_b32 v248, 16, v249
  v_mfma_f32_16x16x32_bf16 v[192:195], a[0:3], a[80:83], v[192:195]
  v_and_b32 v249, 0xffff0000, v249
  v_fmac_f32 v244, v246, v248
  v_mfma_f32_16x16x32_bf16 v[196:199], a[4:7], a[80:83], v[196:199]
  v_fmac_f32 v244, v247, v249
  v_accvgpr_read_b32 v249, a155
  v_mfma_f32_16x16x32_bf16 v[200:203], a[8:11], a[80:83], v[200:203]
  v_lshlrev_b32 v248, 16, v249
  v_and_b32 v249, 0xffff0000, v249
  v_mfma_f32_16x16x32_bf16 v[204:207], a[12:15], a[80:83], v[204:207]
  v_fmac_f32 v245, v246, v248
  v_fmac_f32 v245, v247, v249
  s_waitcnt lgkmcnt(0)
  v_mfma_f32_16x16x32_bf16 v[0:3], a[16:19], a[84:87], v[0:3]
  v_add_f32_dpp v244, v244, v244 row_ror:8 row_mask:0xf bank_mask:0xf
  v_add_f32_dpp v245, v245, v245 row_ror:8 row_mask:0xf bank_mask:0xf
  v_mfma_f32_16x16x32_bf16 v[4:7], a[20:23], a[84:87], v[4:7]
  s_nop 0
  v_mfma_f32_16x16x32_bf16 v[8:11], a[24:27], a[84:87], v[8:11]
  v_add_f32_dpp v244, v244, v244 row_ror:4 row_mask:0xf bank_mask:0xf
  v_add_f32_dpp v245, v245, v245 row_ror:4 row_mask:0xf bank_mask:0xf
  v_mfma_f32_16x16x32_bf16 v[12:15], a[28:31], a[84:87], v[12:15]
  s_nop 0
  v_mfma_f32_16x16x32_bf16 v[28:31], a[28:31], a[88:91], v[28:31]
  v_add_f32_dpp v244, v244, v244 row_ror:2 row_mask:0xf bank_mask:0xf
  v_add_f32_dpp v245, v245, v245 row_ror:2 row_mask:0xf bank_mask:0xf
  v_mfma_f32_16x16x32_bf16 v[24:27], a[24:27], a[88:91], v[24:27]
  s_nop 0
  v_mfma_f32_16x16x32_bf16 v[20:23], a[20:23], a[88:91], v[20:23]
  v_add_f32_dpp v244, v244, v244 row_ror:1 row_mask:0xf bank_mask:0xf
  v_add_f32_dpp v245, v245, v245 row_ror:1 row_mask:0xf bank_mask:0xf
  v_mfma_f32_16x16x32_bf16 v[16:19], a[16:19], a[88:91], v[16:19]
  s_nop 0
  v_mfma_f32_16x16x32_bf16 v[32:35], a[16:19], a[92:95], v[32:35]
  v_readlane_b32 s24, v244, 0
  v_readlane_b32 s25, v244, 16
  v_mfma_f32_16x16x32_bf16 v[36:39], a[20:23], a[92:95], v[36:39]
  v_readlane_b32 s26, v244, 32
  v_readlane_b32 s27, v244, 48
  v_mfma_f32_16x16x32_bf16 v[40:43], a[24:27], a[92:95], v[40:43]
  v_readlane_b32 s28, v245, 0
  v_readlane_b32 s29, v245, 16
  v_mfma_f32_16x16x32_bf16 v[44:47], a[28:31], a[92:95], v[44:47]
  v_readlane_b32 s30, v245, 32
  v_readlane_b32 s31, v245, 48
  v_mfma_f32_16x16x32_bf16 v[60:63], a[28:31], a[96:99], v[60:63]
  v_cmp_eq_u32 vcc, 1, v234
  v_mfma_f32_16x16x32_bf16 v[56:59], a[24:27], a[96:99], v[56:59]
  s_nop 1
  v_mfma_f32_16x16x32_bf16 v[52:55], a[20:23], a[96:99], v[52:55]
  v_mov_b32 v246, s24
  v_mov_b32 v247, s28
  v_mfma_f32_16x16x32_bf16 v[48:51], a[16:19], a[96:99], v[48:51]
  v_add_f32 v246, s25, v246
  v_add_f32 v247, s29, v247
  v_mfma_f32_16x16x32_bf16 v[64:67], a[16:19], a[100:103], v[64:67]
  v_add_f32 v246, s26, v246
  v_add_f32 v247, s30, v247
  v_mfma_f32_16x16x32_bf16 v[68:71], a[20:23], a[100:103], v[68:71]
  v_add_f32 v246, s27, v246
  v_add_f32 v247, s31, v247
  v_mfma_f32_16x16x32_bf16 v[72:75], a[24:27], a[100:103], v[72:75]
  v_cndmask_b32 v246, v246, v247, vcc
  v_mfma_f32_16x16x32_bf16 v[76:79], a[28:31], a[100:103], v[76:79]
  v_mul_f32 v246, 0xbfb8aa3b, v246
  v_mfma_f32_16x16x32_bf16 v[92:95], a[28:31], a[104:107], v[92:95]
  v_exp_f32 v246, v246
  v_mfma_f32_16x16x32_bf16 v[88:91], a[24:27], a[104:107], v[88:91]
  v_lshlrev_b32 v236, 2, v234
  v_mov_b32 v237, 0x80000000
  v_mfma_f32_16x16x32_bf16 v[84:87], a[20:23], a[104:107], v[84:87]
  v_add_f32 v246, 1.0, v246
  v_mfma_f32_16x16x32_bf16 v[80:83], a[16:19], a[104:107], v[80:83]
  v_rcp_f32 v235, v246
  v_mfma_f32_16x16x32_bf16 v[96:99], a[16:19], a[108:111], v[96:99]
  v_cmp_lt_u32 vcc, 1, v234
  v_mfma_f32_16x16x32_bf16 v[100:103], a[20:23], a[108:111], v[100:103]
  s_lshl_b32 s31, s93, 6
  s_add_u32 s31, s31, 42991616
  v_mfma_f32_16x16x32_bf16 v[104:107], a[24:27], a[108:111], v[104:107]
  v_cndmask_b32 v236, v236, v237, vcc
  v_mfma_f32_16x16x32_bf16 v[108:111], a[28:31], a[108:111], v[108:111]
  buffer_store_dword v235, v236, s[4:7], s31 offen sc1
  v_mfma_f32_16x16x32_bf16 v[124:127], a[28:31], a[112:115], v[124:127]
  s_lshl_b32 s32, s80, 3
  v_mfma_f32_16x16x32_bf16 v[120:123], a[24:27], a[112:115], v[120:123]
  s_lshl_b32 s33, s44, 1
  v_mfma_f32_16x16x32_bf16 v[116:119], a[20:23], a[112:115], v[116:119]
  s_add_u32 s32, s32, s33
  v_mfma_f32_16x16x32_bf16 v[112:115], a[16:19], a[112:115], v[112:115]
  v_mov_b32 v254, v234
  v_mfma_f32_16x16x32_bf16 v[128:131], a[16:19], a[116:119], v[128:131]
  v_mov_b32 v255, v233
  v_mfma_f32_16x16x32_bf16 v[132:135], a[20:23], a[116:119], v[132:135]
  v_lshlrev_b32 v253, 2, v234
  v_mfma_f32_16x16x32_bf16 v[136:139], a[24:27], a[116:119], v[136:139]
  v_mov_b32 v252, 1
  v_mfma_f32_16x16x32_bf16 v[140:143], a[28:31], a[116:119], v[140:143]
  v_min_u32 v251, 1, v234
  v_mfma_f32_16x16x32_bf16 v[156:159], a[28:31], a[120:123], v[156:159]
  v_lshlrev_b32 v251, 26, v251
  v_mfma_f32_16x16x32_bf16 v[152:155], a[24:27], a[120:123], v[152:155]
  s_lshl_b32 s51, s81, 3
  v_mfma_f32_16x16x32_bf16 v[148:151], a[20:23], a[120:123], v[148:151]
  s_add_u32 s51, s51, s80
  v_mfma_f32_16x16x32_bf16 v[144:147], a[16:19], a[120:123], v[144:147]
  s_lshl_b32 s51, s51, 2
  v_mfma_f32_16x16x32_bf16 v[160:163], a[16:19], a[124:127], v[160:163]
  s_add_u32 s51, s51, s44
  v_mfma_f32_16x16x32_bf16 v[164:167], a[20:23], a[124:127], v[164:167]
  s_lshl_b32 s51, s51, 2
  v_mfma_f32_16x16x32_bf16 v[168:171], a[24:27], a[124:127], v[168:171]
  s_add_u32 s51, s51, 44052480
  v_mfma_f32_16x16x32_bf16 v[172:175], a[28:31], a[124:127], v[172:175]
  s_mov_b32 s40, 0xbdd2d3e8
  v_mfma_f32_16x16x32_bf16 v[188:191], a[28:31], a[128:131], v[188:191]
  s_mov_b32 s41, 0xbdd2d3e8
  v_mfma_f32_16x16x32_bf16 v[184:187], a[24:27], a[128:131], v[184:187]
  s_mov_b32 s42, 1.0
  v_mfma_f32_16x16x32_bf16 v[180:183], a[20:23], a[128:131], v[180:183]
  s_mov_b32 s43, 1.0
  v_mfma_f32_16x16x32_bf16 v[176:179], a[16:19], a[128:131], v[176:179]
  v_mfma_f32_16x16x32_bf16 v[192:195], a[16:19], a[132:135], v[192:195]
  v_mfma_f32_16x16x32_bf16 v[196:199], a[20:23], a[132:135], v[196:199]
  v_mfma_f32_16x16x32_bf16 v[200:203], a[24:27], a[132:135], v[200:203]
  v_mfma_f32_16x16x32_bf16 v[204:207], a[28:31], a[132:135], v[204:207]
  s_nop 7
  s_mul_i32 s34, s81, 3
  s_add_u32 s34, s34, 0
  s_lshl_b32 s35, s34, 17
  s_lshl_b32 s36, s32, 11
  s_add_u32 s35, s35, s36
  v_cvt_pk_bf16_f32 v212, v112, v113
  v_cvt_pk_bf16_f32 v213, v114, v115
  v_cvt_pk_bf16_f32 v214, v116, v117
  v_cvt_pk_bf16_f32 v215, v118, v119
  buffer_store_dwordx4 v[212:215], v255, s[4:7], s35 offen offset:0 sc1
  v_cvt_pk_bf16_f32 v216, v128, v129
  v_cvt_pk_bf16_f32 v217, v130, v131
  v_cvt_pk_bf16_f32 v218, v132, v133
  v_cvt_pk_bf16_f32 v219, v134, v135
  buffer_store_dwordx4 v[216:219], v255, s[4:7], s35 offen offset:1024 sc1
  v_cvt_pk_bf16_f32 v220, v120, v121
  v_cvt_pk_bf16_f32 v221, v122, v123
  v_cvt_pk_bf16_f32 v222, v124, v125
  v_cvt_pk_bf16_f32 v223, v126, v127
  buffer_store_dwordx4 v[220:223], v255, s[4:7], s35 offen offset:2048 sc1
  v_cvt_pk_bf16_f32 v208, v136, v137
  v_cvt_pk_bf16_f32 v209, v138, v139
  v_cvt_pk_bf16_f32 v210, v140, v141
  v_cvt_pk_bf16_f32 v211, v142, v143
  buffer_store_dwordx4 v[208:211], v255, s[4:7], s35 offen offset:3072 sc1
  s_mul_i32 s34, s81, 3
  s_add_u32 s34, s34, 1
  s_lshl_b32 s35, s34, 17
  s_lshl_b32 s36, s32, 11
  s_add_u32 s35, s35, s36
  v_cvt_pk_bf16_f32 v212, v144, v145
  v_cvt_pk_bf16_f32 v213, v146, v147
  v_cvt_pk_bf16_f32 v214, v148, v149
  v_cvt_pk_bf16_f32 v215, v150, v151
  buffer_store_dwordx4 v[212:215], v255, s[4:7], s35 offen offset:0 sc1
  v_cvt_pk_bf16_f32 v216, v160, v161
  v_cvt_pk_bf16_f32 v217, v162, v163
  v_cvt_pk_bf16_f32 v218, v164, v165
  v_cvt_pk_bf16_f32 v219, v166, v167
  buffer_store_dwordx4 v[216:219], v255, s[4:7], s35 offen offset:1024 sc1
  v_cvt_pk_bf16_f32 v220, v152, v153
  v_cvt_pk_bf16_f32 v221, v154, v155
  v_cvt_pk_bf16_f32 v222, v156, v157
  v_cvt_pk_bf16_f32 v223, v158, v159
  buffer_store_dwordx4 v[220:223], v255, s[4:7], s35 offen offset:2048 sc1
  v_cvt_pk_bf16_f32 v208, v168, v169
  v_cvt_pk_bf16_f32 v209, v170, v171
  v_cvt_pk_bf16_f32 v210, v172, v173
  v_cvt_pk_bf16_f32 v211, v174, v175
  buffer_store_dwordx4 v[208:211], v255, s[4:7], s35 offen offset:3072 sc1
  s_mul_i32 s34, s81, 3
  s_add_u32 s34, s34, 2
  s_lshl_b32 s35, s34, 17
  s_lshl_b32 s36, s32, 11
  s_add_u32 s35, s35, s36
  v_cvt_pk_bf16_f32 v212, v176, v177
  v_cvt_pk_bf16_f32 v213, v178, v179
  v_cvt_pk_bf16_f32 v214, v180, v181
  v_cvt_pk_bf16_f32 v215, v182, v183
  buffer_store_dwordx4 v[212:215], v255, s[4:7], s35 offen offset:0 sc1
  v_cvt_pk_bf16_f32 v216, v192, v193
  v_cvt_pk_bf16_f32 v217, v194, v195
  v_cvt_pk_bf16_f32 v218, v196, v197
  v_cvt_pk_bf16_f32 v219, v198, v199
  buffer_store_dwordx4 v[216:219], v255, s[4:7], s35 offen offset:1024 sc1
  v_cvt_pk_bf16_f32 v220, v184, v185
  v_cvt_pk_bf16_f32 v221, v186, v187
  v_cvt_pk_bf16_f32 v222, v188, v189
  v_cvt_pk_bf16_f32 v223, v190, v191
  buffer_store_dwordx4 v[220:223], v255, s[4:7], s35 offen offset:2048 sc1
  v_cvt_pk_bf16_f32 v208, v200, v201
  v_cvt_pk_bf16_f32 v209, v202, v203
  v_cvt_pk_bf16_f32 v210, v204, v205
  v_cvt_pk_bf16_f32 v211, v206, v207
  buffer_store_dwordx4 v[208:211], v255, s[4:7], s35 offen offset:3072 sc1
gated_mix__mha_block__mixer_gmlp__prompt_kernel_z2ep:
  v_mov_b32 v160, 0xc0135761
  v_mov_b32 v161, 0xc0135761
  s_mul_i32 s35, s32, 114688
  s_mul_i32 s36, s81, 7168
  s_add_u32 s35, s35, s36
  s_add_u32 s35, s35, 46022656
  s_lshl_b32 s36, s44, 13
  s_add_u32 s36, s36, 32768
  v_add_u32 v162, s36, v255
  v_pk_mul_f32 v[112:113], v[0:1], v[0:1]
  v_pk_mul_f32 v[114:115], v[2:3], v[2:3]
  v_pk_mul_f32 v[116:117], v[4:5], v[4:5]
  v_pk_mul_f32 v[118:119], v[6:7], v[6:7]
  v_pk_mul_f32 v[120:121], v[8:9], v[8:9]
  v_pk_mul_f32 v[122:123], v[10:11], v[10:11]
  v_pk_mul_f32 v[124:125], v[12:13], v[12:13]
  v_pk_mul_f32 v[126:127], v[14:15], v[14:15]
  v_pk_fma_f32 v[112:113], v[112:113], s[40:41], v[160:161]
  v_pk_fma_f32 v[114:115], v[114:115], s[40:41], v[160:161]
  v_pk_fma_f32 v[116:117], v[116:117], s[40:41], v[160:161]
  v_pk_fma_f32 v[118:119], v[118:119], s[40:41], v[160:161]
  v_pk_fma_f32 v[120:121], v[120:121], s[40:41], v[160:161]
  v_pk_fma_f32 v[122:123], v[122:123], s[40:41], v[160:161]
  v_pk_fma_f32 v[124:125], v[124:125], s[40:41], v[160:161]
  v_pk_fma_f32 v[126:127], v[126:127], s[40:41], v[160:161]
  v_pk_mul_f32 v[112:113], v[112:113], v[0:1]
  v_pk_mul_f32 v[114:115], v[114:115], v[2:3]
  v_pk_mul_f32 v[116:117], v[116:117], v[4:5]
  v_pk_mul_f32 v[118:119], v[118:119], v[6:7]
  v_pk_mul_f32 v[120:121], v[120:121], v[8:9]
  v_pk_mul_f32 v[122:123], v[122:123], v[10:11]
  v_pk_mul_f32 v[124:125], v[124:125], v[12:13]
  v_pk_mul_f32 v[126:127], v[126:127], v[14:15]
  v_exp_f32 v112, v112
  v_exp_f32 v113, v113
  v_exp_f32 v114, v114
  v_exp_f32 v115, v115
  v_exp_f32 v116, v116
  v_exp_f32 v117, v117
  v_exp_f32 v118, v118
  v_exp_f32 v119, v119
  v_exp_f32 v120, v120
  v_exp_f32 v121, v121
  v_exp_f32 v122, v122
  v_exp_f32 v123, v123
  v_exp_f32 v124, v124
  v_exp_f32 v125, v125
  v_exp_f32 v126, v126
  v_exp_f32 v127, v127
  v_pk_add_f32 v[112:113], v[112:113], s[42:43]
  v_pk_add_f32 v[114:115], v[114:115], s[42:43]
  v_pk_add_f32 v[116:117], v[116:117], s[42:43]
  v_pk_add_f32 v[118:119], v[118:119], s[42:43]
  v_pk_add_f32 v[120:121], v[120:121], s[42:43]
  v_pk_add_f32 v[122:123], v[122:123], s[42:43]
  v_pk_add_f32 v[124:125], v[124:125], s[42:43]
  v_pk_add_f32 v[126:127], v[126:127], s[42:43]
  v_rcp_f32 v112, v112
  v_rcp_f32 v113, v113
  v_rcp_f32 v114, v114
  v_rcp_f32 v115, v115
  v_rcp_f32 v116, v116
  v_rcp_f32 v117, v117
  v_rcp_f32 v118, v118
  v_rcp_f32 v119, v119
  v_rcp_f32 v120, v120
  v_rcp_f32 v121, v121
  v_rcp_f32 v122, v122
  v_rcp_f32 v123, v123
  v_rcp_f32 v124, v124
  v_rcp_f32 v125, v125
  v_rcp_f32 v126, v126
  v_rcp_f32 v127, v127
  v_pk_mul_f32 v[0:1], v[0:1], v[112:113]
  v_pk_mul_f32 v[2:3], v[2:3], v[114:115]
  v_pk_mul_f32 v[4:5], v[4:5], v[116:117]
  v_pk_mul_f32 v[6:7], v[6:7], v[118:119]
  v_pk_mul_f32 v[8:9], v[8:9], v[120:121]
  v_pk_mul_f32 v[10:11], v[10:11], v[122:123]
  v_pk_mul_f32 v[12:13], v[12:13], v[124:125]
  v_pk_mul_f32 v[14:15], v[14:15], v[126:127]
  v_pk_mul_f32 v[144:145], v[0:1], v[0:1]
  v_pk_mul_f32 v[146:147], v[2:3], v[2:3]
  v_pk_mul_f32 v[148:149], v[4:5], v[4:5]
  v_pk_mul_f32 v[150:151], v[6:7], v[6:7]
  v_pk_mul_f32 v[152:153], v[8:9], v[8:9]
  v_pk_mul_f32 v[154:155], v[10:11], v[10:11]
  v_pk_mul_f32 v[156:157], v[12:13], v[12:13]
  v_pk_mul_f32 v[158:159], v[14:15], v[14:15]
  v_cvt_pk_bf16_f32 v212, v0, v1
  v_cvt_pk_bf16_f32 v213, v2, v3
  v_cvt_pk_bf16_f32 v214, v4, v5
  v_cvt_pk_bf16_f32 v215, v6, v7
  ds_write_b128 v162, v[212:215] offset:0
  v_cvt_pk_bf16_f32 v216, v8, v9
  v_cvt_pk_bf16_f32 v217, v10, v11
  v_cvt_pk_bf16_f32 v218, v12, v13
  v_cvt_pk_bf16_f32 v219, v14, v15
  ds_write_b128 v162, v[216:219] offset:32768
  v_pk_mul_f32 v[112:113], v[16:17], v[16:17]
  v_pk_mul_f32 v[114:115], v[18:19], v[18:19]
  v_pk_mul_f32 v[116:117], v[20:21], v[20:21]
  v_pk_mul_f32 v[118:119], v[22:23], v[22:23]
  v_pk_mul_f32 v[120:121], v[24:25], v[24:25]
  v_pk_mul_f32 v[122:123], v[26:27], v[26:27]
  v_pk_mul_f32 v[124:125], v[28:29], v[28:29]
  v_pk_mul_f32 v[126:127], v[30:31], v[30:31]
  v_pk_fma_f32 v[112:113], v[112:113], s[40:41], v[160:161]
  v_pk_fma_f32 v[114:115], v[114:115], s[40:41], v[160:161]
  v_pk_fma_f32 v[116:117], v[116:117], s[40:41], v[160:161]
  v_pk_fma_f32 v[118:119], v[118:119], s[40:41], v[160:161]
  v_pk_fma_f32 v[120:121], v[120:121], s[40:41], v[160:161]
  v_pk_fma_f32 v[122:123], v[122:123], s[40:41], v[160:161]
  v_pk_fma_f32 v[124:125], v[124:125], s[40:41], v[160:161]
  v_pk_fma_f32 v[126:127], v[126:127], s[40:41], v[160:161]
  v_pk_mul_f32 v[112:113], v[112:113], v[16:17]
  v_pk_mul_f32 v[114:115], v[114:115], v[18:19]
  v_pk_mul_f32 v[116:117], v[116:117], v[20:21]
  v_pk_mul_f32 v[118:119], v[118:119], v[22:23]
  v_pk_mul_f32 v[120:121], v[120:121], v[24:25]
  v_pk_mul_f32 v[122:123], v[122:123], v[26:27]
  v_pk_mul_f32 v[124:125], v[124:125], v[28:29]
  v_pk_mul_f32 v[126:127], v[126:127], v[30:31]
  v_exp_f32 v112, v112
  v_exp_f32 v113, v113
  v_exp_f32 v114, v114
  v_exp_f32 v115, v115
  v_exp_f32 v116, v116
  v_exp_f32 v117, v117
  v_exp_f32 v118, v118
  v_exp_f32 v119, v119
  v_exp_f32 v120, v120
  v_exp_f32 v121, v121
  v_exp_f32 v122, v122
  v_exp_f32 v123, v123
  v_exp_f32 v124, v124
  v_exp_f32 v125, v125
  v_exp_f32 v126, v126
  v_exp_f32 v127, v127
  v_pk_add_f32 v[112:113], v[112:113], s[42:43]
  v_pk_add_f32 v[114:115], v[114:115], s[42:43]
  v_pk_add_f32 v[116:117], v[116:117], s[42:43]
  v_pk_add_f32 v[118:119], v[118:119], s[42:43]
  v_pk_add_f32 v[120:121], v[120:121], s[42:43]
  v_pk_add_f32 v[122:123], v[122:123], s[42:43]
  v_pk_add_f32 v[124:125], v[124:125], s[42:43]
  v_pk_add_f32 v[126:127], v[126:127], s[42:43]
  v_rcp_f32 v112, v112
  v_rcp_f32 v113, v113
  v_rcp_f32 v114, v114
  v_rcp_f32 v115, v115
  v_rcp_f32 v116, v116
  v_rcp_f32 v117, v117
  v_rcp_f32 v118, v118
  v_rcp_f32 v119, v119
  v_rcp_f32 v120, v120
  v_rcp_f32 v121, v121
  v_rcp_f32 v122, v122
  v_rcp_f32 v123, v123
  v_rcp_f32 v124, v124
  v_rcp_f32 v125, v125
  v_rcp_f32 v126, v126
  v_rcp_f32 v127, v127
  v_pk_mul_f32 v[16:17], v[16:17], v[112:113]
  v_pk_mul_f32 v[18:19], v[18:19], v[114:115]
  v_pk_mul_f32 v[20:21], v[20:21], v[116:117]
  v_pk_mul_f32 v[22:23], v[22:23], v[118:119]
  v_pk_mul_f32 v[24:25], v[24:25], v[120:121]
  v_pk_mul_f32 v[26:27], v[26:27], v[122:123]
  v_pk_mul_f32 v[28:29], v[28:29], v[124:125]
  v_pk_mul_f32 v[30:31], v[30:31], v[126:127]
  v_pk_fma_f32 v[144:145], v[16:17], v[16:17], v[144:145]
  v_pk_add_f32 v[128:129], v[0:1], v[16:17]
  v_pk_fma_f32 v[146:147], v[18:19], v[18:19], v[146:147]
  v_pk_add_f32 v[130:131], v[2:3], v[18:19]
  v_pk_fma_f32 v[148:149], v[20:21], v[20:21], v[148:149]
  v_pk_add_f32 v[132:133], v[4:5], v[20:21]
  v_pk_fma_f32 v[150:151], v[22:23], v[22:23], v[150:151]
  v_pk_add_f32 v[134:135], v[6:7], v[22:23]
  v_pk_fma_f32 v[152:153], v[24:25], v[24:25], v[152:153]
  v_pk_add_f32 v[136:137], v[8:9], v[24:25]
  v_pk_fma_f32 v[154:155], v[26:27], v[26:27], v[154:155]
  v_pk_add_f32 v[138:139], v[10:11], v[26:27]
  v_pk_fma_f32 v[156:157], v[28:29], v[28:29], v[156:157]
  v_pk_add_f32 v[140:141], v[12:13], v[28:29]
  v_pk_fma_f32 v[158:159], v[30:31], v[30:31], v[158:159]
  v_pk_add_f32 v[142:143], v[14:15], v[30:31]
  v_cvt_pk_bf16_f32 v220, v16, v17
  v_cvt_pk_bf16_f32 v221, v18, v19
  v_cvt_pk_bf16_f32 v222, v20, v21
  v_cvt_pk_bf16_f32 v223, v22, v23
  ds_write_b128 v162, v[220:223] offset:1024
  v_cvt_pk_bf16_f32 v208, v24, v25
  v_cvt_pk_bf16_f32 v209, v26, v27
  v_cvt_pk_bf16_f32 v210, v28, v29
  v_cvt_pk_bf16_f32 v211, v30, v31
  ds_write_b128 v162, v[208:211] offset:33792
  v_pk_mul_f32 v[112:113], v[32:33], v[32:33]
  v_pk_mul_f32 v[114:115], v[34:35], v[34:35]
  v_pk_mul_f32 v[116:117], v[36:37], v[36:37]
  v_pk_mul_f32 v[118:119], v[38:39], v[38:39]
  v_pk_mul_f32 v[120:121], v[40:41], v[40:41]
  v_pk_mul_f32 v[122:123], v[42:43], v[42:43]
  v_pk_mul_f32 v[124:125], v[44:45], v[44:45]
  v_pk_mul_f32 v[126:127], v[46:47], v[46:47]
  v_pk_fma_f32 v[112:113], v[112:113], s[40:41], v[160:161]
  v_pk_fma_f32 v[114:115], v[114:115], s[40:41], v[160:161]
  v_pk_fma_f32 v[116:117], v[116:117], s[40:41], v[160:161]
  v_pk_fma_f32 v[118:119], v[118:119], s[40:41], v[160:161]
  v_pk_fma_f32 v[120:121], v[120:121], s[40:41], v[160:161]
  v_pk_fma_f32 v[122:123], v[122:123], s[40:41], v[160:161]
  v_pk_fma_f32 v[124:125], v[124:125], s[40:41], v[160:161]
  v_pk_fma_f32 v[126:127], v[126:127], s[40:41], v[160:161]
  v_pk_mul_f32 v[112:113], v[112:113], v[32:33]
  v_pk_mul_f32 v[114:115], v[114:115], v[34:35]
  v_pk_mul_f32 v[116:117], v[116:117], v[36:37]
  v_pk_mul_f32 v[118:119], v[118:119], v[38:39]
  v_pk_mul_f32 v[120:121], v[120:121], v[40:41]
  v_pk_mul_f32 v[122:123], v[122:123], v[42:43]
  v_pk_mul_f32 v[124:125], v[124:125], v[44:45]
  v_pk_mul_f32 v[126:127], v[126:127], v[46:47]
  v_exp_f32 v112, v112
  v_exp_f32 v113, v113
  v_exp_f32 v114, v114
  v_exp_f32 v115, v115
  v_exp_f32 v116, v116
  v_exp_f32 v117, v117
  v_exp_f32 v118, v118
  v_exp_f32 v119, v119
  v_exp_f32 v120, v120
  v_exp_f32 v121, v121
  v_exp_f32 v122, v122
  v_exp_f32 v123, v123
  v_exp_f32 v124, v124
  v_exp_f32 v125, v125
  v_exp_f32 v126, v126
  v_exp_f32 v127, v127
  v_pk_add_f32 v[112:113], v[112:113], s[42:43]
  v_pk_add_f32 v[114:115], v[114:115], s[42:43]
  v_pk_add_f32 v[116:117], v[116:117], s[42:43]
  v_pk_add_f32 v[118:119], v[118:119], s[42:43]
  v_pk_add_f32 v[120:121], v[120:121], s[42:43]
  v_pk_add_f32 v[122:123], v[122:123], s[42:43]
  v_pk_add_f32 v[124:125], v[124:125], s[42:43]
  v_pk_add_f32 v[126:127], v[126:127], s[42:43]
  v_rcp_f32 v112, v112
  v_rcp_f32 v113, v113
  v_rcp_f32 v114, v114
  v_rcp_f32 v115, v115
  v_rcp_f32 v116, v116
  v_rcp_f32 v117, v117
  v_rcp_f32 v118, v118
  v_rcp_f32 v119, v119
  v_rcp_f32 v120, v120
  v_rcp_f32 v121, v121
  v_rcp_f32 v122, v122
  v_rcp_f32 v123, v123
  v_rcp_f32 v124, v124
  v_rcp_f32 v125, v125
  v_rcp_f32 v126, v126
  v_rcp_f32 v127, v127
  v_pk_mul_f32 v[32:33], v[32:33], v[112:113]
  v_pk_mul_f32 v[34:35], v[34:35], v[114:115]
  v_pk_mul_f32 v[36:37], v[36:37], v[116:117]
  v_pk_mul_f32 v[38:39], v[38:39], v[118:119]
  v_pk_mul_f32 v[40:41], v[40:41], v[120:121]
  v_pk_mul_f32 v[42:43], v[42:43], v[122:123]
  v_pk_mul_f32 v[44:45], v[44:45], v[124:125]
  v_pk_mul_f32 v[46:47], v[46:47], v[126:127]
  v_pk_fma_f32 v[144:145], v[32:33], v[32:33], v[144:145]
  v_pk_add_f32 v[128:129], v[128:129], v[32:33]
  v_pk_fma_f32 v[146:147], v[34:35], v[34:35], v[146:147]
  v_pk_add_f32 v[130:131], v[130:131], v[34:35]
  v_pk_fma_f32 v[148:149], v[36:37], v[36:37], v[148:149]
  v_pk_add_f32 v[132:133], v[132:133], v[36:37]
  v_pk_fma_f32 v[150:151], v[38:39], v[38:39], v[150:151]
  v_pk_add_f32 v[134:135], v[134:135], v[38:39]
  v_pk_fma_f32 v[152:153], v[40:41], v[40:41], v[152:153]
  v_pk_add_f32 v[136:137], v[136:137], v[40:41]
  v_pk_fma_f32 v[154:155], v[42:43], v[42:43], v[154:155]
  v_pk_add_f32 v[138:139], v[138:139], v[42:43]
  v_pk_fma_f32 v[156:157], v[44:45], v[44:45], v[156:157]
  v_pk_add_f32 v[140:141], v[140:141], v[44:45]
  v_pk_fma_f32 v[158:159], v[46:47], v[46:47], v[158:159]
  v_pk_add_f32 v[142:143], v[142:143], v[46:47]
  v_cvt_pk_bf16_f32 v212, v32, v33
  v_cvt_pk_bf16_f32 v213, v34, v35
  v_cvt_pk_bf16_f32 v214, v36, v37
  v_cvt_pk_bf16_f32 v215, v38, v39
  ds_write_b128 v162, v[212:215] offset:2048
  v_cvt_pk_bf16_f32 v216, v40, v41
  v_cvt_pk_bf16_f32 v217, v42, v43
  v_cvt_pk_bf16_f32 v218, v44, v45
  v_cvt_pk_bf16_f32 v219, v46, v47
  ds_write_b128 v162, v[216:219] offset:34816
  s_waitcnt vmcnt(0)
  buffer_store_dword v252, v251, s[4:7], s51 offen sc1
  s_lshl_b32 s51, s80, 5
  s_add_u32 s51, s51, s81
  s_lshl_b32 s51, s51, 2
  s_add_u32 s51, s51, s44
  s_lshl_b32 s51, s51, 2
  s_add_u32 s51, s51, 44056576
  s_lshl_b32 s24, s45, 17
  s_add_u32 s8, s4, s24
  s_addc_u32 s9, s5, 0
  s_add_u32 s8, s8, 4194304
  s_addc_u32 s9, s9, 0
  s_mov_b32 s10, 131072
  s_mov_b32 s11, 0x00020000
  s_add_u32 s12, s4, s24
  s_addc_u32 s13, s5, 0
  s_add_u32 s12, s12, 8387584
  s_addc_u32 s13, s13, 0
  s_mov_b32 s14, 132096
  s_mov_b32 s15, 0x00020000
  s_add_u32 s25, s45, 0
  s_mul_i32 s25, s25, 171
  s_lshr_b32 s25, s25, 9
  s_lshl_b32 s25, s25, 7
  s_add_u32 s26, s45, 32
  s_mul_i32 s26, s26, 171
  s_lshr_b32 s26, s26, 9
  s_lshl_b32 s26, s26, 7
  s_add_u32 s27, s45, 64
  s_mul_i32 s27, s27, 171
  s_lshr_b32 s27, s27, 9
  s_lshl_b32 s27, s27, 7
  v_and_b32 v167, 31, v254
  v_lshlrev_b32 v167, 2, v167
  v_and_b32 v168, 3, v254
  v_mov_b32 v169, s26
  v_mov_b32 v170, s27
  v_cmp_lt_u32 vcc, 31, v254
  s_lshl_b32 s28, s46, 4
  s_add_u32 s28, s28, s25
  v_cndmask_b32 v169, v169, v170, vcc
  v_add_u32 v167, v167, v169
  v_lshl_add_u32 v168, v168, 2, s28
  s_mov_b32 s52, 44052480
  s_cmp_eq_u32 s44, 0
  s_cselect_b32 s52, s52, 0x70000000
  v_pk_mul_f32 v[112:113], v[48:49], v[48:49]
  v_pk_mul_f32 v[114:115], v[50:51], v[50:51]
  v_pk_mul_f32 v[116:117], v[52:53], v[52:53]
  v_pk_mul_f32 v[118:119], v[54:55], v[54:55]
  v_pk_mul_f32 v[120:121], v[56:57], v[56:57]
  v_pk_mul_f32 v[122:123], v[58:59], v[58:59]
  v_pk_mul_f32 v[124:125], v[60:61], v[60:61]
  v_pk_mul_f32 v[126:127], v[62:63], v[62:63]
  v_pk_fma_f32 v[112:113], v[112:113], s[40:41], v[160:161]
  v_pk_fma_f32 v[114:115], v[114:115], s[40:41], v[160:161]
  v_pk_fma_f32 v[116:117], v[116:117], s[40:41], v[160:161]
  v_pk_fma_f32 v[118:119], v[118:119], s[40:41], v[160:161]
  v_pk_fma_f32 v[120:121], v[120:121], s[40:41], v[160:161]
  v_pk_fma_f32 v[122:123], v[122:123], s[40:41], v[160:161]
  v_pk_fma_f32 v[124:125], v[124:125], s[40:41], v[160:161]
  v_pk_fma_f32 v[126:127], v[126:127], s[40:41], v[160:161]
  v_pk_mul_f32 v[112:113], v[112:113], v[48:49]
  v_pk_mul_f32 v[114:115], v[114:115], v[50:51]
  v_pk_mul_f32 v[116:117], v[116:117], v[52:53]
  v_pk_mul_f32 v[118:119], v[118:119], v[54:55]
  v_pk_mul_f32 v[120:121], v[120:121], v[56:57]
  v_pk_mul_f32 v[122:123], v[122:123], v[58:59]
  v_pk_mul_f32 v[124:125], v[124:125], v[60:61]
  v_pk_mul_f32 v[126:127], v[126:127], v[62:63]
  v_exp_f32 v112, v112
  v_exp_f32 v113, v113
  v_exp_f32 v114, v114
  v_exp_f32 v115, v115
  v_exp_f32 v116, v116
  v_exp_f32 v117, v117
  v_exp_f32 v118, v118
  v_exp_f32 v119, v119
  v_exp_f32 v120, v120
  v_exp_f32 v121, v121
  v_exp_f32 v122, v122
  v_exp_f32 v123, v123
  v_exp_f32 v124, v124
  v_exp_f32 v125, v125
  v_exp_f32 v126, v126
  v_exp_f32 v127, v127
  v_pk_add_f32 v[112:113], v[112:113], s[42:43]
  v_pk_add_f32 v[114:115], v[114:115], s[42:43]
  v_pk_add_f32 v[116:117], v[116:117], s[42:43]
  v_pk_add_f32 v[118:119], v[118:119], s[42:43]
  v_pk_add_f32 v[120:121], v[120:121], s[42:43]
  v_pk_add_f32 v[122:123], v[122:123], s[42:43]
  v_pk_add_f32 v[124:125], v[124:125], s[42:43]
  v_pk_add_f32 v[126:127], v[126:127], s[42:43]
  v_rcp_f32 v112, v112
  v_rcp_f32 v113, v113
  v_rcp_f32 v114, v114
  v_rcp_f32 v115, v115
  v_rcp_f32 v116, v116
  v_rcp_f32 v117, v117
  v_rcp_f32 v118, v118
  v_rcp_f32 v119, v119
  v_rcp_f32 v120, v120
  v_rcp_f32 v121, v121
  v_rcp_f32 v122, v122
  v_rcp_f32 v123, v123
  v_rcp_f32 v124, v124
  v_rcp_f32 v125, v125
  v_rcp_f32 v126, v126
  v_rcp_f32 v127, v127
  v_pk_mul_f32 v[48:49], v[48:49], v[112:113]
  v_pk_mul_f32 v[50:51], v[50:51], v[114:115]
  v_pk_mul_f32 v[52:53], v[52:53], v[116:117]
  v_pk_mul_f32 v[54:55], v[54:55], v[118:119]
  v_pk_mul_f32 v[56:57], v[56:57], v[120:121]
  v_pk_mul_f32 v[58:59], v[58:59], v[122:123]
  v_pk_mul_f32 v[60:61], v[60:61], v[124:125]
  v_pk_mul_f32 v[62:63], v[62:63], v[126:127]
  v_pk_fma_f32 v[144:145], v[48:49], v[48:49], v[144:145]
  v_pk_add_f32 v[128:129], v[128:129], v[48:49]
  v_pk_fma_f32 v[146:147], v[50:51], v[50:51], v[146:147]
  v_pk_add_f32 v[130:131], v[130:131], v[50:51]
  v_pk_fma_f32 v[148:149], v[52:53], v[52:53], v[148:149]
  v_pk_add_f32 v[132:133], v[132:133], v[52:53]
  v_pk_fma_f32 v[150:151], v[54:55], v[54:55], v[150:151]
  v_pk_add_f32 v[134:135], v[134:135], v[54:55]
  v_pk_fma_f32 v[152:153], v[56:57], v[56:57], v[152:153]
  v_pk_add_f32 v[136:137], v[136:137], v[56:57]
  v_pk_fma_f32 v[154:155], v[58:59], v[58:59], v[154:155]
  v_pk_add_f32 v[138:139], v[138:139], v[58:59]
  v_pk_fma_f32 v[156:157], v[60:61], v[60:61], v[156:157]
  v_pk_add_f32 v[140:141], v[140:141], v[60:61]
  v_pk_fma_f32 v[158:159], v[62:63], v[62:63], v[158:159]
  v_pk_add_f32 v[142:143], v[142:143], v[62:63]
  v_cvt_pk_bf16_f32 v220, v48, v49
  v_cvt_pk_bf16_f32 v221, v50, v51
  v_cvt_pk_bf16_f32 v222, v52, v53
  v_cvt_pk_bf16_f32 v223, v54, v55
  ds_write_b128 v162, v[220:223] offset:3072
  v_cvt_pk_bf16_f32 v208, v56, v57
  v_cvt_pk_bf16_f32 v209, v58, v59
  v_cvt_pk_bf16_f32 v210, v60, v61
  v_cvt_pk_bf16_f32 v211, v62, v63
  ds_write_b128 v162, v[208:211] offset:35840
  v_pk_mul_f32 v[112:113], v[64:65], v[64:65]
  v_pk_mul_f32 v[114:115], v[66:67], v[66:67]
  v_pk_mul_f32 v[116:117], v[68:69], v[68:69]
  v_pk_mul_f32 v[118:119], v[70:71], v[70:71]
  v_pk_mul_f32 v[120:121], v[72:73], v[72:73]
  v_pk_mul_f32 v[122:123], v[74:75], v[74:75]
  v_pk_mul_f32 v[124:125], v[76:77], v[76:77]
  v_pk_mul_f32 v[126:127], v[78:79], v[78:79]
  v_pk_fma_f32 v[112:113], v[112:113], s[40:41], v[160:161]
  v_pk_fma_f32 v[114:115], v[114:115], s[40:41], v[160:161]
  v_pk_fma_f32 v[116:117], v[116:117], s[40:41], v[160:161]
  v_pk_fma_f32 v[118:119], v[118:119], s[40:41], v[160:161]
  v_pk_fma_f32 v[120:121], v[120:121], s[40:41], v[160:161]
  v_pk_fma_f32 v[122:123], v[122:123], s[40:41], v[160:161]
  v_pk_fma_f32 v[124:125], v[124:125], s[40:41], v[160:161]
  v_pk_fma_f32 v[126:127], v[126:127], s[40:41], v[160:161]
  v_pk_mul_f32 v[112:113], v[112:113], v[64:65]
  v_pk_mul_f32 v[114:115], v[114:115], v[66:67]
  v_pk_mul_f32 v[116:117], v[116:117], v[68:69]
  v_pk_mul_f32 v[118:119], v[118:119], v[70:71]
  v_pk_mul_f32 v[120:121], v[120:121], v[72:73]
  v_pk_mul_f32 v[122:123], v[122:123], v[74:75]
  v_pk_mul_f32 v[124:125], v[124:125], v[76:77]
  v_pk_mul_f32 v[126:127], v[126:127], v[78:79]
  v_exp_f32 v112, v112
  v_exp_f32 v113, v113
  v_exp_f32 v114, v114
  v_exp_f32 v115, v115
  v_exp_f32 v116, v116
  v_exp_f32 v117, v117
  v_exp_f32 v118, v118
  v_exp_f32 v119, v119
  v_exp_f32 v120, v120
  v_exp_f32 v121, v121
  v_exp_f32 v122, v122
  v_exp_f32 v123, v123
  v_exp_f32 v124, v124
  v_exp_f32 v125, v125
  v_exp_f32 v126, v126
  v_exp_f32 v127, v127
  v_pk_add_f32 v[112:113], v[112:113], s[42:43]
  v_pk_add_f32 v[114:115], v[114:115], s[42:43]
  v_pk_add_f32 v[116:117], v[116:117], s[42:43]
  v_pk_add_f32 v[118:119], v[118:119], s[42:43]
  v_pk_add_f32 v[120:121], v[120:121], s[42:43]
  v_pk_add_f32 v[122:123], v[122:123], s[42:43]
  v_pk_add_f32 v[124:125], v[124:125], s[42:43]
  v_pk_add_f32 v[126:127], v[126:127], s[42:43]
  v_rcp_f32 v112, v112
  v_rcp_f32 v113, v113
  v_rcp_f32 v114, v114
  v_rcp_f32 v115, v115
  v_rcp_f32 v116, v116
  v_rcp_f32 v117, v117
  v_rcp_f32 v118, v118
  v_rcp_f32 v119, v119
  v_rcp_f32 v120, v120
  v_rcp_f32 v121, v121
  v_rcp_f32 v122, v122
  v_rcp_f32 v123, v123
  v_rcp_f32 v124, v124
  v_rcp_f32 v125, v125
  v_rcp_f32 v126, v126
  v_rcp_f32 v127, v127
  v_pk_mul_f32 v[64:65], v[64:65], v[112:113]
  v_pk_mul_f32 v[66:67], v[66:67], v[114:115]
  v_pk_mul_f32 v[68:69], v[68:69], v[116:117]
  v_pk_mul_f32 v[70:71], v[70:71], v[118:119]
  v_pk_mul_f32 v[72:73], v[72:73], v[120:121]
  v_pk_mul_f32 v[74:75], v[74:75], v[122:123]
  v_pk_mul_f32 v[76:77], v[76:77], v[124:125]
  v_pk_mul_f32 v[78:79], v[78:79], v[126:127]
  v_pk_fma_f32 v[144:145], v[64:65], v[64:65], v[144:145]
  v_pk_add_f32 v[128:129], v[128:129], v[64:65]
  v_pk_fma_f32 v[146:147], v[66:67], v[66:67], v[146:147]
  v_pk_add_f32 v[130:131], v[130:131], v[66:67]
  v_pk_fma_f32 v[148:149], v[68:69], v[68:69], v[148:149]
  v_pk_add_f32 v[132:133], v[132:133], v[68:69]
  v_pk_fma_f32 v[150:151], v[70:71], v[70:71], v[150:151]
  v_pk_add_f32 v[134:135], v[134:135], v[70:71]
  v_pk_fma_f32 v[152:153], v[72:73], v[72:73], v[152:153]
  v_pk_add_f32 v[136:137], v[136:137], v[72:73]
  v_pk_fma_f32 v[154:155], v[74:75], v[74:75], v[154:155]
  v_pk_add_f32 v[138:139], v[138:139], v[74:75]
  v_pk_fma_f32 v[156:157], v[76:77], v[76:77], v[156:157]
  v_pk_add_f32 v[140:141], v[140:141], v[76:77]
  v_pk_fma_f32 v[158:159], v[78:79], v[78:79], v[158:159]
  v_pk_add_f32 v[142:143], v[142:143], v[78:79]
  v_cvt_pk_bf16_f32 v212, v64, v65
  v_cvt_pk_bf16_f32 v213, v66, v67
  v_cvt_pk_bf16_f32 v214, v68, v69
  v_cvt_pk_bf16_f32 v215, v70, v71
  ds_write_b128 v162, v[212:215] offset:4096
  v_cvt_pk_bf16_f32 v216, v72, v73
  v_cvt_pk_bf16_f32 v217, v74, v75
  v_cvt_pk_bf16_f32 v218, v76, v77
  v_cvt_pk_bf16_f32 v219, v78, v79
  ds_write_b128 v162, v[216:219] offset:36864
  buffer_load_dword v164, v167, s[4:7], s52 offen sc1
  buffer_load_dword v165, v168, s[4:7], s52 offen sc1
  v_pk_mul_f32 v[112:113], v[80:81], v[80:81]
  v_pk_mul_f32 v[114:115], v[82:83], v[82:83]
  v_pk_mul_f32 v[116:117], v[84:85], v[84:85]
  v_pk_mul_f32 v[118:119], v[86:87], v[86:87]
  v_pk_mul_f32 v[120:121], v[88:89], v[88:89]
  v_pk_mul_f32 v[122:123], v[90:91], v[90:91]
  v_pk_mul_f32 v[124:125], v[92:93], v[92:93]
  v_pk_mul_f32 v[126:127], v[94:95], v[94:95]
  v_pk_fma_f32 v[112:113], v[112:113], s[40:41], v[160:161]
  v_pk_fma_f32 v[114:115], v[114:115], s[40:41], v[160:161]
  v_pk_fma_f32 v[116:117], v[116:117], s[40:41], v[160:161]
  v_pk_fma_f32 v[118:119], v[118:119], s[40:41], v[160:161]
  v_pk_fma_f32 v[120:121], v[120:121], s[40:41], v[160:161]
  v_pk_fma_f32 v[122:123], v[122:123], s[40:41], v[160:161]
  v_pk_fma_f32 v[124:125], v[124:125], s[40:41], v[160:161]
  v_pk_fma_f32 v[126:127], v[126:127], s[40:41], v[160:161]
  v_pk_mul_f32 v[112:113], v[112:113], v[80:81]
  v_pk_mul_f32 v[114:115], v[114:115], v[82:83]
  v_pk_mul_f32 v[116:117], v[116:117], v[84:85]
  v_pk_mul_f32 v[118:119], v[118:119], v[86:87]
  v_pk_mul_f32 v[120:121], v[120:121], v[88:89]
  v_pk_mul_f32 v[122:123], v[122:123], v[90:91]
  v_pk_mul_f32 v[124:125], v[124:125], v[92:93]
  v_pk_mul_f32 v[126:127], v[126:127], v[94:95]
  v_exp_f32 v112, v112
  v_exp_f32 v113, v113
  v_exp_f32 v114, v114
  v_exp_f32 v115, v115
  v_exp_f32 v116, v116
  v_exp_f32 v117, v117
  v_exp_f32 v118, v118
  v_exp_f32 v119, v119
  v_exp_f32 v120, v120
  v_exp_f32 v121, v121
  v_exp_f32 v122, v122
  v_exp_f32 v123, v123
  v_exp_f32 v124, v124
  v_exp_f32 v125, v125
  v_exp_f32 v126, v126
  v_exp_f32 v127, v127
  v_pk_add_f32 v[112:113], v[112:113], s[42:43]
  v_pk_add_f32 v[114:115], v[114:115], s[42:43]
  v_pk_add_f32 v[116:117], v[116:117], s[42:43]
  v_pk_add_f32 v[118:119], v[118:119], s[42:43]
  v_pk_add_f32 v[120:121], v[120:121], s[42:43]
  v_pk_add_f32 v[122:123], v[122:123], s[42:43]
  v_pk_add_f32 v[124:125], v[124:125], s[42:43]
  v_pk_add_f32 v[126:127], v[126:127], s[42:43]
  v_rcp_f32 v112, v112
  v_rcp_f32 v113, v113
  v_rcp_f32 v114, v114
  v_rcp_f32 v115, v115
  v_rcp_f32 v116, v116
  v_rcp_f32 v117, v117
  v_rcp_f32 v118, v118
  v_rcp_f32 v119, v119
  v_rcp_f32 v120, v120
  v_rcp_f32 v121, v121
  v_rcp_f32 v122, v122
  v_rcp_f32 v123, v123
  v_rcp_f32 v124, v124
  v_rcp_f32 v125, v125
  v_rcp_f32 v126, v126
  v_rcp_f32 v127, v127
  v_pk_mul_f32 v[80:81], v[80:81], v[112:113]
  v_pk_mul_f32 v[82:83], v[82:83], v[114:115]
  v_pk_mul_f32 v[84:85], v[84:85], v[116:117]
  v_pk_mul_f32 v[86:87], v[86:87], v[118:119]
  v_pk_mul_f32 v[88:89], v[88:89], v[120:121]
  v_pk_mul_f32 v[90:91], v[90:91], v[122:123]
  v_pk_mul_f32 v[92:93], v[92:93], v[124:125]
  v_pk_mul_f32 v[94:95], v[94:95], v[126:127]
  v_pk_fma_f32 v[144:145], v[80:81], v[80:81], v[144:145]
  v_pk_add_f32 v[128:129], v[128:129], v[80:81]
  v_pk_fma_f32 v[146:147], v[82:83], v[82:83], v[146:147]
  v_pk_add_f32 v[130:131], v[130:131], v[82:83]
  v_pk_fma_f32 v[148:149], v[84:85], v[84:85], v[148:149]
  v_pk_add_f32 v[132:133], v[132:133], v[84:85]
  v_pk_fma_f32 v[150:151], v[86:87], v[86:87], v[150:151]
  v_pk_add_f32 v[134:135], v[134:135], v[86:87]
  v_pk_fma_f32 v[152:153], v[88:89], v[88:89], v[152:153]
  v_pk_add_f32 v[136:137], v[136:137], v[88:89]
  v_pk_fma_f32 v[154:155], v[90:91], v[90:91], v[154:155]
  v_pk_add_f32 v[138:139], v[138:139], v[90:91]
  v_pk_fma_f32 v[156:157], v[92:93], v[92:93], v[156:157]
  v_pk_add_f32 v[140:141], v[140:141], v[92:93]
  v_pk_fma_f32 v[158:159], v[94:95], v[94:95], v[158:159]
  v_pk_add_f32 v[142:143], v[142:143], v[94:95]
  v_cvt_pk_bf16_f32 v220, v80, v81
  v_cvt_pk_bf16_f32 v221, v82, v83
  v_cvt_pk_bf16_f32 v222, v84, v85
  v_cvt_pk_bf16_f32 v223, v86, v87
  ds_write_b128 v162, v[220:223] offset:5120
  v_cvt_pk_bf16_f32 v208, v88, v89
  v_cvt_pk_bf16_f32 v209, v90, v91
  v_cvt_pk_bf16_f32 v210, v92, v93
  v_cvt_pk_bf16_f32 v211, v94, v95
  ds_write_b128 v162, v[208:211] offset:37888
  v_pk_mul_f32 v[112:113], v[96:97], v[96:97]
  v_pk_mul_f32 v[114:115], v[98:99], v[98:99]
  v_pk_mul_f32 v[116:117], v[100:101], v[100:101]
  v_pk_mul_f32 v[118:119], v[102:103], v[102:103]
  v_pk_mul_f32 v[120:121], v[104:105], v[104:105]
  v_pk_mul_f32 v[122:123], v[106:107], v[106:107]
  v_pk_mul_f32 v[124:125], v[108:109], v[108:109]
  v_pk_mul_f32 v[126:127], v[110:111], v[110:111]
  v_pk_fma_f32 v[112:113], v[112:113], s[40:41], v[160:161]
  v_pk_fma_f32 v[114:115], v[114:115], s[40:41], v[160:161]
  v_pk_fma_f32 v[116:117], v[116:117], s[40:41], v[160:161]
  v_pk_fma_f32 v[118:119], v[118:119], s[40:41], v[160:161]
  v_pk_fma_f32 v[120:121], v[120:121], s[40:41], v[160:161]
  v_pk_fma_f32 v[122:123], v[122:123], s[40:41], v[160:161]
  v_pk_fma_f32 v[124:125], v[124:125], s[40:41], v[160:161]
  v_pk_fma_f32 v[126:127], v[126:127], s[40:41], v[160:161]
  v_pk_mul_f32 v[112:113], v[112:113], v[96:97]
  v_pk_mul_f32 v[114:115], v[114:115], v[98:99]
  v_pk_mul_f32 v[116:117], v[116:117], v[100:101]
  v_pk_mul_f32 v[118:119], v[118:119], v[102:103]
  v_pk_mul_f32 v[120:121], v[120:121], v[104:105]
  v_pk_mul_f32 v[122:123], v[122:123], v[106:107]
  v_pk_mul_f32 v[124:125], v[124:125], v[108:109]
  v_pk_mul_f32 v[126:127], v[126:127], v[110:111]
  v_exp_f32 v112, v112
  v_exp_f32 v113, v113
  v_exp_f32 v114, v114
  v_exp_f32 v115, v115
  v_exp_f32 v116, v116
  v_exp_f32 v117, v117
  v_exp_f32 v118, v118
  v_exp_f32 v119, v119
  v_exp_f32 v120, v120
  v_exp_f32 v121, v121
  v_exp_f32 v122, v122
  v_exp_f32 v123, v123
  v_exp_f32 v124, v124
  v_exp_f32 v125, v125
  v_exp_f32 v126, v126
  v_exp_f32 v127, v127
  v_pk_add_f32 v[112:113], v[112:113], s[42:43]
  v_pk_add_f32 v[114:115], v[114:115], s[42:43]
  v_pk_add_f32 v[116:117], v[116:117], s[42:43]
  v_pk_add_f32 v[118:119], v[118:119], s[42:43]
  v_pk_add_f32 v[120:121], v[120:121], s[42:43]
  v_pk_add_f32 v[122:123], v[122:123], s[42:43]
  v_pk_add_f32 v[124:125], v[124:125], s[42:43]
  v_pk_add_f32 v[126:127], v[126:127], s[42:43]
  v_rcp_f32 v112, v112
  v_rcp_f32 v113, v113
  v_rcp_f32 v114, v114
  v_rcp_f32 v115, v115
  v_rcp_f32 v116, v116
  v_rcp_f32 v117, v117
  v_rcp_f32 v118, v118
  v_rcp_f32 v119, v119
  v_rcp_f32 v120, v120
  v_rcp_f32 v121, v121
  v_rcp_f32 v122, v122
  v_rcp_f32 v123, v123
  v_rcp_f32 v124, v124
  v_rcp_f32 v125, v125
  v_rcp_f32 v126, v126
  v_rcp_f32 v127, v127
  v_pk_mul_f32 v[96:97], v[96:97], v[112:113]
  v_pk_mul_f32 v[98:99], v[98:99], v[114:115]
  v_pk_mul_f32 v[100:101], v[100:101], v[116:117]
  v_pk_mul_f32 v[102:103], v[102:103], v[118:119]
  v_pk_mul_f32 v[104:105], v[104:105], v[120:121]
  v_pk_mul_f32 v[106:107], v[106:107], v[122:123]
  v_pk_mul_f32 v[108:109], v[108:109], v[124:125]
  v_pk_mul_f32 v[110:111], v[110:111], v[126:127]
  v_pk_fma_f32 v[144:145], v[96:97], v[96:97], v[144:145]
  v_pk_add_f32 v[128:129], v[128:129], v[96:97]
  v_pk_fma_f32 v[146:147], v[98:99], v[98:99], v[146:147]
  v_pk_add_f32 v[130:131], v[130:131], v[98:99]
  v_pk_fma_f32 v[148:149], v[100:101], v[100:101], v[148:149]
  v_pk_add_f32 v[132:133], v[132:133], v[100:101]
  v_pk_fma_f32 v[150:151], v[102:103], v[102:103], v[150:151]
  v_pk_add_f32 v[134:135], v[134:135], v[102:103]
  v_pk_fma_f32 v[152:153], v[104:105], v[104:105], v[152:153]
  v_pk_add_f32 v[136:137], v[136:137], v[104:105]
  v_pk_fma_f32 v[154:155], v[106:107], v[106:107], v[154:155]
  v_pk_add_f32 v[138:139], v[138:139], v[106:107]
  v_pk_fma_f32 v[156:157], v[108:109], v[108:109], v[156:157]
  v_pk_add_f32 v[140:141], v[140:141], v[108:109]
  v_pk_fma_f32 v[158:159], v[110:111], v[110:111], v[158:159]
  v_pk_add_f32 v[142:143], v[142:143], v[110:111]
  v_cvt_pk_bf16_f32 v212, v96, v97
  v_cvt_pk_bf16_f32 v213, v98, v99
  v_cvt_pk_bf16_f32 v214, v100, v101
  v_cvt_pk_bf16_f32 v215, v102, v103
  ds_write_b128 v162, v[212:215] offset:6144
  v_cvt_pk_bf16_f32 v216, v104, v105
  v_cvt_pk_bf16_f32 v217, v106, v107
  v_cvt_pk_bf16_f32 v218, v108, v109
  v_cvt_pk_bf16_f32 v219, v110, v111
  ds_write_b128 v162, v[216:219] offset:38912
  v_add_f32_dpp v128, v128, v128 row_ror:8 row_mask:0xf bank_mask:0xf
  v_add_f32_dpp v129, v129, v129 row_ror:8 row_mask:0xf bank_mask:0xf
  v_add_f32_dpp v130, v130, v130 row_ror:8 row_mask:0xf bank_mask:0xf
  v_add_f32_dpp v131, v131, v131 row_ror:8 row_mask:0xf bank_mask:0xf
  v_add_f32_dpp v132, v132, v132 row_ror:8 row_mask:0xf bank_mask:0xf
  v_add_f32_dpp v133, v133, v133 row_ror:8 row_mask:0xf bank_mask:0xf
  v_add_f32_dpp v134, v134, v134 row_ror:8 row_mask:0xf bank_mask:0xf
  v_add_f32_dpp v135, v135, v135 row_ror:8 row_mask:0xf bank_mask:0xf
  v_add_f32_dpp v136, v136, v136 row_ror:8 row_mask:0xf bank_mask:0xf
  v_add_f32_dpp v137, v137, v137 row_ror:8 row_mask:0xf bank_mask:0xf
  v_add_f32_dpp v138, v138, v138 row_ror:8 row_mask:0xf bank_mask:0xf
  v_add_f32_dpp v139, v139, v139 row_ror:8 row_mask:0xf bank_mask:0xf
  v_add_f32_dpp v140, v140, v140 row_ror:8 row_mask:0xf bank_mask:0xf
  v_add_f32_dpp v141, v141, v141 row_ror:8 row_mask:0xf bank_mask:0xf
  v_add_f32_dpp v142, v142, v142 row_ror:8 row_mask:0xf bank_mask:0xf
  v_add_f32_dpp v143, v143, v143 row_ror:8 row_mask:0xf bank_mask:0xf
  v_add_f32_dpp v144, v144, v144 row_ror:8 row_mask:0xf bank_mask:0xf
  v_add_f32_dpp v145, v145, v145 row_ror:8 row_mask:0xf bank_mask:0xf
  v_add_f32_dpp v146, v146, v146 row_ror:8 row_mask:0xf bank_mask:0xf
  v_add_f32_dpp v147, v147, v147 row_ror:8 row_mask:0xf bank_mask:0xf
  v_add_f32_dpp v148, v148, v148 row_ror:8 row_mask:0xf bank_mask:0xf
  v_add_f32_dpp v149, v149, v149 row_ror:8 row_mask:0xf bank_mask:0xf
  v_add_f32_dpp v150, v150, v150 row_ror:8 row_mask:0xf bank_mask:0xf
  v_add_f32_dpp v151, v151, v151 row_ror:8 row_mask:0xf bank_mask:0xf
  v_add_f32_dpp v152, v152, v152 row_ror:8 row_mask:0xf bank_mask:0xf
  v_add_f32_dpp v153, v153, v153 row_ror:8 row_mask:0xf bank_mask:0xf
  v_add_f32_dpp v154, v154, v154 row_ror:8 row_mask:0xf bank_mask:0xf
  v_add_f32_dpp v155, v155, v155 row_ror:8 row_mask:0xf bank_mask:0xf
  v_add_f32_dpp v156, v156, v156 row_ror:8 row_mask:0xf bank_mask:0xf
  v_add_f32_dpp v157, v157, v157 row_ror:8 row_mask:0xf bank_mask:0xf
  v_add_f32_dpp v158, v158, v158 row_ror:8 row_mask:0xf bank_mask:0xf
  v_add_f32_dpp v159, v159, v159 row_ror:8 row_mask:0xf bank_mask:0xf
  v_add_f32_dpp v128, v128, v128 row_ror:4 row_mask:0xf bank_mask:0xf
  v_add_f32_dpp v129, v129, v129 row_ror:4 row_mask:0xf bank_mask:0xf
  v_add_f32_dpp v130, v130, v130 row_ror:4 row_mask:0xf bank_mask:0xf
  v_add_f32_dpp v131, v131, v131 row_ror:4 row_mask:0xf bank_mask:0xf
  v_add_f32_dpp v132, v132, v132 row_ror:4 row_mask:0xf bank_mask:0xf
  v_add_f32_dpp v133, v133, v133 row_ror:4 row_mask:0xf bank_mask:0xf
  v_add_f32_dpp v134, v134, v134 row_ror:4 row_mask:0xf bank_mask:0xf
  v_add_f32_dpp v135, v135, v135 row_ror:4 row_mask:0xf bank_mask:0xf
  v_add_f32_dpp v136, v136, v136 row_ror:4 row_mask:0xf bank_mask:0xf
  v_add_f32_dpp v137, v137, v137 row_ror:4 row_mask:0xf bank_mask:0xf
  v_add_f32_dpp v138, v138, v138 row_ror:4 row_mask:0xf bank_mask:0xf
  v_add_f32_dpp v139, v139, v139 row_ror:4 row_mask:0xf bank_mask:0xf
  v_add_f32_dpp v140, v140, v140 row_ror:4 row_mask:0xf bank_mask:0xf
  v_add_f32_dpp v141, v141, v141 row_ror:4 row_mask:0xf bank_mask:0xf
  v_add_f32_dpp v142, v142, v142 row_ror:4 row_mask:0xf bank_mask:0xf
  v_add_f32_dpp v143, v143, v143 row_ror:4 row_mask:0xf bank_mask:0xf
  v_add_f32_dpp v144, v144, v144 row_ror:4 row_mask:0xf bank_mask:0xf
  v_add_f32_dpp v145, v145, v145 row_ror:4 row_mask:0xf bank_mask:0xf
  v_add_f32_dpp v146, v146, v146 row_ror:4 row_mask:0xf bank_mask:0xf
  v_add_f32_dpp v147, v147, v147 row_ror:4 row_mask:0xf bank_mask:0xf
  v_add_f32_dpp v148, v148, v148 row_ror:4 row_mask:0xf bank_mask:0xf
  v_add_f32_dpp v149, v149, v149 row_ror:4 row_mask:0xf bank_mask:0xf
  v_add_f32_dpp v150, v150, v150 row_ror:4 row_mask:0xf bank_mask:0xf
  v_add_f32_dpp v151, v151, v151 row_ror:4 row_mask:0xf bank_mask:0xf
  v_add_f32_dpp v152, v152, v152 row_ror:4 row_mask:0xf bank_mask:0xf
  v_add_f32_dpp v153, v153, v153 row_ror:4 row_mask:0xf bank_mask:0xf
  v_add_f32_dpp v154, v154, v154 row_ror:4 row_mask:0xf bank_mask:0xf
  v_add_f32_dpp v155, v155, v155 row_ror:4 row_mask:0xf bank_mask:0xf
  v_add_f32_dpp v156, v156, v156 row_ror:4 row_mask:0xf bank_mask:0xf
  v_add_f32_dpp v157, v157, v157 row_ror:4 row_mask:0xf bank_mask:0xf
  v_add_f32_dpp v158, v158, v158 row_ror:4 row_mask:0xf bank_mask:0xf
  v_add_f32_dpp v159, v159, v159 row_ror:4 row_mask:0xf bank_mask:0xf
  v_add_f32_dpp v128, v128, v128 row_ror:2 row_mask:0xf bank_mask:0xf
  v_add_f32_dpp v129, v129, v129 row_ror:2 row_mask:0xf bank_mask:0xf
  v_add_f32_dpp v130, v130, v130 row_ror:2 row_mask:0xf bank_mask:0xf
  v_add_f32_dpp v131, v131, v131 row_ror:2 row_mask:0xf bank_mask:0xf
  v_add_f32_dpp v132, v132, v132 row_ror:2 row_mask:0xf bank_mask:0xf
  v_add_f32_dpp v133, v133, v133 row_ror:2 row_mask:0xf bank_mask:0xf
  v_add_f32_dpp v134, v134, v134 row_ror:2 row_mask:0xf bank_mask:0xf
  v_add_f32_dpp v135, v135, v135 row_ror:2 row_mask:0xf bank_mask:0xf
  v_add_f32_dpp v136, v136, v136 row_ror:2 row_mask:0xf bank_mask:0xf
  v_add_f32_dpp v137, v137, v137 row_ror:2 row_mask:0xf bank_mask:0xf
  v_add_f32_dpp v138, v138, v138 row_ror:2 row_mask:0xf bank_mask:0xf
  v_add_f32_dpp v139, v139, v139 row_ror:2 row_mask:0xf bank_mask:0xf
  v_add_f32_dpp v140, v140, v140 row_ror:2 row_mask:0xf bank_mask:0xf
  v_add_f32_dpp v141, v141, v141 row_ror:2 row_mask:0xf bank_mask:0xf
  v_add_f32_dpp v142, v142, v142 row_ror:2 row_mask:0xf bank_mask:0xf
  v_add_f32_dpp v143, v143, v143 row_ror:2 row_mask:0xf bank_mask:0xf
  v_add_f32_dpp v144, v144, v144 row_ror:2 row_mask:0xf bank_mask:0xf
  v_add_f32_dpp v145, v145, v145 row_ror:2 row_mask:0xf bank_mask:0xf
  v_add_f32_dpp v146, v146, v146 row_ror:2 row_mask:0xf bank_mask:0xf
  v_add_f32_dpp v147, v147, v147 row_ror:2 row_mask:0xf bank_mask:0xf
  v_add_f32_dpp v148, v148, v148 row_ror:2 row_mask:0xf bank_mask:0xf
  v_add_f32_dpp v149, v149, v149 row_ror:2 row_mask:0xf bank_mask:0xf
  v_add_f32_dpp v150, v150, v150 row_ror:2 row_mask:0xf bank_mask:0xf
  v_add_f32_dpp v151, v151, v151 row_ror:2 row_mask:0xf bank_mask:0xf
  v_add_f32_dpp v152, v152, v152 row_ror:2 row_mask:0xf bank_mask:0xf
  v_add_f32_dpp v153, v153, v153 row_ror:2 row_mask:0xf bank_mask:0xf
  v_add_f32_dpp v154, v154, v154 row_ror:2 row_mask:0xf bank_mask:0xf
  v_add_f32_dpp v155, v155, v155 row_ror:2 row_mask:0xf bank_mask:0xf
  v_add_f32_dpp v156, v156, v156 row_ror:2 row_mask:0xf bank_mask:0xf
  v_add_f32_dpp v157, v157, v157 row_ror:2 row_mask:0xf bank_mask:0xf
  v_add_f32_dpp v158, v158, v158 row_ror:2 row_mask:0xf bank_mask:0xf
  v_add_f32_dpp v159, v159, v159 row_ror:2 row_mask:0xf bank_mask:0xf
  v_add_f32_dpp v128, v128, v128 row_ror:1 row_mask:0xf bank_mask:0xf
  v_add_f32_dpp v129, v129, v129 row_ror:1 row_mask:0xf bank_mask:0xf
  v_add_f32_dpp v130, v130, v130 row_ror:1 row_mask:0xf bank_mask:0xf
  v_add_f32_dpp v131, v131, v131 row_ror:1 row_mask:0xf bank_mask:0xf
  v_add_f32_dpp v132, v132, v132 row_ror:1 row_mask:0xf bank_mask:0xf
  v_add_f32_dpp v133, v133, v133 row_ror:1 row_mask:0xf bank_mask:0xf
  v_add_f32_dpp v134, v134, v134 row_ror:1 row_mask:0xf bank_mask:0xf
  v_add_f32_dpp v135, v135, v135 row_ror:1 row_mask:0xf bank_mask:0xf
  v_add_f32_dpp v136, v136, v136 row_ror:1 row_mask:0xf bank_mask:0xf
  v_add_f32_dpp v137, v137, v137 row_ror:1 row_mask:0xf bank_mask:0xf
  v_add_f32_dpp v138, v138, v138 row_ror:1 row_mask:0xf bank_mask:0xf
  v_add_f32_dpp v139, v139, v139 row_ror:1 row_mask:0xf bank_mask:0xf
  v_add_f32_dpp v140, v140, v140 row_ror:1 row_mask:0xf bank_mask:0xf
  v_add_f32_dpp v141, v141, v141 row_ror:1 row_mask:0xf bank_mask:0xf
  v_add_f32_dpp v142, v142, v142 row_ror:1 row_mask:0xf bank_mask:0xf
  v_add_f32_dpp v143, v143, v143 row_ror:1 row_mask:0xf bank_mask:0xf
  v_add_f32_dpp v144, v144, v144 row_ror:1 row_mask:0xf bank_mask:0xf
  v_add_f32_dpp v145, v145, v145 row_ror:1 row_mask:0xf bank_mask:0xf
  v_add_f32_dpp v146, v146, v146 row_ror:1 row_mask:0xf bank_mask:0xf
  v_add_f32_dpp v147, v147, v147 row_ror:1 row_mask:0xf bank_mask:0xf
  v_add_f32_dpp v148, v148, v148 row_ror:1 row_mask:0xf bank_mask:0xf
  v_add_f32_dpp v149, v149, v149 row_ror:1 row_mask:0xf bank_mask:0xf
  v_add_f32_dpp v150, v150, v150 row_ror:1 row_mask:0xf bank_mask:0xf
  v_add_f32_dpp v151, v151, v151 row_ror:1 row_mask:0xf bank_mask:0xf
  v_add_f32_dpp v152, v152, v152 row_ror:1 row_mask:0xf bank_mask:0xf
  v_add_f32_dpp v153, v153, v153 row_ror:1 row_mask:0xf bank_mask:0xf
  v_add_f32_dpp v154, v154, v154 row_ror:1 row_mask:0xf bank_mask:0xf
  v_add_f32_dpp v155, v155, v155 row_ror:1 row_mask:0xf bank_mask:0xf
  v_add_f32_dpp v156, v156, v156 row_ror:1 row_mask:0xf bank_mask:0xf
  v_add_f32_dpp v157, v157, v157 row_ror:1 row_mask:0xf bank_mask:0xf
  v_add_f32_dpp v158, v158, v158 row_ror:1 row_mask:0xf bank_mask:0xf
  v_add_f32_dpp v159, v159, v159 row_ror:1 row_mask:0xf bank_mask:0xf
  v_lshrrev_b32 v112, 4, v254
  v_lshlrev_b32 v112, 5, v112
  s_lshl_b32 s36, s44, 13
  s_add_u32 s36, s36, 39936
  v_add_u32 v112, s36, v112
  v_add_u32 v113, s36, v253
  ds_write_b128 v112, v[128:131] offset:0
  ds_write_b128 v112, v[132:135] offset:16
  ds_write_b128 v112, v[136:139] offset:128
  ds_write_b128 v112, v[140:143] offset:144
  ds_write_b128 v112, v[144:147] offset:256
  ds_write_b128 v112, v[148:151] offset:272
  ds_write_b128 v112, v[152:155] offset:384
  ds_write_b128 v112, v[156:159] offset:400
  s_waitcnt lgkmcnt(0)
  ds_read_b32 v114, v113
  ds_read_b32 v115, v113 offset:256
  s_lshl_b32 s87, s32, 8
  s_lshl_b32 s37, s81, 14
  s_add_u32 s87, s87, s37
  s_add_u32 s87, s87, 41680896
  s_mov_b32 s82, s35
  s_waitcnt vmcnt(0) lgkmcnt(0)
  s_branch gated_mix__mha_block__mixer_gmlp__prompt_kernel_p2
gated_mix__mha_block__mixer_gmlp__prompt_kernel_pfsw1:
  s_mov_b32 s64, s52
  s_mov_b32 s65, s53
  s_mov_b32 s66, 8388608
  s_mov_b32 s68, s54
  s_mov_b32 s69, s55
  s_mov_b32 s70, 3670016
  s_lshl_b32 s90, s92, 10
  s_mov_b32 s91, s90
  s_add_u32 s28, s90, 8388608
  s_add_u32 s29, s90, 1572864
  v_mov_b32 v252, v233
  v_mov_b32 v253, v233
  v_add_u32 v254, 1048576, v233
  v_add_u32 v255, 1048576, v233
  s_setpc_b64 s[24:25]
gated_mix__mha_block__mixer_gmlp__prompt_kernel_pfsw2:
  s_mov_b32 s68, s56
  s_mov_b32 s69, s57
  s_mov_b32 s70, 2097152
  s_lshl_b32 s91, s92, 10
  s_add_u32 s29, s91, 2097152
  s_setpc_b64 s[24:25]
gated_mix__mha_block__mixer_gmlp__prompt_kernel_arrive:
  v_mov_b32 v236, 0
  v_mov_b32 v237, 1
  s_mov_b64 exec, 1
  global_atomic_add v236, v237, s[100:101] sc1
  s_mov_b64 exec, -1
  s_setpc_b64 s[24:25]
gated_mix__mha_block__mixer_gmlp__prompt_kernel_arrchk:
  s_mov_b32 s53, 0x8000
  v_mov_b32 v236, 0
gated_mix__mha_block__mixer_gmlp__prompt_kernel_arrl:
  global_load_dword v237, v236, s[100:101] sc1
  s_waitcnt vmcnt(0)
  v_readfirstlane_b32 s26, v237
  s_nop 3
  s_cmp_ge_u32 s26, 80
  s_cbranch_scc1 gated_mix__mha_block__mixer_gmlp__prompt_kernel_arrok
  s_sleep 16
  s_sub_u32 s53, s53, 1
  s_cmp_lg_u32 s53, 0
  s_cbranch_scc1 gated_mix__mha_block__mixer_gmlp__prompt_kernel_arrl
gated_mix__mha_block__mixer_gmlp__prompt_kernel_arrok:
  s_setpc_b64 s[24:25]
.p2align 12
gated_mix__mha_block__mixer_gmlp__prompt_kernel_p2:
  s_load_dwordx2 s[16:17], s[0:1], 40
  s_load_dwordx2 s[20:21], s[0:1], 56
  s_load_dwordx2 s[24:25], s[0:1], 16
  s_load_dwordx2 s[32:33], s[0:1], 48
  s_load_dwordx2 s[40:41], s[0:1], 72
  s_lshl_b32 s49, s44, 10
  s_lshl_b32 s50, s44, 11
  v_bfe_u32 v176, v254, 4, 1
  v_lshrrev_b32 v177, 5, v254
  v_and_b32 v178, 15, v254
  v_lshlrev_b32 v179, 10, v176
  v_lshl_add_u32 v179, v177, 8, v179
  v_lshl_add_u32 v179, v178, 4, v179
  s_lshl_b32 s73, s46, 3
  s_lshl_b32 s74, s44, 1
  s_add_u32 s73, s73, s74
  s_lshl_b32 s74, s73, 11
  s_lshl_b32 s72, s45, 17
  s_add_u32 s74, s74, s72
  s_lshl_b32 s83, s73, 11
  s_add_u32 s83, s83, 42991616
  s_cmp_lg_u32 s44, 0
  s_cbranch_scc1 gated_mix__mha_block__mixer_gmlp__prompt_kernel_ckv_ok
  s_mov_b32 s53, 0x8000
gated_mix__mha_block__mixer_gmlp__prompt_kernel_ckv:
  v_and_b32 v164, v164, v165
  v_cmp_eq_u32 vcc, 0, v164
  s_nop 3
  s_cmp_eq_u64 vcc, 0
  s_cbranch_scc1 gated_mix__mha_block__mixer_gmlp__prompt_kernel_ckv_ok
  s_sleep 6
  buffer_load_dword v164, v167, s[4:7], s52 offen sc1
  buffer_load_dword v165, v168, s[4:7], s52 offen sc1
  s_waitcnt vmcnt(0)
  s_sub_u32 s53, s53, 1
  s_cmp_lg_u32 s53, 0
  s_cbranch_scc1 gated_mix__mha_block__mixer_gmlp__prompt_kernel_ckv
gated_mix__mha_block__mixer_gmlp__prompt_kernel_ckv_ok:
  s_barrier
  s_add_u32 m0, s50, 0
  s_nop 0
  buffer_load_dwordx4 v255, s[8:11], s49 offen sc1 lds
  buffer_load_dwordx4 v255, s[12:15], s49 offen offset:1024 sc1 lds
  s_add_u32 s49, s49, 4096
  v_lshlrev_b32 v248, 3, v254
  buffer_store_dwordx2 v[114:115], v248, s[4:7], s87 offen sc1
  s_nop 1
  buffer_load_dwordx4 v[112:115], v179, s[4:7], s74 offen offset:0 sc1
  buffer_load_dwordx4 v[116:119], v179, s[4:7], s74 offen offset:512 sc1
  buffer_load_dwordx4 v[120:123], v179, s[4:7], s74 offen offset:2048 sc1
  buffer_load_dwordx4 v[124:127], v179, s[4:7], s74 offen offset:2560 sc1
  s_add_u32 m0, s50, 8192
  s_nop 0
  buffer_load_dwordx4 v255, s[8:11], s49 offen sc1 lds
  buffer_load_dwordx4 v255, s[12:15], s49 offen offset:1024 sc1 lds
  s_add_u32 s49, s49, 4096
  s_add_u32 m0, s50, 16384
  s_nop 0
  buffer_load_dwordx4 v255, s[8:11], s49 offen sc1 lds
  buffer_load_dwordx4 v255, s[12:15], s49 offen offset:1024 sc1 lds
  s_add_u32 s49, s49, 4096
  s_add_u32 m0, s50, 24576
  s_nop 0
  buffer_load_dwordx4 v255, s[8:11], s49 offen sc1 lds
  buffer_load_dwordx4 v255, s[12:15], s49 offen offset:1024 sc1 lds
  s_add_u32 s49, s49, 4096
  s_waitcnt lgkmcnt(0)
  s_mov_b32 s18, 8388608
  s_mov_b32 s19, 0x00020000
  s_mov_b32 s22, 3670016
  s_mov_b32 s23, 0x00020000
  s_mov_b32 s26, 2097152
  s_mov_b32 s27, 0x00020000
  s_mov_b32 s34, 4096
  s_mov_b32 s35, 0x00020000
  s_mov_b32 s42, 4194304
  s_mov_b32 s43, 0x00020000
  v_lshrrev_b32 v180, 2, v178
  v_lshlrev_b32 v180, 3, v180
  v_and_b32 v181, 3, v254
  v_add_u32 v189, v180, v181
  v_lshl_add_u32 v188, v176, 2, v189
  v_and_b32 v181, 1, v188
  v_lshrrev_b32 v188, 1, v188
  v_lshlrev_b32 v188, 7, v188
  v_lshl_add_u32 v188, v181, 2, v188
  v_bfe_u32 v181, v254, 3, 1
  v_lshlrev_b32 v172, 11, v181
  v_lshl_add_u32 v172, v177, 8, v172
  v_lshl_add_u32 v172, v176, 7, v172
  v_and_b32 v181, 7, v254
  v_lshl_add_u32 v172, v181, 4, v172
  v_and_b32 v181, 1, v254
  v_cmp_eq_u32 vcc, v181, v176
  v_mov_b32 v184, 0x3f803f80
  s_nop 0
  v_cndmask_b32 v168, 0, v184, vcc
  v_cndmask_b32 v169, 0, v184, vcc
  v_cndmask_b32 v170, 0, v184, vcc
  v_cndmask_b32 v171, 0, v184, vcc
  v_mov_b32 v32, 0
  v_mov_b32 v33, 0
  v_mov_b32 v34, 0
  v_mov_b32 v35, 0
  v_mov_b32 v36, 0
  v_mov_b32 v37, 0
  v_mov_b32 v38, 0
  v_mov_b32 v39, 0
  v_mov_b32 v40, 0
  v_mov_b32 v41, 0
  v_mov_b32 v42, 0
  v_mov_b32 v43, 0
  v_mov_b32 v44, 0
  v_mov_b32 v45, 0
  v_mov_b32 v46, 0
  v_mov_b32 v47, 0
  v_mov_b32 v48, 0
  v_mov_b32 v49, 0
  v_mov_b32 v50, 0
  v_mov_b32 v51, 0
  v_mov_b32 v52, 0
  v_mov_b32 v53, 0
  v_mov_b32 v54, 0
  v_mov_b32 v55, 0
  v_mov_b32 v56, 0
  v_mov_b32 v57, 0
  v_mov_b32 v58, 0
  v_mov_b32 v59, 0
  v_mov_b32 v60, 0
  v_mov_b32 v61, 0
  v_mov_b32 v62, 0
  v_mov_b32 v63, 0
  v_mov_b32 v160, 0
  v_mov_b32 v161, 0
  v_mov_b32 v162, 0
  v_mov_b32 v163, 0
  v_mov_b32 v164, 0
  v_mov_b32 v165, 0
  v_mov_b32 v166, 0
  v_mov_b32 v167, 0
  s_lshl_b32 s67, s47, 2
  s_add_u32 s67, s67, s44
  s_lshl_b32 s65, s67, 5
  v_lshrrev_b32 v184, 3, v254
  v_add_u32 v184, s65, v184
  v_lshlrev_b32 v184, 12, v184
  v_and_b32 v185, 7, v254
  v_xor_b32 v185, v185, v176
  v_xor_b32 v186, 0, v185
  v_lshl_add_u32 v186, v186, 4, v184
  v_add_u32 v232, 0, v186
  v_xor_b32 v186, 2, v185
  v_lshl_add_u32 v186, v186, 4, v184
  v_add_u32 v233, 31744, v186
  v_xor_b32 v186, 4, v185
  v_lshl_add_u32 v186, v186, 4, v184
  v_add_u32 v234, 63488, v186
  v_xor_b32 v186, 6, v185
  v_lshl_add_u32 v186, v186, 4, v184
  v_add_u32 v235, 95232, v186
  s_lshr_b32 s65, s44, 1
  s_and_b32 s66, s44, 1
  s_mul_i32 s55, s65, 114688
  s_mul_i32 s68, s48, 7168
  s_add_u32 s55, s55, s68
  s_lshl_b32 s68, s66, 12
  s_add_u32 s55, s55, s68
  s_lshl_b32 s68, s66, 31
  v_or_b32 v242, s68, v255
  s_mov_b32 s54, 0
  s_lshl_b32 s57, s44, 12
  s_add_u32 s57, s57, 32768
  s_mul_i32 s58, s48, 7168
  s_mul_i32 s70, s67, 114688
  s_add_u32 s58, s58, s70
  s_add_u32 s58, s58, 12582912
  s_lshl_b32 s59, s67, 6
  s_add_u32 s28, s4, 46137344
  s_addc_u32 s29, s5, 0
  s_mov_b32 s30, 7340032
  s_mov_b32 s31, 0x00020000
  s_mul_i32 s70, s47, 720896
  s_add_u32 s70, s70, 29360128
  s_add_u32 s36, s4, s70
  s_addc_u32 s37, s5, 0
  s_mov_b32 s38, 720896
  s_mov_b32 s39, 0x00020000
  v_lshlrev_b32 v184, 7, v189
  v_lshrrev_b32 v185, 1, v178
  v_lshrrev_b32 v186, 4, v254
  v_xor_b32 v186, v186, v185
  v_lshl_add_u32 v243, v186, 4, v184
  s_lshl_b32 s68, s66, 6
  v_xor_b32 v243, s68, v243
  s_lshl_b32 s68, s44, 12
  s_add_u32 s68, s68, 49152
  v_add_u32 v236, s68, v243
  v_xor_b32 v237, 4096, v236
  v_add_u32 v238, 65536, v236
  v_add_u32 v239, 65536, v237
  s_lshl_b32 s68, s66, 13
  s_add_u32 s68, s68, 32768
  v_add_u32 v240, s68, v255
  v_add_u32 v241, 65536, v240
  s_lshl_b32 s56, s92, 10
  v_lshlrev_b32 v190, 1, v189
  v_and_b32 v181, 1, v189
  v_lshrrev_b32 v191, 1, v189
  v_lshlrev_b32 v191, 7, v191
  v_lshl_add_u32 v191, v181, 2, v191
  s_lshl_b32 s84, s80, 9
  s_add_u32 s84, s84, 44056832
  s_lshl_b32 s85, s80, 3
  s_lshl_b32 s86, s44, 1
  s_add_u32 s85, s85, s86
  s_lshl_b32 s85, s85, 8
  s_add_u32 s85, s85, 41943040
  s_cmp_lt_u32 s81, 16
  s_cselect_b32 s85, 0x70000000, s85
  s_waitcnt vmcnt(6)
  s_barrier
  ds_read_b128 v[128:131], v172 offset:0
  ds_read_b128 v[132:135], v172 offset:512
  ds_read_b128 v[144:147], v172 offset:1024
  ds_read_b128 v[148:151], v172 offset:1536
  s_waitcnt lgkmcnt(0)
  v_mfma_f32_32x32x16_bf16 v[0:15], v[128:131], v[112:115], 0
  v_mfma_f32_32x32x16_bf16 v[0:15], v[132:135], v[116:119], v[0:15]
  v_mfma_f32_32x32x16_bf16 v[16:31], v[128:131], v[120:123], 0
  v_mfma_f32_32x32x16_bf16 v[16:31], v[132:135], v[124:127], v[16:31]
  s_cmp_eq_u32 s44, 0
  s_cselect_b32 s52, s84, 0x70000000
  s_nop 13
  v_max3_f32 v184, v0, v1, v2
  v_max3_f32 v184, v184, v3, v4
  v_max3_f32 v184, v184, v5, v6
  v_max3_f32 v184, v184, v7, v8
  v_max3_f32 v184, v184, v9, v10
  v_max3_f32 v184, v184, v11, v12
  v_max3_f32 v184, v184, v13, v14
  v_max_f32 v184, v184, v15
  v_mov_b32 v186, v184
  v_max3_f32 v185, v16, v17, v18
  v_max3_f32 v185, v185, v19, v20
  v_max3_f32 v185, v185, v21, v22
  v_max3_f32 v185, v185, v23, v24
  v_max3_f32 v185, v185, v25, v26
  v_max3_f32 v185, v185, v27, v28
  v_max3_f32 v185, v185, v29, v30
  v_max_f32 v185, v185, v31
  v_mov_b32 v187, v185
  s_nop 1
  v_permlane32_swap_b32 v184, v186
  v_permlane32_swap_b32 v185, v187
  s_nop 1
  v_max_f32 v184, v184, v186
  v_max_f32 v185, v185, v187
  v_sub_f32 v64, 0, v184
  v_sub_f32 v65, 0, v184
  v_sub_f32 v66, 0, v184
  v_sub_f32 v67, 0, v184
  v_sub_f32 v68, 0, v184
  v_sub_f32 v69, 0, v184
  v_sub_f32 v70, 0, v184
  v_sub_f32 v71, 0, v184
  v_sub_f32 v72, 0, v184
  v_sub_f32 v73, 0, v184
  v_sub_f32 v74, 0, v184
  v_sub_f32 v75, 0, v184
  v_sub_f32 v76, 0, v184
  v_sub_f32 v77, 0, v184
  v_sub_f32 v78, 0, v184
  v_sub_f32 v79, 0, v184
  v_sub_f32 v80, 0, v185
  v_sub_f32 v81, 0, v185
  v_sub_f32 v82, 0, v185
  v_sub_f32 v83, 0, v185
  v_sub_f32 v84, 0, v185
  v_sub_f32 v85, 0, v185
  v_sub_f32 v86, 0, v185
  v_sub_f32 v87, 0, v185
  v_sub_f32 v88, 0, v185
  v_sub_f32 v89, 0, v185
  v_sub_f32 v90, 0, v185
  v_sub_f32 v91, 0, v185
  v_sub_f32 v92, 0, v185
  v_sub_f32 v93, 0, v185
  v_sub_f32 v94, 0, v185
  v_sub_f32 v95, 0, v185
  s_nop 1
  v_mfma_f32_32x32x16_bf16 v[0:15], v[128:131], v[112:115], v[64:79]
  v_mfma_f32_32x32x16_bf16 v[0:15], v[132:135], v[116:119], v[0:15]
  s_nop 11
  s_cmp_lt_u32 s81, 16
  s_cselect_b32 s86, s82, 0x70000000
  v_and_b32 v249, 31, v254
  v_lshlrev_b32 v249, 2, v249
  v_lshlrev_b32 v173, 3, v254
  s_lshl_b32 s60, s46, 9
  s_add_u32 s60, s60, 44056576
  s_lshr_b32 s61, s47, 1
  s_lshl_b32 s61, s61, 9
  s_add_u32 s61, s61, 44056576
  s_cmp_eq_u32 s44, 0
  s_cselect_b32 s60, s60, 0x70000000
  s_cselect_b32 s61, s61, 0x70000000
  v_mfma_f32_32x32x16_bf16 v[16:31], v[128:131], v[120:123], v[80:95]
  ds_read_b128 v[136:139], v172 offset:4096
  v_exp_f32 v0, v0
  v_exp_f32 v1, v1
  v_exp_f32 v2, v2
  v_mfma_f32_32x32x16_bf16 v[16:31], v[132:135], v[124:127], v[16:31]
  ds_read_b128 v[140:143], v172 offset:4608
  v_exp_f32 v3, v3
  v_exp_f32 v4, v4
  v_cvt_pk_bf16_f32 v96, v0, v1
  v_exp_f32 v5, v5
  v_exp_f32 v6, v6
  v_cvt_pk_bf16_f32 v97, v2, v3
  v_exp_f32 v7, v7
  v_exp_f32 v8, v8
  v_cvt_pk_bf16_f32 v98, v4, v5
  v_exp_f32 v9, v9
  v_exp_f32 v10, v10
  v_cvt_pk_bf16_f32 v99, v6, v7
  v_exp_f32 v11, v11
  v_exp_f32 v12, v12
  v_cvt_pk_bf16_f32 v100, v8, v9
  v_exp_f32 v13, v13
  s_waitcnt lgkmcnt(0)
  v_exp_f32 v14, v14
  v_cvt_pk_bf16_f32 v101, v10, v11
  v_exp_f32 v15, v15
  v_cvt_pk_bf16_f32 v102, v12, v13
  v_cvt_pk_bf16_f32 v103, v14, v15
  v_mfma_f32_32x32x16_bf16 v[0:15], v[136:139], v[112:115], v[64:79]
  ds_read_b128 v[152:155], v172 offset:5120
  v_exp_f32 v16, v16
  v_exp_f32 v17, v17
  v_exp_f32 v18, v18
  v_mfma_f32_32x32x16_bf16 v[0:15], v[140:143], v[116:119], v[0:15]
  ds_read_b128 v[156:159], v172 offset:5632
  v_exp_f32 v19, v19
  v_exp_f32 v20, v20
  v_cvt_pk_bf16_f32 v104, v16, v17
  v_exp_f32 v21, v21
  v_mfma_f32_32x32x16_bf16 v[32:47], v[144:147], v[96:99], v[32:47]
  v_exp_f32 v22, v22
  v_cvt_pk_bf16_f32 v105, v18, v19
  v_exp_f32 v23, v23
  v_exp_f32 v24, v24
  v_cvt_pk_bf16_f32 v106, v20, v21
  v_mfma_f32_32x32x16_bf16 v[32:47], v[148:151], v[100:103], v[32:47]
  v_exp_f32 v25, v25
  v_exp_f32 v26, v26
  v_cvt_pk_bf16_f32 v107, v22, v23
  v_exp_f32 v27, v27
  v_mfma_f32_16x16x32_bf16 v[160:163], v[168:171], v[96:99], v[160:163]
  v_exp_f32 v28, v28
  v_cvt_pk_bf16_f32 v108, v24, v25
  v_exp_f32 v29, v29
  v_mfma_f32_16x16x32_bf16 v[160:163], v[168:171], v[100:103], v[160:163]
  s_waitcnt vmcnt(4) lgkmcnt(0)
  s_barrier
  v_exp_f32 v30, v30
  v_cvt_pk_bf16_f32 v109, v26, v27
  v_exp_f32 v31, v31
  v_cvt_pk_bf16_f32 v110, v28, v29
  v_cvt_pk_bf16_f32 v111, v30, v31
  s_waitcnt vmcnt(10)
  buffer_store_dword v252, v251, s[4:7], s51 offen sc1
  s_xor_b32 s51, s81, 16
  s_lshl_b32 s51, s51, 7
  s_lshl_b32 s68, s80, 4
  s_add_u32 s51, s51, s68
  s_lshl_b32 s68, s44, 2
  s_add_u32 s51, s51, s68
  s_add_u32 s51, s51, 44040192
  v_mfma_f32_32x32x16_bf16 v[16:31], v[136:139], v[120:123], v[80:95]
  ds_read_b128 v[128:131], v172 offset:8192
  v_exp_f32 v0, v0
  v_exp_f32 v1, v1
  v_exp_f32 v2, v2
  v_mfma_f32_32x32x16_bf16 v[16:31], v[140:143], v[124:127], v[16:31]
  ds_read_b128 v[132:135], v172 offset:8704
  v_exp_f32 v3, v3
  v_exp_f32 v4, v4
  v_cvt_pk_bf16_f32 v96, v0, v1
  v_exp_f32 v5, v5
  v_mfma_f32_32x32x16_bf16 v[48:63], v[144:147], v[104:107], v[48:63]
  s_add_u32 m0, s50, 0
  v_exp_f32 v6, v6
  v_cvt_pk_bf16_f32 v97, v2, v3
  v_exp_f32 v7, v7
  v_exp_f32 v8, v8
  v_cvt_pk_bf16_f32 v98, v4, v5
  v_mfma_f32_32x32x16_bf16 v[48:63], v[148:151], v[108:111], v[48:63]
  buffer_load_dwordx4 v255, s[8:11], s49 offen sc1 lds
  v_exp_f32 v9, v9
  v_exp_f32 v10, v10
  v_cvt_pk_bf16_f32 v99, v6, v7
  v_exp_f32 v11, v11
  v_mfma_f32_16x16x32_bf16 v[164:167], v[168:171], v[104:107], v[164:167]
  buffer_load_dwordx4 v255, s[12:15], s49 offen offset:1024 sc1 lds
  s_add_u32 s49, s49, 4096
  v_exp_f32 v12, v12
  v_cvt_pk_bf16_f32 v100, v8, v9
  v_exp_f32 v13, v13
  v_mfma_f32_16x16x32_bf16 v[164:167], v[168:171], v[108:111], v[164:167]
  s_waitcnt lgkmcnt(0)
  v_exp_f32 v14, v14
  v_cvt_pk_bf16_f32 v101, v10, v11
  v_exp_f32 v15, v15
  v_cvt_pk_bf16_f32 v102, v12, v13
  v_cvt_pk_bf16_f32 v103, v14, v15
  v_mfma_f32_32x32x16_bf16 v[0:15], v[128:131], v[112:115], v[64:79]
  ds_read_b128 v[144:147], v172 offset:9216
  v_exp_f32 v16, v16
  v_exp_f32 v17, v17
  v_exp_f32 v18, v18
  v_mfma_f32_32x32x16_bf16 v[0:15], v[132:135], v[116:119], v[0:15]
  ds_read_b128 v[148:151], v172 offset:9728
  v_exp_f32 v19, v19
  v_exp_f32 v20, v20
  v_cvt_pk_bf16_f32 v104, v16, v17
  v_exp_f32 v21, v21
  v_mfma_f32_32x32x16_bf16 v[32:47], v[152:155], v[96:99], v[32:47]
  v_exp_f32 v22, v22
  v_cvt_pk_bf16_f32 v105, v18, v19
  v_exp_f32 v23, v23
  v_exp_f32 v24, v24
  v_cvt_pk_bf16_f32 v106, v20, v21
  v_mfma_f32_32x32x16_bf16 v[32:47], v[156:159], v[100:103], v[32:47]
  v_exp_f32 v25, v25
  v_exp_f32 v26, v26
  v_cvt_pk_bf16_f32 v107, v22, v23
  v_exp_f32 v27, v27
  v_mfma_f32_16x16x32_bf16 v[160:163], v[168:171], v[96:99], v[160:163]
  v_exp_f32 v28, v28
  v_cvt_pk_bf16_f32 v108, v24, v25
  v_exp_f32 v29, v29
  v_mfma_f32_16x16x32_bf16 v[160:163], v[168:171], v[100:103], v[160:163]
  s_waitcnt lgkmcnt(0)
  v_exp_f32 v30, v30
  v_cvt_pk_bf16_f32 v109, v26, v27
  v_exp_f32 v31, v31
  v_cvt_pk_bf16_f32 v110, v28, v29
  v_cvt_pk_bf16_f32 v111, v30, v31
  v_mfma_f32_32x32x16_bf16 v[16:31], v[128:131], v[120:123], v[80:95]
  ds_read_b128 v[136:139], v172 offset:12288
  v_exp_f32 v0, v0
  v_exp_f32 v1, v1
  v_exp_f32 v2, v2
  v_mfma_f32_32x32x16_bf16 v[16:31], v[132:135], v[124:127], v[16:31]
  ds_read_b128 v[140:143], v172 offset:12800
  v_exp_f32 v3, v3
  v_exp_f32 v4, v4
  v_cvt_pk_bf16_f32 v96, v0, v1
  v_exp_f32 v5, v5
  v_mfma_f32_32x32x16_bf16 v[48:63], v[152:155], v[104:107], v[48:63]
  v_exp_f32 v6, v6
  v_cvt_pk_bf16_f32 v97, v2, v3
  v_exp_f32 v7, v7
  v_exp_f32 v8, v8
  v_cvt_pk_bf16_f32 v98, v4, v5
  v_mfma_f32_32x32x16_bf16 v[48:63], v[156:159], v[108:111], v[48:63]
  v_exp_f32 v9, v9
  v_exp_f32 v10, v10
  v_cvt_pk_bf16_f32 v99, v6, v7
  v_exp_f32 v11, v11
  v_mfma_f32_16x16x32_bf16 v[164:167], v[168:171], v[104:107], v[164:167]
  v_exp_f32 v12, v12
  v_cvt_pk_bf16_f32 v100, v8, v9
  v_exp_f32 v13, v13
  v_mfma_f32_16x16x32_bf16 v[164:167], v[168:171], v[108:111], v[164:167]
  s_waitcnt lgkmcnt(0)
  v_exp_f32 v14, v14
  v_cvt_pk_bf16_f32 v101, v10, v11
  v_exp_f32 v15, v15
  v_cvt_pk_bf16_f32 v102, v12, v13
  v_cvt_pk_bf16_f32 v103, v14, v15
  v_mfma_f32_32x32x16_bf16 v[0:15], v[136:139], v[112:115], v[64:79]
  ds_read_b128 v[152:155], v172 offset:13312
  v_exp_f32 v16, v16
  v_exp_f32 v17, v17
  v_exp_f32 v18, v18
  v_mfma_f32_32x32x16_bf16 v[0:15], v[140:143], v[116:119], v[0:15]
  ds_read_b128 v[156:159], v172 offset:13824
  v_exp_f32 v19, v19
  v_exp_f32 v20, v20
  v_cvt_pk_bf16_f32 v104, v16, v17
  v_exp_f32 v21, v21
  v_mfma_f32_32x32x16_bf16 v[32:47], v[144:147], v[96:99], v[32:47]
  v_exp_f32 v22, v22
  v_cvt_pk_bf16_f32 v105, v18, v19
  v_exp_f32 v23, v23
  v_exp_f32 v24, v24
  v_cvt_pk_bf16_f32 v106, v20, v21
  v_mfma_f32_32x32x16_bf16 v[32:47], v[148:151], v[100:103], v[32:47]
  v_exp_f32 v25, v25
  v_exp_f32 v26, v26
  v_cvt_pk_bf16_f32 v107, v22, v23
  v_exp_f32 v27, v27
  v_mfma_f32_16x16x32_bf16 v[160:163], v[168:171], v[96:99], v[160:163]
  v_exp_f32 v28, v28
  v_cvt_pk_bf16_f32 v108, v24, v25
  v_exp_f32 v29, v29
  v_mfma_f32_16x16x32_bf16 v[160:163], v[168:171], v[100:103], v[160:163]
  s_waitcnt vmcnt(4) lgkmcnt(0)
  s_barrier
  v_exp_f32 v30, v30
  v_cvt_pk_bf16_f32 v109, v26, v27
  v_exp_f32 v31, v31
  v_cvt_pk_bf16_f32 v110, v28, v29
  v_cvt_pk_bf16_f32 v111, v30, v31
  v_mfma_f32_32x32x16_bf16 v[16:31], v[136:139], v[120:123], v[80:95]
  ds_read_b128 v[128:131], v172 offset:16384
  v_exp_f32 v0, v0
  v_exp_f32 v1, v1
  v_exp_f32 v2, v2
  v_mfma_f32_32x32x16_bf16 v[16:31], v[140:143], v[124:127], v[16:31]
  ds_read_b128 v[132:135], v172 offset:16896
  v_exp_f32 v3, v3
  v_exp_f32 v4, v4
  v_cvt_pk_bf16_f32 v96, v0, v1
  v_exp_f32 v5, v5
  v_mfma_f32_32x32x16_bf16 v[48:63], v[144:147], v[104:107], v[48:63]
  s_add_u32 m0, s50, 8192
  v_exp_f32 v6, v6
  v_cvt_pk_bf16_f32 v97, v2, v3
  v_exp_f32 v7, v7
  v_exp_f32 v8, v8
  v_cvt_pk_bf16_f32 v98, v4, v5
  v_mfma_f32_32x32x16_bf16 v[48:63], v[148:151], v[108:111], v[48:63]
  buffer_load_dwordx4 v255, s[8:11], s49 offen sc1 lds
  v_exp_f32 v9, v9
  v_exp_f32 v10, v10
  v_cvt_pk_bf16_f32 v99, v6, v7
  v_exp_f32 v11, v11
  v_mfma_f32_16x16x32_bf16 v[164:167], v[168:171], v[104:107], v[164:167]
  buffer_load_dwordx4 v255, s[12:15], s49 offen offset:1024 sc1 lds
  s_add_u32 s49, s49, 4096
  v_exp_f32 v12, v12
  v_cvt_pk_bf16_f32 v100, v8, v9
  v_exp_f32 v13, v13
  v_mfma_f32_16x16x32_bf16 v[164:167], v[168:171], v[108:111], v[164:167]
  s_waitcnt lgkmcnt(0)
  v_exp_f32 v14, v14
  v_cvt_pk_bf16_f32 v101, v10, v11
  v_exp_f32 v15, v15
  v_cvt_pk_bf16_f32 v102, v12, v13
  v_cvt_pk_bf16_f32 v103, v14, v15
  v_mfma_f32_32x32x16_bf16 v[0:15], v[128:131], v[112:115], v[64:79]
  ds_read_b128 v[144:147], v172 offset:17408
  v_exp_f32 v16, v16
  v_exp_f32 v17, v17
  v_exp_f32 v18, v18
  v_mfma_f32_32x32x16_bf16 v[0:15], v[132:135], v[116:119], v[0:15]
  ds_read_b128 v[148:151], v172 offset:17920
  v_exp_f32 v19, v19
  v_exp_f32 v20, v20
  v_cvt_pk_bf16_f32 v104, v16, v17
  v_exp_f32 v21, v21
  v_mfma_f32_32x32x16_bf16 v[32:47], v[152:155], v[96:99], v[32:47]
  v_exp_f32 v22, v22
  v_cvt_pk_bf16_f32 v105, v18, v19
  v_exp_f32 v23, v23
  v_exp_f32 v24, v24
  v_cvt_pk_bf16_f32 v106, v20, v21
  v_mfma_f32_32x32x16_bf16 v[32:47], v[156:159], v[100:103], v[32:47]
  v_exp_f32 v25, v25
  v_exp_f32 v26, v26
  v_cvt_pk_bf16_f32 v107, v22, v23
  v_exp_f32 v27, v27
  v_mfma_f32_16x16x32_bf16 v[160:163], v[168:171], v[96:99], v[160:163]
  v_exp_f32 v28, v28
  v_cvt_pk_bf16_f32 v108, v24, v25
  v_exp_f32 v29, v29
  v_mfma_f32_16x16x32_bf16 v[160:163], v[168:171], v[100:103], v[160:163]
  s_waitcnt lgkmcnt(0)
  v_exp_f32 v30, v30
  v_cvt_pk_bf16_f32 v109, v26, v27
  v_exp_f32 v31, v31
  v_cvt_pk_bf16_f32 v110, v28, v29
  v_cvt_pk_bf16_f32 v111, v30, v31
  v_mfma_f32_32x32x16_bf16 v[16:31], v[128:131], v[120:123], v[80:95]
  ds_read_b128 v[136:139], v172 offset:20480
  v_exp_f32 v0, v0
  v_exp_f32 v1, v1
  v_exp_f32 v2, v2
  v_mfma_f32_32x32x16_bf16 v[16:31], v[132:135], v[124:127], v[16:31]
  ds_read_b128 v[140:143], v172 offset:20992
  v_exp_f32 v3, v3
  v_exp_f32 v4, v4
  v_cvt_pk_bf16_f32 v96, v0, v1
  v_exp_f32 v5, v5
  v_mfma_f32_32x32x16_bf16 v[48:63], v[152:155], v[104:107], v[48:63]
  v_exp_f32 v6, v6
  v_cvt_pk_bf16_f32 v97, v2, v3
  v_exp_f32 v7, v7
  v_exp_f32 v8, v8
  v_cvt_pk_bf16_f32 v98, v4, v5
  v_mfma_f32_32x32x16_bf16 v[48:63], v[156:159], v[108:111], v[48:63]
  v_exp_f32 v9, v9
  v_exp_f32 v10, v10
  v_cvt_pk_bf16_f32 v99, v6, v7
  v_exp_f32 v11, v11
  v_mfma_f32_16x16x32_bf16 v[164:167], v[168:171], v[104:107], v[164:167]
  v_exp_f32 v12, v12
  v_cvt_pk_bf16_f32 v100, v8, v9
  v_exp_f32 v13, v13
  v_mfma_f32_16x16x32_bf16 v[164:167], v[168:171], v[108:111], v[164:167]
  s_waitcnt lgkmcnt(0)
  v_exp_f32 v14, v14
  v_cvt_pk_bf16_f32 v101, v10, v11
  v_exp_f32 v15, v15
  v_cvt_pk_bf16_f32 v102, v12, v13
  v_cvt_pk_bf16_f32 v103, v14, v15
  v_mfma_f32_32x32x16_bf16 v[0:15], v[136:139], v[112:115], v[64:79]
  ds_read_b128 v[152:155], v172 offset:21504
  v_exp_f32 v16, v16
  v_exp_f32 v17, v17
  v_exp_f32 v18, v18
  v_mfma_f32_32x32x16_bf16 v[0:15], v[140:143], v[116:119], v[0:15]
  ds_read_b128 v[156:159], v172 offset:22016
  v_exp_f32 v19, v19
  v_exp_f32 v20, v20
  v_cvt_pk_bf16_f32 v104, v16, v17
  v_exp_f32 v21, v21
  v_mfma_f32_32x32x16_bf16 v[32:47], v[144:147], v[96:99], v[32:47]
  v_exp_f32 v22, v22
  v_cvt_pk_bf16_f32 v105, v18, v19
  v_exp_f32 v23, v23
  v_exp_f32 v24, v24
  v_cvt_pk_bf16_f32 v106, v20, v21
  v_mfma_f32_32x32x16_bf16 v[32:47], v[148:151], v[100:103], v[32:47]
  v_exp_f32 v25, v25
  v_exp_f32 v26, v26
  v_cvt_pk_bf16_f32 v107, v22, v23
  v_exp_f32 v27, v27
  v_mfma_f32_16x16x32_bf16 v[160:163], v[168:171], v[96:99], v[160:163]
  v_exp_f32 v28, v28
  v_cvt_pk_bf16_f32 v108, v24, v25
  v_exp_f32 v29, v29
  v_mfma_f32_16x16x32_bf16 v[160:163], v[168:171], v[100:103], v[160:163]
  s_waitcnt vmcnt(4) lgkmcnt(0)
  s_barrier
  v_exp_f32 v30, v30
  v_cvt_pk_bf16_f32 v109, v26, v27
  v_exp_f32 v31, v31
  v_cvt_pk_bf16_f32 v110, v28, v29
  v_cvt_pk_bf16_f32 v111, v30, v31
  v_mfma_f32_32x32x16_bf16 v[16:31], v[136:139], v[120:123], v[80:95]
  ds_read_b128 v[128:131], v172 offset:24576
  v_exp_f32 v0, v0
  v_exp_f32 v1, v1
  v_exp_f32 v2, v2
  v_mfma_f32_32x32x16_bf16 v[16:31], v[140:143], v[124:127], v[16:31]
  ds_read_b128 v[132:135], v172 offset:25088
  v_exp_f32 v3, v3
  v_exp_f32 v4, v4
  v_cvt_pk_bf16_f32 v96, v0, v1
  v_exp_f32 v5, v5
  v_mfma_f32_32x32x16_bf16 v[48:63], v[144:147], v[104:107], v[48:63]
  s_add_u32 m0, s50, 16384
  v_exp_f32 v6, v6
  v_cvt_pk_bf16_f32 v97, v2, v3
  v_exp_f32 v7, v7
  v_exp_f32 v8, v8
  v_cvt_pk_bf16_f32 v98, v4, v5
  v_mfma_f32_32x32x16_bf16 v[48:63], v[148:151], v[108:111], v[48:63]
  buffer_load_dwordx4 v255, s[8:11], s49 offen sc1 lds
  v_exp_f32 v9, v9
  v_exp_f32 v10, v10
  v_cvt_pk_bf16_f32 v99, v6, v7
  v_exp_f32 v11, v11
  v_mfma_f32_16x16x32_bf16 v[164:167], v[168:171], v[104:107], v[164:167]
  buffer_load_dwordx4 v255, s[12:15], s49 offen offset:1024 sc1 lds
  s_add_u32 s49, s49, 4096
  v_exp_f32 v12, v12
  v_cvt_pk_bf16_f32 v100, v8, v9
  v_exp_f32 v13, v13
  v_mfma_f32_16x16x32_bf16 v[164:167], v[168:171], v[108:111], v[164:167]
  s_waitcnt lgkmcnt(0)
  v_exp_f32 v14, v14
  v_cvt_pk_bf16_f32 v101, v10, v11
  v_exp_f32 v15, v15
  v_cvt_pk_bf16_f32 v102, v12, v13
  v_cvt_pk_bf16_f32 v103, v14, v15
  v_mfma_f32_32x32x16_bf16 v[0:15], v[128:131], v[112:115], v[64:79]
  ds_read_b128 v[144:147], v172 offset:25600
  v_exp_f32 v16, v16
  v_exp_f32 v17, v17
  v_exp_f32 v18, v18
  v_mfma_f32_32x32x16_bf16 v[0:15], v[132:135], v[116:119], v[0:15]
  ds_read_b128 v[148:151], v172 offset:26112
  v_exp_f32 v19, v19
  v_exp_f32 v20, v20
  v_cvt_pk_bf16_f32 v104, v16, v17
  v_exp_f32 v21, v21
  v_mfma_f32_32x32x16_bf16 v[32:47], v[152:155], v[96:99], v[32:47]
  v_exp_f32 v22, v22
  v_cvt_pk_bf16_f32 v105, v18, v19
  v_exp_f32 v23, v23
  v_exp_f32 v24, v24
  v_cvt_pk_bf16_f32 v106, v20, v21
  v_mfma_f32_32x32x16_bf16 v[32:47], v[156:159], v[100:103], v[32:47]
  v_exp_f32 v25, v25
  v_exp_f32 v26, v26
  v_cvt_pk_bf16_f32 v107, v22, v23
  v_exp_f32 v27, v27
  v_mfma_f32_16x16x32_bf16 v[160:163], v[168:171], v[96:99], v[160:163]
  v_exp_f32 v28, v28
  v_cvt_pk_bf16_f32 v108, v24, v25
  v_exp_f32 v29, v29
  v_mfma_f32_16x16x32_bf16 v[160:163], v[168:171], v[100:103], v[160:163]
  s_waitcnt lgkmcnt(0)
  v_exp_f32 v30, v30
  v_cvt_pk_bf16_f32 v109, v26, v27
  v_exp_f32 v31, v31
  v_cvt_pk_bf16_f32 v110, v28, v29
  v_cvt_pk_bf16_f32 v111, v30, v31
  v_mfma_f32_32x32x16_bf16 v[16:31], v[128:131], v[120:123], v[80:95]
  ds_read_b128 v[136:139], v172 offset:28672
  v_exp_f32 v0, v0
  v_exp_f32 v1, v1
  v_exp_f32 v2, v2
  v_mfma_f32_32x32x16_bf16 v[16:31], v[132:135], v[124:127], v[16:31]
  ds_read_b128 v[140:143], v172 offset:29184
  v_exp_f32 v3, v3
  v_exp_f32 v4, v4
  v_cvt_pk_bf16_f32 v96, v0, v1
  v_exp_f32 v5, v5
  v_mfma_f32_32x32x16_bf16 v[48:63], v[152:155], v[104:107], v[48:63]
  v_exp_f32 v6, v6
  v_cvt_pk_bf16_f32 v97, v2, v3
  v_exp_f32 v7, v7
  v_exp_f32 v8, v8
  v_cvt_pk_bf16_f32 v98, v4, v5
  v_mfma_f32_32x32x16_bf16 v[48:63], v[156:159], v[108:111], v[48:63]
  v_exp_f32 v9, v9
  v_exp_f32 v10, v10
  v_cvt_pk_bf16_f32 v99, v6, v7
  v_exp_f32 v11, v11
  v_mfma_f32_16x16x32_bf16 v[164:167], v[168:171], v[104:107], v[164:167]
  v_exp_f32 v12, v12
  v_cvt_pk_bf16_f32 v100, v8, v9
  v_exp_f32 v13, v13
  v_mfma_f32_16x16x32_bf16 v[164:167], v[168:171], v[108:111], v[164:167]
  s_waitcnt lgkmcnt(0)
  v_exp_f32 v14, v14
  v_cvt_pk_bf16_f32 v101, v10, v11
  v_exp_f32 v15, v15
  v_cvt_pk_bf16_f32 v102, v12, v13
  v_cvt_pk_bf16_f32 v103, v14, v15
  v_mfma_f32_32x32x16_bf16 v[0:15], v[136:139], v[112:115], v[64:79]
  ds_read_b128 v[152:155], v172 offset:29696
  v_exp_f32 v16, v16
  v_exp_f32 v17, v17
  v_exp_f32 v18, v18
  v_mfma_f32_32x32x16_bf16 v[0:15], v[140:143], v[116:119], v[0:15]
  ds_read_b128 v[156:159], v172 offset:30208
  v_exp_f32 v19, v19
  v_exp_f32 v20, v20
  v_cvt_pk_bf16_f32 v104, v16, v17
  v_exp_f32 v21, v21
  v_mfma_f32_32x32x16_bf16 v[32:47], v[144:147], v[96:99], v[32:47]
  v_exp_f32 v22, v22
  v_cvt_pk_bf16_f32 v105, v18, v19
  v_exp_f32 v23, v23
  v_exp_f32 v24, v24
  v_cvt_pk_bf16_f32 v106, v20, v21
  v_mfma_f32_32x32x16_bf16 v[32:47], v[148:151], v[100:103], v[32:47]
  v_exp_f32 v25, v25
  v_exp_f32 v26, v26
  v_cvt_pk_bf16_f32 v107, v22, v23
  v_exp_f32 v27, v27
  v_mfma_f32_16x16x32_bf16 v[160:163], v[168:171], v[96:99], v[160:163]
  v_exp_f32 v28, v28
  v_cvt_pk_bf16_f32 v108, v24, v25
  v_exp_f32 v29, v29
  v_mfma_f32_16x16x32_bf16 v[160:163], v[168:171], v[100:103], v[160:163]
  s_waitcnt vmcnt(4) lgkmcnt(0)
  s_barrier
  v_exp_f32 v30, v30
  v_cvt_pk_bf16_f32 v109, v26, v27
  v_exp_f32 v31, v31
  v_cvt_pk_bf16_f32 v110, v28, v29
  v_cvt_pk_bf16_f32 v111, v30, v31
  v_mfma_f32_32x32x16_bf16 v[16:31], v[136:139], v[120:123], v[80:95]
  ds_read_b128 v[128:131], v172 offset:0
  v_exp_f32 v0, v0
  v_exp_f32 v1, v1
  v_exp_f32 v2, v2
  v_mfma_f32_32x32x16_bf16 v[16:31], v[140:143], v[124:127], v[16:31]
  ds_read_b128 v[132:135], v172 offset:512
  v_exp_f32 v3, v3
  v_exp_f32 v4, v4
  v_cvt_pk_bf16_f32 v96, v0, v1
  v_exp_f32 v5, v5
  v_mfma_f32_32x32x16_bf16 v[48:63], v[144:147], v[104:107], v[48:63]
  s_add_u32 m0, s50, 24576
  v_exp_f32 v6, v6
  v_cvt_pk_bf16_f32 v97, v2, v3
  v_exp_f32 v7, v7
  v_exp_f32 v8, v8
  v_cvt_pk_bf16_f32 v98, v4, v5
  v_mfma_f32_32x32x16_bf16 v[48:63], v[148:151], v[108:111], v[48:63]
  buffer_load_dwordx4 v255, s[8:11], s49 offen sc1 lds
  v_exp_f32 v9, v9
  v_exp_f32 v10, v10
  v_cvt_pk_bf16_f32 v99, v6, v7
  v_exp_f32 v11, v11
  v_mfma_f32_16x16x32_bf16 v[164:167], v[168:171], v[104:107], v[164:167]
  buffer_load_dwordx4 v255, s[12:15], s49 offen offset:1024 sc1 lds
  s_add_u32 s49, s49, 4096
  v_exp_f32 v12, v12
  v_cvt_pk_bf16_f32 v100, v8, v9
  v_exp_f32 v13, v13
  v_mfma_f32_16x16x32_bf16 v[164:167], v[168:171], v[108:111], v[164:167]
  s_waitcnt lgkmcnt(0)
  v_exp_f32 v14, v14
  v_cvt_pk_bf16_f32 v101, v10, v11
  v_exp_f32 v15, v15
  v_cvt_pk_bf16_f32 v102, v12, v13
  v_cvt_pk_bf16_f32 v103, v14, v15
  v_mfma_f32_32x32x16_bf16 v[0:15], v[128:131], v[112:115], v[64:79]
  ds_read_b128 v[144:147], v172 offset:1024
  v_exp_f32 v16, v16
  v_exp_f32 v17, v17
  v_exp_f32 v18, v18
  v_mfma_f32_32x32x16_bf16 v[0:15], v[132:135], v[116:119], v[0:15]
  ds_read_b128 v[148:151], v172 offset:1536
  v_exp_f32 v19, v19
  v_exp_f32 v20, v20
  v_cvt_pk_bf16_f32 v104, v16, v17
  v_exp_f32 v21, v21
  v_mfma_f32_32x32x16_bf16 v[32:47], v[152:155], v[96:99], v[32:47]
  v_exp_f32 v22, v22
  v_cvt_pk_bf16_f32 v105, v18, v19
  v_exp_f32 v23, v23
  v_exp_f32 v24, v24
  v_cvt_pk_bf16_f32 v106, v20, v21
  v_mfma_f32_32x32x16_bf16 v[32:47], v[156:159], v[100:103], v[32:47]
  v_exp_f32 v25, v25
  v_exp_f32 v26, v26
  v_cvt_pk_bf16_f32 v107, v22, v23
  v_exp_f32 v27, v27
  v_mfma_f32_16x16x32_bf16 v[160:163], v[168:171], v[96:99], v[160:163]
  v_exp_f32 v28, v28
  v_cvt_pk_bf16_f32 v108, v24, v25
  v_exp_f32 v29, v29
  v_mfma_f32_16x16x32_bf16 v[160:163], v[168:171], v[100:103], v[160:163]
  s_waitcnt lgkmcnt(0)
  v_exp_f32 v30, v30
  v_cvt_pk_bf16_f32 v109, v26, v27
  v_exp_f32 v31, v31
  v_cvt_pk_bf16_f32 v110, v28, v29
  v_cvt_pk_bf16_f32 v111, v30, v31
  v_mfma_f32_32x32x16_bf16 v[16:31], v[128:131], v[120:123], v[80:95]
  ds_read_b128 v[136:139], v172 offset:4096
  v_exp_f32 v0, v0
  v_exp_f32 v1, v1
  v_exp_f32 v2, v2
  v_mfma_f32_32x32x16_bf16 v[16:31], v[132:135], v[124:127], v[16:31]
  ds_read_b128 v[140:143], v172 offset:4608
  v_exp_f32 v3, v3
  v_exp_f32 v4, v4
  v_cvt_pk_bf16_f32 v96, v0, v1
  v_exp_f32 v5, v5
  v_mfma_f32_32x32x16_bf16 v[48:63], v[152:155], v[104:107], v[48:63]
  v_exp_f32 v6, v6
  v_cvt_pk_bf16_f32 v97, v2, v3
  v_exp_f32 v7, v7
  v_exp_f32 v8, v8
  v_cvt_pk_bf16_f32 v98, v4, v5
  v_mfma_f32_32x32x16_bf16 v[48:63], v[156:159], v[108:111], v[48:63]
  v_exp_f32 v9, v9
  v_exp_f32 v10, v10
  v_cvt_pk_bf16_f32 v99, v6, v7
  v_exp_f32 v11, v11
  v_mfma_f32_16x16x32_bf16 v[164:167], v[168:171], v[104:107], v[164:167]
  v_exp_f32 v12, v12
  v_cvt_pk_bf16_f32 v100, v8, v9
  v_exp_f32 v13, v13
  v_mfma_f32_16x16x32_bf16 v[164:167], v[168:171], v[108:111], v[164:167]
  s_waitcnt lgkmcnt(0)
  v_exp_f32 v14, v14
  v_cvt_pk_bf16_f32 v101, v10, v11
  v_exp_f32 v15, v15
  v_cvt_pk_bf16_f32 v102, v12, v13
  v_cvt_pk_bf16_f32 v103, v14, v15
  v_mfma_f32_32x32x16_bf16 v[0:15], v[136:139], v[112:115], v[64:79]
  ds_read_b128 v[152:155], v172 offset:5120
  v_exp_f32 v16, v16
  v_exp_f32 v17, v17
  v_exp_f32 v18, v18
  v_mfma_f32_32x32x16_bf16 v[0:15], v[140:143], v[116:119], v[0:15]
  ds_read_b128 v[156:159], v172 offset:5632
  v_exp_f32 v19, v19
  v_exp_f32 v20, v20
  v_cvt_pk_bf16_f32 v104, v16, v17
  v_exp_f32 v21, v21
  v_mfma_f32_32x32x16_bf16 v[32:47], v[144:147], v[96:99], v[32:47]
  v_exp_f32 v22, v22
  v_cvt_pk_bf16_f32 v105, v18, v19
  v_exp_f32 v23, v23
  v_exp_f32 v24, v24
  v_cvt_pk_bf16_f32 v106, v20, v21
  v_mfma_f32_32x32x16_bf16 v[32:47], v[148:151], v[100:103], v[32:47]
  v_exp_f32 v25, v25
  v_exp_f32 v26, v26
  v_cvt_pk_bf16_f32 v107, v22, v23
  v_exp_f32 v27, v27
  v_mfma_f32_16x16x32_bf16 v[160:163], v[168:171], v[96:99], v[160:163]
  v_exp_f32 v28, v28
  v_cvt_pk_bf16_f32 v108, v24, v25
  v_exp_f32 v29, v29
  v_mfma_f32_16x16x32_bf16 v[160:163], v[168:171], v[100:103], v[160:163]
  s_waitcnt vmcnt(4) lgkmcnt(0)
  s_barrier
  v_exp_f32 v30, v30
  v_cvt_pk_bf16_f32 v109, v26, v27
  v_exp_f32 v31, v31
  v_cvt_pk_bf16_f32 v110, v28, v29
  v_cvt_pk_bf16_f32 v111, v30, v31
  v_mfma_f32_32x32x16_bf16 v[16:31], v[136:139], v[120:123], v[80:95]
  ds_read_b128 v[128:131], v172 offset:8192
  v_exp_f32 v0, v0
  v_exp_f32 v1, v1
  v_exp_f32 v2, v2
  v_mfma_f32_32x32x16_bf16 v[16:31], v[140:143], v[124:127], v[16:31]
  ds_read_b128 v[132:135], v172 offset:8704
  v_exp_f32 v3, v3
  v_exp_f32 v4, v4
  v_cvt_pk_bf16_f32 v96, v0, v1
  v_exp_f32 v5, v5
  v_mfma_f32_32x32x16_bf16 v[48:63], v[144:147], v[104:107], v[48:63]
  s_add_u32 m0, s50, 0
  v_exp_f32 v6, v6
  v_cvt_pk_bf16_f32 v97, v2, v3
  v_exp_f32 v7, v7
  v_exp_f32 v8, v8
  v_cvt_pk_bf16_f32 v98, v4, v5
  v_mfma_f32_32x32x16_bf16 v[48:63], v[148:151], v[108:111], v[48:63]
  buffer_load_dwordx4 v255, s[8:11], s49 offen sc1 lds
  v_exp_f32 v9, v9
  v_exp_f32 v10, v10
  v_cvt_pk_bf16_f32 v99, v6, v7
  v_exp_f32 v11, v11
  v_mfma_f32_16x16x32_bf16 v[164:167], v[168:171], v[104:107], v[164:167]
  buffer_load_dwordx4 v255, s[12:15], s49 offen offset:1024 sc1 lds
  s_add_u32 s49, s49, 4096
  v_exp_f32 v12, v12
  v_cvt_pk_bf16_f32 v100, v8, v9
  v_exp_f32 v13, v13
  v_mfma_f32_16x16x32_bf16 v[164:167], v[168:171], v[108:111], v[164:167]
  s_waitcnt lgkmcnt(0)
  buffer_load_dword v250, v253, s[4:7], s52 offen sc1
  v_exp_f32 v14, v14
  v_cvt_pk_bf16_f32 v101, v10, v11
  v_exp_f32 v15, v15
  v_cvt_pk_bf16_f32 v102, v12, v13
  v_cvt_pk_bf16_f32 v103, v14, v15
  v_mfma_f32_32x32x16_bf16 v[0:15], v[128:131], v[112:115], v[64:79]
  ds_read_b128 v[144:147], v172 offset:9216
  v_exp_f32 v16, v16
  v_exp_f32 v17, v17
  v_exp_f32 v18, v18
  v_mfma_f32_32x32x16_bf16 v[0:15], v[132:135], v[116:119], v[0:15]
  ds_read_b128 v[148:151], v172 offset:9728
  v_exp_f32 v19, v19
  v_exp_f32 v20, v20
  v_cvt_pk_bf16_f32 v104, v16, v17
  v_exp_f32 v21, v21
  v_mfma_f32_32x32x16_bf16 v[32:47], v[152:155], v[96:99], v[32:47]
  buffer_load_dwordx2 v[244:245], v173, s[4:7], s60 offen sc1
  v_exp_f32 v22, v22
  v_cvt_pk_bf16_f32 v105, v18, v19
  v_exp_f32 v23, v23
  v_exp_f32 v24, v24
  v_cvt_pk_bf16_f32 v106, v20, v21
  v_mfma_f32_32x32x16_bf16 v[32:47], v[156:159], v[100:103], v[32:47]
  buffer_load_dwordx2 v[246:247], v173, s[4:7], s61 offen sc1
  v_exp_f32 v25, v25
  v_exp_f32 v26, v26
  v_cvt_pk_bf16_f32 v107, v22, v23
  v_exp_f32 v27, v27
  v_mfma_f32_16x16x32_bf16 v[160:163], v[168:171], v[96:99], v[160:163]
  v_exp_f32 v28, v28
  v_cvt_pk_bf16_f32 v108, v24, v25
  v_exp_f32 v29, v29
  v_mfma_f32_16x16x32_bf16 v[160:163], v[168:171], v[100:103], v[160:163]
  s_waitcnt lgkmcnt(0)
  v_exp_f32 v30, v30
  v_cvt_pk_bf16_f32 v109, v26, v27
  v_exp_f32 v31, v31
  v_cvt_pk_bf16_f32 v110, v28, v29
  v_cvt_pk_bf16_f32 v111, v30, v31
  v_mfma_f32_32x32x16_bf16 v[16:31], v[128:131], v[120:123], v[80:95]
  ds_read_b128 v[136:139], v172 offset:12288
  v_exp_f32 v0, v0
  v_exp_f32 v1, v1
  v_exp_f32 v2, v2
  v_mfma_f32_32x32x16_bf16 v[16:31], v[132:135], v[124:127], v[16:31]
  ds_read_b128 v[140:143], v172 offset:12800
  v_exp_f32 v3, v3
  v_exp_f32 v4, v4
  v_cvt_pk_bf16_f32 v96, v0, v1
  v_exp_f32 v5, v5
  v_mfma_f32_32x32x16_bf16 v[48:63], v[152:155], v[104:107], v[48:63]
  v_exp_f32 v6, v6
  v_cvt_pk_bf16_f32 v97, v2, v3
  v_exp_f32 v7, v7
  v_exp_f32 v8, v8
  v_cvt_pk_bf16_f32 v98, v4, v5
  v_mfma_f32_32x32x16_bf16 v[48:63], v[156:159], v[108:111], v[48:63]
  v_exp_f32 v9, v9
  v_exp_f32 v10, v10
  v_cvt_pk_bf16_f32 v99, v6, v7
  v_exp_f32 v11, v11
  v_mfma_f32_16x16x32_bf16 v[164:167], v[168:171], v[104:107], v[164:167]
  v_exp_f32 v12, v12
  v_cvt_pk_bf16_f32 v100, v8, v9
  v_exp_f32 v13, v13
  v_mfma_f32_16x16x32_bf16 v[164:167], v[168:171], v[108:111], v[164:167]
  s_waitcnt lgkmcnt(0)
  v_exp_f32 v14, v14
  v_cvt_pk_bf16_f32 v101, v10, v11
  v_exp_f32 v15, v15
  v_cvt_pk_bf16_f32 v102, v12, v13
  v_cvt_pk_bf16_f32 v103, v14, v15
  s_waitcnt vmcnt(2)
  s_cmp_lg_u32 s44, 0
  s_cbranch_scc1 gated_mix__mha_block__mixer_gmlp__prompt_kernel_cs_ok
  s_mov_b32 s53, 0x8000
gated_mix__mha_block__mixer_gmlp__prompt_kernel_cs:
  v_cmp_eq_u32 vcc, 0, v250
  s_nop 3
  s_cmp_eq_u64 vcc, 0
  s_cbranch_scc1 gated_mix__mha_block__mixer_gmlp__prompt_kernel_cs_ok
  s_sleep 8
  buffer_load_dword v250, v253, s[4:7], s52 offen sc1
  s_waitcnt vmcnt(0)
  s_sub_u32 s53, s53, 1
  s_cmp_lg_u32 s53, 0
  s_cbranch_scc1 gated_mix__mha_block__mixer_gmlp__prompt_kernel_cs
gated_mix__mha_block__mixer_gmlp__prompt_kernel_cs_ok:
  v_mfma_f32_32x32x16_bf16 v[0:15], v[136:139], v[112:115], v[64:79]
  ds_read_b128 v[152:155], v172 offset:13312
  v_exp_f32 v16, v16
  v_exp_f32 v17, v17
  v_exp_f32 v18, v18
  v_mfma_f32_32x32x16_bf16 v[0:15], v[140:143], v[116:119], v[0:15]
  ds_read_b128 v[156:159], v172 offset:13824
  v_exp_f32 v19, v19
  v_exp_f32 v20, v20
  v_cvt_pk_bf16_f32 v104, v16, v17
  v_exp_f32 v21, v21
  v_mfma_f32_32x32x16_bf16 v[32:47], v[144:147], v[96:99], v[32:47]
  v_exp_f32 v22, v22
  v_cvt_pk_bf16_f32 v105, v18, v19
  v_exp_f32 v23, v23
  v_exp_f32 v24, v24
  v_cvt_pk_bf16_f32 v106, v20, v21
  v_mfma_f32_32x32x16_bf16 v[32:47], v[148:151], v[100:103], v[32:47]
  v_exp_f32 v25, v25
  v_exp_f32 v26, v26
  v_cvt_pk_bf16_f32 v107, v22, v23
  v_exp_f32 v27, v27
  v_mfma_f32_16x16x32_bf16 v[160:163], v[168:171], v[96:99], v[160:163]
  v_exp_f32 v28, v28
  v_cvt_pk_bf16_f32 v108, v24, v25
  v_exp_f32 v29, v29
  v_mfma_f32_16x16x32_bf16 v[160:163], v[168:171], v[100:103], v[160:163]
  s_waitcnt vmcnt(7) lgkmcnt(0)
  s_barrier
  v_exp_f32 v30, v30
  v_cvt_pk_bf16_f32 v109, v26, v27
  v_exp_f32 v31, v31
  v_cvt_pk_bf16_f32 v110, v28, v29
  v_cvt_pk_bf16_f32 v111, v30, v31
  v_mfma_f32_32x32x16_bf16 v[16:31], v[136:139], v[120:123], v[80:95]
  ds_read_b128 v[128:131], v172 offset:16384
  v_exp_f32 v0, v0
  v_exp_f32 v1, v1
  v_exp_f32 v2, v2
  v_mfma_f32_32x32x16_bf16 v[16:31], v[140:143], v[124:127], v[16:31]
  ds_read_b128 v[132:135], v172 offset:16896
  v_exp_f32 v3, v3
  v_exp_f32 v4, v4
  v_cvt_pk_bf16_f32 v96, v0, v1
  v_exp_f32 v5, v5
  v_mfma_f32_32x32x16_bf16 v[48:63], v[144:147], v[104:107], v[48:63]
  s_add_u32 m0, s50, 8192
  v_exp_f32 v6, v6
  v_cvt_pk_bf16_f32 v97, v2, v3
  v_exp_f32 v7, v7
  v_exp_f32 v8, v8
  v_cvt_pk_bf16_f32 v98, v4, v5
  v_mfma_f32_32x32x16_bf16 v[48:63], v[148:151], v[108:111], v[48:63]
  buffer_load_dwordx4 v255, s[8:11], s49 offen sc1 lds
  v_exp_f32 v9, v9
  v_exp_f32 v10, v10
  v_cvt_pk_bf16_f32 v99, v6, v7
  v_exp_f32 v11, v11
  v_mfma_f32_16x16x32_bf16 v[164:167], v[168:171], v[104:107], v[164:167]
  buffer_load_dwordx4 v255, s[12:15], s49 offen offset:1024 sc1 lds
  s_add_u32 s49, s49, 4096
  v_exp_f32 v12, v12
  v_cvt_pk_bf16_f32 v100, v8, v9
  v_exp_f32 v13, v13
  v_mfma_f32_16x16x32_bf16 v[164:167], v[168:171], v[108:111], v[164:167]
  s_waitcnt lgkmcnt(0)
  buffer_load_dwordx2 v[200:201], v248, s[4:7], s85 offen sc1
  s_add_u32 s85, s85, 16384
  v_exp_f32 v14, v14
  v_cvt_pk_bf16_f32 v101, v10, v11
  v_exp_f32 v15, v15
  v_cvt_pk_bf16_f32 v102, v12, v13
  v_cvt_pk_bf16_f32 v103, v14, v15
  v_mfma_f32_32x32x16_bf16 v[0:15], v[128:131], v[112:115], v[64:79]
  ds_read_b128 v[144:147], v172 offset:17408
  v_exp_f32 v16, v16
  v_exp_f32 v17, v17
  v_exp_f32 v18, v18
  v_mfma_f32_32x32x16_bf16 v[0:15], v[132:135], v[116:119], v[0:15]
  ds_read_b128 v[148:151], v172 offset:17920
  v_exp_f32 v19, v19
  v_exp_f32 v20, v20
  v_cvt_pk_bf16_f32 v104, v16, v17
  v_exp_f32 v21, v21
  v_mfma_f32_32x32x16_bf16 v[32:47], v[152:155], v[96:99], v[32:47]
  buffer_load_dwordx2 v[202:203], v248, s[4:7], s85 offen sc1
  s_add_u32 s85, s85, 16384
  v_exp_f32 v22, v22
  v_cvt_pk_bf16_f32 v105, v18, v19
  v_exp_f32 v23, v23
  v_exp_f32 v24, v24
  v_cvt_pk_bf16_f32 v106, v20, v21
  v_mfma_f32_32x32x16_bf16 v[32:47], v[156:159], v[100:103], v[32:47]
  buffer_load_dwordx2 v[204:205], v248, s[4:7], s85 offen sc1
  s_add_u32 s85, s85, 16384
  v_exp_f32 v25, v25
  v_exp_f32 v26, v26
  v_cvt_pk_bf16_f32 v107, v22, v23
  v_exp_f32 v27, v27
  v_mfma_f32_16x16x32_bf16 v[160:163], v[168:171], v[96:99], v[160:163]
  buffer_load_dwordx2 v[206:207], v248, s[4:7], s85 offen sc1
  s_add_u32 s85, s85, 16384
  v_exp_f32 v28, v28
  v_cvt_pk_bf16_f32 v108, v24, v25
  v_exp_f32 v29, v29
  v_mfma_f32_16x16x32_bf16 v[160:163], v[168:171], v[100:103], v[160:163]
  s_waitcnt lgkmcnt(0)
  buffer_load_dwordx2 v[208:209], v248, s[4:7], s85 offen sc1
  s_add_u32 s85, s85, 16384
  v_exp_f32 v30, v30
  v_cvt_pk_bf16_f32 v109, v26, v27
  v_exp_f32 v31, v31
  v_cvt_pk_bf16_f32 v110, v28, v29
  v_cvt_pk_bf16_f32 v111, v30, v31
  v_mfma_f32_32x32x16_bf16 v[16:31], v[128:131], v[120:123], v[80:95]
  ds_read_b128 v[136:139], v172 offset:20480
  v_exp_f32 v0, v0
  v_exp_f32 v1, v1
  v_exp_f32 v2, v2
  v_mfma_f32_32x32x16_bf16 v[16:31], v[132:135], v[124:127], v[16:31]
  ds_read_b128 v[140:143], v172 offset:20992
  v_exp_f32 v3, v3
  v_exp_f32 v4, v4
  v_cvt_pk_bf16_f32 v96, v0, v1
  v_exp_f32 v5, v5
  v_mfma_f32_32x32x16_bf16 v[48:63], v[152:155], v[104:107], v[48:63]
  buffer_load_dwordx2 v[210:211], v248, s[4:7], s85 offen sc1
  s_add_u32 s85, s85, 16384
  v_exp_f32 v6, v6
  v_cvt_pk_bf16_f32 v97, v2, v3
  v_exp_f32 v7, v7
  v_exp_f32 v8, v8
  v_cvt_pk_bf16_f32 v98, v4, v5
  v_mfma_f32_32x32x16_bf16 v[48:63], v[156:159], v[108:111], v[48:63]
  buffer_load_dwordx2 v[212:213], v248, s[4:7], s85 offen sc1
  s_add_u32 s85, s85, 16384
  v_exp_f32 v9, v9
  v_exp_f32 v10, v10
  v_cvt_pk_bf16_f32 v99, v6, v7
  v_exp_f32 v11, v11
  v_mfma_f32_16x16x32_bf16 v[164:167], v[168:171], v[104:107], v[164:167]
  buffer_load_dwordx2 v[214:215], v248, s[4:7], s85 offen sc1
  s_add_u32 s85, s85, 16384
  v_exp_f32 v12, v12
  v_cvt_pk_bf16_f32 v100, v8, v9
  v_exp_f32 v13, v13
  v_mfma_f32_16x16x32_bf16 v[164:167], v[168:171], v[108:111], v[164:167]
  s_waitcnt lgkmcnt(0)
  buffer_load_dwordx2 v[216:217], v248, s[4:7], s85 offen sc1
  s_add_u32 s85, s85, 16384
  v_exp_f32 v14, v14
  v_cvt_pk_bf16_f32 v101, v10, v11
  v_exp_f32 v15, v15
  v_cvt_pk_bf16_f32 v102, v12, v13
  v_cvt_pk_bf16_f32 v103, v14, v15
  s_waitcnt vmcnt(11)
  s_cmp_lg_u32 s44, 0
  s_cbranch_scc1 gated_mix__mha_block__mixer_gmlp__prompt_kernel_cg_ok
  s_mov_b32 s53, 0x8000
gated_mix__mha_block__mixer_gmlp__prompt_kernel_cg:
  v_and_b32 v244, v244, v245
  v_and_b32 v246, v246, v247
  v_and_b32 v244, v244, v246
  v_cmp_eq_u32 vcc, 0, v244
  s_nop 3
  s_cmp_eq_u64 vcc, 0
  s_cbranch_scc1 gated_mix__mha_block__mixer_gmlp__prompt_kernel_cg_ok
  s_sleep 8
  buffer_load_dwordx2 v[244:245], v173, s[4:7], s60 offen sc1
  buffer_load_dwordx2 v[246:247], v173, s[4:7], s61 offen sc1
  s_waitcnt vmcnt(0)
  s_sub_u32 s53, s53, 1
  s_cmp_lg_u32 s53, 0
  s_cbranch_scc1 gated_mix__mha_block__mixer_gmlp__prompt_kernel_cg
gated_mix__mha_block__mixer_gmlp__prompt_kernel_cg_ok:
  v_mfma_f32_32x32x16_bf16 v[0:15], v[136:139], v[112:115], v[64:79]
  ds_read_b128 v[152:155], v172 offset:21504
  v_exp_f32 v16, v16
  v_exp_f32 v17, v17
  v_exp_f32 v18, v18
  v_mfma_f32_32x32x16_bf16 v[0:15], v[140:143], v[116:119], v[0:15]
  ds_read_b128 v[156:159], v172 offset:22016
  v_exp_f32 v19, v19
  v_exp_f32 v20, v20
  v_cvt_pk_bf16_f32 v104, v16, v17
  v_exp_f32 v21, v21
  v_mfma_f32_32x32x16_bf16 v[32:47], v[144:147], v[96:99], v[32:47]
  buffer_load_dwordx2 v[218:219], v248, s[4:7], s85 offen sc1
  s_add_u32 s85, s85, 16384
  v_exp_f32 v22, v22
  v_cvt_pk_bf16_f32 v105, v18, v19
  v_exp_f32 v23, v23
  v_exp_f32 v24, v24
  v_cvt_pk_bf16_f32 v106, v20, v21
  v_mfma_f32_32x32x16_bf16 v[32:47], v[148:151], v[100:103], v[32:47]
  buffer_load_dwordx2 v[220:221], v248, s[4:7], s85 offen sc1
  s_add_u32 s85, s85, 16384
  v_exp_f32 v25, v25
  v_exp_f32 v26, v26
  v_cvt_pk_bf16_f32 v107, v22, v23
  v_exp_f32 v27, v27
  v_mfma_f32_16x16x32_bf16 v[160:163], v[168:171], v[96:99], v[160:163]
  buffer_load_dwordx2 v[222:223], v248, s[4:7], s85 offen sc1
  s_add_u32 s85, s85, 16384
  v_exp_f32 v28, v28
  v_cvt_pk_bf16_f32 v108, v24, v25
  v_exp_f32 v29, v29
  v_mfma_f32_16x16x32_bf16 v[160:163], v[168:171], v[100:103], v[160:163]
  s_waitcnt vmcnt(19) lgkmcnt(0)
  s_barrier
  v_exp_f32 v30, v30
  v_cvt_pk_bf16_f32 v109, v26, v27
  v_exp_f32 v31, v31
  v_cvt_pk_bf16_f32 v110, v28, v29
  v_cvt_pk_bf16_f32 v111, v30, v31
  v_mfma_f32_32x32x16_bf16 v[16:31], v[136:139], v[120:123], v[80:95]
  ds_read_b128 v[128:131], v172 offset:24576
  v_exp_f32 v0, v0
  v_exp_f32 v1, v1
  v_exp_f32 v2, v2
  v_mfma_f32_32x32x16_bf16 v[16:31], v[140:143], v[124:127], v[16:31]
  ds_read_b128 v[132:135], v172 offset:25088
  v_exp_f32 v3, v3
  v_exp_f32 v4, v4
  v_cvt_pk_bf16_f32 v96, v0, v1
  v_exp_f32 v5, v5
  v_mfma_f32_32x32x16_bf16 v[48:63], v[144:147], v[104:107], v[48:63]
  s_add_u32 m0, s50, 16384
  v_exp_f32 v6, v6
  v_cvt_pk_bf16_f32 v97, v2, v3
  v_exp_f32 v7, v7
  v_exp_f32 v8, v8
  v_cvt_pk_bf16_f32 v98, v4, v5
  v_mfma_f32_32x32x16_bf16 v[48:63], v[148:151], v[108:111], v[48:63]
  buffer_load_dwordx4 v255, s[8:11], s49 offen sc1 lds
  v_exp_f32 v9, v9
  v_exp_f32 v10, v10
  v_cvt_pk_bf16_f32 v99, v6, v7
  v_exp_f32 v11, v11
  v_mfma_f32_16x16x32_bf16 v[164:167], v[168:171], v[104:107], v[164:167]
  buffer_load_dwordx4 v255, s[12:15], s49 offen offset:1024 sc1 lds
  s_add_u32 s49, s49, 4096
  v_exp_f32 v12, v12
  v_cvt_pk_bf16_f32 v100, v8, v9
  v_exp_f32 v13, v13
  v_mfma_f32_16x16x32_bf16 v[164:167], v[168:171], v[108:111], v[164:167]
  s_waitcnt lgkmcnt(0)
  buffer_load_dwordx2 v[224:225], v248, s[4:7], s85 offen sc1
  s_add_u32 s85, s85, 16384
  v_exp_f32 v14, v14
  v_cvt_pk_bf16_f32 v101, v10, v11
  v_exp_f32 v15, v15
  v_cvt_pk_bf16_f32 v102, v12, v13
  v_cvt_pk_bf16_f32 v103, v14, v15
  v_mfma_f32_32x32x16_bf16 v[0:15], v[128:131], v[112:115], v[64:79]
  ds_read_b128 v[144:147], v172 offset:25600
  v_exp_f32 v16, v16
  v_exp_f32 v17, v17
  v_exp_f32 v18, v18
  v_mfma_f32_32x32x16_bf16 v[0:15], v[132:135], v[116:119], v[0:15]
  ds_read_b128 v[148:151], v172 offset:26112
  v_exp_f32 v19, v19
  v_exp_f32 v20, v20
  v_cvt_pk_bf16_f32 v104, v16, v17
  v_exp_f32 v21, v21
  v_mfma_f32_32x32x16_bf16 v[32:47], v[152:155], v[96:99], v[32:47]
  buffer_load_dwordx2 v[226:227], v248, s[4:7], s85 offen sc1
  s_add_u32 s85, s85, 16384
  v_exp_f32 v22, v22
  v_cvt_pk_bf16_f32 v105, v18, v19
  v_exp_f32 v23, v23
  v_exp_f32 v24, v24
  v_cvt_pk_bf16_f32 v106, v20, v21
  v_mfma_f32_32x32x16_bf16 v[32:47], v[156:159], v[100:103], v[32:47]
  buffer_load_dwordx2 v[228:229], v248, s[4:7], s85 offen sc1
  s_add_u32 s85, s85, 16384
  v_exp_f32 v25, v25
  v_exp_f32 v26, v26
  v_cvt_pk_bf16_f32 v107, v22, v23
  v_exp_f32 v27, v27
  v_mfma_f32_16x16x32_bf16 v[160:163], v[168:171], v[96:99], v[160:163]
  buffer_load_dwordx2 v[230:231], v248, s[4:7], s85 offen sc1
  s_add_u32 s85, s85, 16384
  v_exp_f32 v28, v28
  v_cvt_pk_bf16_f32 v108, v24, v25
  v_exp_f32 v29, v29
  v_mfma_f32_16x16x32_bf16 v[160:163], v[168:171], v[100:103], v[160:163]
  s_waitcnt lgkmcnt(0)
  v_exp_f32 v30, v30
  v_cvt_pk_bf16_f32 v109, v26, v27
  v_exp_f32 v31, v31
  v_cvt_pk_bf16_f32 v110, v28, v29
  v_cvt_pk_bf16_f32 v111, v30, v31
  v_mfma_f32_32x32x16_bf16 v[16:31], v[128:131], v[120:123], v[80:95]
  ds_read_b128 v[136:139], v172 offset:28672
  v_exp_f32 v0, v0
  v_exp_f32 v1, v1
  v_exp_f32 v2, v2
  v_mfma_f32_32x32x16_bf16 v[16:31], v[132:135], v[124:127], v[16:31]
  ds_read_b128 v[140:143], v172 offset:29184
  v_exp_f32 v3, v3
  v_exp_f32 v4, v4
  v_cvt_pk_bf16_f32 v96, v0, v1
  v_exp_f32 v5, v5
  v_mfma_f32_32x32x16_bf16 v[48:63], v[152:155], v[104:107], v[48:63]
  v_exp_f32 v6, v6
  v_cvt_pk_bf16_f32 v97, v2, v3
  v_exp_f32 v7, v7
  v_exp_f32 v8, v8
  v_cvt_pk_bf16_f32 v98, v4, v5
  v_mfma_f32_32x32x16_bf16 v[48:63], v[156:159], v[108:111], v[48:63]
  v_exp_f32 v9, v9
  v_exp_f32 v10, v10
  v_cvt_pk_bf16_f32 v99, v6, v7
  v_exp_f32 v11, v11
  v_mfma_f32_16x16x32_bf16 v[164:167], v[168:171], v[104:107], v[164:167]
  v_exp_f32 v12, v12
  v_cvt_pk_bf16_f32 v100, v8, v9
  v_exp_f32 v13, v13
  v_mfma_f32_16x16x32_bf16 v[164:167], v[168:171], v[108:111], v[164:167]
  s_waitcnt lgkmcnt(0)
  v_exp_f32 v14, v14
  v_cvt_pk_bf16_f32 v101, v10, v11
  v_exp_f32 v15, v15
  v_cvt_pk_bf16_f32 v102, v12, v13
  v_cvt_pk_bf16_f32 v103, v14, v15
  v_mfma_f32_32x32x16_bf16 v[0:15], v[136:139], v[112:115], v[64:79]
  ds_read_b128 v[152:155], v172 offset:29696
  v_exp_f32 v16, v16
  v_exp_f32 v17, v17
  v_exp_f32 v18, v18
  v_mfma_f32_32x32x16_bf16 v[0:15], v[140:143], v[116:119], v[0:15]
  ds_read_b128 v[156:159], v172 offset:30208
  v_exp_f32 v19, v19
  v_exp_f32 v20, v20
  v_cvt_pk_bf16_f32 v104, v16, v17
  v_exp_f32 v21, v21
  v_mfma_f32_32x32x16_bf16 v[32:47], v[144:147], v[96:99], v[32:47]
  v_exp_f32 v22, v22
  v_cvt_pk_bf16_f32 v105, v18, v19
  v_exp_f32 v23, v23
  v_exp_f32 v24, v24
  v_cvt_pk_bf16_f32 v106, v20, v21
  v_mfma_f32_32x32x16_bf16 v[32:47], v[148:151], v[100:103], v[32:47]
  v_exp_f32 v25, v25
  v_exp_f32 v26, v26
  v_cvt_pk_bf16_f32 v107, v22, v23
  v_exp_f32 v27, v27
  v_mfma_f32_16x16x32_bf16 v[160:163], v[168:171], v[96:99], v[160:163]
  v_exp_f32 v28, v28
  v_cvt_pk_bf16_f32 v108, v24, v25
  v_exp_f32 v29, v29
  v_mfma_f32_16x16x32_bf16 v[160:163], v[168:171], v[100:103], v[160:163]
  s_waitcnt vmcnt(23) lgkmcnt(0)
  s_barrier
  v_exp_f32 v30, v30
  v_cvt_pk_bf16_f32 v109, v26, v27
  v_exp_f32 v31, v31
  v_cvt_pk_bf16_f32 v110, v28, v29
  v_cvt_pk_bf16_f32 v111, v30, v31
  s_waitcnt vmcnt(0)
  s_cmp_lt_u32 s81, 16
  s_cbranch_scc1 gated_mix__mha_block__mixer_gmlp__prompt_kernel_nonorm
  v_pk_add_f32 v[200:201], v[200:201], v[216:217]
  v_pk_add_f32 v[202:203], v[202:203], v[218:219]
  v_pk_add_f32 v[204:205], v[204:205], v[220:221]
  v_pk_add_f32 v[206:207], v[206:207], v[222:223]
  v_pk_add_f32 v[208:209], v[208:209], v[224:225]
  v_pk_add_f32 v[210:211], v[210:211], v[226:227]
  v_pk_add_f32 v[212:213], v[212:213], v[228:229]
  v_pk_add_f32 v[214:215], v[214:215], v[230:231]
  v_pk_add_f32 v[200:201], v[200:201], v[208:209]
  v_pk_add_f32 v[202:203], v[202:203], v[210:211]
  v_pk_add_f32 v[204:205], v[204:205], v[212:213]
  v_pk_add_f32 v[206:207], v[206:207], v[214:215]
  v_pk_add_f32 v[200:201], v[200:201], v[204:205]
  v_pk_add_f32 v[202:203], v[202:203], v[206:207]
  v_pk_add_f32 v[200:201], v[200:201], v[202:203]
  v_mul_f32 v200, 0x3a124925, v200
  v_mul_f32 v201, 0x3a124925, v201
  v_fma_f32 v201, -v200, v200, v201
  v_max_f32 v201, 0, v201
  v_add_f32 v201, 0x3727c5ac, v201
  v_rsq_f32 v202, v201
  s_lshl_b32 s68, s44, 13
  s_add_u32 s68, s68, 32768
  v_mul_f32 v203, v200, v202
  v_sub_f32 v203, 0, v203
  v_add_u32 v184, s68, v253
  ds_write_b32 v184, v202 offset:7168
  ds_write_b32 v184, v203 offset:7424
  v_lshrrev_b32 v185, 4, v254
  v_lshlrev_b32 v185, 5, v185
  v_add_u32 v185, s68, v185
  v_add_u32 v184, s68, v255
  s_waitcnt lgkmcnt(0)
  ds_read_b128 v[200:203], v185 offset:7168
  ds_read_b128 v[204:207], v185 offset:7184
  ds_read_b128 v[208:211], v185 offset:7424
  ds_read_b128 v[212:215], v185 offset:7440
  ds_read_b128 v[216:219], v185 offset:7296
  ds_read_b128 v[220:223], v185 offset:7312
  ds_read_b128 v[224:227], v185 offset:7552
  ds_read_b128 v[228:231], v185 offset:7568
  ds_read_b128 v[244:247], v184 offset:0
  ds_read_b128 v[192:195], v184 offset:1024
  s_waitcnt lgkmcnt(1)
  v_lshlrev_b32 v186, 16, v244
  v_and_b32 v187, 0xffff0000, v244
  v_lshlrev_b32 v196, 16, v245
  v_and_b32 v197, 0xffff0000, v245
  v_pk_fma_f32 v[186:187], v[186:187], v[200:201], v[208:209]
  v_pk_fma_f32 v[196:197], v[196:197], v[202:203], v[210:211]
  v_cvt_pk_bf16_f32 v244, v186, v187
  v_cvt_pk_bf16_f32 v245, v196, v197
  v_lshlrev_b32 v186, 16, v246
  v_and_b32 v187, 0xffff0000, v246
  v_lshlrev_b32 v196, 16, v247
  v_and_b32 v197, 0xffff0000, v247
  v_pk_fma_f32 v[186:187], v[186:187], v[204:205], v[212:213]
  v_pk_fma_f32 v[196:197], v[196:197], v[206:207], v[214:215]
  v_cvt_pk_bf16_f32 v246, v186, v187
  v_cvt_pk_bf16_f32 v247, v196, v197
  s_add_u32 s68, s82, 0
  buffer_store_dwordx4 v[244:247], v255, s[4:7], s68 offen sc1
  ds_read_b128 v[180:183], v184 offset:2048
  s_waitcnt lgkmcnt(1)
  v_lshlrev_b32 v186, 16, v192
  v_and_b32 v187, 0xffff0000, v192
  v_lshlrev_b32 v196, 16, v193
  v_and_b32 v197, 0xffff0000, v193
  v_pk_fma_f32 v[186:187], v[186:187], v[200:201], v[208:209]
  v_pk_fma_f32 v[196:197], v[196:197], v[202:203], v[210:211]
  v_cvt_pk_bf16_f32 v192, v186, v187
  v_cvt_pk_bf16_f32 v193, v196, v197
  v_lshlrev_b32 v186, 16, v194
  v_and_b32 v187, 0xffff0000, v194
  v_lshlrev_b32 v196, 16, v195
  v_and_b32 v197, 0xffff0000, v195
  v_pk_fma_f32 v[186:187], v[186:187], v[204:205], v[212:213]
  v_pk_fma_f32 v[196:197], v[196:197], v[206:207], v[214:215]
  v_cvt_pk_bf16_f32 v194, v186, v187
  v_cvt_pk_bf16_f32 v195, v196, v197
  s_add_u32 s68, s82, 1024
  buffer_store_dwordx4 v[192:195], v255, s[4:7], s68 offen sc1
  ds_read_b128 v[244:247], v184 offset:3072
  s_waitcnt lgkmcnt(1)
  v_lshlrev_b32 v186, 16, v180
  v_and_b32 v187, 0xffff0000, v180
  v_lshlrev_b32 v196, 16, v181
  v_and_b32 v197, 0xffff0000, v181
  v_pk_fma_f32 v[186:187], v[186:187], v[200:201], v[208:209]
  v_pk_fma_f32 v[196:197], v[196:197], v[202:203], v[210:211]
  v_cvt_pk_bf16_f32 v180, v186, v187
  v_cvt_pk_bf16_f32 v181, v196, v197
  v_lshlrev_b32 v186, 16, v182
  v_and_b32 v187, 0xffff0000, v182
  v_lshlrev_b32 v196, 16, v183
  v_and_b32 v197, 0xffff0000, v183
  v_pk_fma_f32 v[186:187], v[186:187], v[204:205], v[212:213]
  v_pk_fma_f32 v[196:197], v[196:197], v[206:207], v[214:215]
  v_cvt_pk_bf16_f32 v182, v186, v187
  v_cvt_pk_bf16_f32 v183, v196, v197
  s_add_u32 s68, s82, 2048
  buffer_store_dwordx4 v[180:183], v255, s[4:7], s68 offen sc1
  ds_read_b128 v[192:195], v184 offset:4096
  s_waitcnt lgkmcnt(1)
  v_lshlrev_b32 v186, 16, v244
  v_and_b32 v187, 0xffff0000, v244
  v_lshlrev_b32 v196, 16, v245
  v_and_b32 v197, 0xffff0000, v245
  v_pk_fma_f32 v[186:187], v[186:187], v[200:201], v[208:209]
  v_pk_fma_f32 v[196:197], v[196:197], v[202:203], v[210:211]
  v_cvt_pk_bf16_f32 v244, v186, v187
  v_cvt_pk_bf16_f32 v245, v196, v197
  v_lshlrev_b32 v186, 16, v246
  v_and_b32 v187, 0xffff0000, v246
  v_lshlrev_b32 v196, 16, v247
  v_and_b32 v197, 0xffff0000, v247
  v_pk_fma_f32 v[186:187], v[186:187], v[204:205], v[212:213]
  v_pk_fma_f32 v[196:197], v[196:197], v[206:207], v[214:215]
  v_cvt_pk_bf16_f32 v246, v186, v187
  v_cvt_pk_bf16_f32 v247, v196, v197
  s_add_u32 s68, s82, 3072
  buffer_store_dwordx4 v[244:247], v255, s[4:7], s68 offen sc1
  ds_read_b128 v[180:183], v184 offset:5120
  s_waitcnt lgkmcnt(1)
  v_lshlrev_b32 v186, 16, v192
  v_and_b32 v187, 0xffff0000, v192
  v_lshlrev_b32 v196, 16, v193
  v_and_b32 v197, 0xffff0000, v193
  v_pk_fma_f32 v[186:187], v[186:187], v[200:201], v[208:209]
  v_pk_fma_f32 v[196:197], v[196:197], v[202:203], v[210:211]
  v_cvt_pk_bf16_f32 v192, v186, v187
  v_cvt_pk_bf16_f32 v193, v196, v197
  v_lshlrev_b32 v186, 16, v194
  v_and_b32 v187, 0xffff0000, v194
  v_lshlrev_b32 v196, 16, v195
  v_and_b32 v197, 0xffff0000, v195
  v_pk_fma_f32 v[186:187], v[186:187], v[204:205], v[212:213]
  v_pk_fma_f32 v[196:197], v[196:197], v[206:207], v[214:215]
  v_cvt_pk_bf16_f32 v194, v186, v187
  v_cvt_pk_bf16_f32 v195, v196, v197
  s_add_u32 s68, s82, 4096
  buffer_store_dwordx4 v[192:195], v255, s[4:7], s68 offen sc1
  ds_read_b128 v[244:247], v184 offset:6144
  s_waitcnt lgkmcnt(1)
  v_lshlrev_b32 v186, 16, v180
  v_and_b32 v187, 0xffff0000, v180
  v_lshlrev_b32 v196, 16, v181
  v_and_b32 v197, 0xffff0000, v181
  v_pk_fma_f32 v[186:187], v[186:187], v[200:201], v[208:209]
  v_pk_fma_f32 v[196:197], v[196:197], v[202:203], v[210:211]
  v_cvt_pk_bf16_f32 v180, v186, v187
  v_cvt_pk_bf16_f32 v181, v196, v197
  v_lshlrev_b32 v186, 16, v182
  v_and_b32 v187, 0xffff0000, v182
  v_lshlrev_b32 v196, 16, v183
  v_and_b32 v197, 0xffff0000, v183
  v_pk_fma_f32 v[186:187], v[186:187], v[204:205], v[212:213]
  v_pk_fma_f32 v[196:197], v[196:197], v[206:207], v[214:215]
  v_cvt_pk_bf16_f32 v182, v186, v187
  v_cvt_pk_bf16_f32 v183, v196, v197
  s_add_u32 s68, s82, 5120
  buffer_store_dwordx4 v[180:183], v255, s[4:7], s68 offen sc1
  ds_read_b128 v[192:195], v184 offset:32768
  s_waitcnt lgkmcnt(1)
  v_lshlrev_b32 v186, 16, v244
  v_and_b32 v187, 0xffff0000, v244
  v_lshlrev_b32 v196, 16, v245
  v_and_b32 v197, 0xffff0000, v245
  v_pk_fma_f32 v[186:187], v[186:187], v[200:201], v[208:209]
  v_pk_fma_f32 v[196:197], v[196:197], v[202:203], v[210:211]
  v_cvt_pk_bf16_f32 v244, v186, v187
  v_cvt_pk_bf16_f32 v245, v196, v197
  v_lshlrev_b32 v186, 16, v246
  v_and_b32 v187, 0xffff0000, v246
  v_lshlrev_b32 v196, 16, v247
  v_and_b32 v197, 0xffff0000, v247
  v_pk_fma_f32 v[186:187], v[186:187], v[204:205], v[212:213]
  v_pk_fma_f32 v[196:197], v[196:197], v[206:207], v[214:215]
  v_cvt_pk_bf16_f32 v246, v186, v187
  v_cvt_pk_bf16_f32 v247, v196, v197
  s_add_u32 s68, s82, 6144
  buffer_store_dwordx4 v[244:247], v255, s[4:7], s68 offen sc1
  ds_read_b128 v[180:183], v184 offset:33792
  s_waitcnt lgkmcnt(1)
  v_lshlrev_b32 v186, 16, v192
  v_and_b32 v187, 0xffff0000, v192
  v_lshlrev_b32 v196, 16, v193
  v_and_b32 v197, 0xffff0000, v193
  v_pk_fma_f32 v[186:187], v[186:187], v[216:217], v[224:225]
  v_pk_fma_f32 v[196:197], v[196:197], v[218:219], v[226:227]
  v_cvt_pk_bf16_f32 v192, v186, v187
  v_cvt_pk_bf16_f32 v193, v196, v197
  v_lshlrev_b32 v186, 16, v194
  v_and_b32 v187, 0xffff0000, v194
  v_lshlrev_b32 v196, 16, v195
  v_and_b32 v197, 0xffff0000, v195
  v_pk_fma_f32 v[186:187], v[186:187], v[220:221], v[228:229]
  v_pk_fma_f32 v[196:197], v[196:197], v[222:223], v[230:231]
  v_cvt_pk_bf16_f32 v194, v186, v187
  v_cvt_pk_bf16_f32 v195, v196, v197
  s_add_u32 s68, s82, 114688
  buffer_store_dwordx4 v[192:195], v255, s[4:7], s68 offen sc1
  ds_read_b128 v[244:247], v184 offset:34816
  s_waitcnt lgkmcnt(1)
  v_lshlrev_b32 v186, 16, v180
  v_and_b32 v187, 0xffff0000, v180
  v_lshlrev_b32 v196, 16, v181
  v_and_b32 v197, 0xffff0000, v181
  v_pk_fma_f32 v[186:187], v[186:187], v[216:217], v[224:225]
  v_pk_fma_f32 v[196:197], v[196:197], v[218:219], v[226:227]
  v_cvt_pk_bf16_f32 v180, v186, v187
  v_cvt_pk_bf16_f32 v181, v196, v197
  v_lshlrev_b32 v186, 16, v182
  v_and_b32 v187, 0xffff0000, v182
  v_lshlrev_b32 v196, 16, v183
  v_and_b32 v197, 0xffff0000, v183
  v_pk_fma_f32 v[186:187], v[186:187], v[220:221], v[228:229]
  v_pk_fma_f32 v[196:197], v[196:197], v[222:223], v[230:231]
  v_cvt_pk_bf16_f32 v182, v186, v187
  v_cvt_pk_bf16_f32 v183, v196, v197
  s_add_u32 s68, s82, 115712
  buffer_store_dwordx4 v[180:183], v255, s[4:7], s68 offen sc1
  ds_read_b128 v[192:195], v184 offset:35840
  s_waitcnt lgkmcnt(1)
  v_lshlrev_b32 v186, 16, v244
  v_and_b32 v187, 0xffff0000, v244
  v_lshlrev_b32 v196, 16, v245
  v_and_b32 v197, 0xffff0000, v245
  v_pk_fma_f32 v[186:187], v[186:187], v[216:217], v[224:225]
  v_pk_fma_f32 v[196:197], v[196:197], v[218:219], v[226:227]
  v_cvt_pk_bf16_f32 v244, v186, v187
  v_cvt_pk_bf16_f32 v245, v196, v197
  v_lshlrev_b32 v186, 16, v246
  v_and_b32 v187, 0xffff0000, v246
  v_lshlrev_b32 v196, 16, v247
  v_and_b32 v197, 0xffff0000, v247
  v_pk_fma_f32 v[186:187], v[186:187], v[220:221], v[228:229]
  v_pk_fma_f32 v[196:197], v[196:197], v[222:223], v[230:231]
  v_cvt_pk_bf16_f32 v246, v186, v187
  v_cvt_pk_bf16_f32 v247, v196, v197
  s_add_u32 s68, s82, 116736
  buffer_store_dwordx4 v[244:247], v255, s[4:7], s68 offen sc1
  ds_read_b128 v[180:183], v184 offset:36864
  s_waitcnt lgkmcnt(1)
  v_lshlrev_b32 v186, 16, v192
  v_and_b32 v187, 0xffff0000, v192
  v_lshlrev_b32 v196, 16, v193
  v_and_b32 v197, 0xffff0000, v193
  v_pk_fma_f32 v[186:187], v[186:187], v[216:217], v[224:225]
  v_pk_fma_f32 v[196:197], v[196:197], v[218:219], v[226:227]
  v_cvt_pk_bf16_f32 v192, v186, v187
  v_cvt_pk_bf16_f32 v193, v196, v197
  v_lshlrev_b32 v186, 16, v194
  v_and_b32 v187, 0xffff0000, v194
  v_lshlrev_b32 v196, 16, v195
  v_and_b32 v197, 0xffff0000, v195
  v_pk_fma_f32 v[186:187], v[186:187], v[220:221], v[228:229]
  v_pk_fma_f32 v[196:197], v[196:197], v[222:223], v[230:231]
  v_cvt_pk_bf16_f32 v194, v186, v187
  v_cvt_pk_bf16_f32 v195, v196, v197
  s_add_u32 s68, s82, 117760
  buffer_store_dwordx4 v[192:195], v255, s[4:7], s68 offen sc1
  ds_read_b128 v[244:247], v184 offset:37888
  s_waitcnt lgkmcnt(1)
  v_lshlrev_b32 v186, 16, v180
  v_and_b32 v187, 0xffff0000, v180
  v_lshlrev_b32 v196, 16, v181
  v_and_b32 v197, 0xffff0000, v181
  v_pk_fma_f32 v[186:187], v[186:187], v[216:217], v[224:225]
  v_pk_fma_f32 v[196:197], v[196:197], v[218:219], v[226:227]
  v_cvt_pk_bf16_f32 v180, v186, v187
  v_cvt_pk_bf16_f32 v181, v196, v197
  v_lshlrev_b32 v186, 16, v182
  v_and_b32 v187, 0xffff0000, v182
  v_lshlrev_b32 v196, 16, v183
  v_and_b32 v197, 0xffff0000, v183
  v_pk_fma_f32 v[186:187], v[186:187], v[220:221], v[228:229]
  v_pk_fma_f32 v[196:197], v[196:197], v[222:223], v[230:231]
  v_cvt_pk_bf16_f32 v182, v186, v187
  v_cvt_pk_bf16_f32 v183, v196, v197
  s_add_u32 s68, s82, 118784
  buffer_store_dwordx4 v[180:183], v255, s[4:7], s68 offen sc1
  ds_read_b128 v[192:195], v184 offset:38912
  s_waitcnt lgkmcnt(1)
  v_lshlrev_b32 v186, 16, v244
  v_and_b32 v187, 0xffff0000, v244
  v_lshlrev_b32 v196, 16, v245
  v_and_b32 v197, 0xffff0000, v245
  v_pk_fma_f32 v[186:187], v[186:187], v[216:217], v[224:225]
  v_pk_fma_f32 v[196:197], v[196:197], v[218:219], v[226:227]
  v_cvt_pk_bf16_f32 v244, v186, v187
  v_cvt_pk_bf16_f32 v245, v196, v197
  v_lshlrev_b32 v186, 16, v246
  v_and_b32 v187, 0xffff0000, v246
  v_lshlrev_b32 v196, 16, v247
  v_and_b32 v197, 0xffff0000, v247
  v_pk_fma_f32 v[186:187], v[186:187], v[220:221], v[228:229]
  v_pk_fma_f32 v[196:197], v[196:197], v[222:223], v[230:231]
  v_cvt_pk_bf16_f32 v246, v186, v187
  v_cvt_pk_bf16_f32 v247, v196, v197
  s_add_u32 s68, s82, 119808
  buffer_store_dwordx4 v[244:247], v255, s[4:7], s68 offen sc1
  s_waitcnt lgkmcnt(0)
  v_lshlrev_b32 v186, 16, v192
  v_and_b32 v187, 0xffff0000, v192
  v_lshlrev_b32 v196, 16, v193
  v_and_b32 v197, 0xffff0000, v193
  v_pk_fma_f32 v[186:187], v[186:187], v[216:217], v[224:225]
  v_pk_fma_f32 v[196:197], v[196:197], v[218:219], v[226:227]
  v_cvt_pk_bf16_f32 v192, v186, v187
  v_cvt_pk_bf16_f32 v193, v196, v197
  v_lshlrev_b32 v186, 16, v194
  v_and_b32 v187, 0xffff0000, v194
  v_lshlrev_b32 v196, 16, v195
  v_and_b32 v197, 0xffff0000, v195
  v_pk_fma_f32 v[186:187], v[186:187], v[220:221], v[228:229]
  v_pk_fma_f32 v[196:197], v[196:197], v[222:223], v[230:231]
  v_cvt_pk_bf16_f32 v194, v186, v187
  v_cvt_pk_bf16_f32 v195, v196, v197
  s_add_u32 s68, s82, 120832
  buffer_store_dwordx4 v[192:195], v255, s[4:7], s68 offen sc1
  s_branch gated_mix__mha_block__mixer_gmlp__prompt_kernel_normdone
gated_mix__mha_block__mixer_gmlp__prompt_kernel_nonorm:
  s_lshl_b32 s68, s44, 13
  s_add_u32 s68, s68, 32768
  v_add_u32 v184, s68, v255
  ds_read_b128 a[0:3], v184 offset:0
  ds_read_b128 a[4:7], v184 offset:1024
  ds_read_b128 a[8:11], v184 offset:2048
  ds_read_b128 a[12:15], v184 offset:3072
  ds_read_b128 a[16:19], v184 offset:4096
  ds_read_b128 a[20:23], v184 offset:5120
  ds_read_b128 a[24:27], v184 offset:6144
  ds_read_b128 a[28:31], v184 offset:32768
  ds_read_b128 a[32:35], v184 offset:33792
  ds_read_b128 a[36:39], v184 offset:34816
  ds_read_b128 a[40:43], v184 offset:35840
  ds_read_b128 a[44:47], v184 offset:36864
  ds_read_b128 a[48:51], v184 offset:37888
  ds_read_b128 a[52:55], v184 offset:38912
gated_mix__mha_block__mixer_gmlp__prompt_kernel_normdone:
  s_lshl_b32 s52, s48, 7
  s_add_u32 s52, s52, 44040192
  s_cmp_eq_u32 s44, 0
  s_cselect_b32 s52, s52, 0x70000000
  v_mfma_f32_32x32x16_bf16 v[16:31], v[136:139], v[120:123], v[80:95]
  ds_read_b128 v[128:131], v172 offset:0
  v_exp_f32 v0, v0
  v_exp_f32 v1, v1
  v_exp_f32 v2, v2
  v_mfma_f32_32x32x16_bf16 v[16:31], v[140:143], v[124:127], v[16:31]
  ds_read_b128 v[132:135], v172 offset:512
  v_exp_f32 v3, v3
  v_exp_f32 v4, v4
  v_cvt_pk_bf16_f32 v96, v0, v1
  v_exp_f32 v5, v5
  v_mfma_f32_32x32x16_bf16 v[48:63], v[144:147], v[104:107], v[48:63]
  s_add_u32 m0, s50, 24576
  v_exp_f32 v6, v6
  v_cvt_pk_bf16_f32 v97, v2, v3
  v_exp_f32 v7, v7
  v_exp_f32 v8, v8
  v_cvt_pk_bf16_f32 v98, v4, v5
  v_mfma_f32_32x32x16_bf16 v[48:63], v[148:151], v[108:111], v[48:63]
  buffer_load_dwordx4 v255, s[8:11], s49 offen sc1 lds
  v_exp_f32 v9, v9
  v_exp_f32 v10, v10
  v_cvt_pk_bf16_f32 v99, v6, v7
  v_exp_f32 v11, v11
  v_mfma_f32_16x16x32_bf16 v[164:167], v[168:171], v[104:107], v[164:167]
  buffer_load_dwordx4 v255, s[12:15], s49 offen offset:1024 sc1 lds
  s_add_u32 s49, s49, 4096
  v_exp_f32 v12, v12
  v_cvt_pk_bf16_f32 v100, v8, v9
  v_exp_f32 v13, v13
  v_mfma_f32_16x16x32_bf16 v[164:167], v[168:171], v[108:111], v[164:167]
  s_waitcnt lgkmcnt(0)
  v_exp_f32 v14, v14
  v_cvt_pk_bf16_f32 v101, v10, v11
  v_exp_f32 v15, v15
  v_cvt_pk_bf16_f32 v102, v12, v13
  v_cvt_pk_bf16_f32 v103, v14, v15
  v_mfma_f32_32x32x16_bf16 v[0:15], v[128:131], v[112:115], v[64:79]
  ds_read_b128 v[144:147], v172 offset:1024
  v_exp_f32 v16, v16
  v_exp_f32 v17, v17
  v_exp_f32 v18, v18
  v_mfma_f32_32x32x16_bf16 v[0:15], v[132:135], v[116:119], v[0:15]
  ds_read_b128 v[148:151], v172 offset:1536
  v_exp_f32 v19, v19
  v_exp_f32 v20, v20
  v_cvt_pk_bf16_f32 v104, v16, v17
  v_exp_f32 v21, v21
  v_mfma_f32_32x32x16_bf16 v[32:47], v[152:155], v[96:99], v[32:47]
  v_exp_f32 v22, v22
  v_cvt_pk_bf16_f32 v105, v18, v19
  v_exp_f32 v23, v23
  v_exp_f32 v24, v24
  v_cvt_pk_bf16_f32 v106, v20, v21
  v_mfma_f32_32x32x16_bf16 v[32:47], v[156:159], v[100:103], v[32:47]
  v_exp_f32 v25, v25
  v_exp_f32 v26, v26
  v_cvt_pk_bf16_f32 v107, v22, v23
  v_exp_f32 v27, v27
  v_mfma_f32_16x16x32_bf16 v[160:163], v[168:171], v[96:99], v[160:163]
  v_exp_f32 v28, v28
  v_cvt_pk_bf16_f32 v108, v24, v25
  v_exp_f32 v29, v29
  v_mfma_f32_16x16x32_bf16 v[160:163], v[168:171], v[100:103], v[160:163]
  s_waitcnt lgkmcnt(0)
  v_exp_f32 v30, v30
  v_cvt_pk_bf16_f32 v109, v26, v27
  v_exp_f32 v31, v31
  v_cvt_pk_bf16_f32 v110, v28, v29
  v_cvt_pk_bf16_f32 v111, v30, v31
  v_mfma_f32_32x32x16_bf16 v[16:31], v[128:131], v[120:123], v[80:95]
  ds_read_b128 v[136:139], v172 offset:4096
  v_exp_f32 v0, v0
  v_exp_f32 v1, v1
  v_exp_f32 v2, v2
  v_mfma_f32_32x32x16_bf16 v[16:31], v[132:135], v[124:127], v[16:31]
  ds_read_b128 v[140:143], v172 offset:4608
  v_exp_f32 v3, v3
  v_exp_f32 v4, v4
  v_cvt_pk_bf16_f32 v96, v0, v1
  v_exp_f32 v5, v5
  v_mfma_f32_32x32x16_bf16 v[48:63], v[152:155], v[104:107], v[48:63]
  v_exp_f32 v6, v6
  v_cvt_pk_bf16_f32 v97, v2, v3
  v_exp_f32 v7, v7
  v_exp_f32 v8, v8
  v_cvt_pk_bf16_f32 v98, v4, v5
  v_mfma_f32_32x32x16_bf16 v[48:63], v[156:159], v[108:111], v[48:63]
  v_exp_f32 v9, v9
  v_exp_f32 v10, v10
  v_cvt_pk_bf16_f32 v99, v6, v7
  v_exp_f32 v11, v11
  v_mfma_f32_16x16x32_bf16 v[164:167], v[168:171], v[104:107], v[164:167]
  v_exp_f32 v12, v12
  v_cvt_pk_bf16_f32 v100, v8, v9
  v_exp_f32 v13, v13
  v_mfma_f32_16x16x32_bf16 v[164:167], v[168:171], v[108:111], v[164:167]
  s_waitcnt lgkmcnt(0)
  v_exp_f32 v14, v14
  v_cvt_pk_bf16_f32 v101, v10, v11
  v_exp_f32 v15, v15
  v_cvt_pk_bf16_f32 v102, v12, v13
  v_cvt_pk_bf16_f32 v103, v14, v15
  v_mfma_f32_32x32x16_bf16 v[0:15], v[136:139], v[112:115], v[64:79]
  ds_read_b128 v[152:155], v172 offset:5120
  v_exp_f32 v16, v16
  v_exp_f32 v17, v17
  v_exp_f32 v18, v18
  v_mfma_f32_32x32x16_bf16 v[0:15], v[140:143], v[116:119], v[0:15]
  ds_read_b128 v[156:159], v172 offset:5632
  v_exp_f32 v19, v19
  v_exp_f32 v20, v20
  v_cvt_pk_bf16_f32 v104, v16, v17
  v_exp_f32 v21, v21
  v_mfma_f32_32x32x16_bf16 v[32:47], v[144:147], v[96:99], v[32:47]
  v_exp_f32 v22, v22
  v_cvt_pk_bf16_f32 v105, v18, v19
  v_exp_f32 v23, v23
  v_exp_f32 v24, v24
  v_cvt_pk_bf16_f32 v106, v20, v21
  v_mfma_f32_32x32x16_bf16 v[32:47], v[148:151], v[100:103], v[32:47]
  v_exp_f32 v25, v25
  v_exp_f32 v26, v26
  v_cvt_pk_bf16_f32 v107, v22, v23
  v_exp_f32 v27, v27
  v_mfma_f32_16x16x32_bf16 v[160:163], v[168:171], v[96:99], v[160:163]
  v_exp_f32 v28, v28
  v_cvt_pk_bf16_f32 v108, v24, v25
  v_exp_f32 v29, v29
  v_mfma_f32_16x16x32_bf16 v[160:163], v[168:171], v[100:103], v[160:163]
  s_waitcnt vmcnt(20) lgkmcnt(0)
  s_barrier
  v_exp_f32 v30, v30
  v_cvt_pk_bf16_f32 v109, v26, v27
  v_exp_f32 v31, v31
  v_cvt_pk_bf16_f32 v110, v28, v29
  v_cvt_pk_bf16_f32 v111, v30, v31
  s_waitcnt vmcnt(2)
  s_cmp_lt_u32 s81, 16
  s_cbranch_scc1 gated_mix__mha_block__mixer_gmlp__prompt_kernel_np0
  buffer_store_dword v252, v251, s[4:7], s51 offen sc1
gated_mix__mha_block__mixer_gmlp__prompt_kernel_np0:
  v_mfma_f32_32x32x16_bf16 v[16:31], v[136:139], v[120:123], v[80:95]
  ds_read_b128 v[128:131], v172 offset:8192
  v_exp_f32 v0, v0
  v_exp_f32 v1, v1
  v_exp_f32 v2, v2
  v_mfma_f32_32x32x16_bf16 v[16:31], v[140:143], v[124:127], v[16:31]
  ds_read_b128 v[132:135], v172 offset:8704
  v_exp_f32 v3, v3
  v_exp_f32 v4, v4
  v_cvt_pk_bf16_f32 v96, v0, v1
  v_exp_f32 v5, v5
  v_mfma_f32_32x32x16_bf16 v[48:63], v[144:147], v[104:107], v[48:63]
  s_add_u32 m0, s50, 0
  v_exp_f32 v6, v6
  v_cvt_pk_bf16_f32 v97, v2, v3
  v_exp_f32 v7, v7
  v_exp_f32 v8, v8
  v_cvt_pk_bf16_f32 v98, v4, v5
  v_mfma_f32_32x32x16_bf16 v[48:63], v[148:151], v[108:111], v[48:63]
  buffer_load_dwordx4 v255, s[8:11], s49 offen sc1 lds
  v_exp_f32 v9, v9
  v_exp_f32 v10, v10
  v_cvt_pk_bf16_f32 v99, v6, v7
  v_exp_f32 v11, v11
  v_mfma_f32_16x16x32_bf16 v[164:167], v[168:171], v[104:107], v[164:167]
  buffer_load_dwordx4 v255, s[12:15], s49 offen offset:1024 sc1 lds
  s_add_u32 s49, s49, 4096
  v_exp_f32 v12, v12
  v_cvt_pk_bf16_f32 v100, v8, v9
  v_exp_f32 v13, v13
  v_mfma_f32_16x16x32_bf16 v[164:167], v[168:171], v[108:111], v[164:167]
  s_waitcnt lgkmcnt(0)
  s_add_u32 m0, s57, 16384
  v_exp_f32 v14, v14
  v_cvt_pk_bf16_f32 v101, v10, v11
  v_exp_f32 v15, v15
  v_cvt_pk_bf16_f32 v102, v12, v13
  v_cvt_pk_bf16_f32 v103, v14, v15
  v_mfma_f32_32x32x16_bf16 v[0:15], v[128:131], v[112:115], v[64:79]
  ds_read_b128 v[144:147], v172 offset:9216
  v_exp_f32 v16, v16
  v_exp_f32 v17, v17
  v_exp_f32 v18, v18
  v_mfma_f32_32x32x16_bf16 v[0:15], v[132:135], v[116:119], v[0:15]
  ds_read_b128 v[148:151], v172 offset:9728
  v_exp_f32 v19, v19
  v_exp_f32 v20, v20
  v_cvt_pk_bf16_f32 v104, v16, v17
  v_exp_f32 v21, v21
  v_mfma_f32_32x32x16_bf16 v[32:47], v[152:155], v[96:99], v[32:47]
  buffer_load_dwordx4 v232, s[16:19], s54 offen offset:0 lds
  v_exp_f32 v22, v22
  v_cvt_pk_bf16_f32 v105, v18, v19
  v_exp_f32 v23, v23
  v_exp_f32 v24, v24
  v_cvt_pk_bf16_f32 v106, v20, v21
  v_mfma_f32_32x32x16_bf16 v[32:47], v[156:159], v[100:103], v[32:47]
  buffer_load_dwordx4 v233, s[16:19], s54 offen offset:1024 lds
  v_exp_f32 v25, v25
  v_exp_f32 v26, v26
  v_cvt_pk_bf16_f32 v107, v22, v23
  v_exp_f32 v27, v27
  v_mfma_f32_16x16x32_bf16 v[160:163], v[168:171], v[96:99], v[160:163]
  buffer_load_ushort v192, v190, s[32:35], s59 offen offset:0
  v_exp_f32 v28, v28
  v_cvt_pk_bf16_f32 v108, v24, v25
  v_exp_f32 v29, v29
  v_mfma_f32_16x16x32_bf16 v[160:163], v[168:171], v[100:103], v[160:163]
  s_waitcnt lgkmcnt(0)
  buffer_load_ushort v193, v190, s[32:35], s59 offen offset:8
  s_lshl_b32 s59, s59, 5
  s_add_u32 s59, s59, 42991616
  v_exp_f32 v30, v30
  v_cvt_pk_bf16_f32 v109, v26, v27
  v_exp_f32 v31, v31
  v_cvt_pk_bf16_f32 v110, v28, v29
  v_cvt_pk_bf16_f32 v111, v30, v31
  v_mfma_f32_32x32x16_bf16 v[16:31], v[128:131], v[120:123], v[80:95]
  ds_read_b128 v[136:139], v172 offset:12288
  v_exp_f32 v0, v0
  v_exp_f32 v1, v1
  v_exp_f32 v2, v2
  v_mfma_f32_32x32x16_bf16 v[16:31], v[132:135], v[124:127], v[16:31]
  ds_read_b128 v[140:143], v172 offset:12800
  v_exp_f32 v3, v3
  v_exp_f32 v4, v4
  v_cvt_pk_bf16_f32 v96, v0, v1
  v_exp_f32 v5, v5
  v_mfma_f32_32x32x16_bf16 v[48:63], v[152:155], v[104:107], v[48:63]
  buffer_load_dword v198, v191, s[4:7], s59 offen offset:0 sc1
  v_exp_f32 v6, v6
  v_cvt_pk_bf16_f32 v97, v2, v3
  v_exp_f32 v7, v7
  v_exp_f32 v8, v8
  v_cvt_pk_bf16_f32 v98, v4, v5
  v_mfma_f32_32x32x16_bf16 v[48:63], v[156:159], v[108:111], v[48:63]
  buffer_load_dword v199, v191, s[4:7], s59 offen offset:256 sc1
  v_exp_f32 v9, v9
  v_exp_f32 v10, v10
  v_cvt_pk_bf16_f32 v99, v6, v7
  v_exp_f32 v11, v11
  v_mfma_f32_16x16x32_bf16 v[164:167], v[168:171], v[104:107], v[164:167]
  buffer_load_dword v174, v188, s[4:7], s83 offen offset:0 sc1
  v_exp_f32 v12, v12
  v_cvt_pk_bf16_f32 v100, v8, v9
  v_exp_f32 v13, v13
  v_mfma_f32_16x16x32_bf16 v[164:167], v[168:171], v[108:111], v[164:167]
  s_waitcnt lgkmcnt(0)
  buffer_load_dword v175, v188, s[4:7], s83 offen offset:2048 sc1
  v_exp_f32 v14, v14
  v_cvt_pk_bf16_f32 v101, v10, v11
  v_exp_f32 v15, v15
  v_cvt_pk_bf16_f32 v102, v12, v13
  v_cvt_pk_bf16_f32 v103, v14, v15
  v_mfma_f32_32x32x16_bf16 v[0:15], v[136:139], v[112:115], v[64:79]
  ds_read_b128 v[152:155], v172 offset:13312
  v_exp_f32 v16, v16
  v_exp_f32 v17, v17
  v_exp_f32 v18, v18
  v_mfma_f32_32x32x16_bf16 v[0:15], v[140:143], v[116:119], v[0:15]
  ds_read_b128 v[156:159], v172 offset:13824
  v_exp_f32 v19, v19
  v_exp_f32 v20, v20
  v_cvt_pk_bf16_f32 v104, v16, v17
  v_exp_f32 v21, v21
  v_mfma_f32_32x32x16_bf16 v[32:47], v[144:147], v[96:99], v[32:47]
  buffer_load_dwordx4 v234, s[16:19], s54 offen offset:2048 lds
  v_exp_f32 v22, v22
  v_cvt_pk_bf16_f32 v105, v18, v19
  v_exp_f32 v23, v23
  v_exp_f32 v24, v24
  v_cvt_pk_bf16_f32 v106, v20, v21
  v_mfma_f32_32x32x16_bf16 v[32:47], v[148:151], v[100:103], v[32:47]
  buffer_store_dwordx4 a[0:3], v255, s[4:7], s86 offen sc1
  s_add_u32 s86, s86, 1024
  v_exp_f32 v25, v25
  v_exp_f32 v26, v26
  v_cvt_pk_bf16_f32 v107, v22, v23
  v_exp_f32 v27, v27
  v_mfma_f32_16x16x32_bf16 v[160:163], v[168:171], v[96:99], v[160:163]
  buffer_load_dwordx4 v235, s[16:19], s54 offen offset:3072 lds
  s_add_u32 s54, s54, 128
  v_exp_f32 v28, v28
  v_cvt_pk_bf16_f32 v108, v24, v25
  v_exp_f32 v29, v29
  v_mfma_f32_16x16x32_bf16 v[160:163], v[168:171], v[100:103], v[160:163]
  s_waitcnt vmcnt(19) lgkmcnt(0)
  s_barrier
  v_exp_f32 v30, v30
  v_cvt_pk_bf16_f32 v109, v26, v27
  v_exp_f32 v31, v31
  v_cvt_pk_bf16_f32 v110, v28, v29
  v_cvt_pk_bf16_f32 v111, v30, v31
  v_mfma_f32_32x32x16_bf16 v[16:31], v[136:139], v[120:123], v[80:95]
  ds_read_b128 v[128:131], v172 offset:16384
  v_exp_f32 v0, v0
  v_exp_f32 v1, v1
  v_exp_f32 v2, v2
  v_mfma_f32_32x32x16_bf16 v[16:31], v[140:143], v[124:127], v[16:31]
  ds_read_b128 v[132:135], v172 offset:16896
  v_exp_f32 v3, v3
  v_exp_f32 v4, v4
  v_cvt_pk_bf16_f32 v96, v0, v1
  v_exp_f32 v5, v5
  v_mfma_f32_32x32x16_bf16 v[48:63], v[144:147], v[104:107], v[48:63]
  s_add_u32 m0, s50, 8192
  v_exp_f32 v6, v6
  v_cvt_pk_bf16_f32 v97, v2, v3
  v_exp_f32 v7, v7
  v_exp_f32 v8, v8
  v_cvt_pk_bf16_f32 v98, v4, v5
  v_mfma_f32_32x32x16_bf16 v[48:63], v[148:151], v[108:111], v[48:63]
  buffer_load_dwordx4 v255, s[8:11], s49 offen sc1 lds
  v_exp_f32 v9, v9
  v_exp_f32 v10, v10
  v_cvt_pk_bf16_f32 v99, v6, v7
  v_exp_f32 v11, v11
  v_mfma_f32_16x16x32_bf16 v[164:167], v[168:171], v[104:107], v[164:167]
  buffer_load_dwordx4 v255, s[12:15], s49 offen offset:1024 sc1 lds
  s_add_u32 s49, s49, 4096
  v_exp_f32 v12, v12
  v_cvt_pk_bf16_f32 v100, v8, v9
  v_exp_f32 v13, v13
  v_mfma_f32_16x16x32_bf16 v[164:167], v[168:171], v[108:111], v[164:167]
  s_waitcnt lgkmcnt(0)
  s_add_u32 m0, s57, 49152
  v_exp_f32 v14, v14
  v_cvt_pk_bf16_f32 v101, v10, v11
  v_exp_f32 v15, v15
  v_cvt_pk_bf16_f32 v102, v12, v13
  v_cvt_pk_bf16_f32 v103, v14, v15
  v_mfma_f32_32x32x16_bf16 v[0:15], v[128:131], v[112:115], v[64:79]
  ds_read_b128 v[144:147], v172 offset:17408
  v_exp_f32 v16, v16
  v_exp_f32 v17, v17
  v_exp_f32 v18, v18
  v_mfma_f32_32x32x16_bf16 v[0:15], v[132:135], v[116:119], v[0:15]
  ds_read_b128 v[148:151], v172 offset:17920
  v_exp_f32 v19, v19
  v_exp_f32 v20, v20
  v_cvt_pk_bf16_f32 v104, v16, v17
  v_exp_f32 v21, v21
  v_mfma_f32_32x32x16_bf16 v[32:47], v[152:155], v[96:99], v[32:47]
  buffer_load_dwordx4 v232, s[16:19], s54 offen offset:0 lds
  v_exp_f32 v22, v22
  v_cvt_pk_bf16_f32 v105, v18, v19
  v_exp_f32 v23, v23
  v_exp_f32 v24, v24
  v_cvt_pk_bf16_f32 v106, v20, v21
  v_mfma_f32_32x32x16_bf16 v[32:47], v[156:159], v[100:103], v[32:47]
  buffer_store_dwordx4 a[4:7], v255, s[4:7], s86 offen sc1
  s_add_u32 s86, s86, 1024
  v_exp_f32 v25, v25
  v_exp_f32 v26, v26
  v_cvt_pk_bf16_f32 v107, v22, v23
  v_exp_f32 v27, v27
  v_mfma_f32_16x16x32_bf16 v[160:163], v[168:171], v[96:99], v[160:163]
  buffer_load_dwordx4 v233, s[16:19], s54 offen offset:1024 lds
  v_exp_f32 v28, v28
  v_cvt_pk_bf16_f32 v108, v24, v25
  v_exp_f32 v29, v29
  v_mfma_f32_16x16x32_bf16 v[160:163], v[168:171], v[100:103], v[160:163]
  s_waitcnt lgkmcnt(0)
  buffer_store_dwordx4 a[8:11], v255, s[4:7], s86 offen sc1
  s_add_u32 s86, s86, 1024
  v_exp_f32 v30, v30
  v_cvt_pk_bf16_f32 v109, v26, v27
  v_exp_f32 v31, v31
  v_cvt_pk_bf16_f32 v110, v28, v29
  v_cvt_pk_bf16_f32 v111, v30, v31
  v_mfma_f32_32x32x16_bf16 v[16:31], v[128:131], v[120:123], v[80:95]
  ds_read_b128 v[136:139], v172 offset:20480
  v_exp_f32 v0, v0
  v_exp_f32 v1, v1
  v_exp_f32 v2, v2
  v_mfma_f32_32x32x16_bf16 v[16:31], v[132:135], v[124:127], v[16:31]
  ds_read_b128 v[140:143], v172 offset:20992
  v_exp_f32 v3, v3
  v_exp_f32 v4, v4
  v_cvt_pk_bf16_f32 v96, v0, v1
  v_exp_f32 v5, v5
  v_mfma_f32_32x32x16_bf16 v[48:63], v[152:155], v[104:107], v[48:63]
  buffer_load_dwordx4 v234, s[16:19], s54 offen offset:2048 lds
  v_exp_f32 v6, v6
  v_cvt_pk_bf16_f32 v97, v2, v3
  v_exp_f32 v7, v7
  v_exp_f32 v8, v8
  v_cvt_pk_bf16_f32 v98, v4, v5
  v_mfma_f32_32x32x16_bf16 v[48:63], v[156:159], v[108:111], v[48:63]
  buffer_load_dwordx4 v235, s[16:19], s54 offen offset:3072 lds
  s_add_u32 s54, s54, 128
  v_exp_f32 v9, v9
  v_exp_f32 v10, v10
  v_cvt_pk_bf16_f32 v99, v6, v7
  v_exp_f32 v11, v11
  v_mfma_f32_16x16x32_bf16 v[164:167], v[168:171], v[104:107], v[164:167]
  buffer_store_dwordx4 a[12:15], v255, s[4:7], s86 offen sc1
  s_add_u32 s86, s86, 1024
  v_exp_f32 v12, v12
  v_cvt_pk_bf16_f32 v100, v8, v9
  v_exp_f32 v13, v13
  v_mfma_f32_16x16x32_bf16 v[164:167], v[168:171], v[108:111], v[164:167]
  s_waitcnt lgkmcnt(0)
  s_add_u32 m0, s57, 81920
  v_exp_f32 v14, v14
  v_cvt_pk_bf16_f32 v101, v10, v11
  v_exp_f32 v15, v15
  v_cvt_pk_bf16_f32 v102, v12, v13
  v_cvt_pk_bf16_f32 v103, v14, v15
  v_mfma_f32_32x32x16_bf16 v[0:15], v[136:139], v[112:115], v[64:79]
  ds_read_b128 v[152:155], v172 offset:21504
  v_exp_f32 v16, v16
  v_exp_f32 v17, v17
  v_exp_f32 v18, v18
  v_mfma_f32_32x32x16_bf16 v[0:15], v[140:143], v[116:119], v[0:15]
  ds_read_b128 v[156:159], v172 offset:22016
  v_exp_f32 v19, v19
  v_exp_f32 v20, v20
  v_cvt_pk_bf16_f32 v104, v16, v17
  v_exp_f32 v21, v21
  v_mfma_f32_32x32x16_bf16 v[32:47], v[144:147], v[96:99], v[32:47]
  buffer_load_dwordx4 v232, s[16:19], s54 offen offset:0 lds
  v_exp_f32 v22, v22
  v_cvt_pk_bf16_f32 v105, v18, v19
  v_exp_f32 v23, v23
  v_exp_f32 v24, v24
  v_cvt_pk_bf16_f32 v106, v20, v21
  v_mfma_f32_32x32x16_bf16 v[32:47], v[148:151], v[100:103], v[32:47]
  buffer_store_dwordx4 a[16:19], v255, s[4:7], s86 offen sc1
  s_add_u32 s86, s86, 1024
  v_exp_f32 v25, v25
  v_exp_f32 v26, v26
  v_cvt_pk_bf16_f32 v107, v22, v23
  v_exp_f32 v27, v27
  v_mfma_f32_16x16x32_bf16 v[160:163], v[168:171], v[96:99], v[160:163]
  buffer_load_dwordx4 v233, s[16:19], s54 offen offset:1024 lds
  v_exp_f32 v28, v28
  v_cvt_pk_bf16_f32 v108, v24, v25
  v_exp_f32 v29, v29
  v_mfma_f32_16x16x32_bf16 v[160:163], v[168:171], v[100:103], v[160:163]
  s_waitcnt vmcnt(25) lgkmcnt(0)
  s_barrier
  v_exp_f32 v30, v30
  v_cvt_pk_bf16_f32 v109, v26, v27
  v_exp_f32 v31, v31
  v_cvt_pk_bf16_f32 v110, v28, v29
  v_cvt_pk_bf16_f32 v111, v30, v31
  v_mfma_f32_32x32x16_bf16 v[16:31], v[136:139], v[120:123], v[80:95]
  ds_read_b128 v[128:131], v172 offset:24576
  v_exp_f32 v0, v0
  v_exp_f32 v1, v1
  v_exp_f32 v2, v2
  v_mfma_f32_32x32x16_bf16 v[16:31], v[140:143], v[124:127], v[16:31]
  ds_read_b128 v[132:135], v172 offset:25088
  v_exp_f32 v3, v3
  v_exp_f32 v4, v4
  v_cvt_pk_bf16_f32 v96, v0, v1
  v_exp_f32 v5, v5
  v_mfma_f32_32x32x16_bf16 v[48:63], v[144:147], v[104:107], v[48:63]
  s_add_u32 m0, s50, 16384
  v_exp_f32 v6, v6
  v_cvt_pk_bf16_f32 v97, v2, v3
  v_exp_f32 v7, v7
  v_exp_f32 v8, v8
  v_cvt_pk_bf16_f32 v98, v4, v5
  v_mfma_f32_32x32x16_bf16 v[48:63], v[148:151], v[108:111], v[48:63]
  buffer_load_dwordx4 v255, s[8:11], s49 offen sc1 lds
  v_exp_f32 v9, v9
  v_exp_f32 v10, v10
  v_cvt_pk_bf16_f32 v99, v6, v7
  v_exp_f32 v11, v11
  v_mfma_f32_16x16x32_bf16 v[164:167], v[168:171], v[104:107], v[164:167]
  buffer_load_dwordx4 v255, s[12:15], s49 offen offset:1024 sc1 lds
  s_add_u32 s49, s49, 4096
  v_exp_f32 v12, v12
  v_cvt_pk_bf16_f32 v100, v8, v9
  v_exp_f32 v13, v13
  v_mfma_f32_16x16x32_bf16 v[164:167], v[168:171], v[108:111], v[164:167]
  s_waitcnt lgkmcnt(0)
  s_add_u32 m0, s57, 81920
  s_nop 0
  buffer_load_dwordx4 v234, s[16:19], s54 offen offset:2048 lds
  v_exp_f32 v14, v14
  v_cvt_pk_bf16_f32 v101, v10, v11
  v_exp_f32 v15, v15
  v_cvt_pk_bf16_f32 v102, v12, v13
  v_cvt_pk_bf16_f32 v103, v14, v15
  v_mfma_f32_32x32x16_bf16 v[0:15], v[128:131], v[112:115], v[64:79]
  ds_read_b128 v[144:147], v172 offset:25600
  v_exp_f32 v16, v16
  v_exp_f32 v17, v17
  v_exp_f32 v18, v18
  v_mfma_f32_32x32x16_bf16 v[0:15], v[132:135], v[116:119], v[0:15]
  ds_read_b128 v[148:151], v172 offset:26112
  v_exp_f32 v19, v19
  v_exp_f32 v20, v20
  v_cvt_pk_bf16_f32 v104, v16, v17
  v_exp_f32 v21, v21
  v_mfma_f32_32x32x16_bf16 v[32:47], v[152:155], v[96:99], v[32:47]
  buffer_store_dwordx4 a[20:23], v255, s[4:7], s86 offen sc1
  s_add_u32 s86, s86, 1024
  v_exp_f32 v22, v22
  v_cvt_pk_bf16_f32 v105, v18, v19
  v_exp_f32 v23, v23
  v_exp_f32 v24, v24
  v_cvt_pk_bf16_f32 v106, v20, v21
  v_mfma_f32_32x32x16_bf16 v[32:47], v[156:159], v[100:103], v[32:47]
  buffer_load_dwordx4 v235, s[16:19], s54 offen offset:3072 lds
  s_add_u32 s54, s54, 128
  v_exp_f32 v25, v25
  v_exp_f32 v26, v26
  v_cvt_pk_bf16_f32 v107, v22, v23
  v_exp_f32 v27, v27
  v_mfma_f32_16x16x32_bf16 v[160:163], v[168:171], v[96:99], v[160:163]
  buffer_store_dwordx4 a[24:27], v255, s[4:7], s86 offen sc1
  s_add_u32 s86, s86, 108544
  v_exp_f32 v28, v28
  v_cvt_pk_bf16_f32 v108, v24, v25
  v_exp_f32 v29, v29
  v_mfma_f32_16x16x32_bf16 v[160:163], v[168:171], v[100:103], v[160:163]
  s_waitcnt lgkmcnt(0)
  s_add_u32 m0, s57, 114688
  v_exp_f32 v30, v30
  v_cvt_pk_bf16_f32 v109, v26, v27
  v_exp_f32 v31, v31
  v_cvt_pk_bf16_f32 v110, v28, v29
  v_cvt_pk_bf16_f32 v111, v30, v31
  v_mfma_f32_32x32x16_bf16 v[16:31], v[128:131], v[120:123], v[80:95]
  ds_read_b128 v[136:139], v172 offset:28672
  v_exp_f32 v0, v0
  v_exp_f32 v1, v1
  v_exp_f32 v2, v2
  v_mfma_f32_32x32x16_bf16 v[16:31], v[132:135], v[124:127], v[16:31]
  ds_read_b128 v[140:143], v172 offset:29184
  v_exp_f32 v3, v3
  v_exp_f32 v4, v4
  v_cvt_pk_bf16_f32 v96, v0, v1
  v_exp_f32 v5, v5
  v_mfma_f32_32x32x16_bf16 v[48:63], v[152:155], v[104:107], v[48:63]
  buffer_load_dwordx4 v232, s[16:19], s54 offen offset:0 lds
  v_exp_f32 v6, v6
  v_cvt_pk_bf16_f32 v97, v2, v3
  v_exp_f32 v7, v7
  v_exp_f32 v8, v8
  v_cvt_pk_bf16_f32 v98, v4, v5
  v_mfma_f32_32x32x16_bf16 v[48:63], v[156:159], v[108:111], v[48:63]
  buffer_load_dwordx4 v233, s[16:19], s54 offen offset:1024 lds
  v_exp_f32 v9, v9
  v_exp_f32 v10, v10
  v_cvt_pk_bf16_f32 v99, v6, v7
  v_exp_f32 v11, v11
  v_mfma_f32_16x16x32_bf16 v[164:167], v[168:171], v[104:107], v[164:167]
  buffer_store_dwordx4 a[28:31], v255, s[4:7], s86 offen sc1
  s_add_u32 s86, s86, 1024
  v_exp_f32 v12, v12
  v_cvt_pk_bf16_f32 v100, v8, v9
  v_exp_f32 v13, v13
  v_mfma_f32_16x16x32_bf16 v[164:167], v[168:171], v[108:111], v[164:167]
  s_waitcnt lgkmcnt(0)
  buffer_load_dwordx4 v234, s[16:19], s54 offen offset:2048 lds
  v_exp_f32 v14, v14
  v_cvt_pk_bf16_f32 v101, v10, v11
  v_exp_f32 v15, v15
  v_cvt_pk_bf16_f32 v102, v12, v13
  v_cvt_pk_bf16_f32 v103, v14, v15
  v_mfma_f32_32x32x16_bf16 v[0:15], v[136:139], v[112:115], v[64:79]
  ds_read_b128 v[152:155], v172 offset:29696
  v_exp_f32 v16, v16
  v_exp_f32 v17, v17
  v_exp_f32 v18, v18
  v_mfma_f32_32x32x16_bf16 v[0:15], v[140:143], v[116:119], v[0:15]
  ds_read_b128 v[156:159], v172 offset:30208
  v_exp_f32 v19, v19
  v_exp_f32 v20, v20
  v_cvt_pk_bf16_f32 v104, v16, v17
  v_exp_f32 v21, v21
  v_mfma_f32_32x32x16_bf16 v[32:47], v[144:147], v[96:99], v[32:47]
  buffer_store_dwordx4 a[32:35], v255, s[4:7], s86 offen sc1
  s_add_u32 s86, s86, 1024
  v_exp_f32 v22, v22
  v_cvt_pk_bf16_f32 v105, v18, v19
  v_exp_f32 v23, v23
  v_exp_f32 v24, v24
  v_cvt_pk_bf16_f32 v106, v20, v21
  v_mfma_f32_32x32x16_bf16 v[32:47], v[148:151], v[100:103], v[32:47]
  buffer_load_dwordx4 v235, s[16:19], s54 offen offset:3072 lds
  s_add_u32 s54, s54, 128
  v_exp_f32 v25, v25
  v_exp_f32 v26, v26
  v_cvt_pk_bf16_f32 v107, v22, v23
  v_exp_f32 v27, v27
  v_mfma_f32_16x16x32_bf16 v[160:163], v[168:171], v[96:99], v[160:163]
  buffer_store_dwordx4 a[36:39], v255, s[4:7], s86 offen sc1
  s_add_u32 s86, s86, 1024
  v_exp_f32 v28, v28
  v_cvt_pk_bf16_f32 v108, v24, v25
  v_exp_f32 v29, v29
  v_mfma_f32_16x16x32_bf16 v[160:163], v[168:171], v[100:103], v[160:163]
  s_waitcnt vmcnt(36) lgkmcnt(0)
  s_barrier
  v_exp_f32 v30, v30
  v_cvt_pk_bf16_f32 v109, v26, v27
  v_exp_f32 v31, v31
  v_cvt_pk_bf16_f32 v110, v28, v29
  v_cvt_pk_bf16_f32 v111, v30, v31
  v_mfma_f32_32x32x16_bf16 v[16:31], v[136:139], v[120:123], v[80:95]
  ds_read_b128 v[128:131], v172 offset:0
  v_exp_f32 v0, v0
  v_exp_f32 v1, v1
  v_exp_f32 v2, v2
  v_mfma_f32_32x32x16_bf16 v[16:31], v[140:143], v[124:127], v[16:31]
  ds_read_b128 v[132:135], v172 offset:512
  v_exp_f32 v3, v3
  v_exp_f32 v4, v4
  v_cvt_pk_bf16_f32 v96, v0, v1
  v_exp_f32 v5, v5
  v_mfma_f32_32x32x16_bf16 v[48:63], v[144:147], v[104:107], v[48:63]
  s_add_u32 m0, s50, 24576
  v_exp_f32 v6, v6
  v_cvt_pk_bf16_f32 v97, v2, v3
  v_exp_f32 v7, v7
  v_exp_f32 v8, v8
  v_cvt_pk_bf16_f32 v98, v4, v5
  v_mfma_f32_32x32x16_bf16 v[48:63], v[148:151], v[108:111], v[48:63]
  buffer_load_dwordx4 v255, s[8:11], s49 offen sc1 lds
  v_exp_f32 v9, v9
  v_exp_f32 v10, v10
  v_cvt_pk_bf16_f32 v99, v6, v7
  v_exp_f32 v11, v11
  v_mfma_f32_16x16x32_bf16 v[164:167], v[168:171], v[104:107], v[164:167]
  buffer_load_dwordx4 v255, s[12:15], s49 offen offset:1024 sc1 lds
  s_add_u32 s49, s49, 4096
  v_exp_f32 v12, v12
  v_cvt_pk_bf16_f32 v100, v8, v9
  v_exp_f32 v13, v13
  v_mfma_f32_16x16x32_bf16 v[164:167], v[168:171], v[108:111], v[164:167]
  s_waitcnt lgkmcnt(0)
  buffer_load_dword v250, v249, s[4:7], s52 offen sc1
  v_exp_f32 v14, v14
  v_cvt_pk_bf16_f32 v101, v10, v11
  v_exp_f32 v15, v15
  v_cvt_pk_bf16_f32 v102, v12, v13
  v_cvt_pk_bf16_f32 v103, v14, v15
  v_mfma_f32_32x32x16_bf16 v[0:15], v[128:131], v[112:115], v[64:79]
  ds_read_b128 v[144:147], v172 offset:1024
  v_exp_f32 v16, v16
  v_exp_f32 v17, v17
  v_exp_f32 v18, v18
  v_mfma_f32_32x32x16_bf16 v[0:15], v[132:135], v[116:119], v[0:15]
  ds_read_b128 v[148:151], v172 offset:1536
  v_exp_f32 v19, v19
  v_exp_f32 v20, v20
  v_cvt_pk_bf16_f32 v104, v16, v17
  v_exp_f32 v21, v21
  v_mfma_f32_32x32x16_bf16 v[32:47], v[152:155], v[96:99], v[32:47]
  buffer_store_dwordx4 a[40:43], v255, s[4:7], s86 offen sc1
  s_add_u32 s86, s86, 1024
  v_exp_f32 v22, v22
  v_cvt_pk_bf16_f32 v105, v18, v19
  v_exp_f32 v23, v23
  v_exp_f32 v24, v24
  v_cvt_pk_bf16_f32 v106, v20, v21
  v_mfma_f32_32x32x16_bf16 v[32:47], v[156:159], v[100:103], v[32:47]
  buffer_store_dwordx4 a[44:47], v255, s[4:7], s86 offen sc1
  s_add_u32 s86, s86, 1024
  v_exp_f32 v25, v25
  v_exp_f32 v26, v26
  v_cvt_pk_bf16_f32 v107, v22, v23
  v_exp_f32 v27, v27
  v_mfma_f32_16x16x32_bf16 v[160:163], v[168:171], v[96:99], v[160:163]
  buffer_store_dwordx4 a[48:51], v255, s[4:7], s86 offen sc1
  s_add_u32 s86, s86, 1024
  v_exp_f32 v28, v28
  v_cvt_pk_bf16_f32 v108, v24, v25
  v_exp_f32 v29, v29
  v_mfma_f32_16x16x32_bf16 v[160:163], v[168:171], v[100:103], v[160:163]
  s_waitcnt lgkmcnt(0)
  v_exp_f32 v30, v30
  v_cvt_pk_bf16_f32 v109, v26, v27
  v_exp_f32 v31, v31
  v_cvt_pk_bf16_f32 v110, v28, v29
  v_cvt_pk_bf16_f32 v111, v30, v31
  v_mfma_f32_32x32x16_bf16 v[16:31], v[128:131], v[120:123], v[80:95]
  ds_read_b128 v[136:139], v172 offset:4096
  v_exp_f32 v0, v0
  v_exp_f32 v1, v1
  v_exp_f32 v2, v2
  v_mfma_f32_32x32x16_bf16 v[16:31], v[132:135], v[124:127], v[16:31]
  ds_read_b128 v[140:143], v172 offset:4608
  v_exp_f32 v3, v3
  v_exp_f32 v4, v4
  v_cvt_pk_bf16_f32 v96, v0, v1
  v_exp_f32 v5, v5
  v_mfma_f32_32x32x16_bf16 v[48:63], v[152:155], v[104:107], v[48:63]
  buffer_store_dwordx4 a[52:55], v255, s[4:7], s86 offen sc1
  s_add_u32 s86, s86, 1024
  v_exp_f32 v6, v6
  v_cvt_pk_bf16_f32 v97, v2, v3
  v_exp_f32 v7, v7
  v_exp_f32 v8, v8
  v_cvt_pk_bf16_f32 v98, v4, v5
  v_mfma_f32_32x32x16_bf16 v[48:63], v[156:159], v[108:111], v[48:63]
  v_exp_f32 v9, v9
  v_exp_f32 v10, v10
  v_cvt_pk_bf16_f32 v99, v6, v7
  v_exp_f32 v11, v11
  v_mfma_f32_16x16x32_bf16 v[164:167], v[168:171], v[104:107], v[164:167]
  v_exp_f32 v12, v12
  v_cvt_pk_bf16_f32 v100, v8, v9
  v_exp_f32 v13, v13
  v_mfma_f32_16x16x32_bf16 v[164:167], v[168:171], v[108:111], v[164:167]
  s_waitcnt lgkmcnt(0)
  v_exp_f32 v14, v14
  v_cvt_pk_bf16_f32 v101, v10, v11
  v_exp_f32 v15, v15
  v_cvt_pk_bf16_f32 v102, v12, v13
  v_cvt_pk_bf16_f32 v103, v14, v15
  s_waitcnt vmcnt(4)
  s_cmp_lg_u32 s44, 0
  s_cbranch_scc1 gated_mix__mha_block__mixer_gmlp__prompt_kernel_c0_ok
  s_mov_b32 s53, 0x8000
gated_mix__mha_block__mixer_gmlp__prompt_kernel_c0:
  v_cmp_eq_u32 vcc, 0, v250
  s_nop 3
  s_cmp_eq_u64 vcc, 0
  s_cbranch_scc1 gated_mix__mha_block__mixer_gmlp__prompt_kernel_c0_ok
  s_sleep 8
  buffer_load_dword v250, v249, s[4:7], s52 offen sc1
  s_waitcnt vmcnt(0)
  s_sub_u32 s53, s53, 1
  s_cmp_lg_u32 s53, 0
  s_cbranch_scc1 gated_mix__mha_block__mixer_gmlp__prompt_kernel_c0
gated_mix__mha_block__mixer_gmlp__prompt_kernel_c0_ok:
  v_mfma_f32_32x32x16_bf16 v[0:15], v[136:139], v[112:115], v[64:79]
  ds_read_b128 v[152:155], v172 offset:5120
  v_exp_f32 v16, v16
  v_exp_f32 v17, v17
  v_exp_f32 v18, v18
  v_mfma_f32_32x32x16_bf16 v[0:15], v[140:143], v[116:119], v[0:15]
  ds_read_b128 v[156:159], v172 offset:5632
  v_exp_f32 v19, v19
  v_exp_f32 v20, v20
  v_cvt_pk_bf16_f32 v104, v16, v17
  v_exp_f32 v21, v21
  v_mfma_f32_32x32x16_bf16 v[32:47], v[144:147], v[96:99], v[32:47]
  v_exp_f32 v22, v22
  v_cvt_pk_bf16_f32 v105, v18, v19
  v_exp_f32 v23, v23
  v_exp_f32 v24, v24
  v_cvt_pk_bf16_f32 v106, v20, v21
  v_mfma_f32_32x32x16_bf16 v[32:47], v[148:151], v[100:103], v[32:47]
  v_exp_f32 v25, v25
  v_exp_f32 v26, v26
  v_cvt_pk_bf16_f32 v107, v22, v23
  v_exp_f32 v27, v27
  v_mfma_f32_16x16x32_bf16 v[160:163], v[168:171], v[96:99], v[160:163]
  v_exp_f32 v28, v28
  v_cvt_pk_bf16_f32 v108, v24, v25
  v_exp_f32 v29, v29
  v_mfma_f32_16x16x32_bf16 v[160:163], v[168:171], v[100:103], v[160:163]
  s_waitcnt vmcnt(30) lgkmcnt(0)
  s_barrier
  v_exp_f32 v30, v30
  v_cvt_pk_bf16_f32 v109, v26, v27
  v_exp_f32 v31, v31
  v_cvt_pk_bf16_f32 v110, v28, v29
  v_cvt_pk_bf16_f32 v111, v30, v31
  s_add_u32 s52, s52, 2048
  v_mfma_f32_32x32x16_bf16 v[16:31], v[136:139], v[120:123], v[80:95]
  ds_read_b128 v[128:131], v172 offset:8192
  v_exp_f32 v0, v0
  v_exp_f32 v1, v1
  v_exp_f32 v2, v2
  v_mfma_f32_32x32x16_bf16 v[16:31], v[140:143], v[124:127], v[16:31]
  ds_read_b128 v[132:135], v172 offset:8704
  v_exp_f32 v3, v3
  v_exp_f32 v4, v4
  v_cvt_pk_bf16_f32 v96, v0, v1
  v_exp_f32 v5, v5
  v_mfma_f32_32x32x16_bf16 v[48:63], v[144:147], v[104:107], v[48:63]
  s_add_u32 m0, s50, 0
  v_exp_f32 v6, v6
  v_cvt_pk_bf16_f32 v97, v2, v3
  v_exp_f32 v7, v7
  v_exp_f32 v8, v8
  v_cvt_pk_bf16_f32 v98, v4, v5
  v_mfma_f32_32x32x16_bf16 v[48:63], v[148:151], v[108:111], v[48:63]
  buffer_load_dwordx4 v255, s[8:11], s49 offen sc1 lds
  v_exp_f32 v9, v9
  v_exp_f32 v10, v10
  v_cvt_pk_bf16_f32 v99, v6, v7
  v_exp_f32 v11, v11
  v_mfma_f32_16x16x32_bf16 v[164:167], v[168:171], v[104:107], v[164:167]
  buffer_load_dwordx4 v255, s[12:15], s49 offen offset:1024 sc1 lds
  s_add_u32 s49, s49, 4096
  v_exp_f32 v12, v12
  v_cvt_pk_bf16_f32 v100, v8, v9
  v_exp_f32 v13, v13
  v_mfma_f32_16x16x32_bf16 v[164:167], v[168:171], v[108:111], v[164:167]
  s_waitcnt lgkmcnt(0)
  s_add_u32 m0, s57, 0
  v_exp_f32 v14, v14
  v_cvt_pk_bf16_f32 v101, v10, v11
  v_exp_f32 v15, v15
  v_cvt_pk_bf16_f32 v102, v12, v13
  v_cvt_pk_bf16_f32 v103, v14, v15
  v_mfma_f32_32x32x16_bf16 v[0:15], v[128:131], v[112:115], v[64:79]
  ds_read_b128 v[144:147], v172 offset:9216
  v_exp_f32 v16, v16
  v_exp_f32 v17, v17
  v_exp_f32 v18, v18
  v_mfma_f32_32x32x16_bf16 v[0:15], v[132:135], v[116:119], v[0:15]
  ds_read_b128 v[148:151], v172 offset:9728
  v_exp_f32 v19, v19
  v_exp_f32 v20, v20
  v_cvt_pk_bf16_f32 v104, v16, v17
  v_exp_f32 v21, v21
  v_mfma_f32_32x32x16_bf16 v[32:47], v[152:155], v[96:99], v[32:47]
  buffer_load_dwordx4 v255, s[28:31], s55 offen offset:0 sc1 lds
  v_exp_f32 v22, v22
  v_cvt_pk_bf16_f32 v105, v18, v19
  v_exp_f32 v23, v23
  v_exp_f32 v24, v24
  v_cvt_pk_bf16_f32 v106, v20, v21
  v_mfma_f32_32x32x16_bf16 v[32:47], v[156:159], v[100:103], v[32:47]
  buffer_load_dwordx4 v255, s[28:31], s55 offen offset:1024 sc1 lds
  v_exp_f32 v25, v25
  v_exp_f32 v26, v26
  v_cvt_pk_bf16_f32 v107, v22, v23
  v_exp_f32 v27, v27
  v_mfma_f32_16x16x32_bf16 v[160:163], v[168:171], v[96:99], v[160:163]
  buffer_load_dwordx4 v255, s[28:31], s55 offen offset:2048 sc1 lds
  v_exp_f32 v28, v28
  v_cvt_pk_bf16_f32 v108, v24, v25
  v_exp_f32 v29, v29
  v_mfma_f32_16x16x32_bf16 v[160:163], v[168:171], v[100:103], v[160:163]
  s_waitcnt lgkmcnt(0)
  buffer_load_dwordx4 v242, s[28:31], s55 offen offset:3072 sc1 lds
  s_add_u32 s55, s55, 229376
  v_exp_f32 v30, v30
  v_cvt_pk_bf16_f32 v109, v26, v27
  v_exp_f32 v31, v31
  v_cvt_pk_bf16_f32 v110, v28, v29
  v_cvt_pk_bf16_f32 v111, v30, v31
  v_mfma_f32_32x32x16_bf16 v[16:31], v[128:131], v[120:123], v[80:95]
  ds_read_b128 v[136:139], v172 offset:12288
  v_exp_f32 v0, v0
  v_exp_f32 v1, v1
  v_exp_f32 v2, v2
  v_mfma_f32_32x32x16_bf16 v[16:31], v[132:135], v[124:127], v[16:31]
  ds_read_b128 v[140:143], v172 offset:12800
  v_exp_f32 v3, v3
  v_exp_f32 v4, v4
  v_cvt_pk_bf16_f32 v96, v0, v1
  v_exp_f32 v5, v5
  v_mfma_f32_32x32x16_bf16 v[48:63], v[152:155], v[104:107], v[48:63]
  s_add_u32 m0, s57, 32768
  v_exp_f32 v6, v6
  v_cvt_pk_bf16_f32 v97, v2, v3
  v_exp_f32 v7, v7
  v_exp_f32 v8, v8
  v_cvt_pk_bf16_f32 v98, v4, v5
  v_mfma_f32_32x32x16_bf16 v[48:63], v[156:159], v[108:111], v[48:63]
  buffer_load_dwordx4 v255, s[28:31], s55 offen offset:0 sc1 lds
  v_exp_f32 v9, v9
  v_exp_f32 v10, v10
  v_cvt_pk_bf16_f32 v99, v6, v7
  v_exp_f32 v11, v11
  v_mfma_f32_16x16x32_bf16 v[164:167], v[168:171], v[104:107], v[164:167]
  buffer_load_dwordx4 v255, s[28:31], s55 offen offset:1024 sc1 lds
  v_exp_f32 v12, v12
  v_cvt_pk_bf16_f32 v100, v8, v9
  v_exp_f32 v13, v13
  v_mfma_f32_16x16x32_bf16 v[164:167], v[168:171], v[108:111], v[164:167]
  s_waitcnt lgkmcnt(0)
  buffer_load_dwordx4 v255, s[28:31], s55 offen offset:2048 sc1 lds
  v_exp_f32 v14, v14
  v_cvt_pk_bf16_f32 v101, v10, v11
  v_exp_f32 v15, v15
  v_cvt_pk_bf16_f32 v102, v12, v13
  v_cvt_pk_bf16_f32 v103, v14, v15
  v_mfma_f32_32x32x16_bf16 v[0:15], v[136:139], v[112:115], v[64:79]
  ds_read_b128 v[152:155], v172 offset:13312
  v_exp_f32 v16, v16
  v_exp_f32 v17, v17
  v_exp_f32 v18, v18
  v_mfma_f32_32x32x16_bf16 v[0:15], v[140:143], v[116:119], v[0:15]
  ds_read_b128 v[156:159], v172 offset:13824
  v_exp_f32 v19, v19
  v_exp_f32 v20, v20
  v_cvt_pk_bf16_f32 v104, v16, v17
  v_exp_f32 v21, v21
  v_mfma_f32_32x32x16_bf16 v[32:47], v[144:147], v[96:99], v[32:47]
  buffer_load_dwordx4 v242, s[28:31], s55 offen offset:3072 sc1 lds
  s_add_u32 s55, s55, 229376
  v_exp_f32 v22, v22
  v_cvt_pk_bf16_f32 v105, v18, v19
  v_exp_f32 v23, v23
  v_exp_f32 v24, v24
  v_cvt_pk_bf16_f32 v106, v20, v21
  v_mfma_f32_32x32x16_bf16 v[32:47], v[148:151], v[100:103], v[32:47]
  s_add_u32 m0, s57, 65536
  v_exp_f32 v25, v25
  v_exp_f32 v26, v26
  v_cvt_pk_bf16_f32 v107, v22, v23
  v_exp_f32 v27, v27
  v_mfma_f32_16x16x32_bf16 v[160:163], v[168:171], v[96:99], v[160:163]
  buffer_load_dwordx4 v255, s[28:31], s55 offen offset:0 sc1 lds
  v_exp_f32 v28, v28
  v_cvt_pk_bf16_f32 v108, v24, v25
  v_exp_f32 v29, v29
  v_mfma_f32_16x16x32_bf16 v[160:163], v[168:171], v[100:103], v[160:163]
  s_waitcnt vmcnt(29) lgkmcnt(0)
  s_barrier
  v_exp_f32 v30, v30
  v_cvt_pk_bf16_f32 v109, v26, v27
  v_exp_f32 v31, v31
  v_cvt_pk_bf16_f32 v110, v28, v29
  v_cvt_pk_bf16_f32 v111, v30, v31
  s_waitcnt vmcnt(11)
  s_cmp_ge_u32 s81, 16
  s_cbranch_scc1 gated_mix__mha_block__mixer_gmlp__prompt_kernel_npz
  buffer_store_dword v252, v251, s[4:7], s51 offen sc1
gated_mix__mha_block__mixer_gmlp__prompt_kernel_npz:
  v_mfma_f32_32x32x16_bf16 v[16:31], v[136:139], v[120:123], v[80:95]
  ds_read_b128 v[128:131], v172 offset:16384
  v_exp_f32 v0, v0
  v_exp_f32 v1, v1
  v_exp_f32 v2, v2
  v_mfma_f32_32x32x16_bf16 v[16:31], v[140:143], v[124:127], v[16:31]
  ds_read_b128 v[132:135], v172 offset:16896
  v_exp_f32 v3, v3
  v_exp_f32 v4, v4
  v_cvt_pk_bf16_f32 v96, v0, v1
  v_exp_f32 v5, v5
  v_mfma_f32_32x32x16_bf16 v[48:63], v[144:147], v[104:107], v[48:63]
  s_add_u32 m0, s50, 8192
  v_exp_f32 v6, v6
  v_cvt_pk_bf16_f32 v97, v2, v3
  v_exp_f32 v7, v7
  v_exp_f32 v8, v8
  v_cvt_pk_bf16_f32 v98, v4, v5
  v_mfma_f32_32x32x16_bf16 v[48:63], v[148:151], v[108:111], v[48:63]
  buffer_load_dwordx4 v255, s[8:11], s49 offen sc1 lds
  v_exp_f32 v9, v9
  v_exp_f32 v10, v10
  v_cvt_pk_bf16_f32 v99, v6, v7
  v_exp_f32 v11, v11
  v_mfma_f32_16x16x32_bf16 v[164:167], v[168:171], v[104:107], v[164:167]
  buffer_load_dwordx4 v255, s[12:15], s49 offen offset:1024 sc1 lds
  s_add_u32 s49, s49, 4096
  v_exp_f32 v12, v12
  v_cvt_pk_bf16_f32 v100, v8, v9
  v_exp_f32 v13, v13
  v_mfma_f32_16x16x32_bf16 v[164:167], v[168:171], v[108:111], v[164:167]
  s_waitcnt lgkmcnt(0)
  s_add_u32 m0, s57, 65536
  s_nop 0
  buffer_load_dwordx4 v255, s[28:31], s55 offen offset:1024 sc1 lds
  v_exp_f32 v14, v14
  v_cvt_pk_bf16_f32 v101, v10, v11
  v_exp_f32 v15, v15
  v_cvt_pk_bf16_f32 v102, v12, v13
  v_cvt_pk_bf16_f32 v103, v14, v15
  v_mfma_f32_32x32x16_bf16 v[0:15], v[128:131], v[112:115], v[64:79]
  ds_read_b128 v[144:147], v172 offset:17408
  v_exp_f32 v16, v16
  v_exp_f32 v17, v17
  v_exp_f32 v18, v18
  v_mfma_f32_32x32x16_bf16 v[0:15], v[132:135], v[116:119], v[0:15]
  ds_read_b128 v[148:151], v172 offset:17920
  v_exp_f32 v19, v19
  v_exp_f32 v20, v20
  v_cvt_pk_bf16_f32 v104, v16, v17
  v_exp_f32 v21, v21
  v_mfma_f32_32x32x16_bf16 v[32:47], v[152:155], v[96:99], v[32:47]
  buffer_load_dwordx4 v255, s[28:31], s55 offen offset:2048 sc1 lds
  v_exp_f32 v22, v22
  v_cvt_pk_bf16_f32 v105, v18, v19
  v_exp_f32 v23, v23
  v_exp_f32 v24, v24
  v_cvt_pk_bf16_f32 v106, v20, v21
  v_mfma_f32_32x32x16_bf16 v[32:47], v[156:159], v[100:103], v[32:47]
  buffer_load_dwordx4 v242, s[28:31], s55 offen offset:3072 sc1 lds
  s_add_u32 s55, s55, 229376
  v_exp_f32 v25, v25
  v_exp_f32 v26, v26
  v_cvt_pk_bf16_f32 v107, v22, v23
  v_exp_f32 v27, v27
  v_mfma_f32_16x16x32_bf16 v[160:163], v[168:171], v[96:99], v[160:163]
  s_add_u32 m0, s57, 98304
  v_exp_f32 v28, v28
  v_cvt_pk_bf16_f32 v108, v24, v25
  v_exp_f32 v29, v29
  v_mfma_f32_16x16x32_bf16 v[160:163], v[168:171], v[100:103], v[160:163]
  s_waitcnt lgkmcnt(0)
  buffer_load_dwordx4 v255, s[28:31], s55 offen offset:0 sc1 lds
  v_exp_f32 v30, v30
  v_cvt_pk_bf16_f32 v109, v26, v27
  v_exp_f32 v31, v31
  v_cvt_pk_bf16_f32 v110, v28, v29
  v_cvt_pk_bf16_f32 v111, v30, v31
  v_mfma_f32_32x32x16_bf16 v[16:31], v[128:131], v[120:123], v[80:95]
  ds_read_b128 v[136:139], v172 offset:20480
  v_exp_f32 v0, v0
  v_exp_f32 v1, v1
  v_exp_f32 v2, v2
  v_mfma_f32_32x32x16_bf16 v[16:31], v[132:135], v[124:127], v[16:31]
  ds_read_b128 v[140:143], v172 offset:20992
  v_exp_f32 v3, v3
  v_exp_f32 v4, v4
  v_cvt_pk_bf16_f32 v96, v0, v1
  v_exp_f32 v5, v5
  v_mfma_f32_32x32x16_bf16 v[48:63], v[152:155], v[104:107], v[48:63]
  buffer_load_dwordx4 v255, s[28:31], s55 offen offset:1024 sc1 lds
  v_exp_f32 v6, v6
  v_cvt_pk_bf16_f32 v97, v2, v3
  v_exp_f32 v7, v7
  v_exp_f32 v8, v8
  v_cvt_pk_bf16_f32 v98, v4, v5
  v_mfma_f32_32x32x16_bf16 v[48:63], v[156:159], v[108:111], v[48:63]
  buffer_load_dwordx4 v255, s[28:31], s55 offen offset:2048 sc1 lds
  v_exp_f32 v9, v9
  v_exp_f32 v10, v10
  v_cvt_pk_bf16_f32 v99, v6, v7
  v_exp_f32 v11, v11
  v_mfma_f32_16x16x32_bf16 v[164:167], v[168:171], v[104:107], v[164:167]
  buffer_load_dwordx4 v242, s[28:31], s55 offen offset:3072 sc1 lds
  s_add_u32 s55, s55, 229376
  v_exp_f32 v12, v12
  v_cvt_pk_bf16_f32 v100, v8, v9
  v_exp_f32 v13, v13
  v_mfma_f32_16x16x32_bf16 v[164:167], v[168:171], v[108:111], v[164:167]
  s_waitcnt lgkmcnt(0)
  v_exp_f32 v14, v14
  v_cvt_pk_bf16_f32 v101, v10, v11
  v_exp_f32 v15, v15
  v_cvt_pk_bf16_f32 v102, v12, v13
  v_cvt_pk_bf16_f32 v103, v14, v15
  v_mfma_f32_32x32x16_bf16 v[0:15], v[136:139], v[112:115], v[64:79]
  ds_read_b128 v[152:155], v172 offset:21504
  v_exp_f32 v16, v16
  v_exp_f32 v17, v17
  v_exp_f32 v18, v18
  v_mfma_f32_32x32x16_bf16 v[0:15], v[140:143], v[116:119], v[0:15]
  ds_read_b128 v[156:159], v172 offset:22016
  v_exp_f32 v19, v19
  v_exp_f32 v20, v20
  v_cvt_pk_bf16_f32 v104, v16, v17
  v_exp_f32 v21, v21
  v_mfma_f32_32x32x16_bf16 v[32:47], v[144:147], v[96:99], v[32:47]
  v_exp_f32 v22, v22
  v_cvt_pk_bf16_f32 v105, v18, v19
  v_exp_f32 v23, v23
  v_exp_f32 v24, v24
  v_cvt_pk_bf16_f32 v106, v20, v21
  v_mfma_f32_32x32x16_bf16 v[32:47], v[148:151], v[100:103], v[32:47]
  v_exp_f32 v25, v25
  v_exp_f32 v26, v26
  v_cvt_pk_bf16_f32 v107, v22, v23
  v_exp_f32 v27, v27
  v_mfma_f32_16x16x32_bf16 v[160:163], v[168:171], v[96:99], v[160:163]
  v_exp_f32 v28, v28
  v_cvt_pk_bf16_f32 v108, v24, v25
  v_exp_f32 v29, v29
  v_mfma_f32_16x16x32_bf16 v[160:163], v[168:171], v[100:103], v[160:163]
  s_waitcnt vmcnt(25) lgkmcnt(0)
  s_barrier
  v_exp_f32 v30, v30
  v_cvt_pk_bf16_f32 v109, v26, v27
  v_exp_f32 v31, v31
  v_cvt_pk_bf16_f32 v110, v28, v29
  v_cvt_pk_bf16_f32 v111, v30, v31
  s_waitcnt vmcnt(10)
  s_barrier
  ds_read_b128 a[140:143], v236 offset:0
  ds_read_b128 a[144:147], v236 offset:512
  ds_read_b128 a[148:151], v237 offset:0
  ds_read_b128 a[152:155], v237 offset:512
  ds_read_b128 a[112:115], v240 offset:0
  ds_read_b128 a[116:119], v240 offset:1024
  ds_read_b128 a[120:123], v240 offset:2048
  ds_read_b128 a[124:127], v240 offset:3072
  ds_read_b128 a[128:131], v240 offset:4096
  ds_read_b128 a[132:135], v240 offset:5120
  ds_read_b128 a[136:139], v240 offset:6144
  v_lshlrev_b32 v192, 16, v192
  v_sub_f32 v198, 1.0, v198
  v_accvgpr_write_b32 a200, v192
  v_accvgpr_write_b32 a201, v192
  v_accvgpr_write_b32 a202, v192
  v_accvgpr_write_b32 a203, v192
  v_lshlrev_b32 v193, 16, v193
  v_sub_f32 v199, 1.0, v199
  v_accvgpr_write_b32 a204, v193
  v_accvgpr_write_b32 a205, v193
  v_accvgpr_write_b32 a206, v193
  v_accvgpr_write_b32 a207, v193
  s_waitcnt lgkmcnt(0)
  s_barrier
  v_mfma_f32_16x16x32_bf16 a[0:3], a[112:115], a[140:143], a[200:203]
  ds_read_b128 a[184:187], v236 offset:32768
  v_mfma_f32_16x16x32_bf16 a[4:7], a[112:115], a[144:147], a[204:207]
  s_add_u32 m0, s57, 0
  v_mfma_f32_16x16x32_bf16 a[8:11], a[112:115], a[148:151], 0
  ds_read_b128 a[188:191], v236 offset:33280
  v_mfma_f32_16x16x32_bf16 a[12:15], a[112:115], a[152:155], 0
  buffer_load_dwordx4 v255, s[28:31], s55 offen offset:0 sc1 lds
  v_mfma_f32_16x16x32_bf16 a[28:31], a[116:119], a[152:155], 0
  ds_read_b128 a[192:195], v237 offset:32768
  v_mfma_f32_16x16x32_bf16 a[24:27], a[116:119], a[148:151], 0
  ds_read_b128 a[196:199], v237 offset:33280
  v_mfma_f32_16x16x32_bf16 a[20:23], a[116:119], a[144:147], a[204:207]
  buffer_load_dwordx4 v255, s[28:31], s55 offen offset:1024 sc1 lds
  v_mfma_f32_16x16x32_bf16 a[16:19], a[116:119], a[140:143], a[200:203]
  ds_read_b128 a[156:159], v240 offset:32768
  v_mfma_f32_16x16x32_bf16 a[32:35], a[120:123], a[140:143], a[200:203]
  ds_read_b128 a[160:163], v240 offset:33792
  v_mfma_f32_16x16x32_bf16 a[36:39], a[120:123], a[144:147], a[204:207]
  buffer_load_dwordx4 v255, s[28:31], s55 offen offset:2048 sc1 lds
  v_mfma_f32_16x16x32_bf16 a[40:43], a[120:123], a[148:151], 0
  ds_read_b128 a[164:167], v240 offset:34816
  v_mfma_f32_16x16x32_bf16 a[44:47], a[120:123], a[152:155], 0
  ds_read_b128 a[168:171], v240 offset:35840
  v_mfma_f32_16x16x32_bf16 a[60:63], a[124:127], a[152:155], 0
  buffer_load_dwordx4 v242, s[28:31], s55 offen offset:3072 sc1 lds
  v_mfma_f32_16x16x32_bf16 a[56:59], a[124:127], a[148:151], 0
  ds_read_b128 a[172:175], v240 offset:36864
  v_mfma_f32_16x16x32_bf16 a[52:55], a[124:127], a[144:147], a[204:207]
  s_add_u32 m0, s57, 16384
  v_mfma_f32_16x16x32_bf16 a[48:51], a[124:127], a[140:143], a[200:203]
  ds_read_b128 a[176:179], v240 offset:37888
  v_mfma_f32_16x16x32_bf16 a[64:67], a[128:131], a[140:143], a[200:203]
  buffer_load_dwordx4 v232, s[16:19], s54 offen offset:0 lds
  v_mfma_f32_16x16x32_bf16 a[68:71], a[128:131], a[144:147], a[204:207]
  ds_read_b128 a[180:183], v240 offset:38912
  v_mfma_f32_16x16x32_bf16 a[72:75], a[128:131], a[148:151], 0
  s_add_u32 s55, s55, 229376
  v_mfma_f32_16x16x32_bf16 a[76:79], a[128:131], a[152:155], 0
  buffer_load_dwordx4 v233, s[16:19], s54 offen offset:1024 lds
  v_mfma_f32_16x16x32_bf16 a[92:95], a[132:135], a[152:155], 0
  v_mfma_f32_16x16x32_bf16 a[88:91], a[132:135], a[148:151], 0
  v_mfma_f32_16x16x32_bf16 a[84:87], a[132:135], a[144:147], a[204:207]
  buffer_load_dwordx4 v234, s[16:19], s54 offen offset:2048 lds
  v_mfma_f32_16x16x32_bf16 a[80:83], a[132:135], a[140:143], a[200:203]
  v_mfma_f32_16x16x32_bf16 a[96:99], a[136:139], a[140:143], a[200:203]
  v_mfma_f32_16x16x32_bf16 a[100:103], a[136:139], a[144:147], a[204:207]
  buffer_load_dwordx4 v235, s[16:19], s54 offen offset:3072 lds
  v_mfma_f32_16x16x32_bf16 a[104:107], a[136:139], a[148:151], 0
  s_add_u32 s54, s54, 128
  v_mfma_f32_16x16x32_bf16 a[108:111], a[136:139], a[152:155], 0
  s_waitcnt vmcnt(12) lgkmcnt(0)
  s_barrier
  v_mfma_f32_16x16x32_bf16 a[0:3], a[156:159], a[184:187], a[0:3]
  ds_read_b128 a[140:143], v238 offset:0
  v_mfma_f32_16x16x32_bf16 a[4:7], a[156:159], a[188:191], a[4:7]
  s_add_u32 m0, s57, 32768
  v_mfma_f32_16x16x32_bf16 a[8:11], a[156:159], a[192:195], a[8:11]
  ds_read_b128 a[144:147], v238 offset:512
  v_mfma_f32_16x16x32_bf16 a[12:15], a[156:159], a[196:199], a[12:15]
  buffer_load_dwordx4 v255, s[28:31], s55 offen offset:0 sc1 lds
  v_mfma_f32_16x16x32_bf16 a[28:31], a[160:163], a[196:199], a[28:31]
  ds_read_b128 a[148:151], v239 offset:0
  v_mfma_f32_16x16x32_bf16 a[24:27], a[160:163], a[192:195], a[24:27]
  ds_read_b128 a[152:155], v239 offset:512
  v_mfma_f32_16x16x32_bf16 a[20:23], a[160:163], a[188:191], a[20:23]
  buffer_load_dwordx4 v255, s[28:31], s55 offen offset:1024 sc1 lds
  v_mfma_f32_16x16x32_bf16 a[16:19], a[160:163], a[184:187], a[16:19]
  ds_read_b128 a[112:115], v241 offset:0
  v_mfma_f32_16x16x32_bf16 a[32:35], a[164:167], a[184:187], a[32:35]
  ds_read_b128 a[116:119], v241 offset:1024
  v_mfma_f32_16x16x32_bf16 a[36:39], a[164:167], a[188:191], a[36:39]
  buffer_load_dwordx4 v255, s[28:31], s55 offen offset:2048 sc1 lds
  v_mfma_f32_16x16x32_bf16 a[40:43], a[164:167], a[192:195], a[40:43]
  ds_read_b128 a[120:123], v241 offset:2048
  v_mfma_f32_16x16x32_bf16 a[44:47], a[164:167], a[196:199], a[44:47]
  ds_read_b128 a[124:127], v241 offset:3072
  v_mfma_f32_16x16x32_bf16 a[60:63], a[168:171], a[196:199], a[60:63]
  buffer_load_dwordx4 v242, s[28:31], s55 offen offset:3072 sc1 lds
  v_mfma_f32_16x16x32_bf16 a[56:59], a[168:171], a[192:195], a[56:59]
  ds_read_b128 a[128:131], v241 offset:4096
  v_mfma_f32_16x16x32_bf16 a[52:55], a[168:171], a[188:191], a[52:55]
  s_add_u32 m0, s57, 49152
  v_mfma_f32_16x16x32_bf16 a[48:51], a[168:171], a[184:187], a[48:51]
  ds_read_b128 a[132:135], v241 offset:5120
  v_mfma_f32_16x16x32_bf16 a[64:67], a[172:175], a[184:187], a[64:67]
  buffer_load_dwordx4 v232, s[16:19], s54 offen offset:0 lds
  v_mfma_f32_16x16x32_bf16 a[68:71], a[172:175], a[188:191], a[68:71]
  ds_read_b128 a[136:139], v241 offset:6144
  v_mfma_f32_16x16x32_bf16 a[72:75], a[172:175], a[192:195], a[72:75]
  s_add_u32 s55, s55, 229376
  v_mfma_f32_16x16x32_bf16 a[76:79], a[172:175], a[196:199], a[76:79]
  buffer_load_dwordx4 v233, s[16:19], s54 offen offset:1024 lds
  v_mfma_f32_16x16x32_bf16 a[92:95], a[176:179], a[196:199], a[92:95]
  v_mfma_f32_16x16x32_bf16 a[88:91], a[176:179], a[192:195], a[88:91]
  v_mfma_f32_16x16x32_bf16 a[84:87], a[176:179], a[188:191], a[84:87]
  buffer_load_dwordx4 v234, s[16:19], s54 offen offset:2048 lds
  v_mfma_f32_16x16x32_bf16 a[80:83], a[176:179], a[184:187], a[80:83]
  v_mfma_f32_16x16x32_bf16 a[96:99], a[180:183], a[184:187], a[96:99]
  v_mfma_f32_16x16x32_bf16 a[100:103], a[180:183], a[188:191], a[100:103]
  buffer_load_dwordx4 v235, s[16:19], s54 offen offset:3072 lds
  v_mfma_f32_16x16x32_bf16 a[104:107], a[180:183], a[192:195], a[104:107]
  s_add_u32 s54, s54, 128
  v_mfma_f32_16x16x32_bf16 a[108:111], a[180:183], a[196:199], a[108:111]
  s_waitcnt vmcnt(16) lgkmcnt(0)
  s_barrier
  v_mfma_f32_32x32x16_bf16 v[16:31], v[136:139], v[120:123], v[80:95]
  ds_read_b128 v[128:131], v172 offset:24576
  v_exp_f32 v0, v0
  v_exp_f32 v1, v1
  v_exp_f32 v2, v2
  v_mfma_f32_32x32x16_bf16 v[16:31], v[140:143], v[124:127], v[16:31]
  ds_read_b128 v[132:135], v172 offset:25088
  v_exp_f32 v3, v3
  v_exp_f32 v4, v4
  v_cvt_pk_bf16_f32 v96, v0, v1
  v_exp_f32 v5, v5
  v_mfma_f32_32x32x16_bf16 v[48:63], v[144:147], v[104:107], v[48:63]
  s_add_u32 m0, s50, 16384
  v_exp_f32 v6, v6
  v_cvt_pk_bf16_f32 v97, v2, v3
  v_exp_f32 v7, v7
  v_exp_f32 v8, v8
  v_cvt_pk_bf16_f32 v98, v4, v5
  v_mfma_f32_32x32x16_bf16 v[48:63], v[148:151], v[108:111], v[48:63]
  buffer_load_dwordx4 v255, s[8:11], s49 offen sc1 lds
  v_exp_f32 v9, v9
  v_exp_f32 v10, v10
  v_cvt_pk_bf16_f32 v99, v6, v7
  v_exp_f32 v11, v11
  v_mfma_f32_16x16x32_bf16 v[164:167], v[168:171], v[104:107], v[164:167]
  buffer_load_dwordx4 v255, s[12:15], s49 offen offset:1024 sc1 lds
  s_add_u32 s49, s49, 4096
  v_exp_f32 v12, v12
  v_cvt_pk_bf16_f32 v100, v8, v9
  v_exp_f32 v13, v13
  v_mfma_f32_16x16x32_bf16 v[164:167], v[168:171], v[108:111], v[164:167]
  s_waitcnt lgkmcnt(0)
  v_exp_f32 v14, v14
  v_cvt_pk_bf16_f32 v101, v10, v11
  v_exp_f32 v15, v15
  v_cvt_pk_bf16_f32 v102, v12, v13
  v_cvt_pk_bf16_f32 v103, v14, v15
  v_mfma_f32_16x16x32_bf16 a[0:3], a[112:115], a[140:143], a[0:3]
  ds_read_b128 a[184:187], v238 offset:32768
  v_mfma_f32_16x16x32_bf16 a[4:7], a[112:115], a[144:147], a[4:7]
  s_add_u32 m0, s57, 65536
  v_mfma_f32_16x16x32_bf16 a[8:11], a[112:115], a[148:151], a[8:11]
  ds_read_b128 a[188:191], v238 offset:33280
  v_mfma_f32_16x16x32_bf16 a[12:15], a[112:115], a[152:155], a[12:15]
  buffer_load_dwordx4 v255, s[28:31], s55 offen offset:0 sc1 lds
  v_mfma_f32_16x16x32_bf16 a[28:31], a[116:119], a[152:155], a[28:31]
  ds_read_b128 a[192:195], v239 offset:32768
  v_mfma_f32_16x16x32_bf16 a[24:27], a[116:119], a[148:151], a[24:27]
  ds_read_b128 a[196:199], v239 offset:33280
  v_mfma_f32_16x16x32_bf16 a[20:23], a[116:119], a[144:147], a[20:23]
  buffer_load_dwordx4 v255, s[28:31], s55 offen offset:1024 sc1 lds
  v_mfma_f32_16x16x32_bf16 a[16:19], a[116:119], a[140:143], a[16:19]
  ds_read_b128 a[156:159], v241 offset:32768
  v_mfma_f32_16x16x32_bf16 a[32:35], a[120:123], a[140:143], a[32:35]
  ds_read_b128 a[160:163], v241 offset:33792
  v_mfma_f32_16x16x32_bf16 a[36:39], a[120:123], a[144:147], a[36:39]
  buffer_load_dwordx4 v255, s[28:31], s55 offen offset:2048 sc1 lds
  v_mfma_f32_16x16x32_bf16 a[40:43], a[120:123], a[148:151], a[40:43]
  ds_read_b128 a[164:167], v241 offset:34816
  v_mfma_f32_16x16x32_bf16 a[44:47], a[120:123], a[152:155], a[44:47]
  ds_read_b128 a[168:171], v241 offset:35840
  v_mfma_f32_16x16x32_bf16 a[60:63], a[124:127], a[152:155], a[60:63]
  buffer_load_dwordx4 v242, s[28:31], s55 offen offset:3072 sc1 lds
  v_mfma_f32_16x16x32_bf16 a[56:59], a[124:127], a[148:151], a[56:59]
  ds_read_b128 a[172:175], v241 offset:36864
  v_mfma_f32_16x16x32_bf16 a[52:55], a[124:127], a[144:147], a[52:55]
  s_add_u32 m0, s57, 81920
  v_mfma_f32_16x16x32_bf16 a[48:51], a[124:127], a[140:143], a[48:51]
  ds_read_b128 a[176:179], v241 offset:37888
  v_mfma_f32_16x16x32_bf16 a[64:67], a[128:131], a[140:143], a[64:67]
  buffer_load_dwordx4 v232, s[16:19], s54 offen offset:0 lds
  v_mfma_f32_16x16x32_bf16 a[68:71], a[128:131], a[144:147], a[68:71]
  ds_read_b128 a[180:183], v241 offset:38912
  v_mfma_f32_16x16x32_bf16 a[72:75], a[128:131], a[148:151], a[72:75]
  s_add_u32 s55, s55, 229376
  v_mfma_f32_16x16x32_bf16 a[76:79], a[128:131], a[152:155], a[76:79]
  buffer_load_dwordx4 v233, s[16:19], s54 offen offset:1024 lds
  v_mfma_f32_16x16x32_bf16 a[92:95], a[132:135], a[152:155], a[92:95]
  v_mfma_f32_16x16x32_bf16 a[88:91], a[132:135], a[148:151], a[88:91]
  v_mfma_f32_16x16x32_bf16 a[84:87], a[132:135], a[144:147], a[84:87]
  buffer_load_dwordx4 v234, s[16:19], s54 offen offset:2048 lds
  v_mfma_f32_16x16x32_bf16 a[80:83], a[132:135], a[140:143], a[80:83]
  v_mfma_f32_16x16x32_bf16 a[96:99], a[136:139], a[140:143], a[96:99]
  v_mfma_f32_16x16x32_bf16 a[100:103], a[136:139], a[144:147], a[100:103]
  buffer_load_dwordx4 v235, s[16:19], s54 offen offset:3072 lds
  v_mfma_f32_16x16x32_bf16 a[104:107], a[136:139], a[148:151], a[104:107]
  s_add_u32 s54, s54, 128
  v_mfma_f32_16x16x32_bf16 a[108:111], a[136:139], a[152:155], a[108:111]
  s_waitcnt vmcnt(18) lgkmcnt(0)
  s_barrier
  v_mfma_f32_16x16x32_bf16 a[0:3], a[156:159], a[184:187], a[0:3]
  ds_read_b128 a[140:143], v236 offset:0
  v_mfma_f32_16x16x32_bf16 a[4:7], a[156:159], a[188:191], a[4:7]
  s_add_u32 m0, s57, 98304
  v_mfma_f32_16x16x32_bf16 a[8:11], a[156:159], a[192:195], a[8:11]
  ds_read_b128 a[144:147], v236 offset:512
  v_mfma_f32_16x16x32_bf16 a[12:15], a[156:159], a[196:199], a[12:15]
  buffer_load_dwordx4 v255, s[28:31], s55 offen offset:0 sc1 lds
  v_mfma_f32_16x16x32_bf16 a[28:31], a[160:163], a[196:199], a[28:31]
  ds_read_b128 a[148:151], v237 offset:0
  v_mfma_f32_16x16x32_bf16 a[24:27], a[160:163], a[192:195], a[24:27]
  ds_read_b128 a[152:155], v237 offset:512
  v_mfma_f32_16x16x32_bf16 a[20:23], a[160:163], a[188:191], a[20:23]
  buffer_load_dwordx4 v255, s[28:31], s55 offen offset:1024 sc1 lds
  v_mfma_f32_16x16x32_bf16 a[16:19], a[160:163], a[184:187], a[16:19]
  ds_read_b128 a[112:115], v240 offset:0
  v_mfma_f32_16x16x32_bf16 a[32:35], a[164:167], a[184:187], a[32:35]
  ds_read_b128 a[116:119], v240 offset:1024
  v_mfma_f32_16x16x32_bf16 a[36:39], a[164:167], a[188:191], a[36:39]
  buffer_load_dwordx4 v255, s[28:31], s55 offen offset:2048 sc1 lds
  v_mfma_f32_16x16x32_bf16 a[40:43], a[164:167], a[192:195], a[40:43]
  ds_read_b128 a[120:123], v240 offset:2048
  v_mfma_f32_16x16x32_bf16 a[44:47], a[164:167], a[196:199], a[44:47]
  ds_read_b128 a[124:127], v240 offset:3072
  v_mfma_f32_16x16x32_bf16 a[60:63], a[168:171], a[196:199], a[60:63]
  buffer_load_dwordx4 v242, s[28:31], s55 offen offset:3072 sc1 lds
  v_mfma_f32_16x16x32_bf16 a[56:59], a[168:171], a[192:195], a[56:59]
  ds_read_b128 a[128:131], v240 offset:4096
  v_mfma_f32_16x16x32_bf16 a[52:55], a[168:171], a[188:191], a[52:55]
  s_add_u32 m0, s57, 114688
  v_mfma_f32_16x16x32_bf16 a[48:51], a[168:171], a[184:187], a[48:51]
  ds_read_b128 a[132:135], v240 offset:5120
  v_mfma_f32_16x16x32_bf16 a[64:67], a[172:175], a[184:187], a[64:67]
  buffer_load_dwordx4 v232, s[16:19], s54 offen offset:0 lds
  v_mfma_f32_16x16x32_bf16 a[68:71], a[172:175], a[188:191], a[68:71]
  ds_read_b128 a[136:139], v240 offset:6144
  v_mfma_f32_16x16x32_bf16 a[72:75], a[172:175], a[192:195], a[72:75]
  s_add_u32 s55, s55, 229376
  v_mfma_f32_16x16x32_bf16 a[76:79], a[172:175], a[196:199], a[76:79]
  buffer_load_dwordx4 v233, s[16:19], s54 offen offset:1024 lds
  v_mfma_f32_16x16x32_bf16 a[92:95], a[176:179], a[196:199], a[92:95]
  v_mfma_f32_16x16x32_bf16 a[88:91], a[176:179], a[192:195], a[88:91]
  v_mfma_f32_16x16x32_bf16 a[84:87], a[176:179], a[188:191], a[84:87]
  buffer_load_dwordx4 v234, s[16:19], s54 offen offset:2048 lds
  v_mfma_f32_16x16x32_bf16 a[80:83], a[176:179], a[184:187], a[80:83]
  v_mfma_f32_16x16x32_bf16 a[96:99], a[180:183], a[184:187], a[96:99]
  v_mfma_f32_16x16x32_bf16 a[100:103], a[180:183], a[188:191], a[100:103]
  buffer_load_dwordx4 v235, s[16:19], s54 offen offset:3072 lds
  v_mfma_f32_16x16x32_bf16 a[104:107], a[180:183], a[192:195], a[104:107]
  s_add_u32 s54, s54, 128
  v_mfma_f32_16x16x32_bf16 a[108:111], a[180:183], a[196:199], a[108:111]
  s_waitcnt vmcnt(18) lgkmcnt(0)
  s_barrier
  v_mfma_f32_32x32x16_bf16 v[0:15], v[128:131], v[112:115], v[64:79]
  ds_read_b128 v[144:147], v172 offset:25600
  v_exp_f32 v16, v16
  v_exp_f32 v17, v17
  v_exp_f32 v18, v18
  v_mfma_f32_32x32x16_bf16 v[0:15], v[132:135], v[116:119], v[0:15]
  ds_read_b128 v[148:151], v172 offset:26112
  v_exp_f32 v19, v19
  v_exp_f32 v20, v20
  v_cvt_pk_bf16_f32 v104, v16, v17
  v_exp_f32 v21, v21
  v_mfma_f32_32x32x16_bf16 v[32:47], v[152:155], v[96:99], v[32:47]
  v_exp_f32 v22, v22
  v_cvt_pk_bf16_f32 v105, v18, v19
  v_exp_f32 v23, v23
  v_exp_f32 v24, v24
  v_cvt_pk_bf16_f32 v106, v20, v21
  v_mfma_f32_32x32x16_bf16 v[32:47], v[156:159], v[100:103], v[32:47]
  v_exp_f32 v25, v25
  v_exp_f32 v26, v26
  v_cvt_pk_bf16_f32 v107, v22, v23
  v_exp_f32 v27, v27
  v_mfma_f32_16x16x32_bf16 v[160:163], v[168:171], v[96:99], v[160:163]
  v_exp_f32 v28, v28
  v_cvt_pk_bf16_f32 v108, v24, v25
  v_exp_f32 v29, v29
  v_mfma_f32_16x16x32_bf16 v[160:163], v[168:171], v[100:103], v[160:163]
  s_waitcnt lgkmcnt(0)
  v_exp_f32 v30, v30
  v_cvt_pk_bf16_f32 v109, v26, v27
  v_exp_f32 v31, v31
  v_cvt_pk_bf16_f32 v110, v28, v29
  v_cvt_pk_bf16_f32 v111, v30, v31
  v_mfma_f32_16x16x32_bf16 a[0:3], a[112:115], a[140:143], a[0:3]
  ds_read_b128 a[184:187], v236 offset:32768
  v_mfma_f32_16x16x32_bf16 a[4:7], a[112:115], a[144:147], a[4:7]
  s_add_u32 m0, s57, 0
  v_mfma_f32_16x16x32_bf16 a[8:11], a[112:115], a[148:151], a[8:11]
  ds_read_b128 a[188:191], v236 offset:33280
  v_mfma_f32_16x16x32_bf16 a[12:15], a[112:115], a[152:155], a[12:15]
  buffer_load_dwordx4 v255, s[28:31], s55 offen offset:0 sc1 lds
  v_mfma_f32_16x16x32_bf16 a[28:31], a[116:119], a[152:155], a[28:31]
  ds_read_b128 a[192:195], v237 offset:32768
  v_mfma_f32_16x16x32_bf16 a[24:27], a[116:119], a[148:151], a[24:27]
  ds_read_b128 a[196:199], v237 offset:33280
  v_mfma_f32_16x16x32_bf16 a[20:23], a[116:119], a[144:147], a[20:23]
  buffer_load_dwordx4 v255, s[28:31], s55 offen offset:1024 sc1 lds
  v_mfma_f32_16x16x32_bf16 a[16:19], a[116:119], a[140:143], a[16:19]
  ds_read_b128 a[156:159], v240 offset:32768
  v_mfma_f32_16x16x32_bf16 a[32:35], a[120:123], a[140:143], a[32:35]
  ds_read_b128 a[160:163], v240 offset:33792
  v_mfma_f32_16x16x32_bf16 a[36:39], a[120:123], a[144:147], a[36:39]
  buffer_load_dwordx4 v255, s[28:31], s55 offen offset:2048 sc1 lds
  v_mfma_f32_16x16x32_bf16 a[40:43], a[120:123], a[148:151], a[40:43]
  ds_read_b128 a[164:167], v240 offset:34816
  v_mfma_f32_16x16x32_bf16 a[44:47], a[120:123], a[152:155], a[44:47]
  ds_read_b128 a[168:171], v240 offset:35840
  v_mfma_f32_16x16x32_bf16 a[60:63], a[124:127], a[152:155], a[60:63]
  buffer_load_dwordx4 v242, s[28:31], s55 offen offset:3072 sc1 lds
  v_mfma_f32_16x16x32_bf16 a[56:59], a[124:127], a[148:151], a[56:59]
  ds_read_b128 a[172:175], v240 offset:36864
  v_mfma_f32_16x16x32_bf16 a[52:55], a[124:127], a[144:147], a[52:55]
  s_add_u32 m0, s57, 16384
  v_mfma_f32_16x16x32_bf16 a[48:51], a[124:127], a[140:143], a[48:51]
  ds_read_b128 a[176:179], v240 offset:37888
  v_mfma_f32_16x16x32_bf16 a[64:67], a[128:131], a[140:143], a[64:67]
  buffer_load_dwordx4 v232, s[16:19], s54 offen offset:0 lds
  v_mfma_f32_16x16x32_bf16 a[68:71], a[128:131], a[144:147], a[68:71]
  ds_read_b128 a[180:183], v240 offset:38912
  v_mfma_f32_16x16x32_bf16 a[72:75], a[128:131], a[148:151], a[72:75]
  s_add_u32 s55, s55, 229376
  v_mfma_f32_16x16x32_bf16 a[76:79], a[128:131], a[152:155], a[76:79]
  buffer_load_dwordx4 v233, s[16:19], s54 offen offset:1024 lds
  v_mfma_f32_16x16x32_bf16 a[92:95], a[132:135], a[152:155], a[92:95]
  v_mfma_f32_16x16x32_bf16 a[88:91], a[132:135], a[148:151], a[88:91]
  v_mfma_f32_16x16x32_bf16 a[84:87], a[132:135], a[144:147], a[84:87]
  buffer_load_dwordx4 v234, s[16:19], s54 offen offset:2048 lds
  v_mfma_f32_16x16x32_bf16 a[80:83], a[132:135], a[140:143], a[80:83]
  v_mfma_f32_16x16x32_bf16 a[96:99], a[136:139], a[140:143], a[96:99]
  v_mfma_f32_16x16x32_bf16 a[100:103], a[136:139], a[144:147], a[100:103]
  buffer_load_dwordx4 v235, s[16:19], s54 offen offset:3072 lds
  v_mfma_f32_16x16x32_bf16 a[104:107], a[136:139], a[148:151], a[104:107]
  s_add_u32 s54, s54, 128
  v_mfma_f32_16x16x32_bf16 a[108:111], a[136:139], a[152:155], a[108:111]
  s_waitcnt vmcnt(16) lgkmcnt(0)
  s_barrier
  v_mfma_f32_16x16x32_bf16 a[0:3], a[156:159], a[184:187], a[0:3]
  ds_read_b128 a[140:143], v238 offset:0
  v_mfma_f32_16x16x32_bf16 a[4:7], a[156:159], a[188:191], a[4:7]
  s_add_u32 m0, s57, 32768
  v_mfma_f32_16x16x32_bf16 a[8:11], a[156:159], a[192:195], a[8:11]
  ds_read_b128 a[144:147], v238 offset:512
  v_mfma_f32_16x16x32_bf16 a[12:15], a[156:159], a[196:199], a[12:15]
  buffer_load_dwordx4 v255, s[28:31], s55 offen offset:0 sc1 lds
  v_mfma_f32_16x16x32_bf16 a[28:31], a[160:163], a[196:199], a[28:31]
  ds_read_b128 a[148:151], v239 offset:0
  v_mfma_f32_16x16x32_bf16 a[24:27], a[160:163], a[192:195], a[24:27]
  ds_read_b128 a[152:155], v239 offset:512
  v_mfma_f32_16x16x32_bf16 a[20:23], a[160:163], a[188:191], a[20:23]
  buffer_load_dwordx4 v255, s[28:31], s55 offen offset:1024 sc1 lds
  v_mfma_f32_16x16x32_bf16 a[16:19], a[160:163], a[184:187], a[16:19]
  ds_read_b128 a[112:115], v241 offset:0
  v_mfma_f32_16x16x32_bf16 a[32:35], a[164:167], a[184:187], a[32:35]
  ds_read_b128 a[116:119], v241 offset:1024
  v_mfma_f32_16x16x32_bf16 a[36:39], a[164:167], a[188:191], a[36:39]
  buffer_load_dwordx4 v255, s[28:31], s55 offen offset:2048 sc1 lds
  v_mfma_f32_16x16x32_bf16 a[40:43], a[164:167], a[192:195], a[40:43]
  ds_read_b128 a[120:123], v241 offset:2048
  v_mfma_f32_16x16x32_bf16 a[44:47], a[164:167], a[196:199], a[44:47]
  ds_read_b128 a[124:127], v241 offset:3072
  v_mfma_f32_16x16x32_bf16 a[60:63], a[168:171], a[196:199], a[60:63]
  buffer_load_dwordx4 v242, s[28:31], s55 offen offset:3072 sc1 lds
  v_mfma_f32_16x16x32_bf16 a[56:59], a[168:171], a[192:195], a[56:59]
  ds_read_b128 a[128:131], v241 offset:4096
  v_mfma_f32_16x16x32_bf16 a[52:55], a[168:171], a[188:191], a[52:55]
  s_add_u32 m0, s57, 49152
  v_mfma_f32_16x16x32_bf16 a[48:51], a[168:171], a[184:187], a[48:51]
  ds_read_b128 a[132:135], v241 offset:5120
  v_mfma_f32_16x16x32_bf16 a[64:67], a[172:175], a[184:187], a[64:67]
  buffer_load_dwordx4 v232, s[16:19], s54 offen offset:0 lds
  v_mfma_f32_16x16x32_bf16 a[68:71], a[172:175], a[188:191], a[68:71]
  ds_read_b128 a[136:139], v241 offset:6144
  v_mfma_f32_16x16x32_bf16 a[72:75], a[172:175], a[192:195], a[72:75]
  s_add_u32 s55, s55, 229376
  v_mfma_f32_16x16x32_bf16 a[76:79], a[172:175], a[196:199], a[76:79]
  buffer_load_dwordx4 v233, s[16:19], s54 offen offset:1024 lds
  v_mfma_f32_16x16x32_bf16 a[92:95], a[176:179], a[196:199], a[92:95]
  v_mfma_f32_16x16x32_bf16 a[88:91], a[176:179], a[192:195], a[88:91]
  v_mfma_f32_16x16x32_bf16 a[84:87], a[176:179], a[188:191], a[84:87]
  buffer_load_dwordx4 v234, s[16:19], s54 offen offset:2048 lds
  v_mfma_f32_16x16x32_bf16 a[80:83], a[176:179], a[184:187], a[80:83]
  v_mfma_f32_16x16x32_bf16 a[96:99], a[180:183], a[184:187], a[96:99]
  v_mfma_f32_16x16x32_bf16 a[100:103], a[180:183], a[188:191], a[100:103]
  buffer_load_dwordx4 v235, s[16:19], s54 offen offset:3072 lds
  v_mfma_f32_16x16x32_bf16 a[104:107], a[180:183], a[192:195], a[104:107]
  s_add_u32 s54, s54, 128
  v_mfma_f32_16x16x32_bf16 a[108:111], a[180:183], a[196:199], a[108:111]
  s_waitcnt vmcnt(16) lgkmcnt(0)
  s_barrier
  v_mfma_f32_32x32x16_bf16 v[16:31], v[128:131], v[120:123], v[80:95]
  ds_read_b128 v[136:139], v172 offset:28672
  v_exp_f32 v0, v0
  v_exp_f32 v1, v1
  v_exp_f32 v2, v2
  v_mfma_f32_32x32x16_bf16 v[16:31], v[132:135], v[124:127], v[16:31]
  ds_read_b128 v[140:143], v172 offset:29184
  v_exp_f32 v3, v3
  v_exp_f32 v4, v4
  v_cvt_pk_bf16_f32 v96, v0, v1
  v_exp_f32 v5, v5
  v_mfma_f32_32x32x16_bf16 v[48:63], v[152:155], v[104:107], v[48:63]
  v_exp_f32 v6, v6
  v_cvt_pk_bf16_f32 v97, v2, v3
  v_exp_f32 v7, v7
  v_exp_f32 v8, v8
  v_cvt_pk_bf16_f32 v98, v4, v5
  v_mfma_f32_32x32x16_bf16 v[48:63], v[156:159], v[108:111], v[48:63]
  v_exp_f32 v9, v9
  v_exp_f32 v10, v10
  v_cvt_pk_bf16_f32 v99, v6, v7
  v_exp_f32 v11, v11
  v_mfma_f32_16x16x32_bf16 v[164:167], v[168:171], v[104:107], v[164:167]
  v_exp_f32 v12, v12
  v_cvt_pk_bf16_f32 v100, v8, v9
  v_exp_f32 v13, v13
  v_mfma_f32_16x16x32_bf16 v[164:167], v[168:171], v[108:111], v[164:167]
  s_waitcnt lgkmcnt(0)
  v_exp_f32 v14, v14
  v_cvt_pk_bf16_f32 v101, v10, v11
  v_exp_f32 v15, v15
  v_cvt_pk_bf16_f32 v102, v12, v13
  v_cvt_pk_bf16_f32 v103, v14, v15
  v_mfma_f32_16x16x32_bf16 a[0:3], a[112:115], a[140:143], a[0:3]
  ds_read_b128 a[184:187], v238 offset:32768
  v_mfma_f32_16x16x32_bf16 a[4:7], a[112:115], a[144:147], a[4:7]
  s_add_u32 m0, s57, 65536
  v_mfma_f32_16x16x32_bf16 a[8:11], a[112:115], a[148:151], a[8:11]
  ds_read_b128 a[188:191], v238 offset:33280
  v_mfma_f32_16x16x32_bf16 a[12:15], a[112:115], a[152:155], a[12:15]
  buffer_load_dwordx4 v255, s[28:31], s55 offen offset:0 sc1 lds
  v_mfma_f32_16x16x32_bf16 a[28:31], a[116:119], a[152:155], a[28:31]
  ds_read_b128 a[192:195], v239 offset:32768
  v_mfma_f32_16x16x32_bf16 a[24:27], a[116:119], a[148:151], a[24:27]
  ds_read_b128 a[196:199], v239 offset:33280
  v_mfma_f32_16x16x32_bf16 a[20:23], a[116:119], a[144:147], a[20:23]
  buffer_load_dwordx4 v255, s[28:31], s55 offen offset:1024 sc1 lds
  v_mfma_f32_16x16x32_bf16 a[16:19], a[116:119], a[140:143], a[16:19]
  ds_read_b128 a[156:159], v241 offset:32768
  v_mfma_f32_16x16x32_bf16 a[32:35], a[120:123], a[140:143], a[32:35]
  ds_read_b128 a[160:163], v241 offset:33792
  v_mfma_f32_16x16x32_bf16 a[36:39], a[120:123], a[144:147], a[36:39]
  buffer_load_dwordx4 v255, s[28:31], s55 offen offset:2048 sc1 lds
  v_mfma_f32_16x16x32_bf16 a[40:43], a[120:123], a[148:151], a[40:43]
  ds_read_b128 a[164:167], v241 offset:34816
  v_mfma_f32_16x16x32_bf16 a[44:47], a[120:123], a[152:155], a[44:47]
  ds_read_b128 a[168:171], v241 offset:35840
  v_mfma_f32_16x16x32_bf16 a[60:63], a[124:127], a[152:155], a[60:63]
  buffer_load_dwordx4 v242, s[28:31], s55 offen offset:3072 sc1 lds
  v_mfma_f32_16x16x32_bf16 a[56:59], a[124:127], a[148:151], a[56:59]
  ds_read_b128 a[172:175], v241 offset:36864
  v_mfma_f32_16x16x32_bf16 a[52:55], a[124:127], a[144:147], a[52:55]
  s_add_u32 m0, s57, 81920
  v_mfma_f32_16x16x32_bf16 a[48:51], a[124:127], a[140:143], a[48:51]
  ds_read_b128 a[176:179], v241 offset:37888
  v_mfma_f32_16x16x32_bf16 a[64:67], a[128:131], a[140:143], a[64:67]
  buffer_load_dwordx4 v232, s[16:19], s54 offen offset:0 lds
  v_mfma_f32_16x16x32_bf16 a[68:71], a[128:131], a[144:147], a[68:71]
  ds_read_b128 a[180:183], v241 offset:38912
  v_mfma_f32_16x16x32_bf16 a[72:75], a[128:131], a[148:151], a[72:75]
  s_add_u32 s55, s55, 229376
  v_mfma_f32_16x16x32_bf16 a[76:79], a[128:131], a[152:155], a[76:79]
  buffer_load_dwordx4 v233, s[16:19], s54 offen offset:1024 lds
  v_mfma_f32_16x16x32_bf16 a[92:95], a[132:135], a[152:155], a[92:95]
  v_mfma_f32_16x16x32_bf16 a[88:91], a[132:135], a[148:151], a[88:91]
  v_mfma_f32_16x16x32_bf16 a[84:87], a[132:135], a[144:147], a[84:87]
  buffer_load_dwordx4 v234, s[16:19], s54 offen offset:2048 lds
  v_mfma_f32_16x16x32_bf16 a[80:83], a[132:135], a[140:143], a[80:83]
  v_mfma_f32_16x16x32_bf16 a[96:99], a[136:139], a[140:143], a[96:99]
  v_mfma_f32_16x16x32_bf16 a[100:103], a[136:139], a[144:147], a[100:103]
  buffer_load_dwordx4 v235, s[16:19], s54 offen offset:3072 lds
  v_mfma_f32_16x16x32_bf16 a[104:107], a[136:139], a[148:151], a[104:107]
  s_add_u32 s54, s54, 128
  v_mfma_f32_16x16x32_bf16 a[108:111], a[136:139], a[152:155], a[108:111]
  s_waitcnt vmcnt(16) lgkmcnt(0)
  s_barrier
  v_mfma_f32_16x16x32_bf16 a[0:3], a[156:159], a[184:187], a[0:3]
  ds_read_b128 a[140:143], v236 offset:0
  v_mfma_f32_16x16x32_bf16 a[4:7], a[156:159], a[188:191], a[4:7]
  s_add_u32 m0, s57, 98304
  v_mfma_f32_16x16x32_bf16 a[8:11], a[156:159], a[192:195], a[8:11]
  ds_read_b128 a[144:147], v236 offset:512
  v_mfma_f32_16x16x32_bf16 a[12:15], a[156:159], a[196:199], a[12:15]
  buffer_load_dwordx4 v255, s[28:31], s55 offen offset:0 sc1 lds
  v_mfma_f32_16x16x32_bf16 a[28:31], a[160:163], a[196:199], a[28:31]
  ds_read_b128 a[148:151], v237 offset:0
  v_mfma_f32_16x16x32_bf16 a[24:27], a[160:163], a[192:195], a[24:27]
  ds_read_b128 a[152:155], v237 offset:512
  v_mfma_f32_16x16x32_bf16 a[20:23], a[160:163], a[188:191], a[20:23]
  buffer_load_dwordx4 v255, s[28:31], s55 offen offset:1024 sc1 lds
  v_mfma_f32_16x16x32_bf16 a[16:19], a[160:163], a[184:187], a[16:19]
  ds_read_b128 a[112:115], v240 offset:0
  v_mfma_f32_16x16x32_bf16 a[32:35], a[164:167], a[184:187], a[32:35]
  ds_read_b128 a[116:119], v240 offset:1024
  v_mfma_f32_16x16x32_bf16 a[36:39], a[164:167], a[188:191], a[36:39]
  buffer_load_dwordx4 v255, s[28:31], s55 offen offset:2048 sc1 lds
  v_mfma_f32_16x16x32_bf16 a[40:43], a[164:167], a[192:195], a[40:43]
  ds_read_b128 a[120:123], v240 offset:2048
  v_mfma_f32_16x16x32_bf16 a[44:47], a[164:167], a[196:199], a[44:47]
  ds_read_b128 a[124:127], v240 offset:3072
  v_mfma_f32_16x16x32_bf16 a[60:63], a[168:171], a[196:199], a[60:63]
  buffer_load_dwordx4 v242, s[28:31], s55 offen offset:3072 sc1 lds
  v_mfma_f32_16x16x32_bf16 a[56:59], a[168:171], a[192:195], a[56:59]
  ds_read_b128 a[128:131], v240 offset:4096
  v_mfma_f32_16x16x32_bf16 a[52:55], a[168:171], a[188:191], a[52:55]
  s_add_u32 m0, s57, 114688
  v_mfma_f32_16x16x32_bf16 a[48:51], a[168:171], a[184:187], a[48:51]
  ds_read_b128 a[132:135], v240 offset:5120
  v_mfma_f32_16x16x32_bf16 a[64:67], a[172:175], a[184:187], a[64:67]
  buffer_load_dwordx4 v232, s[16:19], s54 offen offset:0 lds
  v_mfma_f32_16x16x32_bf16 a[68:71], a[172:175], a[188:191], a[68:71]
  ds_read_b128 a[136:139], v240 offset:6144
  v_mfma_f32_16x16x32_bf16 a[72:75], a[172:175], a[192:195], a[72:75]
  s_add_u32 s55, s55, 229376
  v_mfma_f32_16x16x32_bf16 a[76:79], a[172:175], a[196:199], a[76:79]
  buffer_load_dwordx4 v233, s[16:19], s54 offen offset:1024 lds
  v_mfma_f32_16x16x32_bf16 a[92:95], a[176:179], a[196:199], a[92:95]
  v_mfma_f32_16x16x32_bf16 a[88:91], a[176:179], a[192:195], a[88:91]
  v_mfma_f32_16x16x32_bf16 a[84:87], a[176:179], a[188:191], a[84:87]
  buffer_load_dwordx4 v234, s[16:19], s54 offen offset:2048 lds
  v_mfma_f32_16x16x32_bf16 a[80:83], a[176:179], a[184:187], a[80:83]
  v_mfma_f32_16x16x32_bf16 a[96:99], a[180:183], a[184:187], a[96:99]
  v_mfma_f32_16x16x32_bf16 a[100:103], a[180:183], a[188:191], a[100:103]
  buffer_load_dwordx4 v235, s[16:19], s54 offen offset:3072 lds
  v_mfma_f32_16x16x32_bf16 a[104:107], a[180:183], a[192:195], a[104:107]
  s_add_u32 s54, s54, 128
  v_mfma_f32_16x16x32_bf16 a[108:111], a[180:183], a[196:199], a[108:111]
  s_waitcnt vmcnt(16) lgkmcnt(0)
  s_barrier
  v_mfma_f32_32x32x16_bf16 v[0:15], v[136:139], v[112:115], v[64:79]
  ds_read_b128 v[152:155], v172 offset:29696
  v_exp_f32 v16, v16
  v_exp_f32 v17, v17
  v_exp_f32 v18, v18
  v_mfma_f32_32x32x16_bf16 v[0:15], v[140:143], v[116:119], v[0:15]
  ds_read_b128 v[156:159], v172 offset:30208
  v_exp_f32 v19, v19
  v_exp_f32 v20, v20
  v_cvt_pk_bf16_f32 v104, v16, v17
  v_exp_f32 v21, v21
  v_mfma_f32_32x32x16_bf16 v[32:47], v[144:147], v[96:99], v[32:47]
  v_exp_f32 v22, v22
  v_cvt_pk_bf16_f32 v105, v18, v19
  v_exp_f32 v23, v23
  v_exp_f32 v24, v24
  v_cvt_pk_bf16_f32 v106, v20, v21
  v_mfma_f32_32x32x16_bf16 v[32:47], v[148:151], v[100:103], v[32:47]
  v_exp_f32 v25, v25
  v_exp_f32 v26, v26
  v_cvt_pk_bf16_f32 v107, v22, v23
  v_exp_f32 v27, v27
  v_mfma_f32_16x16x32_bf16 v[160:163], v[168:171], v[96:99], v[160:163]
  v_exp_f32 v28, v28
  v_cvt_pk_bf16_f32 v108, v24, v25
  v_exp_f32 v29, v29
  v_mfma_f32_16x16x32_bf16 v[160:163], v[168:171], v[100:103], v[160:163]
  s_waitcnt lgkmcnt(0)
  v_exp_f32 v30, v30
  v_cvt_pk_bf16_f32 v109, v26, v27
  v_exp_f32 v31, v31
  v_cvt_pk_bf16_f32 v110, v28, v29
  v_cvt_pk_bf16_f32 v111, v30, v31
  v_mfma_f32_16x16x32_bf16 a[0:3], a[112:115], a[140:143], a[0:3]
  ds_read_b128 a[184:187], v236 offset:32768
  v_mfma_f32_16x16x32_bf16 a[4:7], a[112:115], a[144:147], a[4:7]
  s_add_u32 m0, s57, 0
  v_mfma_f32_16x16x32_bf16 a[8:11], a[112:115], a[148:151], a[8:11]
  ds_read_b128 a[188:191], v236 offset:33280
  v_mfma_f32_16x16x32_bf16 a[12:15], a[112:115], a[152:155], a[12:15]
  buffer_load_dwordx4 v255, s[28:31], s55 offen offset:0 sc1 lds
  v_mfma_f32_16x16x32_bf16 a[28:31], a[116:119], a[152:155], a[28:31]
  ds_read_b128 a[192:195], v237 offset:32768
  v_mfma_f32_16x16x32_bf16 a[24:27], a[116:119], a[148:151], a[24:27]
  ds_read_b128 a[196:199], v237 offset:33280
  v_mfma_f32_16x16x32_bf16 a[20:23], a[116:119], a[144:147], a[20:23]
  buffer_load_dwordx4 v255, s[28:31], s55 offen offset:1024 sc1 lds
  v_mfma_f32_16x16x32_bf16 a[16:19], a[116:119], a[140:143], a[16:19]
  ds_read_b128 a[156:159], v240 offset:32768
  v_mfma_f32_16x16x32_bf16 a[32:35], a[120:123], a[140:143], a[32:35]
  ds_read_b128 a[160:163], v240 offset:33792
  v_mfma_f32_16x16x32_bf16 a[36:39], a[120:123], a[144:147], a[36:39]
  buffer_load_dwordx4 v255, s[28:31], s55 offen offset:2048 sc1 lds
  v_mfma_f32_16x16x32_bf16 a[40:43], a[120:123], a[148:151], a[40:43]
  ds_read_b128 a[164:167], v240 offset:34816
  v_mfma_f32_16x16x32_bf16 a[44:47], a[120:123], a[152:155], a[44:47]
  ds_read_b128 a[168:171], v240 offset:35840
  v_mfma_f32_16x16x32_bf16 a[60:63], a[124:127], a[152:155], a[60:63]
  buffer_load_dwordx4 v242, s[28:31], s55 offen offset:3072 sc1 lds
  v_mfma_f32_16x16x32_bf16 a[56:59], a[124:127], a[148:151], a[56:59]
  ds_read_b128 a[172:175], v240 offset:36864
  v_mfma_f32_16x16x32_bf16 a[52:55], a[124:127], a[144:147], a[52:55]
  s_add_u32 m0, s57, 16384
  v_mfma_f32_16x16x32_bf16 a[48:51], a[124:127], a[140:143], a[48:51]
  ds_read_b128 a[176:179], v240 offset:37888
  v_mfma_f32_16x16x32_bf16 a[64:67], a[128:131], a[140:143], a[64:67]
  buffer_load_dwordx4 v232, s[16:19], s54 offen offset:0 lds
  v_mfma_f32_16x16x32_bf16 a[68:71], a[128:131], a[144:147], a[68:71]
  ds_read_b128 a[180:183], v240 offset:38912
  v_mfma_f32_16x16x32_bf16 a[72:75], a[128:131], a[148:151], a[72:75]
  s_add_u32 s55, s55, 229376
  v_mfma_f32_16x16x32_bf16 a[76:79], a[128:131], a[152:155], a[76:79]
  buffer_load_dwordx4 v233, s[16:19], s54 offen offset:1024 lds
  v_mfma_f32_16x16x32_bf16 a[92:95], a[132:135], a[152:155], a[92:95]
  v_mfma_f32_16x16x32_bf16 a[88:91], a[132:135], a[148:151], a[88:91]
  v_mfma_f32_16x16x32_bf16 a[84:87], a[132:135], a[144:147], a[84:87]
  buffer_load_dwordx4 v234, s[16:19], s54 offen offset:2048 lds
  v_mfma_f32_16x16x32_bf16 a[80:83], a[132:135], a[140:143], a[80:83]
  v_mfma_f32_16x16x32_bf16 a[96:99], a[136:139], a[140:143], a[96:99]
  v_mfma_f32_16x16x32_bf16 a[100:103], a[136:139], a[144:147], a[100:103]
  buffer_load_dwordx4 v235, s[16:19], s54 offen offset:3072 lds
  v_mfma_f32_16x16x32_bf16 a[104:107], a[136:139], a[148:151], a[104:107]
  s_add_u32 s54, s54, 128
  v_mfma_f32_16x16x32_bf16 a[108:111], a[136:139], a[152:155], a[108:111]
  s_waitcnt vmcnt(16) lgkmcnt(0)
  s_barrier
  v_mfma_f32_16x16x32_bf16 a[0:3], a[156:159], a[184:187], a[0:3]
  ds_read_b128 a[140:143], v238 offset:0
  v_mfma_f32_16x16x32_bf16 a[4:7], a[156:159], a[188:191], a[4:7]
  s_add_u32 m0, s57, 32768
  v_mfma_f32_16x16x32_bf16 a[8:11], a[156:159], a[192:195], a[8:11]
  ds_read_b128 a[144:147], v238 offset:512
  v_mfma_f32_16x16x32_bf16 a[12:15], a[156:159], a[196:199], a[12:15]
  buffer_load_dwordx4 v255, s[28:31], s55 offen offset:0 sc1 lds
  v_mfma_f32_16x16x32_bf16 a[28:31], a[160:163], a[196:199], a[28:31]
  ds_read_b128 a[148:151], v239 offset:0
  v_mfma_f32_16x16x32_bf16 a[24:27], a[160:163], a[192:195], a[24:27]
  ds_read_b128 a[152:155], v239 offset:512
  v_mfma_f32_16x16x32_bf16 a[20:23], a[160:163], a[188:191], a[20:23]
  buffer_load_dwordx4 v255, s[28:31], s55 offen offset:1024 sc1 lds
  v_mfma_f32_16x16x32_bf16 a[16:19], a[160:163], a[184:187], a[16:19]
  ds_read_b128 a[112:115], v241 offset:0
  v_mfma_f32_16x16x32_bf16 a[32:35], a[164:167], a[184:187], a[32:35]
  ds_read_b128 a[116:119], v241 offset:1024
  v_mfma_f32_16x16x32_bf16 a[36:39], a[164:167], a[188:191], a[36:39]
  buffer_load_dwordx4 v255, s[28:31], s55 offen offset:2048 sc1 lds
  v_mfma_f32_16x16x32_bf16 a[40:43], a[164:167], a[192:195], a[40:43]
  ds_read_b128 a[120:123], v241 offset:2048
  v_mfma_f32_16x16x32_bf16 a[44:47], a[164:167], a[196:199], a[44:47]
  ds_read_b128 a[124:127], v241 offset:3072
  v_mfma_f32_16x16x32_bf16 a[60:63], a[168:171], a[196:199], a[60:63]
  buffer_load_dwordx4 v242, s[28:31], s55 offen offset:3072 sc1 lds
  v_mfma_f32_16x16x32_bf16 a[56:59], a[168:171], a[192:195], a[56:59]
  ds_read_b128 a[128:131], v241 offset:4096
  v_mfma_f32_16x16x32_bf16 a[52:55], a[168:171], a[188:191], a[52:55]
  s_add_u32 m0, s57, 49152
  v_mfma_f32_16x16x32_bf16 a[48:51], a[168:171], a[184:187], a[48:51]
  ds_read_b128 a[132:135], v241 offset:5120
  v_mfma_f32_16x16x32_bf16 a[64:67], a[172:175], a[184:187], a[64:67]
  buffer_load_dwordx4 v232, s[16:19], s54 offen offset:0 lds
  v_mfma_f32_16x16x32_bf16 a[68:71], a[172:175], a[188:191], a[68:71]
  ds_read_b128 a[136:139], v241 offset:6144
  v_mfma_f32_16x16x32_bf16 a[72:75], a[172:175], a[192:195], a[72:75]
  s_add_u32 s55, s55, 229376
  v_mfma_f32_16x16x32_bf16 a[76:79], a[172:175], a[196:199], a[76:79]
  buffer_load_dwordx4 v233, s[16:19], s54 offen offset:1024 lds
  v_mfma_f32_16x16x32_bf16 a[92:95], a[176:179], a[196:199], a[92:95]
  v_mfma_f32_16x16x32_bf16 a[88:91], a[176:179], a[192:195], a[88:91]
  v_mfma_f32_16x16x32_bf16 a[84:87], a[176:179], a[188:191], a[84:87]
  buffer_load_dwordx4 v234, s[16:19], s54 offen offset:2048 lds
  v_mfma_f32_16x16x32_bf16 a[80:83], a[176:179], a[184:187], a[80:83]
  v_mfma_f32_16x16x32_bf16 a[96:99], a[180:183], a[184:187], a[96:99]
  v_mfma_f32_16x16x32_bf16 a[100:103], a[180:183], a[188:191], a[100:103]
  buffer_load_dwordx4 v235, s[16:19], s54 offen offset:3072 lds
  v_mfma_f32_16x16x32_bf16 a[104:107], a[180:183], a[192:195], a[104:107]
  s_add_u32 s54, s54, 128
  v_mfma_f32_16x16x32_bf16 a[108:111], a[180:183], a[196:199], a[108:111]
  s_waitcnt vmcnt(16) lgkmcnt(0)
  s_barrier
  v_mfma_f32_32x32x16_bf16 v[16:31], v[136:139], v[120:123], v[80:95]
  ds_read_b128 v[128:131], v172 offset:0
  v_exp_f32 v0, v0
  v_exp_f32 v1, v1
  v_exp_f32 v2, v2
  v_mfma_f32_32x32x16_bf16 v[16:31], v[140:143], v[124:127], v[16:31]
  ds_read_b128 v[132:135], v172 offset:512
  v_exp_f32 v3, v3
  v_exp_f32 v4, v4
  v_cvt_pk_bf16_f32 v96, v0, v1
  v_exp_f32 v5, v5
  v_mfma_f32_32x32x16_bf16 v[48:63], v[144:147], v[104:107], v[48:63]
  s_add_u32 m0, s50, 24576
  v_exp_f32 v6, v6
  v_cvt_pk_bf16_f32 v97, v2, v3
  v_exp_f32 v7, v7
  v_exp_f32 v8, v8
  v_cvt_pk_bf16_f32 v98, v4, v5
  v_mfma_f32_32x32x16_bf16 v[48:63], v[148:151], v[108:111], v[48:63]
  buffer_load_dwordx4 v255, s[8:11], s49 offen sc1 lds
  v_exp_f32 v9, v9
  v_exp_f32 v10, v10
  v_cvt_pk_bf16_f32 v99, v6, v7
  v_exp_f32 v11, v11
  v_mfma_f32_16x16x32_bf16 v[164:167], v[168:171], v[104:107], v[164:167]
  buffer_load_dwordx4 v255, s[12:15], s49 offen offset:1024 sc1 lds
  s_add_u32 s49, s49, 4096
  v_exp_f32 v12, v12
  v_cvt_pk_bf16_f32 v100, v8, v9
  v_exp_f32 v13, v13
  v_mfma_f32_16x16x32_bf16 v[164:167], v[168:171], v[108:111], v[164:167]
  s_waitcnt lgkmcnt(0)
  v_exp_f32 v14, v14
  v_cvt_pk_bf16_f32 v101, v10, v11
  v_exp_f32 v15, v15
  v_cvt_pk_bf16_f32 v102, v12, v13
  v_cvt_pk_bf16_f32 v103, v14, v15
  v_mfma_f32_16x16x32_bf16 a[0:3], a[112:115], a[140:143], a[0:3]
  ds_read_b128 a[184:187], v238 offset:32768
  v_mfma_f32_16x16x32_bf16 a[4:7], a[112:115], a[144:147], a[4:7]
  s_add_u32 m0, s57, 65536
  v_mfma_f32_16x16x32_bf16 a[8:11], a[112:115], a[148:151], a[8:11]
  ds_read_b128 a[188:191], v238 offset:33280
  v_mfma_f32_16x16x32_bf16 a[12:15], a[112:115], a[152:155], a[12:15]
  buffer_load_dwordx4 v255, s[28:31], s55 offen offset:0 sc1 lds
  v_mfma_f32_16x16x32_bf16 a[28:31], a[116:119], a[152:155], a[28:31]
  ds_read_b128 a[192:195], v239 offset:32768
  v_mfma_f32_16x16x32_bf16 a[24:27], a[116:119], a[148:151], a[24:27]
  ds_read_b128 a[196:199], v239 offset:33280
  v_mfma_f32_16x16x32_bf16 a[20:23], a[116:119], a[144:147], a[20:23]
  buffer_load_dwordx4 v255, s[28:31], s55 offen offset:1024 sc1 lds
  v_mfma_f32_16x16x32_bf16 a[16:19], a[116:119], a[140:143], a[16:19]
  ds_read_b128 a[156:159], v241 offset:32768
  v_mfma_f32_16x16x32_bf16 a[32:35], a[120:123], a[140:143], a[32:35]
  ds_read_b128 a[160:163], v241 offset:33792
  v_mfma_f32_16x16x32_bf16 a[36:39], a[120:123], a[144:147], a[36:39]
  buffer_load_dwordx4 v255, s[28:31], s55 offen offset:2048 sc1 lds
  v_mfma_f32_16x16x32_bf16 a[40:43], a[120:123], a[148:151], a[40:43]
  ds_read_b128 a[164:167], v241 offset:34816
  v_mfma_f32_16x16x32_bf16 a[44:47], a[120:123], a[152:155], a[44:47]
  ds_read_b128 a[168:171], v241 offset:35840
  v_mfma_f32_16x16x32_bf16 a[60:63], a[124:127], a[152:155], a[60:63]
  buffer_load_dwordx4 v242, s[28:31], s55 offen offset:3072 sc1 lds
  v_mfma_f32_16x16x32_bf16 a[56:59], a[124:127], a[148:151], a[56:59]
  ds_read_b128 a[172:175], v241 offset:36864
  v_mfma_f32_16x16x32_bf16 a[52:55], a[124:127], a[144:147], a[52:55]
  s_add_u32 m0, s57, 81920
  v_mfma_f32_16x16x32_bf16 a[48:51], a[124:127], a[140:143], a[48:51]
  ds_read_b128 a[176:179], v241 offset:37888
  v_mfma_f32_16x16x32_bf16 a[64:67], a[128:131], a[140:143], a[64:67]
  buffer_load_dwordx4 v232, s[16:19], s54 offen offset:0 lds
  v_mfma_f32_16x16x32_bf16 a[68:71], a[128:131], a[144:147], a[68:71]
  ds_read_b128 a[180:183], v241 offset:38912
  v_mfma_f32_16x16x32_bf16 a[72:75], a[128:131], a[148:151], a[72:75]
  s_add_u32 s55, s55, 229376
  v_mfma_f32_16x16x32_bf16 a[76:79], a[128:131], a[152:155], a[76:79]
  buffer_load_dwordx4 v233, s[16:19], s54 offen offset:1024 lds
  v_mfma_f32_16x16x32_bf16 a[92:95], a[132:135], a[152:155], a[92:95]
  v_mfma_f32_16x16x32_bf16 a[88:91], a[132:135], a[148:151], a[88:91]
  v_mfma_f32_16x16x32_bf16 a[84:87], a[132:135], a[144:147], a[84:87]
  buffer_load_dwordx4 v234, s[16:19], s54 offen offset:2048 lds
  v_mfma_f32_16x16x32_bf16 a[80:83], a[132:135], a[140:143], a[80:83]
  v_mfma_f32_16x16x32_bf16 a[96:99], a[136:139], a[140:143], a[96:99]
  v_mfma_f32_16x16x32_bf16 a[100:103], a[136:139], a[144:147], a[100:103]
  buffer_load_dwordx4 v235, s[16:19], s54 offen offset:3072 lds
  v_mfma_f32_16x16x32_bf16 a[104:107], a[136:139], a[148:151], a[104:107]
  s_add_u32 s54, s54, 128
  v_mfma_f32_16x16x32_bf16 a[108:111], a[136:139], a[152:155], a[108:111]
  s_waitcnt vmcnt(18) lgkmcnt(0)
  s_barrier
  v_mfma_f32_16x16x32_bf16 a[0:3], a[156:159], a[184:187], a[0:3]
  ds_read_b128 a[140:143], v236 offset:0
  v_mfma_f32_16x16x32_bf16 a[4:7], a[156:159], a[188:191], a[4:7]
  s_add_u32 m0, s57, 98304
  v_mfma_f32_16x16x32_bf16 a[8:11], a[156:159], a[192:195], a[8:11]
  ds_read_b128 a[144:147], v236 offset:512
  v_mfma_f32_16x16x32_bf16 a[12:15], a[156:159], a[196:199], a[12:15]
  buffer_load_dwordx4 v255, s[28:31], s55 offen offset:0 sc1 lds
  v_mfma_f32_16x16x32_bf16 a[28:31], a[160:163], a[196:199], a[28:31]
  ds_read_b128 a[148:151], v237 offset:0
  v_mfma_f32_16x16x32_bf16 a[24:27], a[160:163], a[192:195], a[24:27]
  ds_read_b128 a[152:155], v237 offset:512
  v_mfma_f32_16x16x32_bf16 a[20:23], a[160:163], a[188:191], a[20:23]
  buffer_load_dwordx4 v255, s[28:31], s55 offen offset:1024 sc1 lds
  v_mfma_f32_16x16x32_bf16 a[16:19], a[160:163], a[184:187], a[16:19]
  ds_read_b128 a[112:115], v240 offset:0
  v_mfma_f32_16x16x32_bf16 a[32:35], a[164:167], a[184:187], a[32:35]
  ds_read_b128 a[116:119], v240 offset:1024
  v_mfma_f32_16x16x32_bf16 a[36:39], a[164:167], a[188:191], a[36:39]
  buffer_load_dwordx4 v255, s[28:31], s55 offen offset:2048 sc1 lds
  v_mfma_f32_16x16x32_bf16 a[40:43], a[164:167], a[192:195], a[40:43]
  ds_read_b128 a[120:123], v240 offset:2048
  v_mfma_f32_16x16x32_bf16 a[44:47], a[164:167], a[196:199], a[44:47]
  ds_read_b128 a[124:127], v240 offset:3072
  v_mfma_f32_16x16x32_bf16 a[60:63], a[168:171], a[196:199], a[60:63]
  buffer_load_dwordx4 v242, s[28:31], s55 offen offset:3072 sc1 lds
  v_mfma_f32_16x16x32_bf16 a[56:59], a[168:171], a[192:195], a[56:59]
  ds_read_b128 a[128:131], v240 offset:4096
  v_mfma_f32_16x16x32_bf16 a[52:55], a[168:171], a[188:191], a[52:55]
  s_add_u32 m0, s57, 114688
  v_mfma_f32_16x16x32_bf16 a[48:51], a[168:171], a[184:187], a[48:51]
  ds_read_b128 a[132:135], v240 offset:5120
  v_mfma_f32_16x16x32_bf16 a[64:67], a[172:175], a[184:187], a[64:67]
  buffer_load_dwordx4 v232, s[16:19], s54 offen offset:0 lds
  v_mfma_f32_16x16x32_bf16 a[68:71], a[172:175], a[188:191], a[68:71]
  ds_read_b128 a[136:139], v240 offset:6144
  v_mfma_f32_16x16x32_bf16 a[72:75], a[172:175], a[192:195], a[72:75]
  s_add_u32 s55, s55, 229376
  v_mfma_f32_16x16x32_bf16 a[76:79], a[172:175], a[196:199], a[76:79]
  buffer_load_dwordx4 v233, s[16:19], s54 offen offset:1024 lds
  v_mfma_f32_16x16x32_bf16 a[92:95], a[176:179], a[196:199], a[92:95]
  v_mfma_f32_16x16x32_bf16 a[88:91], a[176:179], a[192:195], a[88:91]
  v_mfma_f32_16x16x32_bf16 a[84:87], a[176:179], a[188:191], a[84:87]
  buffer_load_dwordx4 v234, s[16:19], s54 offen offset:2048 lds
  v_mfma_f32_16x16x32_bf16 a[80:83], a[176:179], a[184:187], a[80:83]
  v_mfma_f32_16x16x32_bf16 a[96:99], a[180:183], a[184:187], a[96:99]
  v_mfma_f32_16x16x32_bf16 a[100:103], a[180:183], a[188:191], a[100:103]
  buffer_load_dwordx4 v235, s[16:19], s54 offen offset:3072 lds
  v_mfma_f32_16x16x32_bf16 a[104:107], a[180:183], a[192:195], a[104:107]
  s_add_u32 s54, s54, 128
  v_mfma_f32_16x16x32_bf16 a[108:111], a[180:183], a[196:199], a[108:111]
  s_waitcnt vmcnt(18) lgkmcnt(0)
  s_barrier
  v_mfma_f32_32x32x16_bf16 v[0:15], v[128:131], v[112:115], v[64:79]
  ds_read_b128 v[144:147], v172 offset:1024
  v_exp_f32 v16, v16
  v_exp_f32 v17, v17
  v_exp_f32 v18, v18
  v_mfma_f32_32x32x16_bf16 v[0:15], v[132:135], v[116:119], v[0:15]
  ds_read_b128 v[148:151], v172 offset:1536
  v_exp_f32 v19, v19
  v_exp_f32 v20, v20
  v_cvt_pk_bf16_f32 v104, v16, v17
  v_exp_f32 v21, v21
  v_mfma_f32_32x32x16_bf16 v[32:47], v[152:155], v[96:99], v[32:47]
  v_exp_f32 v22, v22
  v_cvt_pk_bf16_f32 v105, v18, v19
  v_exp_f32 v23, v23
  v_exp_f32 v24, v24
  v_cvt_pk_bf16_f32 v106, v20, v21
  v_mfma_f32_32x32x16_bf16 v[32:47], v[156:159], v[100:103], v[32:47]
  v_exp_f32 v25, v25
  v_exp_f32 v26, v26
  v_cvt_pk_bf16_f32 v107, v22, v23
  v_exp_f32 v27, v27
  v_mfma_f32_16x16x32_bf16 v[160:163], v[168:171], v[96:99], v[160:163]
  v_exp_f32 v28, v28
  v_cvt_pk_bf16_f32 v108, v24, v25
  v_exp_f32 v29, v29
  v_mfma_f32_16x16x32_bf16 v[160:163], v[168:171], v[100:103], v[160:163]
  s_waitcnt lgkmcnt(0)
  v_exp_f32 v30, v30
  v_cvt_pk_bf16_f32 v109, v26, v27
  v_exp_f32 v31, v31
  v_cvt_pk_bf16_f32 v110, v28, v29
  v_cvt_pk_bf16_f32 v111, v30, v31
  v_mfma_f32_16x16x32_bf16 a[0:3], a[112:115], a[140:143], a[0:3]
  ds_read_b128 a[184:187], v236 offset:32768
  v_mfma_f32_16x16x32_bf16 a[4:7], a[112:115], a[144:147], a[4:7]
  s_add_u32 m0, s57, 0
  v_mfma_f32_16x16x32_bf16 a[8:11], a[112:115], a[148:151], a[8:11]
  ds_read_b128 a[188:191], v236 offset:33280
  v_mfma_f32_16x16x32_bf16 a[12:15], a[112:115], a[152:155], a[12:15]
  buffer_load_dwordx4 v255, s[28:31], s55 offen offset:0 sc1 lds
  v_mfma_f32_16x16x32_bf16 a[28:31], a[116:119], a[152:155], a[28:31]
  ds_read_b128 a[192:195], v237 offset:32768
  v_mfma_f32_16x16x32_bf16 a[24:27], a[116:119], a[148:151], a[24:27]
  ds_read_b128 a[196:199], v237 offset:33280
  v_mfma_f32_16x16x32_bf16 a[20:23], a[116:119], a[144:147], a[20:23]
  buffer_load_dwordx4 v255, s[28:31], s55 offen offset:1024 sc1 lds
  v_mfma_f32_16x16x32_bf16 a[16:19], a[116:119], a[140:143], a[16:19]
  ds_read_b128 a[156:159], v240 offset:32768
  v_mfma_f32_16x16x32_bf16 a[32:35], a[120:123], a[140:143], a[32:35]
  ds_read_b128 a[160:163], v240 offset:33792
  v_mfma_f32_16x16x32_bf16 a[36:39], a[120:123], a[144:147], a[36:39]
  buffer_load_dwordx4 v255, s[28:31], s55 offen offset:2048 sc1 lds
  v_mfma_f32_16x16x32_bf16 a[40:43], a[120:123], a[148:151], a[40:43]
  ds_read_b128 a[164:167], v240 offset:34816
  v_mfma_f32_16x16x32_bf16 a[44:47], a[120:123], a[152:155], a[44:47]
  ds_read_b128 a[168:171], v240 offset:35840
  v_mfma_f32_16x16x32_bf16 a[60:63], a[124:127], a[152:155], a[60:63]
  buffer_load_dwordx4 v242, s[28:31], s55 offen offset:3072 sc1 lds
  v_mfma_f32_16x16x32_bf16 a[56:59], a[124:127], a[148:151], a[56:59]
  ds_read_b128 a[172:175], v240 offset:36864
  v_mfma_f32_16x16x32_bf16 a[52:55], a[124:127], a[144:147], a[52:55]
  s_add_u32 m0, s57, 16384
  v_mfma_f32_16x16x32_bf16 a[48:51], a[124:127], a[140:143], a[48:51]
  ds_read_b128 a[176:179], v240 offset:37888
  v_mfma_f32_16x16x32_bf16 a[64:67], a[128:131], a[140:143], a[64:67]
  buffer_load_dwordx4 v232, s[16:19], s54 offen offset:0 lds
  v_mfma_f32_16x16x32_bf16 a[68:71], a[128:131], a[144:147], a[68:71]
  ds_read_b128 a[180:183], v240 offset:38912
  v_mfma_f32_16x16x32_bf16 a[72:75], a[128:131], a[148:151], a[72:75]
  s_add_u32 s55, s55, 229376
  v_mfma_f32_16x16x32_bf16 a[76:79], a[128:131], a[152:155], a[76:79]
  buffer_load_dwordx4 v233, s[16:19], s54 offen offset:1024 lds
  v_mfma_f32_16x16x32_bf16 a[92:95], a[132:135], a[152:155], a[92:95]
  v_mfma_f32_16x16x32_bf16 a[88:91], a[132:135], a[148:151], a[88:91]
  v_mfma_f32_16x16x32_bf16 a[84:87], a[132:135], a[144:147], a[84:87]
  buffer_load_dwordx4 v234, s[16:19], s54 offen offset:2048 lds
  v_mfma_f32_16x16x32_bf16 a[80:83], a[132:135], a[140:143], a[80:83]
  v_mfma_f32_16x16x32_bf16 a[96:99], a[136:139], a[140:143], a[96:99]
  v_mfma_f32_16x16x32_bf16 a[100:103], a[136:139], a[144:147], a[100:103]
  buffer_load_dwordx4 v235, s[16:19], s54 offen offset:3072 lds
  v_mfma_f32_16x16x32_bf16 a[104:107], a[136:139], a[148:151], a[104:107]
  s_add_u32 s54, s54, 128
  v_mfma_f32_16x16x32_bf16 a[108:111], a[136:139], a[152:155], a[108:111]
  s_waitcnt vmcnt(16) lgkmcnt(0)
  s_barrier
  v_mfma_f32_16x16x32_bf16 a[0:3], a[156:159], a[184:187], a[0:3]
  ds_read_b128 a[140:143], v238 offset:0
  v_mfma_f32_16x16x32_bf16 a[4:7], a[156:159], a[188:191], a[4:7]
  s_add_u32 m0, s57, 32768
  v_mfma_f32_16x16x32_bf16 a[8:11], a[156:159], a[192:195], a[8:11]
  ds_read_b128 a[144:147], v238 offset:512
  v_mfma_f32_16x16x32_bf16 a[12:15], a[156:159], a[196:199], a[12:15]
  buffer_load_dwordx4 v255, s[28:31], s55 offen offset:0 sc1 lds
  v_mfma_f32_16x16x32_bf16 a[28:31], a[160:163], a[196:199], a[28:31]
  ds_read_b128 a[148:151], v239 offset:0
  v_mfma_f32_16x16x32_bf16 a[24:27], a[160:163], a[192:195], a[24:27]
  ds_read_b128 a[152:155], v239 offset:512
  v_mfma_f32_16x16x32_bf16 a[20:23], a[160:163], a[188:191], a[20:23]
  buffer_load_dwordx4 v255, s[28:31], s55 offen offset:1024 sc1 lds
  v_mfma_f32_16x16x32_bf16 a[16:19], a[160:163], a[184:187], a[16:19]
  ds_read_b128 a[112:115], v241 offset:0
  v_mfma_f32_16x16x32_bf16 a[32:35], a[164:167], a[184:187], a[32:35]
  ds_read_b128 a[116:119], v241 offset:1024
  v_mfma_f32_16x16x32_bf16 a[36:39], a[164:167], a[188:191], a[36:39]
  buffer_load_dwordx4 v255, s[28:31], s55 offen offset:2048 sc1 lds
  v_mfma_f32_16x16x32_bf16 a[40:43], a[164:167], a[192:195], a[40:43]
  ds_read_b128 a[120:123], v241 offset:2048
  v_mfma_f32_16x16x32_bf16 a[44:47], a[164:167], a[196:199], a[44:47]
  ds_read_b128 a[124:127], v241 offset:3072
  v_mfma_f32_16x16x32_bf16 a[60:63], a[168:171], a[196:199], a[60:63]
  buffer_load_dwordx4 v242, s[28:31], s55 offen offset:3072 sc1 lds
  v_mfma_f32_16x16x32_bf16 a[56:59], a[168:171], a[192:195], a[56:59]
  ds_read_b128 a[128:131], v241 offset:4096
  v_mfma_f32_16x16x32_bf16 a[52:55], a[168:171], a[188:191], a[52:55]
  s_add_u32 m0, s57, 49152
  v_mfma_f32_16x16x32_bf16 a[48:51], a[168:171], a[184:187], a[48:51]
  ds_read_b128 a[132:135], v241 offset:5120
  v_mfma_f32_16x16x32_bf16 a[64:67], a[172:175], a[184:187], a[64:67]
  buffer_load_dwordx4 v232, s[16:19], s54 offen offset:0 lds
  v_mfma_f32_16x16x32_bf16 a[68:71], a[172:175], a[188:191], a[68:71]
  ds_read_b128 a[136:139], v241 offset:6144
  v_mfma_f32_16x16x32_bf16 a[72:75], a[172:175], a[192:195], a[72:75]
  s_add_u32 s55, s55, 229376
  v_mfma_f32_16x16x32_bf16 a[76:79], a[172:175], a[196:199], a[76:79]
  buffer_load_dwordx4 v233, s[16:19], s54 offen offset:1024 lds
  v_mfma_f32_16x16x32_bf16 a[92:95], a[176:179], a[196:199], a[92:95]
  v_mfma_f32_16x16x32_bf16 a[88:91], a[176:179], a[192:195], a[88:91]
  v_mfma_f32_16x16x32_bf16 a[84:87], a[176:179], a[188:191], a[84:87]
  buffer_load_dwordx4 v234, s[16:19], s54 offen offset:2048 lds
  v_mfma_f32_16x16x32_bf16 a[80:83], a[176:179], a[184:187], a[80:83]
  v_mfma_f32_16x16x32_bf16 a[96:99], a[180:183], a[184:187], a[96:99]
  v_mfma_f32_16x16x32_bf16 a[100:103], a[180:183], a[188:191], a[100:103]
  buffer_load_dwordx4 v235, s[16:19], s54 offen offset:3072 lds
  v_mfma_f32_16x16x32_bf16 a[104:107], a[180:183], a[192:195], a[104:107]
  s_add_u32 s54, s54, 128
  v_mfma_f32_16x16x32_bf16 a[108:111], a[180:183], a[196:199], a[108:111]
  s_waitcnt vmcnt(16) lgkmcnt(0)
  s_barrier
  v_mfma_f32_32x32x16_bf16 v[16:31], v[128:131], v[120:123], v[80:95]
  ds_read_b128 v[136:139], v172 offset:4096
  v_exp_f32 v0, v0
  v_exp_f32 v1, v1
  v_exp_f32 v2, v2
  v_mfma_f32_32x32x16_bf16 v[16:31], v[132:135], v[124:127], v[16:31]
  ds_read_b128 v[140:143], v172 offset:4608
  v_exp_f32 v3, v3
  v_exp_f32 v4, v4
  v_cvt_pk_bf16_f32 v96, v0, v1
  v_exp_f32 v5, v5
  v_mfma_f32_32x32x16_bf16 v[48:63], v[152:155], v[104:107], v[48:63]
  v_exp_f32 v6, v6
  v_cvt_pk_bf16_f32 v97, v2, v3
  v_exp_f32 v7, v7
  v_exp_f32 v8, v8
  v_cvt_pk_bf16_f32 v98, v4, v5
  v_mfma_f32_32x32x16_bf16 v[48:63], v[156:159], v[108:111], v[48:63]
  v_exp_f32 v9, v9
  v_exp_f32 v10, v10
  v_cvt_pk_bf16_f32 v99, v6, v7
  v_exp_f32 v11, v11
  v_mfma_f32_16x16x32_bf16 v[164:167], v[168:171], v[104:107], v[164:167]
  v_exp_f32 v12, v12
  v_cvt_pk_bf16_f32 v100, v8, v9
  v_exp_f32 v13, v13
  v_mfma_f32_16x16x32_bf16 v[164:167], v[168:171], v[108:111], v[164:167]
  s_waitcnt lgkmcnt(0)
  v_exp_f32 v14, v14
  v_cvt_pk_bf16_f32 v101, v10, v11
  v_exp_f32 v15, v15
  v_cvt_pk_bf16_f32 v102, v12, v13
  v_cvt_pk_bf16_f32 v103, v14, v15
  v_mfma_f32_16x16x32_bf16 a[0:3], a[112:115], a[140:143], a[0:3]
  ds_read_b128 a[184:187], v238 offset:32768
  v_mfma_f32_16x16x32_bf16 a[4:7], a[112:115], a[144:147], a[4:7]
  s_add_u32 m0, s57, 65536
  v_mfma_f32_16x16x32_bf16 a[8:11], a[112:115], a[148:151], a[8:11]
  ds_read_b128 a[188:191], v238 offset:33280
  v_mfma_f32_16x16x32_bf16 a[12:15], a[112:115], a[152:155], a[12:15]
  buffer_load_dwordx4 v255, s[28:31], s55 offen offset:0 sc1 lds
  v_mfma_f32_16x16x32_bf16 a[28:31], a[116:119], a[152:155], a[28:31]
  ds_read_b128 a[192:195], v239 offset:32768
  v_mfma_f32_16x16x32_bf16 a[24:27], a[116:119], a[148:151], a[24:27]
  ds_read_b128 a[196:199], v239 offset:33280
  v_mfma_f32_16x16x32_bf16 a[20:23], a[116:119], a[144:147], a[20:23]
  buffer_load_dwordx4 v255, s[28:31], s55 offen offset:1024 sc1 lds
  v_mfma_f32_16x16x32_bf16 a[16:19], a[116:119], a[140:143], a[16:19]
  ds_read_b128 a[156:159], v241 offset:32768
  v_mfma_f32_16x16x32_bf16 a[32:35], a[120:123], a[140:143], a[32:35]
  ds_read_b128 a[160:163], v241 offset:33792
  v_mfma_f32_16x16x32_bf16 a[36:39], a[120:123], a[144:147], a[36:39]
  buffer_load_dwordx4 v255, s[28:31], s55 offen offset:2048 sc1 lds
  v_mfma_f32_16x16x32_bf16 a[40:43], a[120:123], a[148:151], a[40:43]
  ds_read_b128 a[164:167], v241 offset:34816
  v_mfma_f32_16x16x32_bf16 a[44:47], a[120:123], a[152:155], a[44:47]
  ds_read_b128 a[168:171], v241 offset:35840
  v_mfma_f32_16x16x32_bf16 a[60:63], a[124:127], a[152:155], a[60:63]
  buffer_load_dwordx4 v242, s[28:31], s55 offen offset:3072 sc1 lds
  v_mfma_f32_16x16x32_bf16 a[56:59], a[124:127], a[148:151], a[56:59]
  ds_read_b128 a[172:175], v241 offset:36864
  v_mfma_f32_16x16x32_bf16 a[52:55], a[124:127], a[144:147], a[52:55]
  s_add_u32 m0, s57, 81920
  v_mfma_f32_16x16x32_bf16 a[48:51], a[124:127], a[140:143], a[48:51]
  ds_read_b128 a[176:179], v241 offset:37888
  v_mfma_f32_16x16x32_bf16 a[64:67], a[128:131], a[140:143], a[64:67]
  buffer_load_dwordx4 v232, s[16:19], s54 offen offset:0 lds
  v_mfma_f32_16x16x32_bf16 a[68:71], a[128:131], a[144:147], a[68:71]
  ds_read_b128 a[180:183], v241 offset:38912
  v_mfma_f32_16x16x32_bf16 a[72:75], a[128:131], a[148:151], a[72:75]
  s_add_u32 s55, s55, 229376
  v_mfma_f32_16x16x32_bf16 a[76:79], a[128:131], a[152:155], a[76:79]
  buffer_load_dwordx4 v233, s[16:19], s54 offen offset:1024 lds
  v_mfma_f32_16x16x32_bf16 a[92:95], a[132:135], a[152:155], a[92:95]
  v_mfma_f32_16x16x32_bf16 a[88:91], a[132:135], a[148:151], a[88:91]
  v_mfma_f32_16x16x32_bf16 a[84:87], a[132:135], a[144:147], a[84:87]
  buffer_load_dwordx4 v234, s[16:19], s54 offen offset:2048 lds
  v_mfma_f32_16x16x32_bf16 a[80:83], a[132:135], a[140:143], a[80:83]
  v_mfma_f32_16x16x32_bf16 a[96:99], a[136:139], a[140:143], a[96:99]
  v_mfma_f32_16x16x32_bf16 a[100:103], a[136:139], a[144:147], a[100:103]
  buffer_load_dwordx4 v235, s[16:19], s54 offen offset:3072 lds
  v_mfma_f32_16x16x32_bf16 a[104:107], a[136:139], a[148:151], a[104:107]
  s_add_u32 s54, s54, 128
  v_mfma_f32_16x16x32_bf16 a[108:111], a[136:139], a[152:155], a[108:111]
  s_waitcnt vmcnt(16) lgkmcnt(0)
  s_barrier
  v_mfma_f32_16x16x32_bf16 a[0:3], a[156:159], a[184:187], a[0:3]
  ds_read_b128 a[140:143], v236 offset:0
  v_mfma_f32_16x16x32_bf16 a[4:7], a[156:159], a[188:191], a[4:7]
  s_add_u32 m0, s57, 98304
  v_mfma_f32_16x16x32_bf16 a[8:11], a[156:159], a[192:195], a[8:11]
  ds_read_b128 a[144:147], v236 offset:512
  v_mfma_f32_16x16x32_bf16 a[12:15], a[156:159], a[196:199], a[12:15]
  buffer_load_dwordx4 v255, s[28:31], s55 offen offset:0 sc1 lds
  v_mfma_f32_16x16x32_bf16 a[28:31], a[160:163], a[196:199], a[28:31]
  ds_read_b128 a[148:151], v237 offset:0
  v_mfma_f32_16x16x32_bf16 a[24:27], a[160:163], a[192:195], a[24:27]
  ds_read_b128 a[152:155], v237 offset:512
  v_mfma_f32_16x16x32_bf16 a[20:23], a[160:163], a[188:191], a[20:23]
  buffer_load_dwordx4 v255, s[28:31], s55 offen offset:1024 sc1 lds
  v_mfma_f32_16x16x32_bf16 a[16:19], a[160:163], a[184:187], a[16:19]
  ds_read_b128 a[112:115], v240 offset:0
  v_mfma_f32_16x16x32_bf16 a[32:35], a[164:167], a[184:187], a[32:35]
  ds_read_b128 a[116:119], v240 offset:1024
  v_mfma_f32_16x16x32_bf16 a[36:39], a[164:167], a[188:191], a[36:39]
  buffer_load_dwordx4 v255, s[28:31], s55 offen offset:2048 sc1 lds
  v_mfma_f32_16x16x32_bf16 a[40:43], a[164:167], a[192:195], a[40:43]
  ds_read_b128 a[120:123], v240 offset:2048
  v_mfma_f32_16x16x32_bf16 a[44:47], a[164:167], a[196:199], a[44:47]
  ds_read_b128 a[124:127], v240 offset:3072
  v_mfma_f32_16x16x32_bf16 a[60:63], a[168:171], a[196:199], a[60:63]
  buffer_load_dwordx4 v242, s[28:31], s55 offen offset:3072 sc1 lds
  v_mfma_f32_16x16x32_bf16 a[56:59], a[168:171], a[192:195], a[56:59]
  ds_read_b128 a[128:131], v240 offset:4096
  v_mfma_f32_16x16x32_bf16 a[52:55], a[168:171], a[188:191], a[52:55]
  s_add_u32 m0, s57, 114688
  v_mfma_f32_16x16x32_bf16 a[48:51], a[168:171], a[184:187], a[48:51]
  ds_read_b128 a[132:135], v240 offset:5120
  v_mfma_f32_16x16x32_bf16 a[64:67], a[172:175], a[184:187], a[64:67]
  buffer_load_dwordx4 v232, s[16:19], s54 offen offset:0 lds
  v_mfma_f32_16x16x32_bf16 a[68:71], a[172:175], a[188:191], a[68:71]
  ds_read_b128 a[136:139], v240 offset:6144
  v_mfma_f32_16x16x32_bf16 a[72:75], a[172:175], a[192:195], a[72:75]
  s_add_u32 s55, s55, 229376
  v_mfma_f32_16x16x32_bf16 a[76:79], a[172:175], a[196:199], a[76:79]
  buffer_load_dwordx4 v233, s[16:19], s54 offen offset:1024 lds
  v_mfma_f32_16x16x32_bf16 a[92:95], a[176:179], a[196:199], a[92:95]
  v_mfma_f32_16x16x32_bf16 a[88:91], a[176:179], a[192:195], a[88:91]
  v_mfma_f32_16x16x32_bf16 a[84:87], a[176:179], a[188:191], a[84:87]
  buffer_load_dwordx4 v234, s[16:19], s54 offen offset:2048 lds
  v_mfma_f32_16x16x32_bf16 a[80:83], a[176:179], a[184:187], a[80:83]
  v_mfma_f32_16x16x32_bf16 a[96:99], a[180:183], a[184:187], a[96:99]
  v_mfma_f32_16x16x32_bf16 a[100:103], a[180:183], a[188:191], a[100:103]
  buffer_load_dwordx4 v235, s[16:19], s54 offen offset:3072 lds
  v_mfma_f32_16x16x32_bf16 a[104:107], a[180:183], a[192:195], a[104:107]
  s_add_u32 s54, s54, 128
  v_mfma_f32_16x16x32_bf16 a[108:111], a[180:183], a[196:199], a[108:111]
  s_waitcnt vmcnt(16) lgkmcnt(0)
  s_barrier
  v_mfma_f32_32x32x16_bf16 v[0:15], v[136:139], v[112:115], v[64:79]
  ds_read_b128 v[152:155], v172 offset:5120
  v_exp_f32 v16, v16
  v_exp_f32 v17, v17
  v_exp_f32 v18, v18
  v_mfma_f32_32x32x16_bf16 v[0:15], v[140:143], v[116:119], v[0:15]
  ds_read_b128 v[156:159], v172 offset:5632
  v_exp_f32 v19, v19
  v_exp_f32 v20, v20
  v_cvt_pk_bf16_f32 v104, v16, v17
  v_exp_f32 v21, v21
  v_mfma_f32_32x32x16_bf16 v[32:47], v[144:147], v[96:99], v[32:47]
  v_exp_f32 v22, v22
  v_cvt_pk_bf16_f32 v105, v18, v19
  v_exp_f32 v23, v23
  v_exp_f32 v24, v24
  v_cvt_pk_bf16_f32 v106, v20, v21
  v_mfma_f32_32x32x16_bf16 v[32:47], v[148:151], v[100:103], v[32:47]
  v_exp_f32 v25, v25
  v_exp_f32 v26, v26
  v_cvt_pk_bf16_f32 v107, v22, v23
  v_exp_f32 v27, v27
  v_mfma_f32_16x16x32_bf16 v[160:163], v[168:171], v[96:99], v[160:163]
  v_exp_f32 v28, v28
  v_cvt_pk_bf16_f32 v108, v24, v25
  v_exp_f32 v29, v29
  v_mfma_f32_16x16x32_bf16 v[160:163], v[168:171], v[100:103], v[160:163]
  s_waitcnt lgkmcnt(0)
  v_exp_f32 v30, v30
  v_cvt_pk_bf16_f32 v109, v26, v27
  v_exp_f32 v31, v31
  v_cvt_pk_bf16_f32 v110, v28, v29
  v_cvt_pk_bf16_f32 v111, v30, v31
  v_mfma_f32_16x16x32_bf16 a[0:3], a[112:115], a[140:143], a[0:3]
  ds_read_b128 a[184:187], v236 offset:32768
  v_mfma_f32_16x16x32_bf16 a[4:7], a[112:115], a[144:147], a[4:7]
  s_add_u32 m0, s57, 0
  v_mfma_f32_16x16x32_bf16 a[8:11], a[112:115], a[148:151], a[8:11]
  ds_read_b128 a[188:191], v236 offset:33280
  v_mfma_f32_16x16x32_bf16 a[12:15], a[112:115], a[152:155], a[12:15]
  buffer_load_dwordx4 v255, s[28:31], s55 offen offset:0 sc1 lds
  v_mfma_f32_16x16x32_bf16 a[28:31], a[116:119], a[152:155], a[28:31]
  ds_read_b128 a[192:195], v237 offset:32768
  v_mfma_f32_16x16x32_bf16 a[24:27], a[116:119], a[148:151], a[24:27]
  ds_read_b128 a[196:199], v237 offset:33280
  v_mfma_f32_16x16x32_bf16 a[20:23], a[116:119], a[144:147], a[20:23]
  buffer_load_dwordx4 v255, s[28:31], s55 offen offset:1024 sc1 lds
  v_mfma_f32_16x16x32_bf16 a[16:19], a[116:119], a[140:143], a[16:19]
  ds_read_b128 a[156:159], v240 offset:32768
  v_mfma_f32_16x16x32_bf16 a[32:35], a[120:123], a[140:143], a[32:35]
  ds_read_b128 a[160:163], v240 offset:33792
  v_mfma_f32_16x16x32_bf16 a[36:39], a[120:123], a[144:147], a[36:39]
  buffer_load_dwordx4 v255, s[28:31], s55 offen offset:2048 sc1 lds
  v_mfma_f32_16x16x32_bf16 a[40:43], a[120:123], a[148:151], a[40:43]
  ds_read_b128 a[164:167], v240 offset:34816
  v_mfma_f32_16x16x32_bf16 a[44:47], a[120:123], a[152:155], a[44:47]
  ds_read_b128 a[168:171], v240 offset:35840
  v_mfma_f32_16x16x32_bf16 a[60:63], a[124:127], a[152:155], a[60:63]
  buffer_load_dwordx4 v242, s[28:31], s55 offen offset:3072 sc1 lds
  v_mfma_f32_16x16x32_bf16 a[56:59], a[124:127], a[148:151], a[56:59]
  ds_read_b128 a[172:175], v240 offset:36864
  v_mfma_f32_16x16x32_bf16 a[52:55], a[124:127], a[144:147], a[52:55]
  s_add_u32 m0, s57, 16384
  v_mfma_f32_16x16x32_bf16 a[48:51], a[124:127], a[140:143], a[48:51]
  ds_read_b128 a[176:179], v240 offset:37888
  v_mfma_f32_16x16x32_bf16 a[64:67], a[128:131], a[140:143], a[64:67]
  buffer_load_dwordx4 v232, s[16:19], s54 offen offset:0 lds
  v_mfma_f32_16x16x32_bf16 a[68:71], a[128:131], a[144:147], a[68:71]
  ds_read_b128 a[180:183], v240 offset:38912
  v_mfma_f32_16x16x32_bf16 a[72:75], a[128:131], a[148:151], a[72:75]
  s_add_u32 s55, s55, 229376
  v_mfma_f32_16x16x32_bf16 a[76:79], a[128:131], a[152:155], a[76:79]
  buffer_load_dwordx4 v233, s[16:19], s54 offen offset:1024 lds
  v_mfma_f32_16x16x32_bf16 a[92:95], a[132:135], a[152:155], a[92:95]
  v_mfma_f32_16x16x32_bf16 a[88:91], a[132:135], a[148:151], a[88:91]
  v_mfma_f32_16x16x32_bf16 a[84:87], a[132:135], a[144:147], a[84:87]
  buffer_load_dwordx4 v234, s[16:19], s54 offen offset:2048 lds
  v_mfma_f32_16x16x32_bf16 a[80:83], a[132:135], a[140:143], a[80:83]
  v_mfma_f32_16x16x32_bf16 a[96:99], a[136:139], a[140:143], a[96:99]
  v_mfma_f32_16x16x32_bf16 a[100:103], a[136:139], a[144:147], a[100:103]
  buffer_load_dwordx4 v235, s[16:19], s54 offen offset:3072 lds
  v_mfma_f32_16x16x32_bf16 a[104:107], a[136:139], a[148:151], a[104:107]
  s_add_u32 s54, s54, 128
  v_mfma_f32_16x16x32_bf16 a[108:111], a[136:139], a[152:155], a[108:111]
  s_waitcnt vmcnt(16) lgkmcnt(0)
  s_barrier
  v_mfma_f32_16x16x32_bf16 a[0:3], a[156:159], a[184:187], a[0:3]
  ds_read_b128 a[140:143], v238 offset:0
  v_mfma_f32_16x16x32_bf16 a[4:7], a[156:159], a[188:191], a[4:7]
  s_add_u32 m0, s57, 32768
  v_mfma_f32_16x16x32_bf16 a[8:11], a[156:159], a[192:195], a[8:11]
  ds_read_b128 a[144:147], v238 offset:512
  v_mfma_f32_16x16x32_bf16 a[12:15], a[156:159], a[196:199], a[12:15]
  buffer_load_dwordx4 v255, s[28:31], s55 offen offset:0 sc1 lds
  v_mfma_f32_16x16x32_bf16 a[28:31], a[160:163], a[196:199], a[28:31]
  ds_read_b128 a[148:151], v239 offset:0
  v_mfma_f32_16x16x32_bf16 a[24:27], a[160:163], a[192:195], a[24:27]
  ds_read_b128 a[152:155], v239 offset:512
  v_mfma_f32_16x16x32_bf16 a[20:23], a[160:163], a[188:191], a[20:23]
  buffer_load_dwordx4 v255, s[28:31], s55 offen offset:1024 sc1 lds
  v_mfma_f32_16x16x32_bf16 a[16:19], a[160:163], a[184:187], a[16:19]
  ds_read_b128 a[112:115], v241 offset:0
  v_mfma_f32_16x16x32_bf16 a[32:35], a[164:167], a[184:187], a[32:35]
  ds_read_b128 a[116:119], v241 offset:1024
  v_mfma_f32_16x16x32_bf16 a[36:39], a[164:167], a[188:191], a[36:39]
  buffer_load_dwordx4 v255, s[28:31], s55 offen offset:2048 sc1 lds
  v_mfma_f32_16x16x32_bf16 a[40:43], a[164:167], a[192:195], a[40:43]
  ds_read_b128 a[120:123], v241 offset:2048
  v_mfma_f32_16x16x32_bf16 a[44:47], a[164:167], a[196:199], a[44:47]
  ds_read_b128 a[124:127], v241 offset:3072
  v_mfma_f32_16x16x32_bf16 a[60:63], a[168:171], a[196:199], a[60:63]
  buffer_load_dwordx4 v242, s[28:31], s55 offen offset:3072 sc1 lds
  v_mfma_f32_16x16x32_bf16 a[56:59], a[168:171], a[192:195], a[56:59]
  ds_read_b128 a[128:131], v241 offset:4096
  v_mfma_f32_16x16x32_bf16 a[52:55], a[168:171], a[188:191], a[52:55]
  s_add_u32 m0, s57, 49152
  v_mfma_f32_16x16x32_bf16 a[48:51], a[168:171], a[184:187], a[48:51]
  ds_read_b128 a[132:135], v241 offset:5120
  v_mfma_f32_16x16x32_bf16 a[64:67], a[172:175], a[184:187], a[64:67]
  buffer_load_dwordx4 v232, s[16:19], s54 offen offset:0 lds
  v_mfma_f32_16x16x32_bf16 a[68:71], a[172:175], a[188:191], a[68:71]
  ds_read_b128 a[136:139], v241 offset:6144
  v_mfma_f32_16x16x32_bf16 a[72:75], a[172:175], a[192:195], a[72:75]
  s_add_u32 s55, s55, 229376
  v_mfma_f32_16x16x32_bf16 a[76:79], a[172:175], a[196:199], a[76:79]
  buffer_load_dwordx4 v233, s[16:19], s54 offen offset:1024 lds
  v_mfma_f32_16x16x32_bf16 a[92:95], a[176:179], a[196:199], a[92:95]
  v_mfma_f32_16x16x32_bf16 a[88:91], a[176:179], a[192:195], a[88:91]
  v_mfma_f32_16x16x32_bf16 a[84:87], a[176:179], a[188:191], a[84:87]
  buffer_load_dwordx4 v234, s[16:19], s54 offen offset:2048 lds
  v_mfma_f32_16x16x32_bf16 a[80:83], a[176:179], a[184:187], a[80:83]
  v_mfma_f32_16x16x32_bf16 a[96:99], a[180:183], a[184:187], a[96:99]
  v_mfma_f32_16x16x32_bf16 a[100:103], a[180:183], a[188:191], a[100:103]
  buffer_load_dwordx4 v235, s[16:19], s54 offen offset:3072 lds
  v_mfma_f32_16x16x32_bf16 a[104:107], a[180:183], a[192:195], a[104:107]
  s_add_u32 s54, s54, 128
  v_mfma_f32_16x16x32_bf16 a[108:111], a[180:183], a[196:199], a[108:111]
  s_waitcnt vmcnt(16) lgkmcnt(0)
  s_barrier
  v_mfma_f32_32x32x16_bf16 v[16:31], v[136:139], v[120:123], v[80:95]
  ds_read_b128 v[128:131], v172 offset:8192
  v_exp_f32 v0, v0
  v_exp_f32 v1, v1
  v_exp_f32 v2, v2
  v_mfma_f32_32x32x16_bf16 v[16:31], v[140:143], v[124:127], v[16:31]
  ds_read_b128 v[132:135], v172 offset:8704
  v_exp_f32 v3, v3
  v_exp_f32 v4, v4
  v_cvt_pk_bf16_f32 v96, v0, v1
  v_exp_f32 v5, v5
  v_mfma_f32_32x32x16_bf16 v[48:63], v[144:147], v[104:107], v[48:63]
  s_add_u32 m0, s50, 0
  v_exp_f32 v6, v6
  v_cvt_pk_bf16_f32 v97, v2, v3
  v_exp_f32 v7, v7
  v_exp_f32 v8, v8
  v_cvt_pk_bf16_f32 v98, v4, v5
  v_mfma_f32_32x32x16_bf16 v[48:63], v[148:151], v[108:111], v[48:63]
  buffer_load_dwordx4 v255, s[8:11], s49 offen sc1 lds
  v_exp_f32 v9, v9
  v_exp_f32 v10, v10
  v_cvt_pk_bf16_f32 v99, v6, v7
  v_exp_f32 v11, v11
  v_mfma_f32_16x16x32_bf16 v[164:167], v[168:171], v[104:107], v[164:167]
  buffer_load_dwordx4 v255, s[12:15], s49 offen offset:1024 sc1 lds
  s_add_u32 s49, s49, 4096
  v_exp_f32 v12, v12
  v_cvt_pk_bf16_f32 v100, v8, v9
  v_exp_f32 v13, v13
  v_mfma_f32_16x16x32_bf16 v[164:167], v[168:171], v[108:111], v[164:167]
  s_waitcnt lgkmcnt(0)
  buffer_load_dword v250, v249, s[4:7], s52 offen sc1
  v_exp_f32 v14, v14
  v_cvt_pk_bf16_f32 v101, v10, v11
  v_exp_f32 v15, v15
  v_cvt_pk_bf16_f32 v102, v12, v13
  v_cvt_pk_bf16_f32 v103, v14, v15
  v_mfma_f32_16x16x32_bf16 a[0:3], a[112:115], a[140:143], a[0:3]
  ds_read_b128 a[184:187], v238 offset:32768
  v_mfma_f32_16x16x32_bf16 a[4:7], a[112:115], a[144:147], a[4:7]
  s_add_u32 m0, s57, 65536
  v_mfma_f32_16x16x32_bf16 a[8:11], a[112:115], a[148:151], a[8:11]
  ds_read_b128 a[188:191], v238 offset:33280
  v_mfma_f32_16x16x32_bf16 a[12:15], a[112:115], a[152:155], a[12:15]
  buffer_load_dwordx4 v255, s[28:31], s55 offen offset:0 sc1 lds
  v_mfma_f32_16x16x32_bf16 a[28:31], a[116:119], a[152:155], a[28:31]
  ds_read_b128 a[192:195], v239 offset:32768
  v_mfma_f32_16x16x32_bf16 a[24:27], a[116:119], a[148:151], a[24:27]
  ds_read_b128 a[196:199], v239 offset:33280
  v_mfma_f32_16x16x32_bf16 a[20:23], a[116:119], a[144:147], a[20:23]
  buffer_load_dwordx4 v255, s[28:31], s55 offen offset:1024 sc1 lds
  v_mfma_f32_16x16x32_bf16 a[16:19], a[116:119], a[140:143], a[16:19]
  ds_read_b128 a[156:159], v241 offset:32768
  v_mfma_f32_16x16x32_bf16 a[32:35], a[120:123], a[140:143], a[32:35]
  ds_read_b128 a[160:163], v241 offset:33792
  v_mfma_f32_16x16x32_bf16 a[36:39], a[120:123], a[144:147], a[36:39]
  buffer_load_dwordx4 v255, s[28:31], s55 offen offset:2048 sc1 lds
  v_mfma_f32_16x16x32_bf16 a[40:43], a[120:123], a[148:151], a[40:43]
  ds_read_b128 a[164:167], v241 offset:34816
  v_mfma_f32_16x16x32_bf16 a[44:47], a[120:123], a[152:155], a[44:47]
  ds_read_b128 a[168:171], v241 offset:35840
  v_mfma_f32_16x16x32_bf16 a[60:63], a[124:127], a[152:155], a[60:63]
  buffer_load_dwordx4 v242, s[28:31], s55 offen offset:3072 sc1 lds
  v_mfma_f32_16x16x32_bf16 a[56:59], a[124:127], a[148:151], a[56:59]
  ds_read_b128 a[172:175], v241 offset:36864
  v_mfma_f32_16x16x32_bf16 a[52:55], a[124:127], a[144:147], a[52:55]
  s_add_u32 m0, s57, 81920
  v_mfma_f32_16x16x32_bf16 a[48:51], a[124:127], a[140:143], a[48:51]
  ds_read_b128 a[176:179], v241 offset:37888
  v_mfma_f32_16x16x32_bf16 a[64:67], a[128:131], a[140:143], a[64:67]
  buffer_load_dwordx4 v232, s[16:19], s54 offen offset:0 lds
  v_mfma_f32_16x16x32_bf16 a[68:71], a[128:131], a[144:147], a[68:71]
  ds_read_b128 a[180:183], v241 offset:38912
  v_mfma_f32_16x16x32_bf16 a[72:75], a[128:131], a[148:151], a[72:75]
  s_add_u32 s55, s55, 229376
  v_mfma_f32_16x16x32_bf16 a[76:79], a[128:131], a[152:155], a[76:79]
  buffer_load_dwordx4 v233, s[16:19], s54 offen offset:1024 lds
  v_mfma_f32_16x16x32_bf16 a[92:95], a[132:135], a[152:155], a[92:95]
  v_mfma_f32_16x16x32_bf16 a[88:91], a[132:135], a[148:151], a[88:91]
  v_mfma_f32_16x16x32_bf16 a[84:87], a[132:135], a[144:147], a[84:87]
  buffer_load_dwordx4 v234, s[16:19], s54 offen offset:2048 lds
  v_mfma_f32_16x16x32_bf16 a[80:83], a[132:135], a[140:143], a[80:83]
  v_mfma_f32_16x16x32_bf16 a[96:99], a[136:139], a[140:143], a[96:99]
  v_mfma_f32_16x16x32_bf16 a[100:103], a[136:139], a[144:147], a[100:103]
  buffer_load_dwordx4 v235, s[16:19], s54 offen offset:3072 lds
  v_mfma_f32_16x16x32_bf16 a[104:107], a[136:139], a[148:151], a[104:107]
  s_add_u32 s54, s54, 128
  v_mfma_f32_16x16x32_bf16 a[108:111], a[136:139], a[152:155], a[108:111]
  s_waitcnt vmcnt(19) lgkmcnt(0)
  s_barrier
  v_mfma_f32_16x16x32_bf16 a[0:3], a[156:159], a[184:187], a[0:3]
  ds_read_b128 a[140:143], v236 offset:0
  v_mfma_f32_16x16x32_bf16 a[4:7], a[156:159], a[188:191], a[4:7]
  s_add_u32 m0, s57, 98304
  v_mfma_f32_16x16x32_bf16 a[8:11], a[156:159], a[192:195], a[8:11]
  ds_read_b128 a[144:147], v236 offset:512
  v_mfma_f32_16x16x32_bf16 a[12:15], a[156:159], a[196:199], a[12:15]
  buffer_load_dwordx4 v255, s[28:31], s55 offen offset:0 sc1 lds
  v_mfma_f32_16x16x32_bf16 a[28:31], a[160:163], a[196:199], a[28:31]
  ds_read_b128 a[148:151], v237 offset:0
  v_mfma_f32_16x16x32_bf16 a[24:27], a[160:163], a[192:195], a[24:27]
  ds_read_b128 a[152:155], v237 offset:512
  v_mfma_f32_16x16x32_bf16 a[20:23], a[160:163], a[188:191], a[20:23]
  buffer_load_dwordx4 v255, s[28:31], s55 offen offset:1024 sc1 lds
  v_mfma_f32_16x16x32_bf16 a[16:19], a[160:163], a[184:187], a[16:19]
  ds_read_b128 a[112:115], v240 offset:0
  v_mfma_f32_16x16x32_bf16 a[32:35], a[164:167], a[184:187], a[32:35]
  ds_read_b128 a[116:119], v240 offset:1024
  v_mfma_f32_16x16x32_bf16 a[36:39], a[164:167], a[188:191], a[36:39]
  buffer_load_dwordx4 v255, s[28:31], s55 offen offset:2048 sc1 lds
  v_mfma_f32_16x16x32_bf16 a[40:43], a[164:167], a[192:195], a[40:43]
  ds_read_b128 a[120:123], v240 offset:2048
  v_mfma_f32_16x16x32_bf16 a[44:47], a[164:167], a[196:199], a[44:47]
  ds_read_b128 a[124:127], v240 offset:3072
  v_mfma_f32_16x16x32_bf16 a[60:63], a[168:171], a[196:199], a[60:63]
  buffer_load_dwordx4 v242, s[28:31], s55 offen offset:3072 sc1 lds
  v_mfma_f32_16x16x32_bf16 a[56:59], a[168:171], a[192:195], a[56:59]
  ds_read_b128 a[128:131], v240 offset:4096
  v_mfma_f32_16x16x32_bf16 a[52:55], a[168:171], a[188:191], a[52:55]
  s_add_u32 m0, s57, 114688
  v_mfma_f32_16x16x32_bf16 a[48:51], a[168:171], a[184:187], a[48:51]
  ds_read_b128 a[132:135], v240 offset:5120
  v_mfma_f32_16x16x32_bf16 a[64:67], a[172:175], a[184:187], a[64:67]
  buffer_load_dwordx4 v232, s[16:19], s54 offen offset:0 lds
  v_mfma_f32_16x16x32_bf16 a[68:71], a[172:175], a[188:191], a[68:71]
  ds_read_b128 a[136:139], v240 offset:6144
  v_mfma_f32_16x16x32_bf16 a[72:75], a[172:175], a[192:195], a[72:75]
  s_add_u32 s55, s55, 229376
  v_mfma_f32_16x16x32_bf16 a[76:79], a[172:175], a[196:199], a[76:79]
  buffer_load_dwordx4 v233, s[16:19], s54 offen offset:1024 lds
  v_mfma_f32_16x16x32_bf16 a[92:95], a[176:179], a[196:199], a[92:95]
  v_mfma_f32_16x16x32_bf16 a[88:91], a[176:179], a[192:195], a[88:91]
  v_mfma_f32_16x16x32_bf16 a[84:87], a[176:179], a[188:191], a[84:87]
  buffer_load_dwordx4 v234, s[16:19], s54 offen offset:2048 lds
  v_mfma_f32_16x16x32_bf16 a[80:83], a[176:179], a[184:187], a[80:83]
  v_mfma_f32_16x16x32_bf16 a[96:99], a[180:183], a[184:187], a[96:99]
  v_mfma_f32_16x16x32_bf16 a[100:103], a[180:183], a[188:191], a[100:103]
  buffer_load_dwordx4 v235, s[16:19], s54 offen offset:3072 lds
  v_mfma_f32_16x16x32_bf16 a[104:107], a[180:183], a[192:195], a[104:107]
  s_add_u32 s54, s54, 128
  v_mfma_f32_16x16x32_bf16 a[108:111], a[180:183], a[196:199], a[108:111]
  s_waitcnt vmcnt(19) lgkmcnt(0)
  s_barrier
  v_mfma_f32_32x32x16_bf16 v[0:15], v[128:131], v[112:115], v[64:79]
  ds_read_b128 v[144:147], v172 offset:9216
  v_exp_f32 v16, v16
  v_exp_f32 v17, v17
  v_exp_f32 v18, v18
  v_mfma_f32_32x32x16_bf16 v[0:15], v[132:135], v[116:119], v[0:15]
  ds_read_b128 v[148:151], v172 offset:9728
  v_exp_f32 v19, v19
  v_exp_f32 v20, v20
  v_cvt_pk_bf16_f32 v104, v16, v17
  v_exp_f32 v21, v21
  v_mfma_f32_32x32x16_bf16 v[32:47], v[152:155], v[96:99], v[32:47]
  v_exp_f32 v22, v22
  v_cvt_pk_bf16_f32 v105, v18, v19
  v_exp_f32 v23, v23
  v_exp_f32 v24, v24
  v_cvt_pk_bf16_f32 v106, v20, v21
  v_mfma_f32_32x32x16_bf16 v[32:47], v[156:159], v[100:103], v[32:47]
  v_exp_f32 v25, v25
  v_exp_f32 v26, v26
  v_cvt_pk_bf16_f32 v107, v22, v23
  v_exp_f32 v27, v27
  v_mfma_f32_16x16x32_bf16 v[160:163], v[168:171], v[96:99], v[160:163]
  v_exp_f32 v28, v28
  v_cvt_pk_bf16_f32 v108, v24, v25
  v_exp_f32 v29, v29
  v_mfma_f32_16x16x32_bf16 v[160:163], v[168:171], v[100:103], v[160:163]
  s_waitcnt lgkmcnt(0)
  v_exp_f32 v30, v30
  v_cvt_pk_bf16_f32 v109, v26, v27
  v_exp_f32 v31, v31
  v_cvt_pk_bf16_f32 v110, v28, v29
  v_cvt_pk_bf16_f32 v111, v30, v31
  v_mfma_f32_16x16x32_bf16 a[0:3], a[112:115], a[140:143], a[0:3]
  ds_read_b128 a[184:187], v236 offset:32768
  v_mfma_f32_16x16x32_bf16 a[4:7], a[112:115], a[144:147], a[4:7]
  s_add_u32 m0, s57, 0
  v_mfma_f32_16x16x32_bf16 a[8:11], a[112:115], a[148:151], a[8:11]
  ds_read_b128 a[188:191], v236 offset:33280
  v_mfma_f32_16x16x32_bf16 a[12:15], a[112:115], a[152:155], a[12:15]
  buffer_load_dwordx4 v255, s[28:31], s55 offen offset:0 sc1 lds
  v_mfma_f32_16x16x32_bf16 a[28:31], a[116:119], a[152:155], a[28:31]
  ds_read_b128 a[192:195], v237 offset:32768
  v_mfma_f32_16x16x32_bf16 a[24:27], a[116:119], a[148:151], a[24:27]
  ds_read_b128 a[196:199], v237 offset:33280
  v_mfma_f32_16x16x32_bf16 a[20:23], a[116:119], a[144:147], a[20:23]
  buffer_load_dwordx4 v255, s[28:31], s55 offen offset:1024 sc1 lds
  v_mfma_f32_16x16x32_bf16 a[16:19], a[116:119], a[140:143], a[16:19]
  ds_read_b128 a[156:159], v240 offset:32768
  v_mfma_f32_16x16x32_bf16 a[32:35], a[120:123], a[140:143], a[32:35]
  ds_read_b128 a[160:163], v240 offset:33792
  v_mfma_f32_16x16x32_bf16 a[36:39], a[120:123], a[144:147], a[36:39]
  buffer_load_dwordx4 v255, s[28:31], s55 offen offset:2048 sc1 lds
  v_mfma_f32_16x16x32_bf16 a[40:43], a[120:123], a[148:151], a[40:43]
  ds_read_b128 a[164:167], v240 offset:34816
  v_mfma_f32_16x16x32_bf16 a[44:47], a[120:123], a[152:155], a[44:47]
  ds_read_b128 a[168:171], v240 offset:35840
  v_mfma_f32_16x16x32_bf16 a[60:63], a[124:127], a[152:155], a[60:63]
  buffer_load_dwordx4 v242, s[28:31], s55 offen offset:3072 sc1 lds
  v_mfma_f32_16x16x32_bf16 a[56:59], a[124:127], a[148:151], a[56:59]
  ds_read_b128 a[172:175], v240 offset:36864
  v_mfma_f32_16x16x32_bf16 a[52:55], a[124:127], a[144:147], a[52:55]
  s_add_u32 m0, s57, 16384
  v_mfma_f32_16x16x32_bf16 a[48:51], a[124:127], a[140:143], a[48:51]
  ds_read_b128 a[176:179], v240 offset:37888
  v_mfma_f32_16x16x32_bf16 a[64:67], a[128:131], a[140:143], a[64:67]
  buffer_load_dwordx4 v232, s[16:19], s54 offen offset:0 lds
  v_mfma_f32_16x16x32_bf16 a[68:71], a[128:131], a[144:147], a[68:71]
  ds_read_b128 a[180:183], v240 offset:38912
  v_mfma_f32_16x16x32_bf16 a[72:75], a[128:131], a[148:151], a[72:75]
  s_add_u32 s55, s55, 229376
  v_mfma_f32_16x16x32_bf16 a[76:79], a[128:131], a[152:155], a[76:79]
  buffer_load_dwordx4 v233, s[16:19], s54 offen offset:1024 lds
  v_mfma_f32_16x16x32_bf16 a[92:95], a[132:135], a[152:155], a[92:95]
  v_mfma_f32_16x16x32_bf16 a[88:91], a[132:135], a[148:151], a[88:91]
  v_mfma_f32_16x16x32_bf16 a[84:87], a[132:135], a[144:147], a[84:87]
  buffer_load_dwordx4 v234, s[16:19], s54 offen offset:2048 lds
  v_mfma_f32_16x16x32_bf16 a[80:83], a[132:135], a[140:143], a[80:83]
  v_mfma_f32_16x16x32_bf16 a[96:99], a[136:139], a[140:143], a[96:99]
  v_mfma_f32_16x16x32_bf16 a[100:103], a[136:139], a[144:147], a[100:103]
  buffer_load_dwordx4 v235, s[16:19], s54 offen offset:3072 lds
  v_mfma_f32_16x16x32_bf16 a[104:107], a[136:139], a[148:151], a[104:107]
  s_add_u32 s54, s54, 128
  v_mfma_f32_16x16x32_bf16 a[108:111], a[136:139], a[152:155], a[108:111]
  s_waitcnt vmcnt(16) lgkmcnt(0)
  s_barrier
  v_mfma_f32_16x16x32_bf16 a[0:3], a[156:159], a[184:187], a[0:3]
  ds_read_b128 a[140:143], v238 offset:0
  v_mfma_f32_16x16x32_bf16 a[4:7], a[156:159], a[188:191], a[4:7]
  s_add_u32 m0, s57, 32768
  v_mfma_f32_16x16x32_bf16 a[8:11], a[156:159], a[192:195], a[8:11]
  ds_read_b128 a[144:147], v238 offset:512
  v_mfma_f32_16x16x32_bf16 a[12:15], a[156:159], a[196:199], a[12:15]
  buffer_load_dwordx4 v255, s[28:31], s55 offen offset:0 sc1 lds
  v_mfma_f32_16x16x32_bf16 a[28:31], a[160:163], a[196:199], a[28:31]
  ds_read_b128 a[148:151], v239 offset:0
  v_mfma_f32_16x16x32_bf16 a[24:27], a[160:163], a[192:195], a[24:27]
  ds_read_b128 a[152:155], v239 offset:512
  v_mfma_f32_16x16x32_bf16 a[20:23], a[160:163], a[188:191], a[20:23]
  buffer_load_dwordx4 v255, s[28:31], s55 offen offset:1024 sc1 lds
  v_mfma_f32_16x16x32_bf16 a[16:19], a[160:163], a[184:187], a[16:19]
  ds_read_b128 a[112:115], v241 offset:0
  v_mfma_f32_16x16x32_bf16 a[32:35], a[164:167], a[184:187], a[32:35]
  ds_read_b128 a[116:119], v241 offset:1024
  v_mfma_f32_16x16x32_bf16 a[36:39], a[164:167], a[188:191], a[36:39]
  buffer_load_dwordx4 v255, s[28:31], s55 offen offset:2048 sc1 lds
  v_mfma_f32_16x16x32_bf16 a[40:43], a[164:167], a[192:195], a[40:43]
  ds_read_b128 a[120:123], v241 offset:2048
  v_mfma_f32_16x16x32_bf16 a[44:47], a[164:167], a[196:199], a[44:47]
  ds_read_b128 a[124:127], v241 offset:3072
  v_mfma_f32_16x16x32_bf16 a[60:63], a[168:171], a[196:199], a[60:63]
  buffer_load_dwordx4 v242, s[28:31], s55 offen offset:3072 sc1 lds
  v_mfma_f32_16x16x32_bf16 a[56:59], a[168:171], a[192:195], a[56:59]
  ds_read_b128 a[128:131], v241 offset:4096
  v_mfma_f32_16x16x32_bf16 a[52:55], a[168:171], a[188:191], a[52:55]
  s_add_u32 m0, s57, 49152
  v_mfma_f32_16x16x32_bf16 a[48:51], a[168:171], a[184:187], a[48:51]
  ds_read_b128 a[132:135], v241 offset:5120
  v_mfma_f32_16x16x32_bf16 a[64:67], a[172:175], a[184:187], a[64:67]
  buffer_load_dwordx4 v232, s[16:19], s54 offen offset:0 lds
  v_mfma_f32_16x16x32_bf16 a[68:71], a[172:175], a[188:191], a[68:71]
  ds_read_b128 a[136:139], v241 offset:6144
  v_mfma_f32_16x16x32_bf16 a[72:75], a[172:175], a[192:195], a[72:75]
  s_add_u32 s55, s55, 229376
  v_mfma_f32_16x16x32_bf16 a[76:79], a[172:175], a[196:199], a[76:79]
  buffer_load_dwordx4 v233, s[16:19], s54 offen offset:1024 lds
  v_mfma_f32_16x16x32_bf16 a[92:95], a[176:179], a[196:199], a[92:95]
  v_mfma_f32_16x16x32_bf16 a[88:91], a[176:179], a[192:195], a[88:91]
  v_mfma_f32_16x16x32_bf16 a[84:87], a[176:179], a[188:191], a[84:87]
  buffer_load_dwordx4 v234, s[16:19], s54 offen offset:2048 lds
  v_mfma_f32_16x16x32_bf16 a[80:83], a[176:179], a[184:187], a[80:83]
  v_mfma_f32_16x16x32_bf16 a[96:99], a[180:183], a[184:187], a[96:99]
  v_mfma_f32_16x16x32_bf16 a[100:103], a[180:183], a[188:191], a[100:103]
  buffer_load_dwordx4 v235, s[16:19], s54 offen offset:3072 lds
  v_mfma_f32_16x16x32_bf16 a[104:107], a[180:183], a[192:195], a[104:107]
  s_add_u32 s54, s54, 128
  v_mfma_f32_16x16x32_bf16 a[108:111], a[180:183], a[196:199], a[108:111]
  s_waitcnt vmcnt(16) lgkmcnt(0)
  s_barrier
  v_mfma_f32_32x32x16_bf16 v[16:31], v[128:131], v[120:123], v[80:95]
  ds_read_b128 v[136:139], v172 offset:12288
  v_exp_f32 v0, v0
  v_exp_f32 v1, v1
  v_exp_f32 v2, v2
  v_mfma_f32_32x32x16_bf16 v[16:31], v[132:135], v[124:127], v[16:31]
  ds_read_b128 v[140:143], v172 offset:12800
  v_exp_f32 v3, v3
  v_exp_f32 v4, v4
  v_cvt_pk_bf16_f32 v96, v0, v1
  v_exp_f32 v5, v5
  v_mfma_f32_32x32x16_bf16 v[48:63], v[152:155], v[104:107], v[48:63]
  v_exp_f32 v6, v6
  v_cvt_pk_bf16_f32 v97, v2, v3
  v_exp_f32 v7, v7
  v_exp_f32 v8, v8
  v_cvt_pk_bf16_f32 v98, v4, v5
  v_mfma_f32_32x32x16_bf16 v[48:63], v[156:159], v[108:111], v[48:63]
  v_exp_f32 v9, v9
  v_exp_f32 v10, v10
  v_cvt_pk_bf16_f32 v99, v6, v7
  v_exp_f32 v11, v11
  v_mfma_f32_16x16x32_bf16 v[164:167], v[168:171], v[104:107], v[164:167]
  v_exp_f32 v12, v12
  v_cvt_pk_bf16_f32 v100, v8, v9
  v_exp_f32 v13, v13
  v_mfma_f32_16x16x32_bf16 v[164:167], v[168:171], v[108:111], v[164:167]
  s_waitcnt lgkmcnt(0)
  v_exp_f32 v14, v14
  v_cvt_pk_bf16_f32 v101, v10, v11
  v_exp_f32 v15, v15
  v_cvt_pk_bf16_f32 v102, v12, v13
  v_cvt_pk_bf16_f32 v103, v14, v15
  s_waitcnt vmcnt(32)
  s_cmp_lg_u32 s44, 0
  s_cbranch_scc1 gated_mix__mha_block__mixer_gmlp__prompt_kernel_cz_ok
  s_mov_b32 s53, 0x8000
gated_mix__mha_block__mixer_gmlp__prompt_kernel_cz:
  v_cmp_eq_u32 vcc, 0, v250
  s_nop 3
  s_cmp_eq_u64 vcc, 0
  s_cbranch_scc1 gated_mix__mha_block__mixer_gmlp__prompt_kernel_cz_ok
  s_sleep 8
  buffer_load_dword v250, v249, s[4:7], s52 offen sc1
  s_waitcnt vmcnt(0)
  s_sub_u32 s53, s53, 1
  s_cmp_lg_u32 s53, 0
  s_cbranch_scc1 gated_mix__mha_block__mixer_gmlp__prompt_kernel_cz
gated_mix__mha_block__mixer_gmlp__prompt_kernel_cz_ok:
  v_mfma_f32_16x16x32_bf16 a[0:3], a[112:115], a[140:143], a[0:3]
  ds_read_b128 a[184:187], v238 offset:32768
  v_mfma_f32_16x16x32_bf16 a[4:7], a[112:115], a[144:147], a[4:7]
  s_add_u32 m0, s57, 65536
  v_mfma_f32_16x16x32_bf16 a[8:11], a[112:115], a[148:151], a[8:11]
  ds_read_b128 a[188:191], v238 offset:33280
  v_mfma_f32_16x16x32_bf16 a[12:15], a[112:115], a[152:155], a[12:15]
  buffer_load_dwordx4 v255, s[28:31], s55 offen offset:0 sc1 lds
  v_mfma_f32_16x16x32_bf16 a[28:31], a[116:119], a[152:155], a[28:31]
  ds_read_b128 a[192:195], v239 offset:32768
  v_mfma_f32_16x16x32_bf16 a[24:27], a[116:119], a[148:151], a[24:27]
  ds_read_b128 a[196:199], v239 offset:33280
  v_mfma_f32_16x16x32_bf16 a[20:23], a[116:119], a[144:147], a[20:23]
  buffer_load_dwordx4 v255, s[28:31], s55 offen offset:1024 sc1 lds
  v_mfma_f32_16x16x32_bf16 a[16:19], a[116:119], a[140:143], a[16:19]
  ds_read_b128 a[156:159], v241 offset:32768
  v_mfma_f32_16x16x32_bf16 a[32:35], a[120:123], a[140:143], a[32:35]
  ds_read_b128 a[160:163], v241 offset:33792
  v_mfma_f32_16x16x32_bf16 a[36:39], a[120:123], a[144:147], a[36:39]
  buffer_load_dwordx4 v255, s[28:31], s55 offen offset:2048 sc1 lds
  v_mfma_f32_16x16x32_bf16 a[40:43], a[120:123], a[148:151], a[40:43]
  ds_read_b128 a[164:167], v241 offset:34816
  v_mfma_f32_16x16x32_bf16 a[44:47], a[120:123], a[152:155], a[44:47]
  ds_read_b128 a[168:171], v241 offset:35840
  v_mfma_f32_16x16x32_bf16 a[60:63], a[124:127], a[152:155], a[60:63]
  buffer_load_dwordx4 v242, s[28:31], s55 offen offset:3072 sc1 lds
  v_mfma_f32_16x16x32_bf16 a[56:59], a[124:127], a[148:151], a[56:59]
  ds_read_b128 a[172:175], v241 offset:36864
  v_mfma_f32_16x16x32_bf16 a[52:55], a[124:127], a[144:147], a[52:55]
  s_add_u32 m0, s57, 81920
  v_mfma_f32_16x16x32_bf16 a[48:51], a[124:127], a[140:143], a[48:51]
  ds_read_b128 a[176:179], v241 offset:37888
  v_mfma_f32_16x16x32_bf16 a[64:67], a[128:131], a[140:143], a[64:67]
  buffer_load_dwordx4 v232, s[16:19], s54 offen offset:0 lds
  v_mfma_f32_16x16x32_bf16 a[68:71], a[128:131], a[144:147], a[68:71]
  ds_read_b128 a[180:183], v241 offset:38912
  v_mfma_f32_16x16x32_bf16 a[72:75], a[128:131], a[148:151], a[72:75]
  s_add_u32 s55, s55, 229376
  v_mfma_f32_16x16x32_bf16 a[76:79], a[128:131], a[152:155], a[76:79]
  buffer_load_dwordx4 v233, s[16:19], s54 offen offset:1024 lds
  v_mfma_f32_16x16x32_bf16 a[92:95], a[132:135], a[152:155], a[92:95]
  v_mfma_f32_16x16x32_bf16 a[88:91], a[132:135], a[148:151], a[88:91]
  v_mfma_f32_16x16x32_bf16 a[84:87], a[132:135], a[144:147], a[84:87]
  buffer_load_dwordx4 v234, s[16:19], s54 offen offset:2048 lds
  v_mfma_f32_16x16x32_bf16 a[80:83], a[132:135], a[140:143], a[80:83]
  v_mfma_f32_16x16x32_bf16 a[96:99], a[136:139], a[140:143], a[96:99]
  v_mfma_f32_16x16x32_bf16 a[100:103], a[136:139], a[144:147], a[100:103]
  buffer_load_dwordx4 v235, s[16:19], s54 offen offset:3072 lds
  v_mfma_f32_16x16x32_bf16 a[104:107], a[136:139], a[148:151], a[104:107]
  s_add_u32 s54, s54, 128
  v_mfma_f32_16x16x32_bf16 a[108:111], a[136:139], a[152:155], a[108:111]
  s_waitcnt vmcnt(16) lgkmcnt(0)
  s_barrier
  v_mfma_f32_16x16x32_bf16 a[0:3], a[156:159], a[184:187], a[0:3]
  ds_read_b128 a[140:143], v236 offset:0
  v_mfma_f32_16x16x32_bf16 a[4:7], a[156:159], a[188:191], a[4:7]
  s_add_u32 m0, s57, 98304
  v_mfma_f32_16x16x32_bf16 a[8:11], a[156:159], a[192:195], a[8:11]
  ds_read_b128 a[144:147], v236 offset:512
  v_mfma_f32_16x16x32_bf16 a[12:15], a[156:159], a[196:199], a[12:15]
  buffer_load_dwordx4 v255, s[28:31], s55 offen offset:0 sc1 lds
  v_mfma_f32_16x16x32_bf16 a[28:31], a[160:163], a[196:199], a[28:31]
  ds_read_b128 a[148:151], v237 offset:0
  v_mfma_f32_16x16x32_bf16 a[24:27], a[160:163], a[192:195], a[24:27]
  ds_read_b128 a[152:155], v237 offset:512
  v_mfma_f32_16x16x32_bf16 a[20:23], a[160:163], a[188:191], a[20:23]
  buffer_load_dwordx4 v255, s[28:31], s55 offen offset:1024 sc1 lds
  v_mfma_f32_16x16x32_bf16 a[16:19], a[160:163], a[184:187], a[16:19]
  ds_read_b128 a[112:115], v240 offset:0
  v_mfma_f32_16x16x32_bf16 a[32:35], a[164:167], a[184:187], a[32:35]
  ds_read_b128 a[116:119], v240 offset:1024
  v_mfma_f32_16x16x32_bf16 a[36:39], a[164:167], a[188:191], a[36:39]
  buffer_load_dwordx4 v255, s[28:31], s55 offen offset:2048 sc1 lds
  v_mfma_f32_16x16x32_bf16 a[40:43], a[164:167], a[192:195], a[40:43]
  ds_read_b128 a[120:123], v240 offset:2048
  v_mfma_f32_16x16x32_bf16 a[44:47], a[164:167], a[196:199], a[44:47]
  ds_read_b128 a[124:127], v240 offset:3072
  v_mfma_f32_16x16x32_bf16 a[60:63], a[168:171], a[196:199], a[60:63]
  buffer_load_dwordx4 v242, s[28:31], s55 offen offset:3072 sc1 lds
  v_mfma_f32_16x16x32_bf16 a[56:59], a[168:171], a[192:195], a[56:59]
  ds_read_b128 a[128:131], v240 offset:4096
  v_mfma_f32_16x16x32_bf16 a[52:55], a[168:171], a[188:191], a[52:55]
  s_add_u32 m0, s57, 114688
  v_mfma_f32_16x16x32_bf16 a[48:51], a[168:171], a[184:187], a[48:51]
  ds_read_b128 a[132:135], v240 offset:5120
  v_mfma_f32_16x16x32_bf16 a[64:67], a[172:175], a[184:187], a[64:67]
  buffer_load_dwordx4 v232, s[16:19], s54 offen offset:0 lds
  v_mfma_f32_16x16x32_bf16 a[68:71], a[172:175], a[188:191], a[68:71]
  ds_read_b128 a[136:139], v240 offset:6144
  v_mfma_f32_16x16x32_bf16 a[72:75], a[172:175], a[192:195], a[72:75]
  s_add_u32 s55, s55, 229376
  v_mfma_f32_16x16x32_bf16 a[76:79], a[172:175], a[196:199], a[76:79]
  buffer_load_dwordx4 v233, s[16:19], s54 offen offset:1024 lds
  v_mfma_f32_16x16x32_bf16 a[92:95], a[176:179], a[196:199], a[92:95]
  v_mfma_f32_16x16x32_bf16 a[88:91], a[176:179], a[192:195], a[88:91]
  v_mfma_f32_16x16x32_bf16 a[84:87], a[176:179], a[188:191], a[84:87]
  buffer_load_dwordx4 v234, s[16:19], s54 offen offset:2048 lds
  v_mfma_f32_16x16x32_bf16 a[80:83], a[176:179], a[184:187], a[80:83]
  v_mfma_f32_16x16x32_bf16 a[96:99], a[180:183], a[184:187], a[96:99]
  v_mfma_f32_16x16x32_bf16 a[100:103], a[180:183], a[188:191], a[100:103]
  buffer_load_dwordx4 v235, s[16:19], s54 offen offset:3072 lds
  v_mfma_f32_16x16x32_bf16 a[104:107], a[180:183], a[192:195], a[104:107]
  s_add_u32 s54, s54, 128
  v_mfma_f32_16x16x32_bf16 a[108:111], a[180:183], a[196:199], a[108:111]
  s_waitcnt vmcnt(16) lgkmcnt(0)
  s_barrier
  v_mfma_f32_32x32x16_bf16 v[0:15], v[136:139], v[112:115], v[64:79]
  ds_read_b128 v[152:155], v172 offset:13312
  v_exp_f32 v16, v16
  v_exp_f32 v17, v17
  v_exp_f32 v18, v18
  v_mfma_f32_32x32x16_bf16 v[0:15], v[140:143], v[116:119], v[0:15]
  ds_read_b128 v[156:159], v172 offset:13824
  v_exp_f32 v19, v19
  v_exp_f32 v20, v20
  v_cvt_pk_bf16_f32 v104, v16, v17
  v_exp_f32 v21, v21
  v_mfma_f32_32x32x16_bf16 v[32:47], v[144:147], v[96:99], v[32:47]
  v_exp_f32 v22, v22
  v_cvt_pk_bf16_f32 v105, v18, v19
  v_exp_f32 v23, v23
  v_exp_f32 v24, v24
  v_cvt_pk_bf16_f32 v106, v20, v21
  v_mfma_f32_32x32x16_bf16 v[32:47], v[148:151], v[100:103], v[32:47]
  v_exp_f32 v25, v25
  v_exp_f32 v26, v26
  v_cvt_pk_bf16_f32 v107, v22, v23
  v_exp_f32 v27, v27
  v_mfma_f32_16x16x32_bf16 v[160:163], v[168:171], v[96:99], v[160:163]
  v_exp_f32 v28, v28
  v_cvt_pk_bf16_f32 v108, v24, v25
  v_exp_f32 v29, v29
  v_mfma_f32_16x16x32_bf16 v[160:163], v[168:171], v[100:103], v[160:163]
  s_waitcnt lgkmcnt(0)
  v_exp_f32 v30, v30
  v_cvt_pk_bf16_f32 v109, v26, v27
  v_exp_f32 v31, v31
  v_cvt_pk_bf16_f32 v110, v28, v29
  v_cvt_pk_bf16_f32 v111, v30, v31
  v_mfma_f32_16x16x32_bf16 a[0:3], a[112:115], a[140:143], a[0:3]
  ds_read_b128 a[184:187], v236 offset:32768
  v_mfma_f32_16x16x32_bf16 a[4:7], a[112:115], a[144:147], a[4:7]
  s_add_u32 m0, s57, 0
  v_mfma_f32_16x16x32_bf16 a[8:11], a[112:115], a[148:151], a[8:11]
  ds_read_b128 a[188:191], v236 offset:33280
  v_mfma_f32_16x16x32_bf16 a[12:15], a[112:115], a[152:155], a[12:15]
  buffer_load_dwordx4 v255, s[28:31], s55 offen offset:0 sc1 lds
  v_mfma_f32_16x16x32_bf16 a[28:31], a[116:119], a[152:155], a[28:31]
  ds_read_b128 a[192:195], v237 offset:32768
  v_mfma_f32_16x16x32_bf16 a[24:27], a[116:119], a[148:151], a[24:27]
  ds_read_b128 a[196:199], v237 offset:33280
  v_mfma_f32_16x16x32_bf16 a[20:23], a[116:119], a[144:147], a[20:23]
  buffer_load_dwordx4 v255, s[28:31], s55 offen offset:1024 sc1 lds
  v_mfma_f32_16x16x32_bf16 a[16:19], a[116:119], a[140:143], a[16:19]
  ds_read_b128 a[156:159], v240 offset:32768
  v_mfma_f32_16x16x32_bf16 a[32:35], a[120:123], a[140:143], a[32:35]
  ds_read_b128 a[160:163], v240 offset:33792
  v_mfma_f32_16x16x32_bf16 a[36:39], a[120:123], a[144:147], a[36:39]
  buffer_load_dwordx4 v255, s[28:31], s55 offen offset:2048 sc1 lds
  v_mfma_f32_16x16x32_bf16 a[40:43], a[120:123], a[148:151], a[40:43]
  ds_read_b128 a[164:167], v240 offset:34816
  v_mfma_f32_16x16x32_bf16 a[44:47], a[120:123], a[152:155], a[44:47]
  ds_read_b128 a[168:171], v240 offset:35840
  v_mfma_f32_16x16x32_bf16 a[60:63], a[124:127], a[152:155], a[60:63]
  buffer_load_dwordx4 v242, s[28:31], s55 offen offset:3072 sc1 lds
  v_mfma_f32_16x16x32_bf16 a[56:59], a[124:127], a[148:151], a[56:59]
  ds_read_b128 a[172:175], v240 offset:36864
  v_mfma_f32_16x16x32_bf16 a[52:55], a[124:127], a[144:147], a[52:55]
  s_add_u32 m0, s57, 16384
  v_mfma_f32_16x16x32_bf16 a[48:51], a[124:127], a[140:143], a[48:51]
  ds_read_b128 a[176:179], v240 offset:37888
  v_mfma_f32_16x16x32_bf16 a[64:67], a[128:131], a[140:143], a[64:67]
  buffer_load_dwordx4 v232, s[16:19], s54 offen offset:0 lds
  v_mfma_f32_16x16x32_bf16 a[68:71], a[128:131], a[144:147], a[68:71]
  ds_read_b128 a[180:183], v240 offset:38912
  v_mfma_f32_16x16x32_bf16 a[72:75], a[128:131], a[148:151], a[72:75]
  s_add_u32 s55, s55, 229376
  v_mfma_f32_16x16x32_bf16 a[76:79], a[128:131], a[152:155], a[76:79]
  buffer_load_dwordx4 v233, s[16:19], s54 offen offset:1024 lds
  v_mfma_f32_16x16x32_bf16 a[92:95], a[132:135], a[152:155], a[92:95]
  v_mfma_f32_16x16x32_bf16 a[88:91], a[132:135], a[148:151], a[88:91]
  v_mfma_f32_16x16x32_bf16 a[84:87], a[132:135], a[144:147], a[84:87]
  buffer_load_dwordx4 v234, s[16:19], s54 offen offset:2048 lds
  v_mfma_f32_16x16x32_bf16 a[80:83], a[132:135], a[140:143], a[80:83]
  v_mfma_f32_16x16x32_bf16 a[96:99], a[136:139], a[140:143], a[96:99]
  v_mfma_f32_16x16x32_bf16 a[100:103], a[136:139], a[144:147], a[100:103]
  buffer_load_dwordx4 v235, s[16:19], s54 offen offset:3072 lds
  v_mfma_f32_16x16x32_bf16 a[104:107], a[136:139], a[148:151], a[104:107]
  s_add_u32 s54, s54, 128
  v_mfma_f32_16x16x32_bf16 a[108:111], a[136:139], a[152:155], a[108:111]
  s_waitcnt vmcnt(16) lgkmcnt(0)
  s_barrier
  v_mfma_f32_16x16x32_bf16 a[0:3], a[156:159], a[184:187], a[0:3]
  ds_read_b128 a[140:143], v238 offset:0
  v_mfma_f32_16x16x32_bf16 a[4:7], a[156:159], a[188:191], a[4:7]
  s_add_u32 m0, s57, 32768
  v_mfma_f32_16x16x32_bf16 a[8:11], a[156:159], a[192:195], a[8:11]
  ds_read_b128 a[144:147], v238 offset:512
  v_mfma_f32_16x16x32_bf16 a[12:15], a[156:159], a[196:199], a[12:15]
  buffer_load_dwordx4 v255, s[28:31], s55 offen offset:0 sc1 lds
  v_mfma_f32_16x16x32_bf16 a[28:31], a[160:163], a[196:199], a[28:31]
  ds_read_b128 a[148:151], v239 offset:0
  v_mfma_f32_16x16x32_bf16 a[24:27], a[160:163], a[192:195], a[24:27]
  ds_read_b128 a[152:155], v239 offset:512
  v_mfma_f32_16x16x32_bf16 a[20:23], a[160:163], a[188:191], a[20:23]
  buffer_load_dwordx4 v255, s[28:31], s55 offen offset:1024 sc1 lds
  v_mfma_f32_16x16x32_bf16 a[16:19], a[160:163], a[184:187], a[16:19]
  ds_read_b128 a[112:115], v241 offset:0
  v_mfma_f32_16x16x32_bf16 a[32:35], a[164:167], a[184:187], a[32:35]
  ds_read_b128 a[116:119], v241 offset:1024
  v_mfma_f32_16x16x32_bf16 a[36:39], a[164:167], a[188:191], a[36:39]
  buffer_load_dwordx4 v255, s[28:31], s55 offen offset:2048 sc1 lds
  v_mfma_f32_16x16x32_bf16 a[40:43], a[164:167], a[192:195], a[40:43]
  ds_read_b128 a[120:123], v241 offset:2048
  v_mfma_f32_16x16x32_bf16 a[44:47], a[164:167], a[196:199], a[44:47]
  ds_read_b128 a[124:127], v241 offset:3072
  v_mfma_f32_16x16x32_bf16 a[60:63], a[168:171], a[196:199], a[60:63]
  buffer_load_dwordx4 v242, s[28:31], s55 offen offset:3072 sc1 lds
  v_mfma_f32_16x16x32_bf16 a[56:59], a[168:171], a[192:195], a[56:59]
  ds_read_b128 a[128:131], v241 offset:4096
  v_mfma_f32_16x16x32_bf16 a[52:55], a[168:171], a[188:191], a[52:55]
  s_add_u32 m0, s57, 49152
  v_mfma_f32_16x16x32_bf16 a[48:51], a[168:171], a[184:187], a[48:51]
  ds_read_b128 a[132:135], v241 offset:5120
  v_mfma_f32_16x16x32_bf16 a[64:67], a[172:175], a[184:187], a[64:67]
  buffer_load_dwordx4 v232, s[16:19], s54 offen offset:0 lds
  v_mfma_f32_16x16x32_bf16 a[68:71], a[172:175], a[188:191], a[68:71]
  ds_read_b128 a[136:139], v241 offset:6144
  v_mfma_f32_16x16x32_bf16 a[72:75], a[172:175], a[192:195], a[72:75]
  s_add_u32 s55, s55, 229376
  v_mfma_f32_16x16x32_bf16 a[76:79], a[172:175], a[196:199], a[76:79]
  buffer_load_dwordx4 v233, s[16:19], s54 offen offset:1024 lds
  v_mfma_f32_16x16x32_bf16 a[92:95], a[176:179], a[196:199], a[92:95]
  v_mfma_f32_16x16x32_bf16 a[88:91], a[176:179], a[192:195], a[88:91]
  v_mfma_f32_16x16x32_bf16 a[84:87], a[176:179], a[188:191], a[84:87]
  buffer_load_dwordx4 v234, s[16:19], s54 offen offset:2048 lds
  v_mfma_f32_16x16x32_bf16 a[80:83], a[176:179], a[184:187], a[80:83]
  v_mfma_f32_16x16x32_bf16 a[96:99], a[180:183], a[184:187], a[96:99]
  v_mfma_f32_16x16x32_bf16 a[100:103], a[180:183], a[188:191], a[100:103]
  buffer_load_dwordx4 v235, s[16:19], s54 offen offset:3072 lds
  v_mfma_f32_16x16x32_bf16 a[104:107], a[180:183], a[192:195], a[104:107]
  s_add_u32 s54, s54, 128
  v_mfma_f32_16x16x32_bf16 a[108:111], a[180:183], a[196:199], a[108:111]
  s_waitcnt vmcnt(16) lgkmcnt(0)
  s_barrier
  v_mfma_f32_32x32x16_bf16 v[16:31], v[136:139], v[120:123], v[80:95]
  ds_read_b128 v[128:131], v172 offset:16384
  v_exp_f32 v0, v0
  v_exp_f32 v1, v1
  v_exp_f32 v2, v2
  v_mfma_f32_32x32x16_bf16 v[16:31], v[140:143], v[124:127], v[16:31]
  ds_read_b128 v[132:135], v172 offset:16896
  v_exp_f32 v3, v3
  v_exp_f32 v4, v4
  v_cvt_pk_bf16_f32 v96, v0, v1
  v_exp_f32 v5, v5
  v_mfma_f32_32x32x16_bf16 v[48:63], v[144:147], v[104:107], v[48:63]
  s_add_u32 m0, s50, 8192
  v_exp_f32 v6, v6
  v_cvt_pk_bf16_f32 v97, v2, v3
  v_exp_f32 v7, v7
  v_exp_f32 v8, v8
  v_cvt_pk_bf16_f32 v98, v4, v5
  v_mfma_f32_32x32x16_bf16 v[48:63], v[148:151], v[108:111], v[48:63]
  buffer_load_dwordx4 v255, s[8:11], s49 offen sc1 lds
  v_exp_f32 v9, v9
  v_exp_f32 v10, v10
  v_cvt_pk_bf16_f32 v99, v6, v7
  v_exp_f32 v11, v11
  v_mfma_f32_16x16x32_bf16 v[164:167], v[168:171], v[104:107], v[164:167]
  buffer_load_dwordx4 v255, s[12:15], s49 offen offset:1024 sc1 lds
  s_add_u32 s49, s49, 4096
  v_exp_f32 v12, v12
  v_cvt_pk_bf16_f32 v100, v8, v9
  v_exp_f32 v13, v13
  v_mfma_f32_16x16x32_bf16 v[164:167], v[168:171], v[108:111], v[164:167]
  s_waitcnt lgkmcnt(0)
  v_exp_f32 v14, v14
  v_cvt_pk_bf16_f32 v101, v10, v11
  v_exp_f32 v15, v15
  v_cvt_pk_bf16_f32 v102, v12, v13
  v_cvt_pk_bf16_f32 v103, v14, v15
  v_mfma_f32_16x16x32_bf16 a[0:3], a[112:115], a[140:143], a[0:3]
  ds_read_b128 a[184:187], v238 offset:32768
  v_mfma_f32_16x16x32_bf16 a[4:7], a[112:115], a[144:147], a[4:7]
  s_add_u32 m0, s57, 65536
  v_mfma_f32_16x16x32_bf16 a[8:11], a[112:115], a[148:151], a[8:11]
  ds_read_b128 a[188:191], v238 offset:33280
  v_mfma_f32_16x16x32_bf16 a[12:15], a[112:115], a[152:155], a[12:15]
  buffer_load_dwordx4 v255, s[28:31], s55 offen offset:0 sc1 lds
  v_mfma_f32_16x16x32_bf16 a[28:31], a[116:119], a[152:155], a[28:31]
  ds_read_b128 a[192:195], v239 offset:32768
  v_mfma_f32_16x16x32_bf16 a[24:27], a[116:119], a[148:151], a[24:27]
  ds_read_b128 a[196:199], v239 offset:33280
  v_mfma_f32_16x16x32_bf16 a[20:23], a[116:119], a[144:147], a[20:23]
  buffer_load_dwordx4 v255, s[28:31], s55 offen offset:1024 sc1 lds
  v_mfma_f32_16x16x32_bf16 a[16:19], a[116:119], a[140:143], a[16:19]
  ds_read_b128 a[156:159], v241 offset:32768
  v_mfma_f32_16x16x32_bf16 a[32:35], a[120:123], a[140:143], a[32:35]
  ds_read_b128 a[160:163], v241 offset:33792
  v_mfma_f32_16x16x32_bf16 a[36:39], a[120:123], a[144:147], a[36:39]
  buffer_load_dwordx4 v255, s[28:31], s55 offen offset:2048 sc1 lds
  v_mfma_f32_16x16x32_bf16 a[40:43], a[120:123], a[148:151], a[40:43]
  ds_read_b128 a[164:167], v241 offset:34816
  v_mfma_f32_16x16x32_bf16 a[44:47], a[120:123], a[152:155], a[44:47]
  ds_read_b128 a[168:171], v241 offset:35840
  v_mfma_f32_16x16x32_bf16 a[60:63], a[124:127], a[152:155], a[60:63]
  buffer_load_dwordx4 v242, s[28:31], s55 offen offset:3072 sc1 lds
  v_mfma_f32_16x16x32_bf16 a[56:59], a[124:127], a[148:151], a[56:59]
  ds_read_b128 a[172:175], v241 offset:36864
  v_mfma_f32_16x16x32_bf16 a[52:55], a[124:127], a[144:147], a[52:55]
  s_add_u32 m0, s57, 81920
  v_mfma_f32_16x16x32_bf16 a[48:51], a[124:127], a[140:143], a[48:51]
  ds_read_b128 a[176:179], v241 offset:37888
  v_mfma_f32_16x16x32_bf16 a[64:67], a[128:131], a[140:143], a[64:67]
  buffer_load_dwordx4 v232, s[16:19], s54 offen offset:0 lds
  v_mfma_f32_16x16x32_bf16 a[68:71], a[128:131], a[144:147], a[68:71]
  ds_read_b128 a[180:183], v241 offset:38912
  v_mfma_f32_16x16x32_bf16 a[72:75], a[128:131], a[148:151], a[72:75]
  s_add_u32 s55, s55, 229376
  v_mfma_f32_16x16x32_bf16 a[76:79], a[128:131], a[152:155], a[76:79]
  buffer_load_dwordx4 v233, s[16:19], s54 offen offset:1024 lds
  v_mfma_f32_16x16x32_bf16 a[92:95], a[132:135], a[152:155], a[92:95]
  v_mfma_f32_16x16x32_bf16 a[88:91], a[132:135], a[148:151], a[88:91]
  v_mfma_f32_16x16x32_bf16 a[84:87], a[132:135], a[144:147], a[84:87]
  buffer_load_dwordx4 v234, s[16:19], s54 offen offset:2048 lds
  v_mfma_f32_16x16x32_bf16 a[80:83], a[132:135], a[140:143], a[80:83]
  v_mfma_f32_16x16x32_bf16 a[96:99], a[136:139], a[140:143], a[96:99]
  v_mfma_f32_16x16x32_bf16 a[100:103], a[136:139], a[144:147], a[100:103]
  buffer_load_dwordx4 v235, s[16:19], s54 offen offset:3072 lds
  v_mfma_f32_16x16x32_bf16 a[104:107], a[136:139], a[148:151], a[104:107]
  s_add_u32 s54, s54, 128
  v_mfma_f32_16x16x32_bf16 a[108:111], a[136:139], a[152:155], a[108:111]
  s_waitcnt vmcnt(18) lgkmcnt(0)
  s_barrier
  v_mfma_f32_16x16x32_bf16 a[0:3], a[156:159], a[184:187], a[0:3]
  ds_read_b128 a[140:143], v236 offset:0
  v_mfma_f32_16x16x32_bf16 a[4:7], a[156:159], a[188:191], a[4:7]
  s_add_u32 m0, s57, 98304
  v_mfma_f32_16x16x32_bf16 a[8:11], a[156:159], a[192:195], a[8:11]
  ds_read_b128 a[144:147], v236 offset:512
  v_mfma_f32_16x16x32_bf16 a[12:15], a[156:159], a[196:199], a[12:15]
  buffer_load_dwordx4 v255, s[28:31], s55 offen offset:0 sc1 lds
  v_mfma_f32_16x16x32_bf16 a[28:31], a[160:163], a[196:199], a[28:31]
  ds_read_b128 a[148:151], v237 offset:0
  v_mfma_f32_16x16x32_bf16 a[24:27], a[160:163], a[192:195], a[24:27]
  ds_read_b128 a[152:155], v237 offset:512
  v_mfma_f32_16x16x32_bf16 a[20:23], a[160:163], a[188:191], a[20:23]
  buffer_load_dwordx4 v255, s[28:31], s55 offen offset:1024 sc1 lds
  v_mfma_f32_16x16x32_bf16 a[16:19], a[160:163], a[184:187], a[16:19]
  ds_read_b128 a[112:115], v240 offset:0
  v_mfma_f32_16x16x32_bf16 a[32:35], a[164:167], a[184:187], a[32:35]
  ds_read_b128 a[116:119], v240 offset:1024
  v_mfma_f32_16x16x32_bf16 a[36:39], a[164:167], a[188:191], a[36:39]
  buffer_load_dwordx4 v255, s[28:31], s55 offen offset:2048 sc1 lds
  v_mfma_f32_16x16x32_bf16 a[40:43], a[164:167], a[192:195], a[40:43]
  ds_read_b128 a[120:123], v240 offset:2048
  v_mfma_f32_16x16x32_bf16 a[44:47], a[164:167], a[196:199], a[44:47]
  ds_read_b128 a[124:127], v240 offset:3072
  v_mfma_f32_16x16x32_bf16 a[60:63], a[168:171], a[196:199], a[60:63]
  buffer_load_dwordx4 v242, s[28:31], s55 offen offset:3072 sc1 lds
  v_mfma_f32_16x16x32_bf16 a[56:59], a[168:171], a[192:195], a[56:59]
  ds_read_b128 a[128:131], v240 offset:4096
  v_mfma_f32_16x16x32_bf16 a[52:55], a[168:171], a[188:191], a[52:55]
  s_add_u32 m0, s57, 114688
  v_mfma_f32_16x16x32_bf16 a[48:51], a[168:171], a[184:187], a[48:51]
  ds_read_b128 a[132:135], v240 offset:5120
  v_mfma_f32_16x16x32_bf16 a[64:67], a[172:175], a[184:187], a[64:67]
  buffer_load_dwordx4 v232, s[16:19], s54 offen offset:0 lds
  v_mfma_f32_16x16x32_bf16 a[68:71], a[172:175], a[188:191], a[68:71]
  ds_read_b128 a[136:139], v240 offset:6144
  v_mfma_f32_16x16x32_bf16 a[72:75], a[172:175], a[192:195], a[72:75]
  s_add_u32 s55, s55, 229376
  v_mfma_f32_16x16x32_bf16 a[76:79], a[172:175], a[196:199], a[76:79]
  buffer_load_dwordx4 v233, s[16:19], s54 offen offset:1024 lds
  v_mfma_f32_16x16x32_bf16 a[92:95], a[176:179], a[196:199], a[92:95]
  v_mfma_f32_16x16x32_bf16 a[88:91], a[176:179], a[192:195], a[88:91]
  v_mfma_f32_16x16x32_bf16 a[84:87], a[176:179], a[188:191], a[84:87]
  buffer_load_dwordx4 v234, s[16:19], s54 offen offset:2048 lds
  v_mfma_f32_16x16x32_bf16 a[80:83], a[176:179], a[184:187], a[80:83]
  v_mfma_f32_16x16x32_bf16 a[96:99], a[180:183], a[184:187], a[96:99]
  v_mfma_f32_16x16x32_bf16 a[100:103], a[180:183], a[188:191], a[100:103]
  buffer_load_dwordx4 v235, s[16:19], s54 offen offset:3072 lds
  v_mfma_f32_16x16x32_bf16 a[104:107], a[180:183], a[192:195], a[104:107]
  s_add_u32 s54, s54, 128
  v_mfma_f32_16x16x32_bf16 a[108:111], a[180:183], a[196:199], a[108:111]
  s_waitcnt vmcnt(18) lgkmcnt(0)
  s_barrier
  v_mfma_f32_32x32x16_bf16 v[0:15], v[128:131], v[112:115], v[64:79]
  ds_read_b128 v[144:147], v172 offset:17408
  v_exp_f32 v16, v16
  v_exp_f32 v17, v17
  v_exp_f32 v18, v18
  v_mfma_f32_32x32x16_bf16 v[0:15], v[132:135], v[116:119], v[0:15]
  ds_read_b128 v[148:151], v172 offset:17920
  v_exp_f32 v19, v19
  v_exp_f32 v20, v20
  v_cvt_pk_bf16_f32 v104, v16, v17
  v_exp_f32 v21, v21
  v_mfma_f32_32x32x16_bf16 v[32:47], v[152:155], v[96:99], v[32:47]
  v_exp_f32 v22, v22
  v_cvt_pk_bf16_f32 v105, v18, v19
  v_exp_f32 v23, v23
  v_exp_f32 v24, v24
  v_cvt_pk_bf16_f32 v106, v20, v21
  v_mfma_f32_32x32x16_bf16 v[32:47], v[156:159], v[100:103], v[32:47]
  v_exp_f32 v25, v25
  v_exp_f32 v26, v26
  v_cvt_pk_bf16_f32 v107, v22, v23
  v_exp_f32 v27, v27
  v_mfma_f32_16x16x32_bf16 v[160:163], v[168:171], v[96:99], v[160:163]
  v_exp_f32 v28, v28
  v_cvt_pk_bf16_f32 v108, v24, v25
  v_exp_f32 v29, v29
  v_mfma_f32_16x16x32_bf16 v[160:163], v[168:171], v[100:103], v[160:163]
  s_waitcnt lgkmcnt(0)
  v_exp_f32 v30, v30
  v_cvt_pk_bf16_f32 v109, v26, v27
  v_exp_f32 v31, v31
  v_cvt_pk_bf16_f32 v110, v28, v29
  v_cvt_pk_bf16_f32 v111, v30, v31
  v_mfma_f32_16x16x32_bf16 a[0:3], a[112:115], a[140:143], a[0:3]
  ds_read_b128 a[184:187], v236 offset:32768
  v_mfma_f32_16x16x32_bf16 a[4:7], a[112:115], a[144:147], a[4:7]
  v_mfma_f32_16x16x32_bf16 a[8:11], a[112:115], a[148:151], a[8:11]
  ds_read_b128 a[188:191], v236 offset:33280
  v_mfma_f32_16x16x32_bf16 a[12:15], a[112:115], a[152:155], a[12:15]
  v_mfma_f32_16x16x32_bf16 a[28:31], a[116:119], a[152:155], a[28:31]
  ds_read_b128 a[192:195], v237 offset:32768
  v_mfma_f32_16x16x32_bf16 a[24:27], a[116:119], a[148:151], a[24:27]
  ds_read_b128 a[196:199], v237 offset:33280
  v_mfma_f32_16x16x32_bf16 a[20:23], a[116:119], a[144:147], a[20:23]
  v_mfma_f32_16x16x32_bf16 a[16:19], a[116:119], a[140:143], a[16:19]
  ds_read_b128 a[156:159], v240 offset:32768
  v_mfma_f32_16x16x32_bf16 a[32:35], a[120:123], a[140:143], a[32:35]
  ds_read_b128 a[160:163], v240 offset:33792
  v_mfma_f32_16x16x32_bf16 a[36:39], a[120:123], a[144:147], a[36:39]
  v_mfma_f32_16x16x32_bf16 a[40:43], a[120:123], a[148:151], a[40:43]
  ds_read_b128 a[164:167], v240 offset:34816
  v_mfma_f32_16x16x32_bf16 a[44:47], a[120:123], a[152:155], a[44:47]
  ds_read_b128 a[168:171], v240 offset:35840
  v_mfma_f32_16x16x32_bf16 a[60:63], a[124:127], a[152:155], a[60:63]
  v_mfma_f32_16x16x32_bf16 a[56:59], a[124:127], a[148:151], a[56:59]
  ds_read_b128 a[172:175], v240 offset:36864
  v_mfma_f32_16x16x32_bf16 a[52:55], a[124:127], a[144:147], a[52:55]
  v_mfma_f32_16x16x32_bf16 a[48:51], a[124:127], a[140:143], a[48:51]
  ds_read_b128 a[176:179], v240 offset:37888
  v_mfma_f32_16x16x32_bf16 a[64:67], a[128:131], a[140:143], a[64:67]
  v_mfma_f32_16x16x32_bf16 a[68:71], a[128:131], a[144:147], a[68:71]
  ds_read_b128 a[180:183], v240 offset:38912
  v_mfma_f32_16x16x32_bf16 a[72:75], a[128:131], a[148:151], a[72:75]
  v_mfma_f32_16x16x32_bf16 a[76:79], a[128:131], a[152:155], a[76:79]
  v_mfma_f32_16x16x32_bf16 a[92:95], a[132:135], a[152:155], a[92:95]
  v_mfma_f32_16x16x32_bf16 a[88:91], a[132:135], a[148:151], a[88:91]
  v_mfma_f32_16x16x32_bf16 a[84:87], a[132:135], a[144:147], a[84:87]
  v_mfma_f32_16x16x32_bf16 a[80:83], a[132:135], a[140:143], a[80:83]
  v_mfma_f32_16x16x32_bf16 a[96:99], a[136:139], a[140:143], a[96:99]
  v_mfma_f32_16x16x32_bf16 a[100:103], a[136:139], a[144:147], a[100:103]
  v_mfma_f32_16x16x32_bf16 a[104:107], a[136:139], a[148:151], a[104:107]
  v_mfma_f32_16x16x32_bf16 a[108:111], a[136:139], a[152:155], a[108:111]
  s_waitcnt vmcnt(8) lgkmcnt(0)
  s_barrier
  v_mfma_f32_16x16x32_bf16 a[0:3], a[156:159], a[184:187], a[0:3]
  ds_read_b128 a[140:143], v238 offset:0
  v_mfma_f32_16x16x32_bf16 a[4:7], a[156:159], a[188:191], a[4:7]
  v_mfma_f32_16x16x32_bf16 a[8:11], a[156:159], a[192:195], a[8:11]
  ds_read_b128 a[144:147], v238 offset:512
  v_mfma_f32_16x16x32_bf16 a[12:15], a[156:159], a[196:199], a[12:15]
  v_mfma_f32_16x16x32_bf16 a[28:31], a[160:163], a[196:199], a[28:31]
  ds_read_b128 a[148:151], v239 offset:0
  v_mfma_f32_16x16x32_bf16 a[24:27], a[160:163], a[192:195], a[24:27]
  ds_read_b128 a[152:155], v239 offset:512
  v_mfma_f32_16x16x32_bf16 a[20:23], a[160:163], a[188:191], a[20:23]
  v_mfma_f32_16x16x32_bf16 a[16:19], a[160:163], a[184:187], a[16:19]
  ds_read_b128 a[112:115], v241 offset:0
  v_mfma_f32_16x16x32_bf16 a[32:35], a[164:167], a[184:187], a[32:35]
  ds_read_b128 a[116:119], v241 offset:1024
  v_mfma_f32_16x16x32_bf16 a[36:39], a[164:167], a[188:191], a[36:39]
  v_mfma_f32_16x16x32_bf16 a[40:43], a[164:167], a[192:195], a[40:43]
  ds_read_b128 a[120:123], v241 offset:2048
  v_mfma_f32_16x16x32_bf16 a[44:47], a[164:167], a[196:199], a[44:47]
  ds_read_b128 a[124:127], v241 offset:3072
  v_mfma_f32_16x16x32_bf16 a[60:63], a[168:171], a[196:199], a[60:63]
  v_mfma_f32_16x16x32_bf16 a[56:59], a[168:171], a[192:195], a[56:59]
  ds_read_b128 a[128:131], v241 offset:4096
  v_mfma_f32_16x16x32_bf16 a[52:55], a[168:171], a[188:191], a[52:55]
  v_mfma_f32_16x16x32_bf16 a[48:51], a[168:171], a[184:187], a[48:51]
  ds_read_b128 a[132:135], v241 offset:5120
  v_mfma_f32_16x16x32_bf16 a[64:67], a[172:175], a[184:187], a[64:67]
  v_mfma_f32_16x16x32_bf16 a[68:71], a[172:175], a[188:191], a[68:71]
  ds_read_b128 a[136:139], v241 offset:6144
  v_mfma_f32_16x16x32_bf16 a[72:75], a[172:175], a[192:195], a[72:75]
  v_mfma_f32_16x16x32_bf16 a[76:79], a[172:175], a[196:199], a[76:79]
  v_mfma_f32_16x16x32_bf16 a[92:95], a[176:179], a[196:199], a[92:95]
  v_mfma_f32_16x16x32_bf16 a[88:91], a[176:179], a[192:195], a[88:91]
  v_mfma_f32_16x16x32_bf16 a[84:87], a[176:179], a[188:191], a[84:87]
  v_mfma_f32_16x16x32_bf16 a[80:83], a[176:179], a[184:187], a[80:83]
  v_mfma_f32_16x16x32_bf16 a[96:99], a[180:183], a[184:187], a[96:99]
  v_mfma_f32_16x16x32_bf16 a[100:103], a[180:183], a[188:191], a[100:103]
  v_mfma_f32_16x16x32_bf16 a[104:107], a[180:183], a[192:195], a[104:107]
  v_mfma_f32_16x16x32_bf16 a[108:111], a[180:183], a[196:199], a[108:111]
  s_waitcnt vmcnt(0) lgkmcnt(0)
  s_barrier
  v_mfma_f32_32x32x16_bf16 v[16:31], v[128:131], v[120:123], v[80:95]
  ds_read_b128 v[136:139], v172 offset:20480
  v_exp_f32 v0, v0
  v_exp_f32 v1, v1
  v_exp_f32 v2, v2
  v_mfma_f32_32x32x16_bf16 v[16:31], v[132:135], v[124:127], v[16:31]
  ds_read_b128 v[140:143], v172 offset:20992
  v_exp_f32 v3, v3
  v_exp_f32 v4, v4
  v_cvt_pk_bf16_f32 v96, v0, v1
  v_exp_f32 v5, v5
  v_mfma_f32_32x32x16_bf16 v[48:63], v[152:155], v[104:107], v[48:63]
  buffer_load_dwordx4 v[200:203], v255, s[4:7], s58 offen sc1
  s_add_u32 s58, s58, 1024
  v_exp_f32 v6, v6
  v_cvt_pk_bf16_f32 v97, v2, v3
  v_exp_f32 v7, v7
  v_exp_f32 v8, v8
  v_cvt_pk_bf16_f32 v98, v4, v5
  v_mfma_f32_32x32x16_bf16 v[48:63], v[156:159], v[108:111], v[48:63]
  buffer_load_dwordx4 v[204:207], v255, s[4:7], s58 offen sc1
  s_add_u32 s58, s58, 1024
  v_exp_f32 v9, v9
  v_exp_f32 v10, v10
  v_cvt_pk_bf16_f32 v99, v6, v7
  v_exp_f32 v11, v11
  v_mfma_f32_16x16x32_bf16 v[164:167], v[168:171], v[104:107], v[164:167]
  buffer_load_dwordx4 v[208:211], v255, s[4:7], s58 offen sc1
  s_add_u32 s58, s58, 1024
  v_exp_f32 v12, v12
  v_cvt_pk_bf16_f32 v100, v8, v9
  v_exp_f32 v13, v13
  v_mfma_f32_16x16x32_bf16 v[164:167], v[168:171], v[108:111], v[164:167]
  s_waitcnt lgkmcnt(0)
  buffer_load_dwordx4 v[212:215], v255, s[4:7], s58 offen sc1
  s_add_u32 s58, s58, 1024
  v_exp_f32 v14, v14
  v_cvt_pk_bf16_f32 v101, v10, v11
  v_exp_f32 v15, v15
  v_cvt_pk_bf16_f32 v102, v12, v13
  v_cvt_pk_bf16_f32 v103, v14, v15
  v_mfma_f32_16x16x32_bf16 a[0:3], a[112:115], a[140:143], a[0:3]
  ds_read_b128 a[184:187], v238 offset:32768
  v_mfma_f32_16x16x32_bf16 a[4:7], a[112:115], a[144:147], a[4:7]
  v_mfma_f32_16x16x32_bf16 a[8:11], a[112:115], a[148:151], a[8:11]
  ds_read_b128 a[188:191], v238 offset:33280
  v_mfma_f32_16x16x32_bf16 a[12:15], a[112:115], a[152:155], a[12:15]
  v_mfma_f32_16x16x32_bf16 a[28:31], a[116:119], a[152:155], a[28:31]
  ds_read_b128 a[192:195], v239 offset:32768
  v_mfma_f32_16x16x32_bf16 a[24:27], a[116:119], a[148:151], a[24:27]
  ds_read_b128 a[196:199], v239 offset:33280
  v_mfma_f32_16x16x32_bf16 a[20:23], a[116:119], a[144:147], a[20:23]
  v_mfma_f32_16x16x32_bf16 a[16:19], a[116:119], a[140:143], a[16:19]
  ds_read_b128 a[156:159], v241 offset:32768
  v_mfma_f32_16x16x32_bf16 a[32:35], a[120:123], a[140:143], a[32:35]
  ds_read_b128 a[160:163], v241 offset:33792
  v_mfma_f32_16x16x32_bf16 a[36:39], a[120:123], a[144:147], a[36:39]
  v_mfma_f32_16x16x32_bf16 a[40:43], a[120:123], a[148:151], a[40:43]
  ds_read_b128 a[164:167], v241 offset:34816
  v_mfma_f32_16x16x32_bf16 a[44:47], a[120:123], a[152:155], a[44:47]
  ds_read_b128 a[168:171], v241 offset:35840
  v_mfma_f32_16x16x32_bf16 a[60:63], a[124:127], a[152:155], a[60:63]
  v_mfma_f32_16x16x32_bf16 a[56:59], a[124:127], a[148:151], a[56:59]
  ds_read_b128 a[172:175], v241 offset:36864
  v_mfma_f32_16x16x32_bf16 a[52:55], a[124:127], a[144:147], a[52:55]
  v_mfma_f32_16x16x32_bf16 a[48:51], a[124:127], a[140:143], a[48:51]
  ds_read_b128 a[176:179], v241 offset:37888
  v_mfma_f32_16x16x32_bf16 a[64:67], a[128:131], a[140:143], a[64:67]
  v_mfma_f32_16x16x32_bf16 a[68:71], a[128:131], a[144:147], a[68:71]
  ds_read_b128 a[180:183], v241 offset:38912
  v_mfma_f32_16x16x32_bf16 a[72:75], a[128:131], a[148:151], a[72:75]
  v_mfma_f32_16x16x32_bf16 a[76:79], a[128:131], a[152:155], a[76:79]
  v_mfma_f32_16x16x32_bf16 a[92:95], a[132:135], a[152:155], a[92:95]
  v_mfma_f32_16x16x32_bf16 a[88:91], a[132:135], a[148:151], a[88:91]
  v_mfma_f32_16x16x32_bf16 a[84:87], a[132:135], a[144:147], a[84:87]
  v_mfma_f32_16x16x32_bf16 a[80:83], a[132:135], a[140:143], a[80:83]
  v_mfma_f32_16x16x32_bf16 a[96:99], a[136:139], a[140:143], a[96:99]
  v_mfma_f32_16x16x32_bf16 a[100:103], a[136:139], a[144:147], a[100:103]
  v_mfma_f32_16x16x32_bf16 a[104:107], a[136:139], a[148:151], a[104:107]
  v_mfma_f32_16x16x32_bf16 a[108:111], a[136:139], a[152:155], a[108:111]
  s_waitcnt lgkmcnt(0)
  v_mfma_f32_16x16x32_bf16 a[0:3], a[156:159], a[184:187], a[0:3]
  v_mfma_f32_16x16x32_bf16 a[4:7], a[156:159], a[188:191], a[4:7]
  v_mfma_f32_16x16x32_bf16 a[8:11], a[156:159], a[192:195], a[8:11]
  v_mfma_f32_16x16x32_bf16 a[12:15], a[156:159], a[196:199], a[12:15]
  v_mfma_f32_16x16x32_bf16 a[28:31], a[160:163], a[196:199], a[28:31]
  v_mfma_f32_16x16x32_bf16 a[24:27], a[160:163], a[192:195], a[24:27]
  v_mfma_f32_16x16x32_bf16 a[20:23], a[160:163], a[188:191], a[20:23]
  v_mfma_f32_16x16x32_bf16 a[16:19], a[160:163], a[184:187], a[16:19]
  v_mfma_f32_16x16x32_bf16 a[32:35], a[164:167], a[184:187], a[32:35]
  v_mfma_f32_16x16x32_bf16 a[36:39], a[164:167], a[188:191], a[36:39]
  v_mfma_f32_16x16x32_bf16 a[40:43], a[164:167], a[192:195], a[40:43]
  v_mfma_f32_16x16x32_bf16 a[44:47], a[164:167], a[196:199], a[44:47]
  v_mfma_f32_16x16x32_bf16 a[60:63], a[168:171], a[196:199], a[60:63]
  v_mfma_f32_16x16x32_bf16 a[56:59], a[168:171], a[192:195], a[56:59]
  v_mfma_f32_16x16x32_bf16 a[52:55], a[168:171], a[188:191], a[52:55]
  v_mfma_f32_16x16x32_bf16 a[48:51], a[168:171], a[184:187], a[48:51]
  v_mfma_f32_16x16x32_bf16 a[64:67], a[172:175], a[184:187], a[64:67]
  v_mfma_f32_16x16x32_bf16 a[68:71], a[172:175], a[188:191], a[68:71]
  v_mfma_f32_16x16x32_bf16 a[72:75], a[172:175], a[192:195], a[72:75]
  v_mfma_f32_16x16x32_bf16 a[76:79], a[172:175], a[196:199], a[76:79]
  v_mfma_f32_16x16x32_bf16 a[92:95], a[176:179], a[196:199], a[92:95]
  v_mfma_f32_16x16x32_bf16 a[88:91], a[176:179], a[192:195], a[88:91]
  v_mfma_f32_16x16x32_bf16 a[84:87], a[176:179], a[188:191], a[84:87]
  v_mfma_f32_16x16x32_bf16 a[80:83], a[176:179], a[184:187], a[80:83]
  v_mfma_f32_16x16x32_bf16 a[96:99], a[180:183], a[184:187], a[96:99]
  v_mfma_f32_16x16x32_bf16 a[100:103], a[180:183], a[188:191], a[100:103]
  v_mfma_f32_16x16x32_bf16 a[104:107], a[180:183], a[192:195], a[104:107]
  v_mfma_f32_16x16x32_bf16 a[108:111], a[180:183], a[196:199], a[108:111]
  v_mfma_f32_32x32x16_bf16 v[0:15], v[136:139], v[112:115], v[64:79]
  ds_read_b128 v[152:155], v172 offset:21504
  v_exp_f32 v16, v16
  v_exp_f32 v17, v17
  v_exp_f32 v18, v18
  v_mfma_f32_32x32x16_bf16 v[0:15], v[140:143], v[116:119], v[0:15]
  ds_read_b128 v[156:159], v172 offset:22016
  v_exp_f32 v19, v19
  v_exp_f32 v20, v20
  v_cvt_pk_bf16_f32 v104, v16, v17
  v_exp_f32 v21, v21
  v_mfma_f32_32x32x16_bf16 v[32:47], v[144:147], v[96:99], v[32:47]
  buffer_load_dwordx4 v[216:219], v255, s[4:7], s58 offen sc1
  s_add_u32 s58, s58, 1024
  v_exp_f32 v22, v22
  v_cvt_pk_bf16_f32 v105, v18, v19
  v_exp_f32 v23, v23
  v_exp_f32 v24, v24
  v_cvt_pk_bf16_f32 v106, v20, v21
  v_mfma_f32_32x32x16_bf16 v[32:47], v[148:151], v[100:103], v[32:47]
  buffer_load_dwordx4 v[220:223], v255, s[4:7], s58 offen sc1
  s_add_u32 s58, s58, 1024
  v_exp_f32 v25, v25
  v_exp_f32 v26, v26
  v_cvt_pk_bf16_f32 v107, v22, v23
  v_exp_f32 v27, v27
  v_mfma_f32_16x16x32_bf16 v[160:163], v[168:171], v[96:99], v[160:163]
  buffer_load_dwordx4 v[224:227], v255, s[4:7], s58 offen sc1
  s_add_u32 s58, s58, 1024
  v_exp_f32 v28, v28
  v_cvt_pk_bf16_f32 v108, v24, v25
  v_exp_f32 v29, v29
  v_mfma_f32_16x16x32_bf16 v[160:163], v[168:171], v[100:103], v[160:163]
  s_waitcnt vmcnt(63) lgkmcnt(0)
  s_barrier
  v_exp_f32 v30, v30
  v_cvt_pk_bf16_f32 v109, v26, v27
  v_exp_f32 v31, v31
  v_cvt_pk_bf16_f32 v110, v28, v29
  v_cvt_pk_bf16_f32 v111, v30, v31
  s_waitcnt vmcnt(0)
  s_lshl_b32 s68, s44, 14
  s_add_u32 s68, s68, 32768
  v_add_u32 v196, s68, v255
  s_xor_b32 s69, s68, 16384
  v_add_u32 v197, s69, v255
  s_barrier
  ds_write_b128 v196, a[8:11] offset:0
  ds_write_b128 v196, a[12:15] offset:1024
  ds_write_b128 v196, a[24:27] offset:2048
  ds_write_b128 v196, a[28:31] offset:3072
  ds_write_b128 v196, a[40:43] offset:4096
  ds_write_b128 v196, a[44:47] offset:5120
  ds_write_b128 v196, a[56:59] offset:6144
  ds_write_b128 v196, a[60:63] offset:7168
  ds_write_b128 v196, a[72:75] offset:8192
  ds_write_b128 v196, a[76:79] offset:9216
  ds_write_b128 v196, a[88:91] offset:10240
  ds_write_b128 v196, a[92:95] offset:11264
  ds_write_b128 v196, a[104:107] offset:12288
  ds_write_b128 v196, a[108:111] offset:13312
  s_lshl_b32 s63, s44, 12
  s_lshl_b32 s60, s44, 11
  s_add_u32 s60, s60, 262144
  s_lshl_b32 s62, s44, 16
  s_lshl_b32 s52, s47, 8
  s_add_u32 s52, s52, 44044288
  s_lshl_b32 s51, s48, 4
  s_add_u32 s51, s51, s52
  s_lshl_b32 s68, s44, 2
  s_add_u32 s51, s51, s68
  s_cmp_eq_u32 s44, 0
  s_cselect_b32 s52, s52, 0x70000000
  v_lshrrev_b32 v192, 3, v254
  v_lshlrev_b32 v192, 11, v192
  v_bfe_u32 v193, v254, 1, 2
  v_lshrrev_b32 v194, 4, v254
  v_xor_b32 v193, v193, v194
  v_lshl_add_u32 v192, v193, 5, v192
  v_and_b32 v193, 1, v254
  v_lshl_add_u32 v192, v193, 4, v192
  s_lshl_b32 s65, s48, 7
  v_add_u32 v232, s65, v192
  v_add_u32 v233, 15360, v232
  v_add_u32 v234, 30720, v232
  v_add_u32 v235, 46080, v232
  s_mov_b32 s65, 32768
  v_lshrrev_b32 v192, 2, v254
  v_bfe_u32 v193, v254, 3, 2
  v_lshlrev_b32 v192, 7, v192
  v_and_b32 v194, 3, v254
  v_lshl_add_u32 v192, v194, 3, v192
  v_add_u32 v192, s65, v192
  v_xor_b32 v194, 0, v193
  v_lshl_add_u32 v236, v194, 5, v192
  v_add_u32 v240, 65536, v236
  v_xor_b32 v194, 1, v193
  v_lshl_add_u32 v237, v194, 5, v192
  v_add_u32 v241, 65536, v237
  v_xor_b32 v194, 2, v193
  v_lshl_add_u32 v238, v194, 5, v192
  v_add_u32 v242, 65536, v238
  v_xor_b32 v194, 3, v193
  v_lshl_add_u32 v239, v194, 5, v192
  v_add_u32 v243, 65536, v239
  v_lshlrev_b32 v249, 3, v254
  s_mul_i32 s68, s48, 7
  s_lshr_b32 s68, s68, 1
  s_add_u32 s68, s68, 32
  s_lshl_b32 s68, s68, 13
  s_lshl_b32 s69, s44, 11
  s_add_u32 s68, s68, s69
  s_waitcnt lgkmcnt(0)
  s_barrier
  s_bitcmp1_b32 s48, 0
  s_cbranch_scc1 gated_mix__mha_block__mixer_gmlp__prompt_kernel_epodd
  ds_read_b128 v[188:191], v197 offset:0
  ds_read_b128 v[192:195], v197 offset:2048
  v_accvgpr_read_b32 v180, a0
  v_accvgpr_read_b32 v181, a1
  v_accvgpr_read_b32 v182, a2
  v_accvgpr_read_b32 v183, a3
  ds_read_b128 v[244:247], v197 offset:1024
  v_lshlrev_b32 v184, 16, v200
  v_and_b32 v185, 0xffff0000, v200
  v_lshlrev_b32 v186, 16, v201
  v_and_b32 v187, 0xffff0000, v201
  s_waitcnt lgkmcnt(2)
  v_pk_add_f32 v[180:181], v[180:181], v[188:189]
  v_pk_add_f32 v[182:183], v[182:183], v[190:191]
  v_pk_mul_f32 v[180:181], v[180:181], v[184:185]
  v_pk_mul_f32 v[182:183], v[182:183], v[186:187]
  v_cvt_pk_bf16_f32 v228, v180, v181
  v_cvt_pk_bf16_f32 v229, v182, v183
  v_accvgpr_read_b32 v180, a16
  v_accvgpr_read_b32 v181, a17
  v_accvgpr_read_b32 v182, a18
  v_accvgpr_read_b32 v183, a19
  ds_read_b128 v[188:191], v197 offset:3072
  v_lshlrev_b32 v184, 16, v204
  v_and_b32 v185, 0xffff0000, v204
  v_lshlrev_b32 v186, 16, v205
  v_and_b32 v187, 0xffff0000, v205
  s_waitcnt lgkmcnt(2)
  v_pk_add_f32 v[180:181], v[180:181], v[192:193]
  v_pk_add_f32 v[182:183], v[182:183], v[194:195]
  v_pk_mul_f32 v[180:181], v[180:181], v[184:185]
  v_pk_mul_f32 v[182:183], v[182:183], v[186:187]
  v_cvt_pk_bf16_f32 v230, v180, v181
  v_cvt_pk_bf16_f32 v231, v182, v183
  buffer_store_dwordx4 v[228:231], v255, s[36:39], s68 offen offset:0 sc1
  v_accvgpr_read_b32 v180, a4
  v_accvgpr_read_b32 v181, a5
  v_accvgpr_read_b32 v182, a6
  v_accvgpr_read_b32 v183, a7
  ds_read_b128 v[192:195], v197 offset:4096
  v_lshlrev_b32 v184, 16, v202
  v_and_b32 v185, 0xffff0000, v202
  v_lshlrev_b32 v186, 16, v203
  v_and_b32 v187, 0xffff0000, v203
  s_waitcnt lgkmcnt(2)
  v_pk_add_f32 v[180:181], v[180:181], v[244:245]
  v_pk_add_f32 v[182:183], v[182:183], v[246:247]
  v_pk_mul_f32 v[180:181], v[180:181], v[184:185]
  v_pk_mul_f32 v[182:183], v[182:183], v[186:187]
  v_cvt_pk_bf16_f32 v200, v180, v181
  v_cvt_pk_bf16_f32 v201, v182, v183
  v_accvgpr_read_b32 v180, a20
  v_accvgpr_read_b32 v181, a21
  v_accvgpr_read_b32 v182, a22
  v_accvgpr_read_b32 v183, a23
  ds_read_b128 v[244:247], v197 offset:6144
  v_lshlrev_b32 v184, 16, v206
  v_and_b32 v185, 0xffff0000, v206
  v_lshlrev_b32 v186, 16, v207
  v_and_b32 v187, 0xffff0000, v207
  s_waitcnt lgkmcnt(2)
  v_pk_add_f32 v[180:181], v[180:181], v[188:189]
  v_pk_add_f32 v[182:183], v[182:183], v[190:191]
  v_pk_mul_f32 v[180:181], v[180:181], v[184:185]
  v_pk_mul_f32 v[182:183], v[182:183], v[186:187]
  v_cvt_pk_bf16_f32 v202, v180, v181
  v_cvt_pk_bf16_f32 v203, v182, v183
  buffer_store_dwordx4 v[200:203], v255, s[36:39], s68 offen offset:1024 sc1
  s_add_u32 s68, s68, 8192
  v_accvgpr_read_b32 v180, a32
  v_accvgpr_read_b32 v181, a33
  v_accvgpr_read_b32 v182, a34
  v_accvgpr_read_b32 v183, a35
  ds_read_b128 v[188:191], v197 offset:5120
  v_lshlrev_b32 v184, 16, v208
  v_and_b32 v185, 0xffff0000, v208
  v_lshlrev_b32 v186, 16, v209
  v_and_b32 v187, 0xffff0000, v209
  s_waitcnt lgkmcnt(2)
  v_pk_add_f32 v[180:181], v[180:181], v[192:193]
  v_pk_add_f32 v[182:183], v[182:183], v[194:195]
  v_pk_mul_f32 v[180:181], v[180:181], v[184:185]
  v_pk_mul_f32 v[182:183], v[182:183], v[186:187]
  v_cvt_pk_bf16_f32 v228, v180, v181
  v_cvt_pk_bf16_f32 v229, v182, v183
  v_accvgpr_read_b32 v180, a48
  v_accvgpr_read_b32 v181, a49
  v_accvgpr_read_b32 v182, a50
  v_accvgpr_read_b32 v183, a51
  ds_read_b128 v[192:195], v197 offset:7168
  v_lshlrev_b32 v184, 16, v212
  v_and_b32 v185, 0xffff0000, v212
  v_lshlrev_b32 v186, 16, v213
  v_and_b32 v187, 0xffff0000, v213
  s_waitcnt lgkmcnt(2)
  v_pk_add_f32 v[180:181], v[180:181], v[244:245]
  v_pk_add_f32 v[182:183], v[182:183], v[246:247]
  v_pk_mul_f32 v[180:181], v[180:181], v[184:185]
  v_pk_mul_f32 v[182:183], v[182:183], v[186:187]
  v_cvt_pk_bf16_f32 v230, v180, v181
  v_cvt_pk_bf16_f32 v231, v182, v183
  buffer_store_dwordx4 v[228:231], v255, s[36:39], s68 offen offset:0 sc1
  v_accvgpr_read_b32 v180, a36
  v_accvgpr_read_b32 v181, a37
  v_accvgpr_read_b32 v182, a38
  v_accvgpr_read_b32 v183, a39
  ds_read_b128 v[244:247], v197 offset:8192
  v_lshlrev_b32 v184, 16, v210
  v_and_b32 v185, 0xffff0000, v210
  v_lshlrev_b32 v186, 16, v211
  v_and_b32 v187, 0xffff0000, v211
  s_waitcnt lgkmcnt(2)
  v_pk_add_f32 v[180:181], v[180:181], v[188:189]
  v_pk_add_f32 v[182:183], v[182:183], v[190:191]
  v_pk_mul_f32 v[180:181], v[180:181], v[184:185]
  v_pk_mul_f32 v[182:183], v[182:183], v[186:187]
  v_cvt_pk_bf16_f32 v200, v180, v181
  v_cvt_pk_bf16_f32 v201, v182, v183
  v_accvgpr_read_b32 v180, a52
  v_accvgpr_read_b32 v181, a53
  v_accvgpr_read_b32 v182, a54
  v_accvgpr_read_b32 v183, a55
  ds_read_b128 v[188:191], v197 offset:10240
  v_lshlrev_b32 v184, 16, v214
  v_and_b32 v185, 0xffff0000, v214
  v_lshlrev_b32 v186, 16, v215
  v_and_b32 v187, 0xffff0000, v215
  s_waitcnt lgkmcnt(2)
  v_pk_add_f32 v[180:181], v[180:181], v[192:193]
  v_pk_add_f32 v[182:183], v[182:183], v[194:195]
  v_pk_mul_f32 v[180:181], v[180:181], v[184:185]
  v_pk_mul_f32 v[182:183], v[182:183], v[186:187]
  v_cvt_pk_bf16_f32 v202, v180, v181
  v_cvt_pk_bf16_f32 v203, v182, v183
  buffer_store_dwordx4 v[200:203], v255, s[36:39], s68 offen offset:1024 sc1
  s_add_u32 s68, s68, 8192
  v_accvgpr_read_b32 v180, a64
  v_accvgpr_read_b32 v181, a65
  v_accvgpr_read_b32 v182, a66
  v_accvgpr_read_b32 v183, a67
  ds_read_b128 v[192:195], v197 offset:9216
  v_lshlrev_b32 v184, 16, v216
  v_and_b32 v185, 0xffff0000, v216
  v_lshlrev_b32 v186, 16, v217
  v_and_b32 v187, 0xffff0000, v217
  s_waitcnt lgkmcnt(2)
  v_pk_add_f32 v[180:181], v[180:181], v[244:245]
  v_pk_add_f32 v[182:183], v[182:183], v[246:247]
  v_pk_mul_f32 v[180:181], v[180:181], v[184:185]
  v_pk_mul_f32 v[182:183], v[182:183], v[186:187]
  v_cvt_pk_bf16_f32 v228, v180, v181
  v_cvt_pk_bf16_f32 v229, v182, v183
  v_accvgpr_read_b32 v180, a80
  v_accvgpr_read_b32 v181, a81
  v_accvgpr_read_b32 v182, a82
  v_accvgpr_read_b32 v183, a83
  ds_read_b128 v[244:247], v197 offset:11264
  v_lshlrev_b32 v184, 16, v220
  v_and_b32 v185, 0xffff0000, v220
  v_lshlrev_b32 v186, 16, v221
  v_and_b32 v187, 0xffff0000, v221
  s_waitcnt lgkmcnt(2)
  v_pk_add_f32 v[180:181], v[180:181], v[188:189]
  v_pk_add_f32 v[182:183], v[182:183], v[190:191]
  v_pk_mul_f32 v[180:181], v[180:181], v[184:185]
  v_pk_mul_f32 v[182:183], v[182:183], v[186:187]
  v_cvt_pk_bf16_f32 v230, v180, v181
  v_cvt_pk_bf16_f32 v231, v182, v183
  buffer_store_dwordx4 v[228:231], v255, s[36:39], s68 offen offset:0 sc1
  v_accvgpr_read_b32 v180, a68
  v_accvgpr_read_b32 v181, a69
  v_accvgpr_read_b32 v182, a70
  v_accvgpr_read_b32 v183, a71
  ds_read_b128 v[188:191], v197 offset:12288
  v_lshlrev_b32 v184, 16, v218
  v_and_b32 v185, 0xffff0000, v218
  v_lshlrev_b32 v186, 16, v219
  v_and_b32 v187, 0xffff0000, v219
  s_waitcnt lgkmcnt(2)
  v_pk_add_f32 v[180:181], v[180:181], v[192:193]
  v_pk_add_f32 v[182:183], v[182:183], v[194:195]
  v_pk_mul_f32 v[180:181], v[180:181], v[184:185]
  v_pk_mul_f32 v[182:183], v[182:183], v[186:187]
  v_cvt_pk_bf16_f32 v200, v180, v181
  v_cvt_pk_bf16_f32 v201, v182, v183
  v_accvgpr_read_b32 v180, a84
  v_accvgpr_read_b32 v181, a85
  v_accvgpr_read_b32 v182, a86
  v_accvgpr_read_b32 v183, a87
  ds_read_b128 v[192:195], v197 offset:13312
  v_lshlrev_b32 v184, 16, v222
  v_and_b32 v185, 0xffff0000, v222
  v_lshlrev_b32 v186, 16, v223
  v_and_b32 v187, 0xffff0000, v223
  s_waitcnt lgkmcnt(2)
  v_pk_add_f32 v[180:181], v[180:181], v[244:245]
  v_pk_add_f32 v[182:183], v[182:183], v[246:247]
  v_pk_mul_f32 v[180:181], v[180:181], v[184:185]
  v_pk_mul_f32 v[182:183], v[182:183], v[186:187]
  v_cvt_pk_bf16_f32 v202, v180, v181
  v_cvt_pk_bf16_f32 v203, v182, v183
  buffer_store_dwordx4 v[200:203], v255, s[36:39], s68 offen offset:1024 sc1
  s_add_u32 s68, s68, 8192
  v_accvgpr_read_b32 v180, a96
  v_accvgpr_read_b32 v181, a97
  v_accvgpr_read_b32 v182, a98
  v_accvgpr_read_b32 v183, a99
  v_lshlrev_b32 v184, 16, v224
  v_and_b32 v185, 0xffff0000, v224
  v_lshlrev_b32 v186, 16, v225
  v_and_b32 v187, 0xffff0000, v225
  s_waitcnt lgkmcnt(1)
  v_pk_add_f32 v[180:181], v[180:181], v[188:189]
  v_pk_add_f32 v[182:183], v[182:183], v[190:191]
  v_pk_mul_f32 v[180:181], v[180:181], v[184:185]
  v_pk_mul_f32 v[182:183], v[182:183], v[186:187]
  v_cvt_pk_bf16_f32 v228, v180, v181
  v_cvt_pk_bf16_f32 v229, v182, v183
  buffer_store_dwordx2 v[228:229], v249, s[36:39], s68 offen offset:0 sc1
  v_accvgpr_read_b32 v180, a100
  v_accvgpr_read_b32 v181, a101
  v_accvgpr_read_b32 v182, a102
  v_accvgpr_read_b32 v183, a103
  v_lshlrev_b32 v184, 16, v226
  v_and_b32 v185, 0xffff0000, v226
  v_lshlrev_b32 v186, 16, v227
  v_and_b32 v187, 0xffff0000, v227
  s_waitcnt lgkmcnt(0)
  v_pk_add_f32 v[180:181], v[180:181], v[192:193]
  v_pk_add_f32 v[182:183], v[182:183], v[194:195]
  v_pk_mul_f32 v[180:181], v[180:181], v[184:185]
  v_pk_mul_f32 v[182:183], v[182:183], v[186:187]
  v_cvt_pk_bf16_f32 v200, v180, v181
  v_cvt_pk_bf16_f32 v201, v182, v183
  buffer_store_dwordx2 v[200:201], v249, s[36:39], s68 offen offset:1024 sc1
  s_branch gated_mix__mha_block__mixer_gmlp__prompt_kernel_epdone
gated_mix__mha_block__mixer_gmlp__prompt_kernel_epodd:
  ds_read_b128 v[188:191], v197 offset:0
  ds_read_b128 v[192:195], v197 offset:1024
  v_accvgpr_read_b32 v180, a0
  v_accvgpr_read_b32 v181, a1
  v_accvgpr_read_b32 v182, a2
  v_accvgpr_read_b32 v183, a3
  ds_read_b128 v[244:247], v197 offset:2048
  v_lshlrev_b32 v184, 16, v200
  v_and_b32 v185, 0xffff0000, v200
  v_lshlrev_b32 v186, 16, v201
  v_and_b32 v187, 0xffff0000, v201
  s_waitcnt lgkmcnt(2)
  v_pk_add_f32 v[180:181], v[180:181], v[188:189]
  v_pk_add_f32 v[182:183], v[182:183], v[190:191]
  v_pk_mul_f32 v[180:181], v[180:181], v[184:185]
  v_pk_mul_f32 v[182:183], v[182:183], v[186:187]
  v_cvt_pk_bf16_f32 v230, v180, v181
  v_cvt_pk_bf16_f32 v231, v182, v183
  buffer_store_dwordx2 v[230:231], v249, s[36:39], s68 offen offset:512 sc1
  v_accvgpr_read_b32 v180, a4
  v_accvgpr_read_b32 v181, a5
  v_accvgpr_read_b32 v182, a6
  v_accvgpr_read_b32 v183, a7
  ds_read_b128 v[188:191], v197 offset:4096
  v_lshlrev_b32 v184, 16, v202
  v_and_b32 v185, 0xffff0000, v202
  v_lshlrev_b32 v186, 16, v203
  v_and_b32 v187, 0xffff0000, v203
  s_waitcnt lgkmcnt(2)
  v_pk_add_f32 v[180:181], v[180:181], v[192:193]
  v_pk_add_f32 v[182:183], v[182:183], v[194:195]
  v_pk_mul_f32 v[180:181], v[180:181], v[184:185]
  v_pk_mul_f32 v[182:183], v[182:183], v[186:187]
  v_cvt_pk_bf16_f32 v202, v180, v181
  v_cvt_pk_bf16_f32 v203, v182, v183
  buffer_store_dwordx2 v[202:203], v249, s[36:39], s68 offen offset:1536 sc1
  s_add_u32 s68, s68, 8192
  v_accvgpr_read_b32 v180, a16
  v_accvgpr_read_b32 v181, a17
  v_accvgpr_read_b32 v182, a18
  v_accvgpr_read_b32 v183, a19
  ds_read_b128 v[192:195], v197 offset:3072
  v_lshlrev_b32 v184, 16, v204
  v_and_b32 v185, 0xffff0000, v204
  v_lshlrev_b32 v186, 16, v205
  v_and_b32 v187, 0xffff0000, v205
  s_waitcnt lgkmcnt(2)
  v_pk_add_f32 v[180:181], v[180:181], v[244:245]
  v_pk_add_f32 v[182:183], v[182:183], v[246:247]
  v_pk_mul_f32 v[180:181], v[180:181], v[184:185]
  v_pk_mul_f32 v[182:183], v[182:183], v[186:187]
  v_cvt_pk_bf16_f32 v228, v180, v181
  v_cvt_pk_bf16_f32 v229, v182, v183
  v_accvgpr_read_b32 v180, a32
  v_accvgpr_read_b32 v181, a33
  v_accvgpr_read_b32 v182, a34
  v_accvgpr_read_b32 v183, a35
  ds_read_b128 v[244:247], v197 offset:5120
  v_lshlrev_b32 v184, 16, v208
  v_and_b32 v185, 0xffff0000, v208
  v_lshlrev_b32 v186, 16, v209
  v_and_b32 v187, 0xffff0000, v209
  s_waitcnt lgkmcnt(2)
  v_pk_add_f32 v[180:181], v[180:181], v[188:189]
  v_pk_add_f32 v[182:183], v[182:183], v[190:191]
  v_pk_mul_f32 v[180:181], v[180:181], v[184:185]
  v_pk_mul_f32 v[182:183], v[182:183], v[186:187]
  v_cvt_pk_bf16_f32 v230, v180, v181
  v_cvt_pk_bf16_f32 v231, v182, v183
  buffer_store_dwordx4 v[228:231], v255, s[36:39], s68 offen offset:0 sc1
  v_accvgpr_read_b32 v180, a20
  v_accvgpr_read_b32 v181, a21
  v_accvgpr_read_b32 v182, a22
  v_accvgpr_read_b32 v183, a23
  ds_read_b128 v[188:191], v197 offset:6144
  v_lshlrev_b32 v184, 16, v206
  v_and_b32 v185, 0xffff0000, v206
  v_lshlrev_b32 v186, 16, v207
  v_and_b32 v187, 0xffff0000, v207
  s_waitcnt lgkmcnt(2)
  v_pk_add_f32 v[180:181], v[180:181], v[192:193]
  v_pk_add_f32 v[182:183], v[182:183], v[194:195]
  v_pk_mul_f32 v[180:181], v[180:181], v[184:185]
  v_pk_mul_f32 v[182:183], v[182:183], v[186:187]
  v_cvt_pk_bf16_f32 v200, v180, v181
  v_cvt_pk_bf16_f32 v201, v182, v183
  v_accvgpr_read_b32 v180, a36
  v_accvgpr_read_b32 v181, a37
  v_accvgpr_read_b32 v182, a38
  v_accvgpr_read_b32 v183, a39
  ds_read_b128 v[192:195], v197 offset:8192
  v_lshlrev_b32 v184, 16, v210
  v_and_b32 v185, 0xffff0000, v210
  v_lshlrev_b32 v186, 16, v211
  v_and_b32 v187, 0xffff0000, v211
  s_waitcnt lgkmcnt(2)
  v_pk_add_f32 v[180:181], v[180:181], v[244:245]
  v_pk_add_f32 v[182:183], v[182:183], v[246:247]
  v_pk_mul_f32 v[180:181], v[180:181], v[184:185]
  v_pk_mul_f32 v[182:183], v[182:183], v[186:187]
  v_cvt_pk_bf16_f32 v202, v180, v181
  v_cvt_pk_bf16_f32 v203, v182, v183
  buffer_store_dwordx4 v[200:203], v255, s[36:39], s68 offen offset:1024 sc1
  s_add_u32 s68, s68, 8192
  v_accvgpr_read_b32 v180, a48
  v_accvgpr_read_b32 v181, a49
  v_accvgpr_read_b32 v182, a50
  v_accvgpr_read_b32 v183, a51
  ds_read_b128 v[244:247], v197 offset:7168
  v_lshlrev_b32 v184, 16, v212
  v_and_b32 v185, 0xffff0000, v212
  v_lshlrev_b32 v186, 16, v213
  v_and_b32 v187, 0xffff0000, v213
  s_waitcnt lgkmcnt(2)
  v_pk_add_f32 v[180:181], v[180:181], v[188:189]
  v_pk_add_f32 v[182:183], v[182:183], v[190:191]
  v_pk_mul_f32 v[180:181], v[180:181], v[184:185]
  v_pk_mul_f32 v[182:183], v[182:183], v[186:187]
  v_cvt_pk_bf16_f32 v228, v180, v181
  v_cvt_pk_bf16_f32 v229, v182, v183
  v_accvgpr_read_b32 v180, a64
  v_accvgpr_read_b32 v181, a65
  v_accvgpr_read_b32 v182, a66
  v_accvgpr_read_b32 v183, a67
  ds_read_b128 v[188:191], v197 offset:9216
  v_lshlrev_b32 v184, 16, v216
  v_and_b32 v185, 0xffff0000, v216
  v_lshlrev_b32 v186, 16, v217
  v_and_b32 v187, 0xffff0000, v217
  s_waitcnt lgkmcnt(2)
  v_pk_add_f32 v[180:181], v[180:181], v[192:193]
  v_pk_add_f32 v[182:183], v[182:183], v[194:195]
  v_pk_mul_f32 v[180:181], v[180:181], v[184:185]
  v_pk_mul_f32 v[182:183], v[182:183], v[186:187]
  v_cvt_pk_bf16_f32 v230, v180, v181
  v_cvt_pk_bf16_f32 v231, v182, v183
  buffer_store_dwordx4 v[228:231], v255, s[36:39], s68 offen offset:0 sc1
  v_accvgpr_read_b32 v180, a52
  v_accvgpr_read_b32 v181, a53
  v_accvgpr_read_b32 v182, a54
  v_accvgpr_read_b32 v183, a55
  ds_read_b128 v[192:195], v197 offset:10240
  v_lshlrev_b32 v184, 16, v214
  v_and_b32 v185, 0xffff0000, v214
  v_lshlrev_b32 v186, 16, v215
  v_and_b32 v187, 0xffff0000, v215
  s_waitcnt lgkmcnt(2)
  v_pk_add_f32 v[180:181], v[180:181], v[244:245]
  v_pk_add_f32 v[182:183], v[182:183], v[246:247]
  v_pk_mul_f32 v[180:181], v[180:181], v[184:185]
  v_pk_mul_f32 v[182:183], v[182:183], v[186:187]
  v_cvt_pk_bf16_f32 v200, v180, v181
  v_cvt_pk_bf16_f32 v201, v182, v183
  v_accvgpr_read_b32 v180, a68
  v_accvgpr_read_b32 v181, a69
  v_accvgpr_read_b32 v182, a70
  v_accvgpr_read_b32 v183, a71
  ds_read_b128 v[244:247], v197 offset:12288
  v_lshlrev_b32 v184, 16, v218
  v_and_b32 v185, 0xffff0000, v218
  v_lshlrev_b32 v186, 16, v219
  v_and_b32 v187, 0xffff0000, v219
  s_waitcnt lgkmcnt(2)
  v_pk_add_f32 v[180:181], v[180:181], v[188:189]
  v_pk_add_f32 v[182:183], v[182:183], v[190:191]
  v_pk_mul_f32 v[180:181], v[180:181], v[184:185]
  v_pk_mul_f32 v[182:183], v[182:183], v[186:187]
  v_cvt_pk_bf16_f32 v202, v180, v181
  v_cvt_pk_bf16_f32 v203, v182, v183
  buffer_store_dwordx4 v[200:203], v255, s[36:39], s68 offen offset:1024 sc1
  s_add_u32 s68, s68, 8192
  v_accvgpr_read_b32 v180, a80
  v_accvgpr_read_b32 v181, a81
  v_accvgpr_read_b32 v182, a82
  v_accvgpr_read_b32 v183, a83
  ds_read_b128 v[188:191], v197 offset:11264
  v_lshlrev_b32 v184, 16, v220
  v_and_b32 v185, 0xffff0000, v220
  v_lshlrev_b32 v186, 16, v221
  v_and_b32 v187, 0xffff0000, v221
  s_waitcnt lgkmcnt(2)
  v_pk_add_f32 v[180:181], v[180:181], v[192:193]
  v_pk_add_f32 v[182:183], v[182:183], v[194:195]
  v_pk_mul_f32 v[180:181], v[180:181], v[184:185]
  v_pk_mul_f32 v[182:183], v[182:183], v[186:187]
  v_cvt_pk_bf16_f32 v228, v180, v181
  v_cvt_pk_bf16_f32 v229, v182, v183
  v_accvgpr_read_b32 v180, a96
  v_accvgpr_read_b32 v181, a97
  v_accvgpr_read_b32 v182, a98
  v_accvgpr_read_b32 v183, a99
  ds_read_b128 v[192:195], v197 offset:13312
  v_lshlrev_b32 v184, 16, v224
  v_and_b32 v185, 0xffff0000, v224
  v_lshlrev_b32 v186, 16, v225
  v_and_b32 v187, 0xffff0000, v225
  s_waitcnt lgkmcnt(2)
  v_pk_add_f32 v[180:181], v[180:181], v[244:245]
  v_pk_add_f32 v[182:183], v[182:183], v[246:247]
  v_pk_mul_f32 v[180:181], v[180:181], v[184:185]
  v_pk_mul_f32 v[182:183], v[182:183], v[186:187]
  v_cvt_pk_bf16_f32 v230, v180, v181
  v_cvt_pk_bf16_f32 v231, v182, v183
  buffer_store_dwordx4 v[228:231], v255, s[36:39], s68 offen offset:0 sc1
  v_accvgpr_read_b32 v180, a84
  v_accvgpr_read_b32 v181, a85
  v_accvgpr_read_b32 v182, a86
  v_accvgpr_read_b32 v183, a87
  v_lshlrev_b32 v184, 16, v222
  v_and_b32 v185, 0xffff0000, v222
  v_lshlrev_b32 v186, 16, v223
  v_and_b32 v187, 0xffff0000, v223
  s_waitcnt lgkmcnt(1)
  v_pk_add_f32 v[180:181], v[180:181], v[188:189]
  v_pk_add_f32 v[182:183], v[182:183], v[190:191]
  v_pk_mul_f32 v[180:181], v[180:181], v[184:185]
  v_pk_mul_f32 v[182:183], v[182:183], v[186:187]
  v_cvt_pk_bf16_f32 v200, v180, v181
  v_cvt_pk_bf16_f32 v201, v182, v183
  v_accvgpr_read_b32 v180, a100
  v_accvgpr_read_b32 v181, a101
  v_accvgpr_read_b32 v182, a102
  v_accvgpr_read_b32 v183, a103
  v_lshlrev_b32 v184, 16, v226
  v_and_b32 v185, 0xffff0000, v226
  v_lshlrev_b32 v186, 16, v227
  v_and_b32 v187, 0xffff0000, v227
  s_waitcnt lgkmcnt(0)
  v_pk_add_f32 v[180:181], v[180:181], v[192:193]
  v_pk_add_f32 v[182:183], v[182:183], v[194:195]
  v_pk_mul_f32 v[180:181], v[180:181], v[184:185]
  v_pk_mul_f32 v[182:183], v[182:183], v[186:187]
  v_cvt_pk_bf16_f32 v202, v180, v181
  v_cvt_pk_bf16_f32 v203, v182, v183
  buffer_store_dwordx4 v[200:203], v255, s[36:39], s68 offen offset:1024 sc1
gated_mix__mha_block__mixer_gmlp__prompt_kernel_epdone:
  v_mfma_f32_32x32x16_bf16 v[16:31], v[136:139], v[120:123], v[80:95]
  ds_read_b128 v[128:131], v172 offset:24576
  v_exp_f32 v0, v0
  v_exp_f32 v1, v1
  v_exp_f32 v2, v2
  v_mfma_f32_32x32x16_bf16 v[16:31], v[140:143], v[124:127], v[16:31]
  ds_read_b128 v[132:135], v172 offset:25088
  v_exp_f32 v3, v3
  v_exp_f32 v4, v4
  v_cvt_pk_bf16_f32 v96, v0, v1
  v_exp_f32 v5, v5
  v_mfma_f32_32x32x16_bf16 v[48:63], v[144:147], v[104:107], v[48:63]
  s_add_u32 m0, s50, 16384
  v_exp_f32 v6, v6
  v_cvt_pk_bf16_f32 v97, v2, v3
  v_exp_f32 v7, v7
  v_exp_f32 v8, v8
  v_cvt_pk_bf16_f32 v98, v4, v5
  v_mfma_f32_32x32x16_bf16 v[48:63], v[148:151], v[108:111], v[48:63]
  buffer_load_dwordx4 v255, s[8:11], s49 offen sc1 lds
  v_exp_f32 v9, v9
  v_exp_f32 v10, v10
  v_cvt_pk_bf16_f32 v99, v6, v7
  v_exp_f32 v11, v11
  v_mfma_f32_16x16x32_bf16 v[164:167], v[168:171], v[104:107], v[164:167]
  buffer_load_dwordx4 v255, s[12:15], s49 offen offset:1024 sc1 lds
  s_add_u32 s49, s49, 4096
  v_exp_f32 v12, v12
  v_cvt_pk_bf16_f32 v100, v8, v9
  v_exp_f32 v13, v13
  v_mfma_f32_16x16x32_bf16 v[164:167], v[168:171], v[108:111], v[164:167]
  s_waitcnt lgkmcnt(0)
  v_exp_f32 v14, v14
  v_cvt_pk_bf16_f32 v101, v10, v11
  v_exp_f32 v15, v15
  v_cvt_pk_bf16_f32 v102, v12, v13
  v_cvt_pk_bf16_f32 v103, v14, v15
  v_mfma_f32_32x32x16_bf16 v[0:15], v[128:131], v[112:115], v[64:79]
  ds_read_b128 v[144:147], v172 offset:25600
  v_exp_f32 v16, v16
  v_exp_f32 v17, v17
  v_exp_f32 v18, v18
  v_mfma_f32_32x32x16_bf16 v[0:15], v[132:135], v[116:119], v[0:15]
  ds_read_b128 v[148:151], v172 offset:26112
  v_exp_f32 v19, v19
  v_exp_f32 v20, v20
  v_cvt_pk_bf16_f32 v104, v16, v17
  v_exp_f32 v21, v21
  v_mfma_f32_32x32x16_bf16 v[32:47], v[152:155], v[96:99], v[32:47]
  v_exp_f32 v22, v22
  v_cvt_pk_bf16_f32 v105, v18, v19
  v_exp_f32 v23, v23
  v_exp_f32 v24, v24
  v_cvt_pk_bf16_f32 v106, v20, v21
  v_mfma_f32_32x32x16_bf16 v[32:47], v[156:159], v[100:103], v[32:47]
  v_exp_f32 v25, v25
  v_exp_f32 v26, v26
  v_cvt_pk_bf16_f32 v107, v22, v23
  v_exp_f32 v27, v27
  v_mfma_f32_16x16x32_bf16 v[160:163], v[168:171], v[96:99], v[160:163]
  v_exp_f32 v28, v28
  v_cvt_pk_bf16_f32 v108, v24, v25
  v_exp_f32 v29, v29
  v_mfma_f32_16x16x32_bf16 v[160:163], v[168:171], v[100:103], v[160:163]
  s_waitcnt lgkmcnt(0)
  v_exp_f32 v30, v30
  v_cvt_pk_bf16_f32 v109, v26, v27
  v_exp_f32 v31, v31
  v_cvt_pk_bf16_f32 v110, v28, v29
  v_cvt_pk_bf16_f32 v111, v30, v31
  v_mfma_f32_32x32x16_bf16 v[16:31], v[128:131], v[120:123], v[80:95]
  ds_read_b128 v[136:139], v172 offset:28672
  v_exp_f32 v0, v0
  v_exp_f32 v1, v1
  v_exp_f32 v2, v2
  v_mfma_f32_32x32x16_bf16 v[16:31], v[132:135], v[124:127], v[16:31]
  ds_read_b128 v[140:143], v172 offset:29184
  v_exp_f32 v3, v3
  v_exp_f32 v4, v4
  v_cvt_pk_bf16_f32 v96, v0, v1
  v_exp_f32 v5, v5
  v_mfma_f32_32x32x16_bf16 v[48:63], v[152:155], v[104:107], v[48:63]
  v_exp_f32 v6, v6
  v_cvt_pk_bf16_f32 v97, v2, v3
  v_exp_f32 v7, v7
  v_exp_f32 v8, v8
  v_cvt_pk_bf16_f32 v98, v4, v5
  v_mfma_f32_32x32x16_bf16 v[48:63], v[156:159], v[108:111], v[48:63]
  v_exp_f32 v9, v9
  v_exp_f32 v10, v10
  v_cvt_pk_bf16_f32 v99, v6, v7
  v_exp_f32 v11, v11
  v_mfma_f32_16x16x32_bf16 v[164:167], v[168:171], v[104:107], v[164:167]
  v_exp_f32 v12, v12
  v_cvt_pk_bf16_f32 v100, v8, v9
  v_exp_f32 v13, v13
  v_mfma_f32_16x16x32_bf16 v[164:167], v[168:171], v[108:111], v[164:167]
  s_waitcnt lgkmcnt(0)
  v_exp_f32 v14, v14
  v_cvt_pk_bf16_f32 v101, v10, v11
  v_exp_f32 v15, v15
  v_cvt_pk_bf16_f32 v102, v12, v13
  v_cvt_pk_bf16_f32 v103, v14, v15
  v_mfma_f32_32x32x16_bf16 v[0:15], v[136:139], v[112:115], v[64:79]
  ds_read_b128 v[152:155], v172 offset:29696
  v_exp_f32 v16, v16
  v_exp_f32 v17, v17
  v_exp_f32 v18, v18
  v_mfma_f32_32x32x16_bf16 v[0:15], v[140:143], v[116:119], v[0:15]
  ds_read_b128 v[156:159], v172 offset:30208
  v_exp_f32 v19, v19
  v_exp_f32 v20, v20
  v_cvt_pk_bf16_f32 v104, v16, v17
  v_exp_f32 v21, v21
  v_mfma_f32_32x32x16_bf16 v[32:47], v[144:147], v[96:99], v[32:47]
  v_exp_f32 v22, v22
  v_cvt_pk_bf16_f32 v105, v18, v19
  v_exp_f32 v23, v23
  v_exp_f32 v24, v24
  v_cvt_pk_bf16_f32 v106, v20, v21
  v_mfma_f32_32x32x16_bf16 v[32:47], v[148:151], v[100:103], v[32:47]
  v_exp_f32 v25, v25
  v_exp_f32 v26, v26
  v_cvt_pk_bf16_f32 v107, v22, v23
  v_exp_f32 v27, v27
  v_mfma_f32_16x16x32_bf16 v[160:163], v[168:171], v[96:99], v[160:163]
  v_exp_f32 v28, v28
  v_cvt_pk_bf16_f32 v108, v24, v25
  v_exp_f32 v29, v29
  v_mfma_f32_16x16x32_bf16 v[160:163], v[168:171], v[100:103], v[160:163]
  s_waitcnt vmcnt(63) lgkmcnt(0)
  s_barrier
  v_exp_f32 v30, v30
  v_cvt_pk_bf16_f32 v109, v26, v27
  v_exp_f32 v31, v31
  v_cvt_pk_bf16_f32 v110, v28, v29
  v_cvt_pk_bf16_f32 v111, v30, v31
  v_mfma_f32_32x32x16_bf16 v[16:31], v[136:139], v[120:123], v[80:95]
  ds_read_b128 v[128:131], v172 offset:0
  v_exp_f32 v0, v0
  v_exp_f32 v1, v1
  v_exp_f32 v2, v2
  v_mfma_f32_32x32x16_bf16 v[16:31], v[140:143], v[124:127], v[16:31]
  ds_read_b128 v[132:135], v172 offset:512
  v_exp_f32 v3, v3
  v_exp_f32 v4, v4
  v_cvt_pk_bf16_f32 v96, v0, v1
  v_exp_f32 v5, v5
  v_mfma_f32_32x32x16_bf16 v[48:63], v[144:147], v[104:107], v[48:63]
  s_add_u32 m0, s50, 24576
  v_exp_f32 v6, v6
  v_cvt_pk_bf16_f32 v97, v2, v3
  v_exp_f32 v7, v7
  v_exp_f32 v8, v8
  v_cvt_pk_bf16_f32 v98, v4, v5
  v_mfma_f32_32x32x16_bf16 v[48:63], v[148:151], v[108:111], v[48:63]
  buffer_load_dwordx4 v255, s[8:11], s49 offen sc1 lds
  v_exp_f32 v9, v9
  v_exp_f32 v10, v10
  v_cvt_pk_bf16_f32 v99, v6, v7
  v_exp_f32 v11, v11
  v_mfma_f32_16x16x32_bf16 v[164:167], v[168:171], v[104:107], v[164:167]
  buffer_load_dwordx4 v255, s[12:15], s49 offen offset:1024 sc1 lds
  s_add_u32 s49, s49, 4096
  v_exp_f32 v12, v12
  v_cvt_pk_bf16_f32 v100, v8, v9
  v_exp_f32 v13, v13
  v_mfma_f32_16x16x32_bf16 v[164:167], v[168:171], v[108:111], v[164:167]
  s_waitcnt lgkmcnt(0)
  v_exp_f32 v14, v14
  v_cvt_pk_bf16_f32 v101, v10, v11
  v_exp_f32 v15, v15
  v_cvt_pk_bf16_f32 v102, v12, v13
  v_cvt_pk_bf16_f32 v103, v14, v15
  v_mfma_f32_32x32x16_bf16 v[0:15], v[128:131], v[112:115], v[64:79]
  ds_read_b128 v[144:147], v172 offset:1024
  v_exp_f32 v16, v16
  v_exp_f32 v17, v17
  v_exp_f32 v18, v18
  v_mfma_f32_32x32x16_bf16 v[0:15], v[132:135], v[116:119], v[0:15]
  ds_read_b128 v[148:151], v172 offset:1536
  v_exp_f32 v19, v19
  v_exp_f32 v20, v20
  v_cvt_pk_bf16_f32 v104, v16, v17
  v_exp_f32 v21, v21
  v_mfma_f32_32x32x16_bf16 v[32:47], v[152:155], v[96:99], v[32:47]
  v_exp_f32 v22, v22
  v_cvt_pk_bf16_f32 v105, v18, v19
  v_exp_f32 v23, v23
  v_exp_f32 v24, v24
  v_cvt_pk_bf16_f32 v106, v20, v21
  v_mfma_f32_32x32x16_bf16 v[32:47], v[156:159], v[100:103], v[32:47]
  v_exp_f32 v25, v25
  v_exp_f32 v26, v26
  v_cvt_pk_bf16_f32 v107, v22, v23
  v_exp_f32 v27, v27
  v_mfma_f32_16x16x32_bf16 v[160:163], v[168:171], v[96:99], v[160:163]
  v_exp_f32 v28, v28
  v_cvt_pk_bf16_f32 v108, v24, v25
  v_exp_f32 v29, v29
  v_mfma_f32_16x16x32_bf16 v[160:163], v[168:171], v[100:103], v[160:163]
  s_waitcnt lgkmcnt(0)
  v_exp_f32 v30, v30
  v_cvt_pk_bf16_f32 v109, v26, v27
  v_exp_f32 v31, v31
  v_cvt_pk_bf16_f32 v110, v28, v29
  v_cvt_pk_bf16_f32 v111, v30, v31
  v_mfma_f32_32x32x16_bf16 v[16:31], v[128:131], v[120:123], v[80:95]
  ds_read_b128 v[136:139], v172 offset:4096
  v_exp_f32 v0, v0
  v_exp_f32 v1, v1
  v_exp_f32 v2, v2
  v_mfma_f32_32x32x16_bf16 v[16:31], v[132:135], v[124:127], v[16:31]
  ds_read_b128 v[140:143], v172 offset:4608
  v_exp_f32 v3, v3
  v_exp_f32 v4, v4
  v_cvt_pk_bf16_f32 v96, v0, v1
  v_exp_f32 v5, v5
  v_mfma_f32_32x32x16_bf16 v[48:63], v[152:155], v[104:107], v[48:63]
  v_exp_f32 v6, v6
  v_cvt_pk_bf16_f32 v97, v2, v3
  v_exp_f32 v7, v7
  v_exp_f32 v8, v8
  v_cvt_pk_bf16_f32 v98, v4, v5
  v_mfma_f32_32x32x16_bf16 v[48:63], v[156:159], v[108:111], v[48:63]
  v_exp_f32 v9, v9
  v_exp_f32 v10, v10
  v_cvt_pk_bf16_f32 v99, v6, v7
  v_exp_f32 v11, v11
  v_mfma_f32_16x16x32_bf16 v[164:167], v[168:171], v[104:107], v[164:167]
  v_exp_f32 v12, v12
  v_cvt_pk_bf16_f32 v100, v8, v9
  v_exp_f32 v13, v13
  v_mfma_f32_16x16x32_bf16 v[164:167], v[168:171], v[108:111], v[164:167]
  s_waitcnt lgkmcnt(0)
  v_exp_f32 v14, v14
  v_cvt_pk_bf16_f32 v101, v10, v11
  v_exp_f32 v15, v15
  v_cvt_pk_bf16_f32 v102, v12, v13
  v_cvt_pk_bf16_f32 v103, v14, v15
  v_mfma_f32_32x32x16_bf16 v[0:15], v[136:139], v[112:115], v[64:79]
  ds_read_b128 v[152:155], v172 offset:5120
  v_exp_f32 v16, v16
  v_exp_f32 v17, v17
  v_exp_f32 v18, v18
  v_mfma_f32_32x32x16_bf16 v[0:15], v[140:143], v[116:119], v[0:15]
  ds_read_b128 v[156:159], v172 offset:5632
  v_exp_f32 v19, v19
  v_exp_f32 v20, v20
  v_cvt_pk_bf16_f32 v104, v16, v17
  v_exp_f32 v21, v21
  v_mfma_f32_32x32x16_bf16 v[32:47], v[144:147], v[96:99], v[32:47]
  v_exp_f32 v22, v22
  v_cvt_pk_bf16_f32 v105, v18, v19
  v_exp_f32 v23, v23
  v_exp_f32 v24, v24
  v_cvt_pk_bf16_f32 v106, v20, v21
  v_mfma_f32_32x32x16_bf16 v[32:47], v[148:151], v[100:103], v[32:47]
  v_exp_f32 v25, v25
  v_exp_f32 v26, v26
  v_cvt_pk_bf16_f32 v107, v22, v23
  v_exp_f32 v27, v27
  v_mfma_f32_16x16x32_bf16 v[160:163], v[168:171], v[96:99], v[160:163]
  v_exp_f32 v28, v28
  v_cvt_pk_bf16_f32 v108, v24, v25
  v_exp_f32 v29, v29
  v_mfma_f32_16x16x32_bf16 v[160:163], v[168:171], v[100:103], v[160:163]
  s_waitcnt vmcnt(35) lgkmcnt(0)
  s_barrier
  v_exp_f32 v30, v30
  v_cvt_pk_bf16_f32 v109, v26, v27
  v_exp_f32 v31, v31
  v_cvt_pk_bf16_f32 v110, v28, v29
  v_cvt_pk_bf16_f32 v111, v30, v31
  s_waitcnt vmcnt(4)
  buffer_store_dword v252, v251, s[4:7], s51 offen sc1
  v_mfma_f32_32x32x16_bf16 v[16:31], v[136:139], v[120:123], v[80:95]
  ds_read_b128 v[128:131], v172 offset:8192
  v_exp_f32 v0, v0
  v_exp_f32 v1, v1
  v_exp_f32 v2, v2
  v_mfma_f32_32x32x16_bf16 v[16:31], v[140:143], v[124:127], v[16:31]
  ds_read_b128 v[132:135], v172 offset:8704
  v_exp_f32 v3, v3
  v_exp_f32 v4, v4
  v_cvt_pk_bf16_f32 v96, v0, v1
  v_exp_f32 v5, v5
  v_mfma_f32_32x32x16_bf16 v[48:63], v[144:147], v[104:107], v[48:63]
  s_add_u32 m0, s50, 0
  v_exp_f32 v6, v6
  v_cvt_pk_bf16_f32 v97, v2, v3
  v_exp_f32 v7, v7
  v_exp_f32 v8, v8
  v_cvt_pk_bf16_f32 v98, v4, v5
  v_mfma_f32_32x32x16_bf16 v[48:63], v[148:151], v[108:111], v[48:63]
  buffer_load_dwordx4 v255, s[8:11], s49 offen sc1 lds
  v_exp_f32 v9, v9
  v_exp_f32 v10, v10
  v_cvt_pk_bf16_f32 v99, v6, v7
  v_exp_f32 v11, v11
  v_mfma_f32_16x16x32_bf16 v[164:167], v[168:171], v[104:107], v[164:167]
  buffer_load_dwordx4 v255, s[12:15], s49 offen offset:1024 sc1 lds
  s_add_u32 s49, s49, 4096
  v_exp_f32 v12, v12
  v_cvt_pk_bf16_f32 v100, v8, v9
  v_exp_f32 v13, v13
  v_mfma_f32_16x16x32_bf16 v[164:167], v[168:171], v[108:111], v[164:167]
  s_waitcnt lgkmcnt(0)
  s_add_u32 m0, s63, 32768
  v_exp_f32 v14, v14
  v_cvt_pk_bf16_f32 v101, v10, v11
  v_exp_f32 v15, v15
  v_cvt_pk_bf16_f32 v102, v12, v13
  v_cvt_pk_bf16_f32 v103, v14, v15
  v_mfma_f32_32x32x16_bf16 v[0:15], v[128:131], v[112:115], v[64:79]
  ds_read_b128 v[144:147], v172 offset:9216
  v_exp_f32 v16, v16
  v_exp_f32 v17, v17
  v_exp_f32 v18, v18
  v_mfma_f32_32x32x16_bf16 v[0:15], v[132:135], v[116:119], v[0:15]
  ds_read_b128 v[148:151], v172 offset:9728
  v_exp_f32 v19, v19
  v_exp_f32 v20, v20
  v_cvt_pk_bf16_f32 v104, v16, v17
  v_exp_f32 v21, v21
  v_mfma_f32_32x32x16_bf16 v[32:47], v[152:155], v[96:99], v[32:47]
  buffer_load_dwordx4 v232, s[20:23], s62 offen offset:0 lds
  v_exp_f32 v22, v22
  v_cvt_pk_bf16_f32 v105, v18, v19
  v_exp_f32 v23, v23
  v_exp_f32 v24, v24
  v_cvt_pk_bf16_f32 v106, v20, v21
  v_mfma_f32_32x32x16_bf16 v[32:47], v[156:159], v[100:103], v[32:47]
  buffer_load_dwordx4 v233, s[20:23], s62 offen offset:1024 lds
  v_exp_f32 v25, v25
  v_exp_f32 v26, v26
  v_cvt_pk_bf16_f32 v107, v22, v23
  v_exp_f32 v27, v27
  v_mfma_f32_16x16x32_bf16 v[160:163], v[168:171], v[96:99], v[160:163]
  buffer_load_dwordx4 v234, s[20:23], s62 offen offset:2048 lds
  v_exp_f32 v28, v28
  v_cvt_pk_bf16_f32 v108, v24, v25
  v_exp_f32 v29, v29
  v_mfma_f32_16x16x32_bf16 v[160:163], v[168:171], v[100:103], v[160:163]
  s_waitcnt lgkmcnt(0)
  buffer_load_dwordx4 v235, s[20:23], s62 offen offset:3072 lds
  s_add_u32 s62, s62, 262144
  v_exp_f32 v30, v30
  v_cvt_pk_bf16_f32 v109, v26, v27
  v_exp_f32 v31, v31
  v_cvt_pk_bf16_f32 v110, v28, v29
  v_cvt_pk_bf16_f32 v111, v30, v31
  v_mfma_f32_32x32x16_bf16 v[16:31], v[128:131], v[120:123], v[80:95]
  ds_read_b128 v[136:139], v172 offset:12288
  v_exp_f32 v0, v0
  v_exp_f32 v1, v1
  v_exp_f32 v2, v2
  v_mfma_f32_32x32x16_bf16 v[16:31], v[132:135], v[124:127], v[16:31]
  ds_read_b128 v[140:143], v172 offset:12800
  v_exp_f32 v3, v3
  v_exp_f32 v4, v4
  v_cvt_pk_bf16_f32 v96, v0, v1
  v_exp_f32 v5, v5
  v_mfma_f32_32x32x16_bf16 v[48:63], v[152:155], v[104:107], v[48:63]
  s_add_u32 m0, s63, 49152
  v_exp_f32 v6, v6
  v_cvt_pk_bf16_f32 v97, v2, v3
  v_exp_f32 v7, v7
  v_exp_f32 v8, v8
  v_cvt_pk_bf16_f32 v98, v4, v5
  v_mfma_f32_32x32x16_bf16 v[48:63], v[156:159], v[108:111], v[48:63]
  buffer_load_dwordx4 v232, s[20:23], s62 offen offset:0 lds
  v_exp_f32 v9, v9
  v_exp_f32 v10, v10
  v_cvt_pk_bf16_f32 v99, v6, v7
  v_exp_f32 v11, v11
  v_mfma_f32_16x16x32_bf16 v[164:167], v[168:171], v[104:107], v[164:167]
  buffer_load_dwordx4 v233, s[20:23], s62 offen offset:1024 lds
  v_exp_f32 v12, v12
  v_cvt_pk_bf16_f32 v100, v8, v9
  v_exp_f32 v13, v13
  v_mfma_f32_16x16x32_bf16 v[164:167], v[168:171], v[108:111], v[164:167]
  s_waitcnt lgkmcnt(0)
  buffer_load_dwordx4 v234, s[20:23], s62 offen offset:2048 lds
  v_exp_f32 v14, v14
  v_cvt_pk_bf16_f32 v101, v10, v11
  v_exp_f32 v15, v15
  v_cvt_pk_bf16_f32 v102, v12, v13
  v_cvt_pk_bf16_f32 v103, v14, v15
  v_mfma_f32_32x32x16_bf16 v[0:15], v[136:139], v[112:115], v[64:79]
  ds_read_b128 v[152:155], v172 offset:13312
  v_exp_f32 v16, v16
  v_exp_f32 v17, v17
  v_exp_f32 v18, v18
  v_mfma_f32_32x32x16_bf16 v[0:15], v[140:143], v[116:119], v[0:15]
  ds_read_b128 v[156:159], v172 offset:13824
  v_exp_f32 v19, v19
  v_exp_f32 v20, v20
  v_cvt_pk_bf16_f32 v104, v16, v17
  v_exp_f32 v21, v21
  v_mfma_f32_32x32x16_bf16 v[32:47], v[144:147], v[96:99], v[32:47]
  buffer_load_dwordx4 v235, s[20:23], s62 offen offset:3072 lds
  s_add_u32 s62, s62, 262144
  v_exp_f32 v22, v22
  v_cvt_pk_bf16_f32 v105, v18, v19
  v_exp_f32 v23, v23
  v_exp_f32 v24, v24
  v_cvt_pk_bf16_f32 v106, v20, v21
  v_mfma_f32_32x32x16_bf16 v[32:47], v[148:151], v[100:103], v[32:47]
  s_add_u32 m0, s63, 65536
  v_exp_f32 v25, v25
  v_exp_f32 v26, v26
  v_cvt_pk_bf16_f32 v107, v22, v23
  v_exp_f32 v27, v27
  v_mfma_f32_16x16x32_bf16 v[160:163], v[168:171], v[96:99], v[160:163]
  buffer_load_dwordx4 v232, s[20:23], s62 offen offset:0 lds
  v_exp_f32 v28, v28
  v_cvt_pk_bf16_f32 v108, v24, v25
  v_exp_f32 v29, v29
  v_mfma_f32_16x16x32_bf16 v[160:163], v[168:171], v[100:103], v[160:163]
  s_waitcnt vmcnt(13) lgkmcnt(0)
  s_barrier
  v_exp_f32 v30, v30
  v_cvt_pk_bf16_f32 v109, v26, v27
  v_exp_f32 v31, v31
  v_cvt_pk_bf16_f32 v110, v28, v29
  v_cvt_pk_bf16_f32 v111, v30, v31
  v_mfma_f32_32x32x16_bf16 v[16:31], v[136:139], v[120:123], v[80:95]
  ds_read_b128 v[128:131], v172 offset:16384
  v_exp_f32 v0, v0
  v_exp_f32 v1, v1
  v_exp_f32 v2, v2
  v_mfma_f32_32x32x16_bf16 v[16:31], v[140:143], v[124:127], v[16:31]
  ds_read_b128 v[132:135], v172 offset:16896
  v_exp_f32 v3, v3
  v_exp_f32 v4, v4
  v_cvt_pk_bf16_f32 v96, v0, v1
  v_exp_f32 v5, v5
  v_mfma_f32_32x32x16_bf16 v[48:63], v[144:147], v[104:107], v[48:63]
  s_add_u32 m0, s50, 8192
  v_exp_f32 v6, v6
  v_cvt_pk_bf16_f32 v97, v2, v3
  v_exp_f32 v7, v7
  v_exp_f32 v8, v8
  v_cvt_pk_bf16_f32 v98, v4, v5
  v_mfma_f32_32x32x16_bf16 v[48:63], v[148:151], v[108:111], v[48:63]
  buffer_load_dwordx4 v255, s[8:11], s49 offen sc1 lds
  v_exp_f32 v9, v9
  v_exp_f32 v10, v10
  v_cvt_pk_bf16_f32 v99, v6, v7
  v_exp_f32 v11, v11
  v_mfma_f32_16x16x32_bf16 v[164:167], v[168:171], v[104:107], v[164:167]
  buffer_load_dwordx4 v255, s[12:15], s49 offen offset:1024 sc1 lds
  s_add_u32 s49, s49, 4096
  v_exp_f32 v12, v12
  v_cvt_pk_bf16_f32 v100, v8, v9
  v_exp_f32 v13, v13
  v_mfma_f32_16x16x32_bf16 v[164:167], v[168:171], v[108:111], v[164:167]
  s_waitcnt lgkmcnt(0)
  s_add_u32 m0, s63, 65536
  s_nop 0
  buffer_load_dwordx4 v233, s[20:23], s62 offen offset:1024 lds
  v_exp_f32 v14, v14
  v_cvt_pk_bf16_f32 v101, v10, v11
  v_exp_f32 v15, v15
  v_cvt_pk_bf16_f32 v102, v12, v13
  v_cvt_pk_bf16_f32 v103, v14, v15
  v_mfma_f32_32x32x16_bf16 v[0:15], v[128:131], v[112:115], v[64:79]
  ds_read_b128 v[144:147], v172 offset:17408
  v_exp_f32 v16, v16
  v_exp_f32 v17, v17
  v_exp_f32 v18, v18
  v_mfma_f32_32x32x16_bf16 v[0:15], v[132:135], v[116:119], v[0:15]
  ds_read_b128 v[148:151], v172 offset:17920
  v_exp_f32 v19, v19
  v_exp_f32 v20, v20
  v_cvt_pk_bf16_f32 v104, v16, v17
  v_exp_f32 v21, v21
  v_mfma_f32_32x32x16_bf16 v[32:47], v[152:155], v[96:99], v[32:47]
  buffer_load_dwordx4 v234, s[20:23], s62 offen offset:2048 lds
  v_exp_f32 v22, v22
  v_cvt_pk_bf16_f32 v105, v18, v19
  v_exp_f32 v23, v23
  v_exp_f32 v24, v24
  v_cvt_pk_bf16_f32 v106, v20, v21
  v_mfma_f32_32x32x16_bf16 v[32:47], v[156:159], v[100:103], v[32:47]
  buffer_load_dwordx4 v235, s[20:23], s62 offen offset:3072 lds
  s_add_u32 s62, s62, 262144
  v_exp_f32 v25, v25
  v_exp_f32 v26, v26
  v_cvt_pk_bf16_f32 v107, v22, v23
  v_exp_f32 v27, v27
  v_mfma_f32_16x16x32_bf16 v[160:163], v[168:171], v[96:99], v[160:163]
  s_add_u32 m0, s63, 81920
  v_exp_f32 v28, v28
  v_cvt_pk_bf16_f32 v108, v24, v25
  v_exp_f32 v29, v29
  v_mfma_f32_16x16x32_bf16 v[160:163], v[168:171], v[100:103], v[160:163]
  s_waitcnt lgkmcnt(0)
  buffer_load_dwordx4 v232, s[20:23], s62 offen offset:0 lds
  v_exp_f32 v30, v30
  v_cvt_pk_bf16_f32 v109, v26, v27
  v_exp_f32 v31, v31
  v_cvt_pk_bf16_f32 v110, v28, v29
  v_cvt_pk_bf16_f32 v111, v30, v31
  v_mfma_f32_32x32x16_bf16 v[16:31], v[128:131], v[120:123], v[80:95]
  ds_read_b128 v[136:139], v172 offset:20480
  v_exp_f32 v0, v0
  v_exp_f32 v1, v1
  v_exp_f32 v2, v2
  v_mfma_f32_32x32x16_bf16 v[16:31], v[132:135], v[124:127], v[16:31]
  ds_read_b128 v[140:143], v172 offset:20992
  v_exp_f32 v3, v3
  v_exp_f32 v4, v4
  v_cvt_pk_bf16_f32 v96, v0, v1
  v_exp_f32 v5, v5
  v_mfma_f32_32x32x16_bf16 v[48:63], v[152:155], v[104:107], v[48:63]
  buffer_load_dwordx4 v233, s[20:23], s62 offen offset:1024 lds
  v_exp_f32 v6, v6
  v_cvt_pk_bf16_f32 v97, v2, v3
  v_exp_f32 v7, v7
  v_exp_f32 v8, v8
  v_cvt_pk_bf16_f32 v98, v4, v5
  v_mfma_f32_32x32x16_bf16 v[48:63], v[156:159], v[108:111], v[48:63]
  buffer_load_dwordx4 v234, s[20:23], s62 offen offset:2048 lds
  v_exp_f32 v9, v9
  v_exp_f32 v10, v10
  v_cvt_pk_bf16_f32 v99, v6, v7
  v_exp_f32 v11, v11
  v_mfma_f32_16x16x32_bf16 v[164:167], v[168:171], v[104:107], v[164:167]
  buffer_load_dwordx4 v235, s[20:23], s62 offen offset:3072 lds
  s_add_u32 s62, s62, 262144
  v_exp_f32 v12, v12
  v_cvt_pk_bf16_f32 v100, v8, v9
  v_exp_f32 v13, v13
  v_mfma_f32_16x16x32_bf16 v[164:167], v[168:171], v[108:111], v[164:167]
  s_waitcnt lgkmcnt(0)
  s_add_u32 m0, s63, 98304
  v_exp_f32 v14, v14
  v_cvt_pk_bf16_f32 v101, v10, v11
  v_exp_f32 v15, v15
  v_cvt_pk_bf16_f32 v102, v12, v13
  v_cvt_pk_bf16_f32 v103, v14, v15
  v_mfma_f32_32x32x16_bf16 v[0:15], v[136:139], v[112:115], v[64:79]
  ds_read_b128 v[152:155], v172 offset:21504
  v_exp_f32 v16, v16
  v_exp_f32 v17, v17
  v_exp_f32 v18, v18
  v_mfma_f32_32x32x16_bf16 v[0:15], v[140:143], v[116:119], v[0:15]
  ds_read_b128 v[156:159], v172 offset:22016
  v_exp_f32 v19, v19
  v_exp_f32 v20, v20
  v_cvt_pk_bf16_f32 v104, v16, v17
  v_exp_f32 v21, v21
  v_mfma_f32_32x32x16_bf16 v[32:47], v[144:147], v[96:99], v[32:47]
  buffer_load_dwordx4 v232, s[20:23], s62 offen offset:0 lds
  v_exp_f32 v22, v22
  v_cvt_pk_bf16_f32 v105, v18, v19
  v_exp_f32 v23, v23
  v_exp_f32 v24, v24
  v_cvt_pk_bf16_f32 v106, v20, v21
  v_mfma_f32_32x32x16_bf16 v[32:47], v[148:151], v[100:103], v[32:47]
  buffer_load_dwordx4 v233, s[20:23], s62 offen offset:1024 lds
  v_exp_f32 v25, v25
  v_exp_f32 v26, v26
  v_cvt_pk_bf16_f32 v107, v22, v23
  v_exp_f32 v27, v27
  v_mfma_f32_16x16x32_bf16 v[160:163], v[168:171], v[96:99], v[160:163]
  buffer_load_dwordx4 v234, s[20:23], s62 offen offset:2048 lds
  v_exp_f32 v28, v28
  v_cvt_pk_bf16_f32 v108, v24, v25
  v_exp_f32 v29, v29
  v_mfma_f32_16x16x32_bf16 v[160:163], v[168:171], v[100:103], v[160:163]
  s_waitcnt vmcnt(23) lgkmcnt(0)
  s_barrier
  v_exp_f32 v30, v30
  v_cvt_pk_bf16_f32 v109, v26, v27
  v_exp_f32 v31, v31
  v_cvt_pk_bf16_f32 v110, v28, v29
  v_cvt_pk_bf16_f32 v111, v30, v31
  v_mfma_f32_32x32x16_bf16 v[16:31], v[136:139], v[120:123], v[80:95]
  ds_read_b128 v[128:131], v172 offset:24576
  v_exp_f32 v0, v0
  v_exp_f32 v1, v1
  v_exp_f32 v2, v2
  v_mfma_f32_32x32x16_bf16 v[16:31], v[140:143], v[124:127], v[16:31]
  ds_read_b128 v[132:135], v172 offset:25088
  v_exp_f32 v3, v3
  v_exp_f32 v4, v4
  v_cvt_pk_bf16_f32 v96, v0, v1
  v_exp_f32 v5, v5
  v_mfma_f32_32x32x16_bf16 v[48:63], v[144:147], v[104:107], v[48:63]
  s_add_u32 m0, s50, 16384
  v_exp_f32 v6, v6
  v_cvt_pk_bf16_f32 v97, v2, v3
  v_exp_f32 v7, v7
  v_exp_f32 v8, v8
  v_cvt_pk_bf16_f32 v98, v4, v5
  v_mfma_f32_32x32x16_bf16 v[48:63], v[148:151], v[108:111], v[48:63]
  buffer_load_dwordx4 v255, s[8:11], s49 offen sc1 lds
  v_exp_f32 v9, v9
  v_exp_f32 v10, v10
  v_cvt_pk_bf16_f32 v99, v6, v7
  v_exp_f32 v11, v11
  v_mfma_f32_16x16x32_bf16 v[164:167], v[168:171], v[104:107], v[164:167]
  buffer_load_dwordx4 v255, s[12:15], s49 offen offset:1024 sc1 lds
  s_add_u32 s49, s49, 4096
  v_exp_f32 v12, v12
  v_cvt_pk_bf16_f32 v100, v8, v9
  v_exp_f32 v13, v13
  v_mfma_f32_16x16x32_bf16 v[164:167], v[168:171], v[108:111], v[164:167]
  s_waitcnt lgkmcnt(0)
  s_add_u32 m0, s63, 98304
  s_nop 0
  buffer_load_dwordx4 v235, s[20:23], s62 offen offset:3072 lds
  s_add_u32 s62, s62, 262144
  v_exp_f32 v14, v14
  v_cvt_pk_bf16_f32 v101, v10, v11
  v_exp_f32 v15, v15
  v_cvt_pk_bf16_f32 v102, v12, v13
  v_cvt_pk_bf16_f32 v103, v14, v15
  v_mfma_f32_32x32x16_bf16 v[0:15], v[128:131], v[112:115], v[64:79]
  ds_read_b128 v[144:147], v172 offset:25600
  v_exp_f32 v16, v16
  v_exp_f32 v17, v17
  v_exp_f32 v18, v18
  v_mfma_f32_32x32x16_bf16 v[0:15], v[132:135], v[116:119], v[0:15]
  ds_read_b128 v[148:151], v172 offset:26112
  v_exp_f32 v19, v19
  v_exp_f32 v20, v20
  v_cvt_pk_bf16_f32 v104, v16, v17
  v_exp_f32 v21, v21
  v_mfma_f32_32x32x16_bf16 v[32:47], v[152:155], v[96:99], v[32:47]
  s_add_u32 m0, s63, 114688
  v_exp_f32 v22, v22
  v_cvt_pk_bf16_f32 v105, v18, v19
  v_exp_f32 v23, v23
  v_exp_f32 v24, v24
  v_cvt_pk_bf16_f32 v106, v20, v21
  v_mfma_f32_32x32x16_bf16 v[32:47], v[156:159], v[100:103], v[32:47]
  buffer_load_dwordx4 v232, s[20:23], s62 offen offset:0 lds
  v_exp_f32 v25, v25
  v_exp_f32 v26, v26
  v_cvt_pk_bf16_f32 v107, v22, v23
  v_exp_f32 v27, v27
  v_mfma_f32_16x16x32_bf16 v[160:163], v[168:171], v[96:99], v[160:163]
  buffer_load_dwordx4 v233, s[20:23], s62 offen offset:1024 lds
  v_exp_f32 v28, v28
  v_cvt_pk_bf16_f32 v108, v24, v25
  v_exp_f32 v29, v29
  v_mfma_f32_16x16x32_bf16 v[160:163], v[168:171], v[100:103], v[160:163]
  s_waitcnt lgkmcnt(0)
  buffer_load_dwordx4 v234, s[20:23], s62 offen offset:2048 lds
  v_exp_f32 v30, v30
  v_cvt_pk_bf16_f32 v109, v26, v27
  v_exp_f32 v31, v31
  v_cvt_pk_bf16_f32 v110, v28, v29
  v_cvt_pk_bf16_f32 v111, v30, v31
  v_mfma_f32_32x32x16_bf16 v[16:31], v[128:131], v[120:123], v[80:95]
  ds_read_b128 v[136:139], v172 offset:28672
  v_exp_f32 v0, v0
  v_exp_f32 v1, v1
  v_exp_f32 v2, v2
  v_mfma_f32_32x32x16_bf16 v[16:31], v[132:135], v[124:127], v[16:31]
  ds_read_b128 v[140:143], v172 offset:29184
  v_exp_f32 v3, v3
  v_exp_f32 v4, v4
  v_cvt_pk_bf16_f32 v96, v0, v1
  v_exp_f32 v5, v5
  v_mfma_f32_32x32x16_bf16 v[48:63], v[152:155], v[104:107], v[48:63]
  buffer_load_dwordx4 v235, s[20:23], s62 offen offset:3072 lds
  s_add_u32 s62, s62, 262144
  v_exp_f32 v6, v6
  v_cvt_pk_bf16_f32 v97, v2, v3
  v_exp_f32 v7, v7
  v_exp_f32 v8, v8
  v_cvt_pk_bf16_f32 v98, v4, v5
  v_mfma_f32_32x32x16_bf16 v[48:63], v[156:159], v[108:111], v[48:63]
  s_add_u32 m0, s63, 131072
  v_exp_f32 v9, v9
  v_exp_f32 v10, v10
  v_cvt_pk_bf16_f32 v99, v6, v7
  v_exp_f32 v11, v11
  v_mfma_f32_16x16x32_bf16 v[164:167], v[168:171], v[104:107], v[164:167]
  buffer_load_dwordx4 v232, s[20:23], s62 offen offset:0 lds
  v_exp_f32 v12, v12
  v_cvt_pk_bf16_f32 v100, v8, v9
  v_exp_f32 v13, v13
  v_mfma_f32_16x16x32_bf16 v[164:167], v[168:171], v[108:111], v[164:167]
  s_waitcnt lgkmcnt(0)
  buffer_load_dwordx4 v233, s[20:23], s62 offen offset:1024 lds
  v_exp_f32 v14, v14
  v_cvt_pk_bf16_f32 v101, v10, v11
  v_exp_f32 v15, v15
  v_cvt_pk_bf16_f32 v102, v12, v13
  v_cvt_pk_bf16_f32 v103, v14, v15
  v_mfma_f32_32x32x16_bf16 v[0:15], v[136:139], v[112:115], v[64:79]
  ds_read_b128 v[152:155], v172 offset:29696
  v_exp_f32 v16, v16
  v_exp_f32 v17, v17
  v_exp_f32 v18, v18
  v_mfma_f32_32x32x16_bf16 v[0:15], v[140:143], v[116:119], v[0:15]
  ds_read_b128 v[156:159], v172 offset:30208
  v_exp_f32 v19, v19
  v_exp_f32 v20, v20
  v_cvt_pk_bf16_f32 v104, v16, v17
  v_exp_f32 v21, v21
  v_mfma_f32_32x32x16_bf16 v[32:47], v[144:147], v[96:99], v[32:47]
  buffer_load_dwordx4 v234, s[20:23], s62 offen offset:2048 lds
  v_exp_f32 v22, v22
  v_cvt_pk_bf16_f32 v105, v18, v19
  v_exp_f32 v23, v23
  v_exp_f32 v24, v24
  v_cvt_pk_bf16_f32 v106, v20, v21
  v_mfma_f32_32x32x16_bf16 v[32:47], v[148:151], v[100:103], v[32:47]
  buffer_load_dwordx4 v235, s[20:23], s62 offen offset:3072 lds
  s_add_u32 s62, s62, 262144
  v_exp_f32 v25, v25
  v_exp_f32 v26, v26
  v_cvt_pk_bf16_f32 v107, v22, v23
  v_exp_f32 v27, v27
  v_mfma_f32_16x16x32_bf16 v[160:163], v[168:171], v[96:99], v[160:163]
  s_add_u32 m0, s63, 147456
  v_exp_f32 v28, v28
  v_cvt_pk_bf16_f32 v108, v24, v25
  v_exp_f32 v29, v29
  v_mfma_f32_16x16x32_bf16 v[160:163], v[168:171], v[100:103], v[160:163]
  s_waitcnt vmcnt(32) lgkmcnt(0)
  s_barrier
  v_exp_f32 v30, v30
  v_cvt_pk_bf16_f32 v109, v26, v27
  v_exp_f32 v31, v31
  v_cvt_pk_bf16_f32 v110, v28, v29
  v_cvt_pk_bf16_f32 v111, v30, v31
  v_mfma_f32_32x32x16_bf16 v[16:31], v[136:139], v[120:123], v[80:95]
  ds_read_b128 v[128:131], v172 offset:0
  v_exp_f32 v0, v0
  v_exp_f32 v1, v1
  v_exp_f32 v2, v2
  v_mfma_f32_32x32x16_bf16 v[16:31], v[140:143], v[124:127], v[16:31]
  ds_read_b128 v[132:135], v172 offset:512
  v_exp_f32 v3, v3
  v_exp_f32 v4, v4
  v_cvt_pk_bf16_f32 v96, v0, v1
  v_exp_f32 v5, v5
  v_mfma_f32_32x32x16_bf16 v[48:63], v[144:147], v[104:107], v[48:63]
  s_add_u32 m0, s50, 24576
  v_exp_f32 v6, v6
  v_cvt_pk_bf16_f32 v97, v2, v3
  v_exp_f32 v7, v7
  v_exp_f32 v8, v8
  v_cvt_pk_bf16_f32 v98, v4, v5
  v_mfma_f32_32x32x16_bf16 v[48:63], v[148:151], v[108:111], v[48:63]
  buffer_load_dwordx4 v255, s[8:11], s49 offen sc1 lds
  v_exp_f32 v9, v9
  v_exp_f32 v10, v10
  v_cvt_pk_bf16_f32 v99, v6, v7
  v_exp_f32 v11, v11
  v_mfma_f32_16x16x32_bf16 v[164:167], v[168:171], v[104:107], v[164:167]
  buffer_load_dwordx4 v255, s[12:15], s49 offen offset:1024 sc1 lds
  s_add_u32 s49, s49, 4096
  v_exp_f32 v12, v12
  v_cvt_pk_bf16_f32 v100, v8, v9
  v_exp_f32 v13, v13
  v_mfma_f32_16x16x32_bf16 v[164:167], v[168:171], v[108:111], v[164:167]
  s_waitcnt lgkmcnt(0)
  buffer_load_dword v250, v253, s[4:7], s52 offen sc1
  v_exp_f32 v14, v14
  v_cvt_pk_bf16_f32 v101, v10, v11
  v_exp_f32 v15, v15
  v_cvt_pk_bf16_f32 v102, v12, v13
  v_cvt_pk_bf16_f32 v103, v14, v15
  v_mfma_f32_32x32x16_bf16 v[0:15], v[128:131], v[112:115], v[64:79]
  ds_read_b128 v[144:147], v172 offset:1024
  v_exp_f32 v16, v16
  v_exp_f32 v17, v17
  v_exp_f32 v18, v18
  v_mfma_f32_32x32x16_bf16 v[0:15], v[132:135], v[116:119], v[0:15]
  ds_read_b128 v[148:151], v172 offset:1536
  v_exp_f32 v19, v19
  v_exp_f32 v20, v20
  v_cvt_pk_bf16_f32 v104, v16, v17
  v_exp_f32 v21, v21
  v_mfma_f32_32x32x16_bf16 v[32:47], v[152:155], v[96:99], v[32:47]
  s_add_u32 m0, s63, 147456
  s_nop 0
  buffer_load_dwordx4 v232, s[20:23], s62 offen offset:0 lds
  v_exp_f32 v22, v22
  v_cvt_pk_bf16_f32 v105, v18, v19
  v_exp_f32 v23, v23
  v_exp_f32 v24, v24
  v_cvt_pk_bf16_f32 v106, v20, v21
  v_mfma_f32_32x32x16_bf16 v[32:47], v[156:159], v[100:103], v[32:47]
  buffer_load_dwordx4 v233, s[20:23], s62 offen offset:1024 lds
  v_exp_f32 v25, v25
  v_exp_f32 v26, v26
  v_cvt_pk_bf16_f32 v107, v22, v23
  v_exp_f32 v27, v27
  v_mfma_f32_16x16x32_bf16 v[160:163], v[168:171], v[96:99], v[160:163]
  buffer_load_dwordx4 v234, s[20:23], s62 offen offset:2048 lds
  v_exp_f32 v28, v28
  v_cvt_pk_bf16_f32 v108, v24, v25
  v_exp_f32 v29, v29
  v_mfma_f32_16x16x32_bf16 v[160:163], v[168:171], v[100:103], v[160:163]
  s_waitcnt lgkmcnt(0)
  buffer_load_dwordx4 v235, s[20:23], s62 offen offset:3072 lds
  s_add_u32 s62, s62, 262144
  v_exp_f32 v30, v30
  v_cvt_pk_bf16_f32 v109, v26, v27
  v_exp_f32 v31, v31
  v_cvt_pk_bf16_f32 v110, v28, v29
  v_cvt_pk_bf16_f32 v111, v30, v31
  v_mfma_f32_32x32x16_bf16 v[16:31], v[128:131], v[120:123], v[80:95]
  ds_read_b128 v[136:139], v172 offset:4096
  v_exp_f32 v0, v0
  v_exp_f32 v1, v1
  v_exp_f32 v2, v2
  v_mfma_f32_32x32x16_bf16 v[16:31], v[132:135], v[124:127], v[16:31]
  ds_read_b128 v[140:143], v172 offset:4608
  v_exp_f32 v3, v3
  v_exp_f32 v4, v4
  v_cvt_pk_bf16_f32 v96, v0, v1
  v_exp_f32 v5, v5
  v_mfma_f32_32x32x16_bf16 v[48:63], v[152:155], v[104:107], v[48:63]
  v_exp_f32 v6, v6
  v_cvt_pk_bf16_f32 v97, v2, v3
  v_exp_f32 v7, v7
  v_exp_f32 v8, v8
  v_cvt_pk_bf16_f32 v98, v4, v5
  v_mfma_f32_32x32x16_bf16 v[48:63], v[156:159], v[108:111], v[48:63]
  v_exp_f32 v9, v9
  v_exp_f32 v10, v10
  v_cvt_pk_bf16_f32 v99, v6, v7
  v_exp_f32 v11, v11
  v_mfma_f32_16x16x32_bf16 v[164:167], v[168:171], v[104:107], v[164:167]
  v_exp_f32 v12, v12
  v_cvt_pk_bf16_f32 v100, v8, v9
  v_exp_f32 v13, v13
  v_mfma_f32_16x16x32_bf16 v[164:167], v[168:171], v[108:111], v[164:167]
  s_waitcnt lgkmcnt(0)
  v_exp_f32 v14, v14
  v_cvt_pk_bf16_f32 v101, v10, v11
  v_exp_f32 v15, v15
  v_cvt_pk_bf16_f32 v102, v12, v13
  v_cvt_pk_bf16_f32 v103, v14, v15
  s_waitcnt vmcnt(4)
  s_cmp_lg_u32 s44, 0
  s_cbranch_scc1 gated_mix__mha_block__mixer_gmlp__prompt_kernel_c1_ok
  s_mov_b32 s53, 0x8000
gated_mix__mha_block__mixer_gmlp__prompt_kernel_c1:
  v_cmp_eq_u32 vcc, 0, v250
  s_nop 3
  s_cmp_eq_u64 vcc, 0
  s_cbranch_scc1 gated_mix__mha_block__mixer_gmlp__prompt_kernel_c1_ok
  s_sleep 8
  buffer_load_dword v250, v253, s[4:7], s52 offen sc1
  s_waitcnt vmcnt(0)
  s_sub_u32 s53, s53, 1
  s_cmp_lg_u32 s53, 0
  s_cbranch_scc1 gated_mix__mha_block__mixer_gmlp__prompt_kernel_c1
gated_mix__mha_block__mixer_gmlp__prompt_kernel_c1_ok:
  v_mfma_f32_32x32x16_bf16 v[0:15], v[136:139], v[112:115], v[64:79]
  ds_read_b128 v[152:155], v172 offset:5120
  v_exp_f32 v16, v16
  v_exp_f32 v17, v17
  v_exp_f32 v18, v18
  v_mfma_f32_32x32x16_bf16 v[0:15], v[140:143], v[116:119], v[0:15]
  ds_read_b128 v[156:159], v172 offset:5632
  v_exp_f32 v19, v19
  v_exp_f32 v20, v20
  v_cvt_pk_bf16_f32 v104, v16, v17
  v_exp_f32 v21, v21
  v_mfma_f32_32x32x16_bf16 v[32:47], v[144:147], v[96:99], v[32:47]
  v_exp_f32 v22, v22
  v_cvt_pk_bf16_f32 v105, v18, v19
  v_exp_f32 v23, v23
  v_exp_f32 v24, v24
  v_cvt_pk_bf16_f32 v106, v20, v21
  v_mfma_f32_32x32x16_bf16 v[32:47], v[148:151], v[100:103], v[32:47]
  v_exp_f32 v25, v25
  v_exp_f32 v26, v26
  v_cvt_pk_bf16_f32 v107, v22, v23
  v_exp_f32 v27, v27
  v_mfma_f32_16x16x32_bf16 v[160:163], v[168:171], v[96:99], v[160:163]
  v_exp_f32 v28, v28
  v_cvt_pk_bf16_f32 v108, v24, v25
  v_exp_f32 v29, v29
  v_mfma_f32_16x16x32_bf16 v[160:163], v[168:171], v[100:103], v[160:163]
  s_waitcnt vmcnt(28) lgkmcnt(0)
  s_barrier
  v_exp_f32 v30, v30
  v_cvt_pk_bf16_f32 v109, v26, v27
  v_exp_f32 v31, v31
  v_cvt_pk_bf16_f32 v110, v28, v29
  v_cvt_pk_bf16_f32 v111, v30, v31
  v_mfma_f32_32x32x16_bf16 v[16:31], v[136:139], v[120:123], v[80:95]
  ds_read_b128 v[128:131], v172 offset:8192
  v_exp_f32 v0, v0
  v_exp_f32 v1, v1
  v_exp_f32 v2, v2
  v_mfma_f32_32x32x16_bf16 v[16:31], v[140:143], v[124:127], v[16:31]
  ds_read_b128 v[132:135], v172 offset:8704
  v_exp_f32 v3, v3
  v_exp_f32 v4, v4
  v_cvt_pk_bf16_f32 v96, v0, v1
  v_exp_f32 v5, v5
  v_mfma_f32_32x32x16_bf16 v[48:63], v[144:147], v[104:107], v[48:63]
  s_add_u32 m0, s50, 0
  v_exp_f32 v6, v6
  v_cvt_pk_bf16_f32 v97, v2, v3
  v_exp_f32 v7, v7
  v_exp_f32 v8, v8
  v_cvt_pk_bf16_f32 v98, v4, v5
  v_mfma_f32_32x32x16_bf16 v[48:63], v[148:151], v[108:111], v[48:63]
  buffer_load_dwordx4 v255, s[8:11], s49 offen sc1 lds
  v_exp_f32 v9, v9
  v_exp_f32 v10, v10
  v_cvt_pk_bf16_f32 v99, v6, v7
  v_exp_f32 v11, v11
  v_mfma_f32_16x16x32_bf16 v[164:167], v[168:171], v[104:107], v[164:167]
  buffer_load_dwordx4 v255, s[12:15], s49 offen offset:1024 sc1 lds
  s_add_u32 s49, s49, 4096
  v_exp_f32 v12, v12
  v_cvt_pk_bf16_f32 v100, v8, v9
  v_exp_f32 v13, v13
  v_mfma_f32_16x16x32_bf16 v[164:167], v[168:171], v[108:111], v[164:167]
  s_waitcnt lgkmcnt(0)
  buffer_load_dwordx4 a[64:67], v255, s[36:39], s60 offen offset:0 sc1
  v_exp_f32 v14, v14
  v_cvt_pk_bf16_f32 v101, v10, v11
  v_exp_f32 v15, v15
  v_cvt_pk_bf16_f32 v102, v12, v13
  v_cvt_pk_bf16_f32 v103, v14, v15
  v_mfma_f32_32x32x16_bf16 v[0:15], v[128:131], v[112:115], v[64:79]
  ds_read_b128 v[144:147], v172 offset:9216
  v_exp_f32 v16, v16
  v_exp_f32 v17, v17
  v_exp_f32 v18, v18
  v_mfma_f32_32x32x16_bf16 v[0:15], v[132:135], v[116:119], v[0:15]
  ds_read_b128 v[148:151], v172 offset:9728
  v_exp_f32 v19, v19
  v_exp_f32 v20, v20
  v_cvt_pk_bf16_f32 v104, v16, v17
  v_exp_f32 v21, v21
  v_mfma_f32_32x32x16_bf16 v[32:47], v[152:155], v[96:99], v[32:47]
  buffer_load_dwordx4 a[68:71], v255, s[36:39], s60 offen offset:1024 sc1
  s_add_u32 s60, s60, 8192
  v_exp_f32 v22, v22
  v_cvt_pk_bf16_f32 v105, v18, v19
  v_exp_f32 v23, v23
  v_exp_f32 v24, v24
  v_cvt_pk_bf16_f32 v106, v20, v21
  v_mfma_f32_32x32x16_bf16 v[32:47], v[156:159], v[100:103], v[32:47]
  buffer_load_dwordx4 a[72:75], v255, s[36:39], s60 offen offset:0 sc1
  v_exp_f32 v25, v25
  v_exp_f32 v26, v26
  v_cvt_pk_bf16_f32 v107, v22, v23
  v_exp_f32 v27, v27
  v_mfma_f32_16x16x32_bf16 v[160:163], v[168:171], v[96:99], v[160:163]
  buffer_load_dwordx4 a[76:79], v255, s[36:39], s60 offen offset:1024 sc1
  s_add_u32 s60, s60, 8192
  v_exp_f32 v28, v28
  v_cvt_pk_bf16_f32 v108, v24, v25
  v_exp_f32 v29, v29
  v_mfma_f32_16x16x32_bf16 v[160:163], v[168:171], v[100:103], v[160:163]
  s_waitcnt lgkmcnt(0)
  buffer_load_dwordx4 a[80:83], v255, s[36:39], s60 offen offset:0 sc1
  v_exp_f32 v30, v30
  v_cvt_pk_bf16_f32 v109, v26, v27
  v_exp_f32 v31, v31
  v_cvt_pk_bf16_f32 v110, v28, v29
  v_cvt_pk_bf16_f32 v111, v30, v31
  v_mfma_f32_32x32x16_bf16 v[16:31], v[128:131], v[120:123], v[80:95]
  ds_read_b128 v[136:139], v172 offset:12288
  v_exp_f32 v0, v0
  v_exp_f32 v1, v1
  v_exp_f32 v2, v2
  v_mfma_f32_32x32x16_bf16 v[16:31], v[132:135], v[124:127], v[16:31]
  ds_read_b128 v[140:143], v172 offset:12800
  v_exp_f32 v3, v3
  v_exp_f32 v4, v4
  v_cvt_pk_bf16_f32 v96, v0, v1
  v_exp_f32 v5, v5
  v_mfma_f32_32x32x16_bf16 v[48:63], v[152:155], v[104:107], v[48:63]
  buffer_load_dwordx4 a[84:87], v255, s[36:39], s60 offen offset:1024 sc1
  s_add_u32 s60, s60, 8192
  v_exp_f32 v6, v6
  v_cvt_pk_bf16_f32 v97, v2, v3
  v_exp_f32 v7, v7
  v_exp_f32 v8, v8
  v_cvt_pk_bf16_f32 v98, v4, v5
  v_mfma_f32_32x32x16_bf16 v[48:63], v[156:159], v[108:111], v[48:63]
  buffer_load_dwordx2 a[88:89], v249, s[36:39], s60 offen offset:0 sc1
  v_exp_f32 v9, v9
  v_exp_f32 v10, v10
  v_cvt_pk_bf16_f32 v99, v6, v7
  v_exp_f32 v11, v11
  v_mfma_f32_16x16x32_bf16 v[164:167], v[168:171], v[104:107], v[164:167]
  buffer_load_dwordx2 a[90:91], v249, s[36:39], s60 offen offset:512 sc1
  v_exp_f32 v12, v12
  v_cvt_pk_bf16_f32 v100, v8, v9
  v_exp_f32 v13, v13
  v_mfma_f32_16x16x32_bf16 v[164:167], v[168:171], v[108:111], v[164:167]
  s_waitcnt lgkmcnt(0)
  buffer_load_dwordx2 a[92:93], v249, s[36:39], s60 offen offset:1024 sc1
  v_exp_f32 v14, v14
  v_cvt_pk_bf16_f32 v101, v10, v11
  v_exp_f32 v15, v15
  v_cvt_pk_bf16_f32 v102, v12, v13
  v_cvt_pk_bf16_f32 v103, v14, v15
  v_mfma_f32_32x32x16_bf16 v[0:15], v[136:139], v[112:115], v[64:79]
  ds_read_b128 v[152:155], v172 offset:13312
  v_exp_f32 v16, v16
  v_exp_f32 v17, v17
  v_exp_f32 v18, v18
  v_mfma_f32_32x32x16_bf16 v[0:15], v[140:143], v[116:119], v[0:15]
  ds_read_b128 v[156:159], v172 offset:13824
  v_exp_f32 v19, v19
  v_exp_f32 v20, v20
  v_cvt_pk_bf16_f32 v104, v16, v17
  v_exp_f32 v21, v21
  v_mfma_f32_32x32x16_bf16 v[32:47], v[144:147], v[96:99], v[32:47]
  buffer_load_dwordx2 a[94:95], v249, s[36:39], s60 offen offset:1536 sc1
  s_add_u32 s60, s60, 8192
  v_exp_f32 v22, v22
  v_cvt_pk_bf16_f32 v105, v18, v19
  v_exp_f32 v23, v23
  v_exp_f32 v24, v24
  v_cvt_pk_bf16_f32 v106, v20, v21
  v_mfma_f32_32x32x16_bf16 v[32:47], v[148:151], v[100:103], v[32:47]
  buffer_load_dwordx4 a[96:99], v255, s[36:39], s60 offen offset:0 sc1
  v_exp_f32 v25, v25
  v_exp_f32 v26, v26
  v_cvt_pk_bf16_f32 v107, v22, v23
  v_exp_f32 v27, v27
  v_mfma_f32_16x16x32_bf16 v[160:163], v[168:171], v[96:99], v[160:163]
  buffer_load_dwordx4 a[100:103], v255, s[36:39], s60 offen offset:1024 sc1
  s_add_u32 s60, s60, 8192
  v_exp_f32 v28, v28
  v_cvt_pk_bf16_f32 v108, v24, v25
  v_exp_f32 v29, v29
  v_mfma_f32_16x16x32_bf16 v[160:163], v[168:171], v[100:103], v[160:163]
  s_waitcnt vmcnt(30) lgkmcnt(0)
  s_barrier
  v_exp_f32 v30, v30
  v_cvt_pk_bf16_f32 v109, v26, v27
  v_exp_f32 v31, v31
  v_cvt_pk_bf16_f32 v110, v28, v29
  v_cvt_pk_bf16_f32 v111, v30, v31
  v_mfma_f32_32x32x16_bf16 v[16:31], v[136:139], v[120:123], v[80:95]
  ds_read_b128 v[128:131], v172 offset:16384
  v_exp_f32 v0, v0
  v_exp_f32 v1, v1
  v_exp_f32 v2, v2
  v_mfma_f32_32x32x16_bf16 v[16:31], v[140:143], v[124:127], v[16:31]
  ds_read_b128 v[132:135], v172 offset:16896
  v_exp_f32 v3, v3
  v_exp_f32 v4, v4
  v_cvt_pk_bf16_f32 v96, v0, v1
  v_exp_f32 v5, v5
  v_mfma_f32_32x32x16_bf16 v[48:63], v[144:147], v[104:107], v[48:63]
  s_add_u32 m0, s50, 8192
  v_exp_f32 v6, v6
  v_cvt_pk_bf16_f32 v97, v2, v3
  v_exp_f32 v7, v7
  v_exp_f32 v8, v8
  v_cvt_pk_bf16_f32 v98, v4, v5
  v_mfma_f32_32x32x16_bf16 v[48:63], v[148:151], v[108:111], v[48:63]
  buffer_load_dwordx4 v255, s[8:11], s49 offen sc1 lds
  v_exp_f32 v9, v9
  v_exp_f32 v10, v10
  v_cvt_pk_bf16_f32 v99, v6, v7
  v_exp_f32 v11, v11
  v_mfma_f32_16x16x32_bf16 v[164:167], v[168:171], v[104:107], v[164:167]
  buffer_load_dwordx4 v255, s[12:15], s49 offen offset:1024 sc1 lds
  s_add_u32 s49, s49, 4096
  v_exp_f32 v12, v12
  v_cvt_pk_bf16_f32 v100, v8, v9
  v_exp_f32 v13, v13
  v_mfma_f32_16x16x32_bf16 v[164:167], v[168:171], v[108:111], v[164:167]
  s_waitcnt lgkmcnt(0)
  buffer_load_dwordx4 a[104:107], v255, s[36:39], s60 offen offset:0 sc1
  v_exp_f32 v14, v14
  v_cvt_pk_bf16_f32 v101, v10, v11
  v_exp_f32 v15, v15
  v_cvt_pk_bf16_f32 v102, v12, v13
  v_cvt_pk_bf16_f32 v103, v14, v15
  v_mfma_f32_32x32x16_bf16 v[0:15], v[128:131], v[112:115], v[64:79]
  ds_read_b128 v[144:147], v172 offset:17408
  v_exp_f32 v16, v16
  v_exp_f32 v17, v17
  v_exp_f32 v18, v18
  v_mfma_f32_32x32x16_bf16 v[0:15], v[132:135], v[116:119], v[0:15]
  ds_read_b128 v[148:151], v172 offset:17920
  v_exp_f32 v19, v19
  v_exp_f32 v20, v20
  v_cvt_pk_bf16_f32 v104, v16, v17
  v_exp_f32 v21, v21
  v_mfma_f32_32x32x16_bf16 v[32:47], v[152:155], v[96:99], v[32:47]
  buffer_load_dwordx4 a[108:111], v255, s[36:39], s60 offen offset:1024 sc1
  s_add_u32 s60, s60, 8192
  v_exp_f32 v22, v22
  v_cvt_pk_bf16_f32 v105, v18, v19
  v_exp_f32 v23, v23
  v_exp_f32 v24, v24
  v_cvt_pk_bf16_f32 v106, v20, v21
  v_mfma_f32_32x32x16_bf16 v[32:47], v[156:159], v[100:103], v[32:47]
  buffer_load_dwordx4 a[112:115], v255, s[36:39], s60 offen offset:0 sc1
  v_exp_f32 v25, v25
  v_exp_f32 v26, v26
  v_cvt_pk_bf16_f32 v107, v22, v23
  v_exp_f32 v27, v27
  v_mfma_f32_16x16x32_bf16 v[160:163], v[168:171], v[96:99], v[160:163]
  buffer_load_dwordx4 a[116:119], v255, s[36:39], s60 offen offset:1024 sc1
  s_add_u32 s60, s60, 8192
  v_exp_f32 v28, v28
  v_cvt_pk_bf16_f32 v108, v24, v25
  v_exp_f32 v29, v29
  v_mfma_f32_16x16x32_bf16 v[160:163], v[168:171], v[100:103], v[160:163]
  s_waitcnt lgkmcnt(0)
  buffer_load_dwordx4 a[120:123], v255, s[36:39], s60 offen offset:0 sc1
  v_exp_f32 v30, v30
  v_cvt_pk_bf16_f32 v109, v26, v27
  v_exp_f32 v31, v31
  v_cvt_pk_bf16_f32 v110, v28, v29
  v_cvt_pk_bf16_f32 v111, v30, v31
  v_mfma_f32_32x32x16_bf16 v[16:31], v[128:131], v[120:123], v[80:95]
  ds_read_b128 v[136:139], v172 offset:20480
  v_exp_f32 v0, v0
  v_exp_f32 v1, v1
  v_exp_f32 v2, v2
  v_mfma_f32_32x32x16_bf16 v[16:31], v[132:135], v[124:127], v[16:31]
  ds_read_b128 v[140:143], v172 offset:20992
  v_exp_f32 v3, v3
  v_exp_f32 v4, v4
  v_cvt_pk_bf16_f32 v96, v0, v1
  v_exp_f32 v5, v5
  v_mfma_f32_32x32x16_bf16 v[48:63], v[152:155], v[104:107], v[48:63]
  buffer_load_dwordx4 a[124:127], v255, s[36:39], s60 offen offset:1024 sc1
  s_add_u32 s60, s60, 8192
  v_exp_f32 v6, v6
  v_cvt_pk_bf16_f32 v97, v2, v3
  v_exp_f32 v7, v7
  v_exp_f32 v8, v8
  v_cvt_pk_bf16_f32 v98, v4, v5
  v_mfma_f32_32x32x16_bf16 v[48:63], v[156:159], v[108:111], v[48:63]
  buffer_load_dwordx4 a[128:131], v255, s[36:39], s60 offen offset:0 sc1
  v_exp_f32 v9, v9
  v_exp_f32 v10, v10
  v_cvt_pk_bf16_f32 v99, v6, v7
  v_exp_f32 v11, v11
  v_mfma_f32_16x16x32_bf16 v[164:167], v[168:171], v[104:107], v[164:167]
  buffer_load_dwordx4 a[132:135], v255, s[36:39], s60 offen offset:1024 sc1
  s_add_u32 s60, s60, 8192
  v_exp_f32 v12, v12
  v_cvt_pk_bf16_f32 v100, v8, v9
  v_exp_f32 v13, v13
  v_mfma_f32_16x16x32_bf16 v[164:167], v[168:171], v[108:111], v[164:167]
  s_waitcnt lgkmcnt(0)
  buffer_load_dwordx4 a[136:139], v255, s[36:39], s60 offen offset:0 sc1
  v_exp_f32 v14, v14
  v_cvt_pk_bf16_f32 v101, v10, v11
  v_exp_f32 v15, v15
  v_cvt_pk_bf16_f32 v102, v12, v13
  v_cvt_pk_bf16_f32 v103, v14, v15
  v_mfma_f32_32x32x16_bf16 v[0:15], v[136:139], v[112:115], v[64:79]
  ds_read_b128 v[152:155], v172 offset:21504
  v_exp_f32 v16, v16
  v_exp_f32 v17, v17
  v_exp_f32 v18, v18
  v_mfma_f32_32x32x16_bf16 v[0:15], v[140:143], v[116:119], v[0:15]
  ds_read_b128 v[156:159], v172 offset:22016
  v_exp_f32 v19, v19
  v_exp_f32 v20, v20
  v_cvt_pk_bf16_f32 v104, v16, v17
  v_exp_f32 v21, v21
  v_mfma_f32_32x32x16_bf16 v[32:47], v[144:147], v[96:99], v[32:47]
  buffer_load_dwordx4 a[140:143], v255, s[36:39], s60 offen offset:1024 sc1
  s_add_u32 s60, s60, 8192
  v_exp_f32 v22, v22
  v_cvt_pk_bf16_f32 v105, v18, v19
  v_exp_f32 v23, v23
  v_exp_f32 v24, v24
  v_cvt_pk_bf16_f32 v106, v20, v21
  v_mfma_f32_32x32x16_bf16 v[32:47], v[148:151], v[100:103], v[32:47]
  buffer_load_dwordx2 a[144:145], v249, s[36:39], s60 offen offset:0 sc1
  v_exp_f32 v25, v25
  v_exp_f32 v26, v26
  v_cvt_pk_bf16_f32 v107, v22, v23
  v_exp_f32 v27, v27
  v_mfma_f32_16x16x32_bf16 v[160:163], v[168:171], v[96:99], v[160:163]
  buffer_load_dwordx2 a[146:147], v249, s[36:39], s60 offen offset:512 sc1
  v_exp_f32 v28, v28
  v_cvt_pk_bf16_f32 v108, v24, v25
  v_exp_f32 v29, v29
  v_mfma_f32_16x16x32_bf16 v[160:163], v[168:171], v[100:103], v[160:163]
  s_waitcnt vmcnt(33) lgkmcnt(0)
  s_barrier
  v_exp_f32 v30, v30
  v_cvt_pk_bf16_f32 v109, v26, v27
  v_exp_f32 v31, v31
  v_cvt_pk_bf16_f32 v110, v28, v29
  v_cvt_pk_bf16_f32 v111, v30, v31
  v_mfma_f32_32x32x16_bf16 v[16:31], v[136:139], v[120:123], v[80:95]
  ds_read_b128 v[128:131], v172 offset:24576
  v_exp_f32 v0, v0
  v_exp_f32 v1, v1
  v_exp_f32 v2, v2
  v_mfma_f32_32x32x16_bf16 v[16:31], v[140:143], v[124:127], v[16:31]
  ds_read_b128 v[132:135], v172 offset:25088
  v_exp_f32 v3, v3
  v_exp_f32 v4, v4
  v_cvt_pk_bf16_f32 v96, v0, v1
  v_exp_f32 v5, v5
  v_mfma_f32_32x32x16_bf16 v[48:63], v[144:147], v[104:107], v[48:63]
  s_add_u32 m0, s50, 16384
  v_exp_f32 v6, v6
  v_cvt_pk_bf16_f32 v97, v2, v3
  v_exp_f32 v7, v7
  v_exp_f32 v8, v8
  v_cvt_pk_bf16_f32 v98, v4, v5
  v_mfma_f32_32x32x16_bf16 v[48:63], v[148:151], v[108:111], v[48:63]
  buffer_load_dwordx4 v255, s[8:11], s49 offen sc1 lds
  v_exp_f32 v9, v9
  v_exp_f32 v10, v10
  v_cvt_pk_bf16_f32 v99, v6, v7
  v_exp_f32 v11, v11
  v_mfma_f32_16x16x32_bf16 v[164:167], v[168:171], v[104:107], v[164:167]
  buffer_load_dwordx4 v255, s[12:15], s49 offen offset:1024 sc1 lds
  s_add_u32 s49, s49, 4096
  v_exp_f32 v12, v12
  v_cvt_pk_bf16_f32 v100, v8, v9
  v_exp_f32 v13, v13
  v_mfma_f32_16x16x32_bf16 v[164:167], v[168:171], v[108:111], v[164:167]
  s_waitcnt lgkmcnt(0)
  buffer_load_dwordx2 a[148:149], v249, s[36:39], s60 offen offset:1024 sc1
  v_exp_f32 v14, v14
  v_cvt_pk_bf16_f32 v101, v10, v11
  v_exp_f32 v15, v15
  v_cvt_pk_bf16_f32 v102, v12, v13
  v_cvt_pk_bf16_f32 v103, v14, v15
  v_mfma_f32_32x32x16_bf16 v[0:15], v[128:131], v[112:115], v[64:79]
  ds_read_b128 v[144:147], v172 offset:25600
  v_exp_f32 v16, v16
  v_exp_f32 v17, v17
  v_exp_f32 v18, v18
  v_mfma_f32_32x32x16_bf16 v[0:15], v[132:135], v[116:119], v[0:15]
  ds_read_b128 v[148:151], v172 offset:26112
  v_exp_f32 v19, v19
  v_exp_f32 v20, v20
  v_cvt_pk_bf16_f32 v104, v16, v17
  v_exp_f32 v21, v21
  v_mfma_f32_32x32x16_bf16 v[32:47], v[152:155], v[96:99], v[32:47]
  buffer_load_dwordx2 a[150:151], v249, s[36:39], s60 offen offset:1536 sc1
  s_add_u32 s60, s60, 8192
  v_exp_f32 v22, v22
  v_cvt_pk_bf16_f32 v105, v18, v19
  v_exp_f32 v23, v23
  v_exp_f32 v24, v24
  v_cvt_pk_bf16_f32 v106, v20, v21
  v_mfma_f32_32x32x16_bf16 v[32:47], v[156:159], v[100:103], v[32:47]
  buffer_load_dwordx4 a[152:155], v255, s[36:39], s60 offen offset:0 sc1
  v_exp_f32 v25, v25
  v_exp_f32 v26, v26
  v_cvt_pk_bf16_f32 v107, v22, v23
  v_exp_f32 v27, v27
  v_mfma_f32_16x16x32_bf16 v[160:163], v[168:171], v[96:99], v[160:163]
  buffer_load_dwordx4 a[156:159], v255, s[36:39], s60 offen offset:1024 sc1
  s_add_u32 s60, s60, 8192
  v_exp_f32 v28, v28
  v_cvt_pk_bf16_f32 v108, v24, v25
  v_exp_f32 v29, v29
  v_mfma_f32_16x16x32_bf16 v[160:163], v[168:171], v[100:103], v[160:163]
  s_waitcnt lgkmcnt(0)
  buffer_load_dwordx4 a[160:163], v255, s[36:39], s60 offen offset:0 sc1
  v_exp_f32 v30, v30
  v_cvt_pk_bf16_f32 v109, v26, v27
  v_exp_f32 v31, v31
  v_cvt_pk_bf16_f32 v110, v28, v29
  v_cvt_pk_bf16_f32 v111, v30, v31
  v_mfma_f32_32x32x16_bf16 v[16:31], v[128:131], v[120:123], v[80:95]
  ds_read_b128 v[136:139], v172 offset:28672
  v_exp_f32 v0, v0
  v_exp_f32 v1, v1
  v_exp_f32 v2, v2
  v_mfma_f32_32x32x16_bf16 v[16:31], v[132:135], v[124:127], v[16:31]
  ds_read_b128 v[140:143], v172 offset:29184
  v_exp_f32 v3, v3
  v_exp_f32 v4, v4
  v_cvt_pk_bf16_f32 v96, v0, v1
  v_exp_f32 v5, v5
  v_mfma_f32_32x32x16_bf16 v[48:63], v[152:155], v[104:107], v[48:63]
  buffer_load_dwordx4 a[164:167], v255, s[36:39], s60 offen offset:1024 sc1
  s_add_u32 s60, s60, 8192
  v_exp_f32 v6, v6
  v_cvt_pk_bf16_f32 v97, v2, v3
  v_exp_f32 v7, v7
  v_exp_f32 v8, v8
  v_cvt_pk_bf16_f32 v98, v4, v5
  v_mfma_f32_32x32x16_bf16 v[48:63], v[156:159], v[108:111], v[48:63]
  buffer_load_dwordx4 a[168:171], v255, s[36:39], s60 offen offset:0 sc1
  v_exp_f32 v9, v9
  v_exp_f32 v10, v10
  v_cvt_pk_bf16_f32 v99, v6, v7
  v_exp_f32 v11, v11
  v_mfma_f32_16x16x32_bf16 v[164:167], v[168:171], v[104:107], v[164:167]
  buffer_load_dwordx4 a[172:175], v255, s[36:39], s60 offen offset:1024 sc1
  s_add_u32 s60, s60, 8192
  v_exp_f32 v12, v12
  v_cvt_pk_bf16_f32 v100, v8, v9
  v_exp_f32 v13, v13
  v_mfma_f32_16x16x32_bf16 v[164:167], v[168:171], v[108:111], v[164:167]
  s_waitcnt lgkmcnt(0)
  buffer_load_dwordx4 a[176:179], v255, s[36:39], s60 offen offset:0 sc1
  v_exp_f32 v14, v14
  v_cvt_pk_bf16_f32 v101, v10, v11
  v_exp_f32 v15, v15
  v_cvt_pk_bf16_f32 v102, v12, v13
  v_cvt_pk_bf16_f32 v103, v14, v15
  v_mfma_f32_32x32x16_bf16 v[0:15], v[136:139], v[112:115], v[64:79]
  ds_read_b128 v[152:155], v172 offset:29696
  v_exp_f32 v16, v16
  v_exp_f32 v17, v17
  v_exp_f32 v18, v18
  v_mfma_f32_32x32x16_bf16 v[0:15], v[140:143], v[116:119], v[0:15]
  ds_read_b128 v[156:159], v172 offset:30208
  v_exp_f32 v19, v19
  v_exp_f32 v20, v20
  v_cvt_pk_bf16_f32 v104, v16, v17
  v_exp_f32 v21, v21
  v_mfma_f32_32x32x16_bf16 v[32:47], v[144:147], v[96:99], v[32:47]
  buffer_load_dwordx4 a[180:183], v255, s[36:39], s60 offen offset:1024 sc1
  s_add_u32 s60, s60, 8192
  v_exp_f32 v22, v22
  v_cvt_pk_bf16_f32 v105, v18, v19
  v_exp_f32 v23, v23
  v_exp_f32 v24, v24
  v_cvt_pk_bf16_f32 v106, v20, v21
  v_mfma_f32_32x32x16_bf16 v[32:47], v[148:151], v[100:103], v[32:47]
  buffer_load_dwordx4 a[184:187], v255, s[36:39], s60 offen offset:0 sc1
  v_exp_f32 v25, v25
  v_exp_f32 v26, v26
  v_cvt_pk_bf16_f32 v107, v22, v23
  v_exp_f32 v27, v27
  v_mfma_f32_16x16x32_bf16 v[160:163], v[168:171], v[96:99], v[160:163]
  buffer_load_dwordx4 a[188:191], v255, s[36:39], s60 offen offset:1024 sc1
  s_add_u32 s60, s60, 8192
  v_exp_f32 v28, v28
  v_cvt_pk_bf16_f32 v108, v24, v25
  v_exp_f32 v29, v29
  v_mfma_f32_16x16x32_bf16 v[160:163], v[168:171], v[100:103], v[160:163]
  s_waitcnt vmcnt(40) lgkmcnt(0)
  s_barrier
  v_exp_f32 v30, v30
  v_cvt_pk_bf16_f32 v109, v26, v27
  v_exp_f32 v31, v31
  v_cvt_pk_bf16_f32 v110, v28, v29
  v_cvt_pk_bf16_f32 v111, v30, v31
  ds_read_b64_tr_b16 a[0:1], v236 offset:0
  ds_read_b64_tr_b16 a[2:3], v236 offset:2048
  ds_read_b64_tr_b16 a[4:5], v237 offset:0
  ds_read_b64_tr_b16 a[6:7], v237 offset:2048
  ds_read_b64_tr_b16 a[8:9], v238 offset:0
  ds_read_b64_tr_b16 a[10:11], v238 offset:2048
  ds_read_b64_tr_b16 a[12:13], v239 offset:0
  ds_read_b64_tr_b16 a[14:15], v239 offset:2048
  ds_read_b64_tr_b16 a[16:17], v236 offset:4096
  ds_read_b64_tr_b16 a[18:19], v236 offset:6144
  ds_read_b64_tr_b16 a[20:21], v237 offset:4096
  ds_read_b64_tr_b16 a[22:23], v237 offset:6144
  ds_read_b64_tr_b16 a[24:25], v238 offset:4096
  ds_read_b64_tr_b16 a[26:27], v238 offset:6144
  ds_read_b64_tr_b16 a[28:29], v239 offset:4096
  ds_read_b64_tr_b16 a[30:31], v239 offset:6144
  s_waitcnt vmcnt(38) lgkmcnt(8)
  v_mfma_f32_16x16x32_bf16 v[200:203], a[0:3], a[64:67], 0
  ds_read_b64_tr_b16 a[32:33], v236 offset:8192
  v_mfma_f32_16x16x32_bf16 v[204:207], a[4:7], a[64:67], 0
  ds_read_b64_tr_b16 a[34:35], v236 offset:10240
  v_mfma_f32_16x16x32_bf16 v[208:211], a[8:11], a[64:67], 0
  ds_read_b64_tr_b16 a[36:37], v237 offset:8192
  buffer_load_dwordx4 a[192:195], v255, s[36:39], s60 offen offset:0 sc1
  v_mfma_f32_16x16x32_bf16 v[212:215], a[12:15], a[64:67], 0
  ds_read_b64_tr_b16 a[38:39], v237 offset:10240
  v_mfma_f32_16x16x32_bf16 v[228:231], a[12:15], a[68:71], 0
  ds_read_b64_tr_b16 a[40:41], v238 offset:8192
  v_mfma_f32_16x16x32_bf16 v[224:227], a[8:11], a[68:71], 0
  ds_read_b64_tr_b16 a[42:43], v238 offset:10240
  buffer_load_dwordx4 a[196:199], v255, s[36:39], s60 offen offset:1024 sc1
  v_mfma_f32_16x16x32_bf16 v[220:223], a[4:7], a[68:71], 0
  ds_read_b64_tr_b16 a[44:45], v239 offset:8192
  v_mfma_f32_16x16x32_bf16 v[216:219], a[0:3], a[68:71], 0
  ds_read_b64_tr_b16 a[46:47], v239 offset:10240
  s_add_u32 s60, s60, 8192
  s_waitcnt vmcnt(38) lgkmcnt(8)
  v_mfma_f32_16x16x32_bf16 v[200:203], a[16:19], a[72:75], v[200:203]
  ds_read_b64_tr_b16 a[0:1], v236 offset:12288
  v_mfma_f32_16x16x32_bf16 v[204:207], a[20:23], a[72:75], v[204:207]
  ds_read_b64_tr_b16 a[2:3], v236 offset:14336
  buffer_load_dwordx2 a[200:201], v249, s[36:39], s60 offen offset:0 sc1
  v_mfma_f32_16x16x32_bf16 v[208:211], a[24:27], a[72:75], v[208:211]
  ds_read_b64_tr_b16 a[4:5], v237 offset:12288
  v_mfma_f32_16x16x32_bf16 v[212:215], a[28:31], a[72:75], v[212:215]
  ds_read_b64_tr_b16 a[6:7], v237 offset:14336
  buffer_load_dwordx2 a[202:203], v249, s[36:39], s60 offen offset:512 sc1
  v_mfma_f32_16x16x32_bf16 v[228:231], a[28:31], a[76:79], v[228:231]
  ds_read_b64_tr_b16 a[8:9], v238 offset:12288
  v_mfma_f32_16x16x32_bf16 v[224:227], a[24:27], a[76:79], v[224:227]
  ds_read_b64_tr_b16 a[10:11], v238 offset:14336
  buffer_load_dwordx2 a[204:205], v249, s[36:39], s60 offen offset:1024 sc1
  v_mfma_f32_16x16x32_bf16 v[220:223], a[20:23], a[76:79], v[220:223]
  ds_read_b64_tr_b16 a[12:13], v239 offset:12288
  buffer_load_dwordx2 a[206:207], v249, s[36:39], s60 offen offset:1536 sc1
  v_mfma_f32_16x16x32_bf16 v[216:219], a[16:19], a[76:79], v[216:219]
  ds_read_b64_tr_b16 a[14:15], v239 offset:14336
  s_add_u32 s60, s60, 8192
  s_waitcnt vmcnt(40) lgkmcnt(8)
  v_mfma_f32_16x16x32_bf16 v[200:203], a[32:35], a[80:83], v[200:203]
  ds_read_b64_tr_b16 a[16:17], v236 offset:16384
  v_mfma_f32_16x16x32_bf16 v[204:207], a[36:39], a[80:83], v[204:207]
  ds_read_b64_tr_b16 a[18:19], v236 offset:18432
  v_mfma_f32_16x16x32_bf16 v[208:211], a[40:43], a[80:83], v[208:211]
  ds_read_b64_tr_b16 a[20:21], v237 offset:16384
  buffer_load_dwordx4 a[208:211], v255, s[36:39], s60 offen offset:0 sc1
  v_mfma_f32_16x16x32_bf16 v[212:215], a[44:47], a[80:83], v[212:215]
  ds_read_b64_tr_b16 a[22:23], v237 offset:18432
  v_mfma_f32_16x16x32_bf16 v[228:231], a[44:47], a[84:87], v[228:231]
  ds_read_b64_tr_b16 a[24:25], v238 offset:16384
  v_mfma_f32_16x16x32_bf16 v[224:227], a[40:43], a[84:87], v[224:227]
  ds_read_b64_tr_b16 a[26:27], v238 offset:18432
  buffer_load_dwordx4 a[212:215], v255, s[36:39], s60 offen offset:1024 sc1
  v_mfma_f32_16x16x32_bf16 v[220:223], a[36:39], a[84:87], v[220:223]
  ds_read_b64_tr_b16 a[28:29], v239 offset:16384
  v_mfma_f32_16x16x32_bf16 v[216:219], a[32:35], a[84:87], v[216:219]
  ds_read_b64_tr_b16 a[30:31], v239 offset:18432
  s_add_u32 s60, s60, 8192
  s_waitcnt vmcnt(38) lgkmcnt(8)
  v_mfma_f32_16x16x32_bf16 v[200:203], a[0:3], a[88:91], v[200:203]
  ds_read_b64_tr_b16 a[32:33], v236 offset:20480
  v_mfma_f32_16x16x32_bf16 v[204:207], a[4:7], a[88:91], v[204:207]
  ds_read_b64_tr_b16 a[34:35], v236 offset:22528
  v_mfma_f32_16x16x32_bf16 v[208:211], a[8:11], a[88:91], v[208:211]
  ds_read_b64_tr_b16 a[36:37], v237 offset:20480
  buffer_load_dwordx4 a[216:219], v255, s[36:39], s60 offen offset:0 sc1
  v_mfma_f32_16x16x32_bf16 v[212:215], a[12:15], a[88:91], v[212:215]
  ds_read_b64_tr_b16 a[38:39], v237 offset:22528
  v_mfma_f32_16x16x32_bf16 v[228:231], a[12:15], a[92:95], v[228:231]
  ds_read_b64_tr_b16 a[40:41], v238 offset:20480
  v_mfma_f32_16x16x32_bf16 v[224:227], a[8:11], a[92:95], v[224:227]
  ds_read_b64_tr_b16 a[42:43], v238 offset:22528
  buffer_load_dwordx4 a[220:223], v255, s[36:39], s60 offen offset:1024 sc1
  v_mfma_f32_16x16x32_bf16 v[220:223], a[4:7], a[92:95], v[220:223]
  ds_read_b64_tr_b16 a[44:45], v239 offset:20480
  v_mfma_f32_16x16x32_bf16 v[216:219], a[0:3], a[92:95], v[216:219]
  ds_read_b64_tr_b16 a[46:47], v239 offset:22528
  s_add_u32 s60, s60, 8192
  s_waitcnt lgkmcnt(0)
  v_mfma_f32_32x32x16_bf16 v[16:31], v[136:139], v[120:123], v[80:95]
  ds_read_b128 v[128:131], v172 offset:0
  v_exp_f32 v0, v0
  v_exp_f32 v1, v1
  v_exp_f32 v2, v2
  v_mfma_f32_32x32x16_bf16 v[16:31], v[140:143], v[124:127], v[16:31]
  ds_read_b128 v[132:135], v172 offset:512
  v_exp_f32 v3, v3
  v_exp_f32 v4, v4
  v_cvt_pk_bf16_f32 v96, v0, v1
  v_exp_f32 v5, v5
  v_mfma_f32_32x32x16_bf16 v[48:63], v[144:147], v[104:107], v[48:63]
  s_add_u32 m0, s50, 24576
  v_exp_f32 v6, v6
  v_cvt_pk_bf16_f32 v97, v2, v3
  v_exp_f32 v7, v7
  v_exp_f32 v8, v8
  v_cvt_pk_bf16_f32 v98, v4, v5
  v_mfma_f32_32x32x16_bf16 v[48:63], v[148:151], v[108:111], v[48:63]
  buffer_load_dwordx4 v255, s[8:11], s49 offen sc1 lds
  v_exp_f32 v9, v9
  v_exp_f32 v10, v10
  v_cvt_pk_bf16_f32 v99, v6, v7
  v_exp_f32 v11, v11
  v_mfma_f32_16x16x32_bf16 v[164:167], v[168:171], v[104:107], v[164:167]
  buffer_load_dwordx4 v255, s[12:15], s49 offen offset:1024 sc1 lds
  s_add_u32 s49, s49, 4096
  v_exp_f32 v12, v12
  v_cvt_pk_bf16_f32 v100, v8, v9
  v_exp_f32 v13, v13
  v_mfma_f32_16x16x32_bf16 v[164:167], v[168:171], v[108:111], v[164:167]
  s_waitcnt lgkmcnt(0)
  v_exp_f32 v14, v14
  v_cvt_pk_bf16_f32 v101, v10, v11
  v_exp_f32 v15, v15
  v_cvt_pk_bf16_f32 v102, v12, v13
  v_cvt_pk_bf16_f32 v103, v14, v15
  s_waitcnt vmcnt(40) lgkmcnt(8)
  v_mfma_f32_16x16x32_bf16 v[200:203], a[16:19], a[96:99], v[200:203]
  ds_read_b64_tr_b16 a[0:1], v236 offset:24576
  v_mfma_f32_16x16x32_bf16 v[204:207], a[20:23], a[96:99], v[204:207]
  ds_read_b64_tr_b16 a[2:3], v236 offset:26624
  v_mfma_f32_16x16x32_bf16 v[208:211], a[24:27], a[96:99], v[208:211]
  ds_read_b64_tr_b16 a[4:5], v237 offset:24576
  buffer_load_dwordx4 a[224:227], v255, s[36:39], s60 offen offset:0 sc1
  v_mfma_f32_16x16x32_bf16 v[212:215], a[28:31], a[96:99], v[212:215]
  ds_read_b64_tr_b16 a[6:7], v237 offset:26624
  v_mfma_f32_16x16x32_bf16 v[228:231], a[28:31], a[100:103], v[228:231]
  ds_read_b64_tr_b16 a[8:9], v238 offset:24576
  v_mfma_f32_16x16x32_bf16 v[224:227], a[24:27], a[100:103], v[224:227]
  ds_read_b64_tr_b16 a[10:11], v238 offset:26624
  buffer_load_dwordx4 a[228:231], v255, s[36:39], s60 offen offset:1024 sc1
  v_mfma_f32_16x16x32_bf16 v[220:223], a[20:23], a[100:103], v[220:223]
  ds_read_b64_tr_b16 a[12:13], v239 offset:24576
  v_mfma_f32_16x16x32_bf16 v[216:219], a[16:19], a[100:103], v[216:219]
  ds_read_b64_tr_b16 a[14:15], v239 offset:26624
  s_add_u32 s60, s60, 8192
  s_waitcnt vmcnt(38) lgkmcnt(8)
  v_mfma_f32_16x16x32_bf16 v[200:203], a[32:35], a[104:107], v[200:203]
  ds_read_b64_tr_b16 a[16:17], v236 offset:28672
  v_mfma_f32_16x16x32_bf16 v[204:207], a[36:39], a[104:107], v[204:207]
  ds_read_b64_tr_b16 a[18:19], v236 offset:30720
  v_mfma_f32_16x16x32_bf16 v[208:211], a[40:43], a[104:107], v[208:211]
  ds_read_b64_tr_b16 a[20:21], v237 offset:28672
  buffer_load_dwordx4 a[64:67], v255, s[36:39], s60 offen offset:0 sc1
  v_mfma_f32_16x16x32_bf16 v[212:215], a[44:47], a[104:107], v[212:215]
  ds_read_b64_tr_b16 a[22:23], v237 offset:30720
  v_mfma_f32_16x16x32_bf16 v[228:231], a[44:47], a[108:111], v[228:231]
  ds_read_b64_tr_b16 a[24:25], v238 offset:28672
  v_mfma_f32_16x16x32_bf16 v[224:227], a[40:43], a[108:111], v[224:227]
  ds_read_b64_tr_b16 a[26:27], v238 offset:30720
  buffer_load_dwordx4 a[68:71], v255, s[36:39], s60 offen offset:1024 sc1
  v_mfma_f32_16x16x32_bf16 v[220:223], a[36:39], a[108:111], v[220:223]
  ds_read_b64_tr_b16 a[28:29], v239 offset:28672
  v_mfma_f32_16x16x32_bf16 v[216:219], a[32:35], a[108:111], v[216:219]
  ds_read_b64_tr_b16 a[30:31], v239 offset:30720
  s_add_u32 s60, s60, 8192
  s_waitcnt vmcnt(38) lgkmcnt(8)
  v_mfma_f32_16x16x32_bf16 v[200:203], a[0:3], a[112:115], v[200:203]
  ds_read_b64_tr_b16 a[32:33], v236 offset:32768
  v_mfma_f32_16x16x32_bf16 v[204:207], a[4:7], a[112:115], v[204:207]
  ds_read_b64_tr_b16 a[34:35], v236 offset:34816
  v_mfma_f32_16x16x32_bf16 v[208:211], a[8:11], a[112:115], v[208:211]
  ds_read_b64_tr_b16 a[36:37], v237 offset:32768
  buffer_load_dwordx4 a[72:75], v255, s[36:39], s60 offen offset:0 sc1
  v_mfma_f32_16x16x32_bf16 v[212:215], a[12:15], a[112:115], v[212:215]
  ds_read_b64_tr_b16 a[38:39], v237 offset:34816
  v_mfma_f32_16x16x32_bf16 v[228:231], a[12:15], a[116:119], v[228:231]
  ds_read_b64_tr_b16 a[40:41], v238 offset:32768
  v_mfma_f32_16x16x32_bf16 v[224:227], a[8:11], a[116:119], v[224:227]
  ds_read_b64_tr_b16 a[42:43], v238 offset:34816
  buffer_load_dwordx4 a[76:79], v255, s[36:39], s60 offen offset:1024 sc1
  v_mfma_f32_16x16x32_bf16 v[220:223], a[4:7], a[116:119], v[220:223]
  ds_read_b64_tr_b16 a[44:45], v239 offset:32768
  v_mfma_f32_16x16x32_bf16 v[216:219], a[0:3], a[116:119], v[216:219]
  ds_read_b64_tr_b16 a[46:47], v239 offset:34816
  s_add_u32 s60, s60, 8192
  s_waitcnt vmcnt(38) lgkmcnt(8)
  v_mfma_f32_16x16x32_bf16 v[200:203], a[16:19], a[120:123], v[200:203]
  ds_read_b64_tr_b16 a[0:1], v236 offset:36864
  v_mfma_f32_16x16x32_bf16 v[204:207], a[20:23], a[120:123], v[204:207]
  ds_read_b64_tr_b16 a[2:3], v236 offset:38912
  v_mfma_f32_16x16x32_bf16 v[208:211], a[24:27], a[120:123], v[208:211]
  ds_read_b64_tr_b16 a[4:5], v237 offset:36864
  buffer_load_dwordx4 a[80:83], v255, s[36:39], s60 offen offset:0 sc1
  v_mfma_f32_16x16x32_bf16 v[212:215], a[28:31], a[120:123], v[212:215]
  ds_read_b64_tr_b16 a[6:7], v237 offset:38912
  v_mfma_f32_16x16x32_bf16 v[228:231], a[28:31], a[124:127], v[228:231]
  ds_read_b64_tr_b16 a[8:9], v238 offset:36864
  v_mfma_f32_16x16x32_bf16 v[224:227], a[24:27], a[124:127], v[224:227]
  ds_read_b64_tr_b16 a[10:11], v238 offset:38912
  buffer_load_dwordx4 a[84:87], v255, s[36:39], s60 offen offset:1024 sc1
  v_mfma_f32_16x16x32_bf16 v[220:223], a[20:23], a[124:127], v[220:223]
  ds_read_b64_tr_b16 a[12:13], v239 offset:36864
  v_mfma_f32_16x16x32_bf16 v[216:219], a[16:19], a[124:127], v[216:219]
  ds_read_b64_tr_b16 a[14:15], v239 offset:38912
  s_add_u32 s60, s60, 8192
  s_waitcnt lgkmcnt(0)
  v_mfma_f32_32x32x16_bf16 v[0:15], v[128:131], v[112:115], v[64:79]
  ds_read_b128 v[144:147], v172 offset:1024
  v_exp_f32 v16, v16
  v_exp_f32 v17, v17
  v_exp_f32 v18, v18
  v_mfma_f32_32x32x16_bf16 v[0:15], v[132:135], v[116:119], v[0:15]
  ds_read_b128 v[148:151], v172 offset:1536
  v_exp_f32 v19, v19
  v_exp_f32 v20, v20
  v_cvt_pk_bf16_f32 v104, v16, v17
  v_exp_f32 v21, v21
  v_mfma_f32_32x32x16_bf16 v[32:47], v[152:155], v[96:99], v[32:47]
  v_exp_f32 v22, v22
  v_cvt_pk_bf16_f32 v105, v18, v19
  v_exp_f32 v23, v23
  v_exp_f32 v24, v24
  v_cvt_pk_bf16_f32 v106, v20, v21
  v_mfma_f32_32x32x16_bf16 v[32:47], v[156:159], v[100:103], v[32:47]
  v_exp_f32 v25, v25
  v_exp_f32 v26, v26
  v_cvt_pk_bf16_f32 v107, v22, v23
  v_exp_f32 v27, v27
  v_mfma_f32_16x16x32_bf16 v[160:163], v[168:171], v[96:99], v[160:163]
  v_exp_f32 v28, v28
  v_cvt_pk_bf16_f32 v108, v24, v25
  v_exp_f32 v29, v29
  v_mfma_f32_16x16x32_bf16 v[160:163], v[168:171], v[100:103], v[160:163]
  s_waitcnt lgkmcnt(0)
  v_exp_f32 v30, v30
  v_cvt_pk_bf16_f32 v109, v26, v27
  v_exp_f32 v31, v31
  v_cvt_pk_bf16_f32 v110, v28, v29
  v_cvt_pk_bf16_f32 v111, v30, v31
  v_mfma_f32_32x32x16_bf16 v[16:31], v[128:131], v[120:123], v[80:95]
  ds_read_b128 v[136:139], v172 offset:4096
  v_exp_f32 v0, v0
  v_exp_f32 v1, v1
  v_exp_f32 v2, v2
  v_mfma_f32_32x32x16_bf16 v[16:31], v[132:135], v[124:127], v[16:31]
  ds_read_b128 v[140:143], v172 offset:4608
  v_exp_f32 v3, v3
  v_exp_f32 v4, v4
  v_cvt_pk_bf16_f32 v96, v0, v1
  v_exp_f32 v5, v5
  v_mfma_f32_32x32x16_bf16 v[48:63], v[152:155], v[104:107], v[48:63]
  v_exp_f32 v6, v6
  v_cvt_pk_bf16_f32 v97, v2, v3
  v_exp_f32 v7, v7
  v_exp_f32 v8, v8
  v_cvt_pk_bf16_f32 v98, v4, v5
  v_mfma_f32_32x32x16_bf16 v[48:63], v[156:159], v[108:111], v[48:63]
  v_exp_f32 v9, v9
  v_exp_f32 v10, v10
  v_cvt_pk_bf16_f32 v99, v6, v7
  v_exp_f32 v11, v11
  v_mfma_f32_16x16x32_bf16 v[164:167], v[168:171], v[104:107], v[164:167]
  v_exp_f32 v12, v12
  v_cvt_pk_bf16_f32 v100, v8, v9
  v_exp_f32 v13, v13
  v_mfma_f32_16x16x32_bf16 v[164:167], v[168:171], v[108:111], v[164:167]
  s_waitcnt lgkmcnt(0)
  v_exp_f32 v14, v14
  v_cvt_pk_bf16_f32 v101, v10, v11
  v_exp_f32 v15, v15
  v_cvt_pk_bf16_f32 v102, v12, v13
  v_cvt_pk_bf16_f32 v103, v14, v15
  s_waitcnt vmcnt(38) lgkmcnt(8)
  v_mfma_f32_16x16x32_bf16 v[200:203], a[32:35], a[128:131], v[200:203]
  ds_read_b64_tr_b16 a[16:17], v236 offset:40960
  v_mfma_f32_16x16x32_bf16 v[204:207], a[36:39], a[128:131], v[204:207]
  ds_read_b64_tr_b16 a[18:19], v236 offset:43008
  buffer_load_dwordx2 a[88:89], v249, s[36:39], s60 offen offset:0 sc1
  v_mfma_f32_16x16x32_bf16 v[208:211], a[40:43], a[128:131], v[208:211]
  ds_read_b64_tr_b16 a[20:21], v237 offset:40960
  v_mfma_f32_16x16x32_bf16 v[212:215], a[44:47], a[128:131], v[212:215]
  ds_read_b64_tr_b16 a[22:23], v237 offset:43008
  buffer_load_dwordx2 a[90:91], v249, s[36:39], s60 offen offset:512 sc1
  v_mfma_f32_16x16x32_bf16 v[228:231], a[44:47], a[132:135], v[228:231]
  ds_read_b64_tr_b16 a[24:25], v238 offset:40960
  v_mfma_f32_16x16x32_bf16 v[224:227], a[40:43], a[132:135], v[224:227]
  ds_read_b64_tr_b16 a[26:27], v238 offset:43008
  buffer_load_dwordx2 a[92:93], v249, s[36:39], s60 offen offset:1024 sc1
  v_mfma_f32_16x16x32_bf16 v[220:223], a[36:39], a[132:135], v[220:223]
  ds_read_b64_tr_b16 a[28:29], v239 offset:40960
  buffer_load_dwordx2 a[94:95], v249, s[36:39], s60 offen offset:1536 sc1
  v_mfma_f32_16x16x32_bf16 v[216:219], a[32:35], a[132:135], v[216:219]
  ds_read_b64_tr_b16 a[30:31], v239 offset:43008
  s_add_u32 s60, s60, 8192
  s_waitcnt vmcnt(40) lgkmcnt(8)
  v_mfma_f32_16x16x32_bf16 v[200:203], a[0:3], a[136:139], v[200:203]
  ds_read_b64_tr_b16 a[32:33], v236 offset:45056
  v_mfma_f32_16x16x32_bf16 v[204:207], a[4:7], a[136:139], v[204:207]
  ds_read_b64_tr_b16 a[34:35], v236 offset:47104
  v_mfma_f32_16x16x32_bf16 v[208:211], a[8:11], a[136:139], v[208:211]
  ds_read_b64_tr_b16 a[36:37], v237 offset:45056
  buffer_load_dwordx4 a[96:99], v255, s[36:39], s60 offen offset:0 sc1
  v_mfma_f32_16x16x32_bf16 v[212:215], a[12:15], a[136:139], v[212:215]
  ds_read_b64_tr_b16 a[38:39], v237 offset:47104
  v_mfma_f32_16x16x32_bf16 v[228:231], a[12:15], a[140:143], v[228:231]
  ds_read_b64_tr_b16 a[40:41], v238 offset:45056
  v_mfma_f32_16x16x32_bf16 v[224:227], a[8:11], a[140:143], v[224:227]
  ds_read_b64_tr_b16 a[42:43], v238 offset:47104
  buffer_load_dwordx4 a[100:103], v255, s[36:39], s60 offen offset:1024 sc1
  v_mfma_f32_16x16x32_bf16 v[220:223], a[4:7], a[140:143], v[220:223]
  ds_read_b64_tr_b16 a[44:45], v239 offset:45056
  v_mfma_f32_16x16x32_bf16 v[216:219], a[0:3], a[140:143], v[216:219]
  ds_read_b64_tr_b16 a[46:47], v239 offset:47104
  s_add_u32 s60, s60, 8192
  s_waitcnt vmcnt(36) lgkmcnt(8)
  v_mfma_f32_16x16x32_bf16 v[200:203], a[16:19], a[144:147], v[200:203]
  ds_read_b64_tr_b16 a[0:1], v236 offset:49152
  v_mfma_f32_16x16x32_bf16 v[204:207], a[20:23], a[144:147], v[204:207]
  ds_read_b64_tr_b16 a[2:3], v236 offset:51200
  v_mfma_f32_16x16x32_bf16 v[208:211], a[24:27], a[144:147], v[208:211]
  ds_read_b64_tr_b16 a[4:5], v237 offset:49152
  buffer_load_dwordx4 a[104:107], v255, s[36:39], s60 offen offset:0 sc1
  v_mfma_f32_16x16x32_bf16 v[212:215], a[28:31], a[144:147], v[212:215]
  ds_read_b64_tr_b16 a[6:7], v237 offset:51200
  v_mfma_f32_16x16x32_bf16 v[228:231], a[28:31], a[148:151], v[228:231]
  ds_read_b64_tr_b16 a[8:9], v238 offset:49152
  v_mfma_f32_16x16x32_bf16 v[224:227], a[24:27], a[148:151], v[224:227]
  ds_read_b64_tr_b16 a[10:11], v238 offset:51200
  buffer_load_dwordx4 a[108:111], v255, s[36:39], s60 offen offset:1024 sc1
  v_mfma_f32_16x16x32_bf16 v[220:223], a[20:23], a[148:151], v[220:223]
  ds_read_b64_tr_b16 a[12:13], v239 offset:49152
  v_mfma_f32_16x16x32_bf16 v[216:219], a[16:19], a[148:151], v[216:219]
  ds_read_b64_tr_b16 a[14:15], v239 offset:51200
  s_add_u32 s60, s60, 8192
  s_waitcnt vmcnt(36) lgkmcnt(8)
  v_mfma_f32_16x16x32_bf16 v[200:203], a[32:35], a[152:155], v[200:203]
  ds_read_b64_tr_b16 a[16:17], v236 offset:53248
  v_mfma_f32_16x16x32_bf16 v[204:207], a[36:39], a[152:155], v[204:207]
  ds_read_b64_tr_b16 a[18:19], v236 offset:55296
  v_mfma_f32_16x16x32_bf16 v[208:211], a[40:43], a[152:155], v[208:211]
  ds_read_b64_tr_b16 a[20:21], v237 offset:53248
  buffer_load_dwordx4 a[112:115], v255, s[36:39], s60 offen offset:0 sc1
  v_mfma_f32_16x16x32_bf16 v[212:215], a[44:47], a[152:155], v[212:215]
  ds_read_b64_tr_b16 a[22:23], v237 offset:55296
  v_mfma_f32_16x16x32_bf16 v[228:231], a[44:47], a[156:159], v[228:231]
  ds_read_b64_tr_b16 a[24:25], v238 offset:53248
  v_mfma_f32_16x16x32_bf16 v[224:227], a[40:43], a[156:159], v[224:227]
  ds_read_b64_tr_b16 a[26:27], v238 offset:55296
  buffer_load_dwordx4 a[116:119], v255, s[36:39], s60 offen offset:1024 sc1
  v_mfma_f32_16x16x32_bf16 v[220:223], a[36:39], a[156:159], v[220:223]
  ds_read_b64_tr_b16 a[28:29], v239 offset:53248
  v_mfma_f32_16x16x32_bf16 v[216:219], a[32:35], a[156:159], v[216:219]
  ds_read_b64_tr_b16 a[30:31], v239 offset:55296
  s_add_u32 s60, s60, 8192
  s_waitcnt lgkmcnt(0)
  v_mfma_f32_32x32x16_bf16 v[0:15], v[136:139], v[112:115], v[64:79]
  ds_read_b128 v[152:155], v172 offset:5120
  v_exp_f32 v16, v16
  v_exp_f32 v17, v17
  v_exp_f32 v18, v18
  v_mfma_f32_32x32x16_bf16 v[0:15], v[140:143], v[116:119], v[0:15]
  ds_read_b128 v[156:159], v172 offset:5632
  v_exp_f32 v19, v19
  v_exp_f32 v20, v20
  v_cvt_pk_bf16_f32 v104, v16, v17
  v_exp_f32 v21, v21
  v_mfma_f32_32x32x16_bf16 v[32:47], v[144:147], v[96:99], v[32:47]
  v_exp_f32 v22, v22
  v_cvt_pk_bf16_f32 v105, v18, v19
  v_exp_f32 v23, v23
  v_exp_f32 v24, v24
  v_cvt_pk_bf16_f32 v106, v20, v21
  v_mfma_f32_32x32x16_bf16 v[32:47], v[148:151], v[100:103], v[32:47]
  v_exp_f32 v25, v25
  v_exp_f32 v26, v26
  v_cvt_pk_bf16_f32 v107, v22, v23
  v_exp_f32 v27, v27
  v_mfma_f32_16x16x32_bf16 v[160:163], v[168:171], v[96:99], v[160:163]
  v_exp_f32 v28, v28
  v_cvt_pk_bf16_f32 v108, v24, v25
  v_exp_f32 v29, v29
  v_mfma_f32_16x16x32_bf16 v[160:163], v[168:171], v[100:103], v[160:163]
  s_waitcnt vmcnt(56) lgkmcnt(0)
  s_barrier
  v_exp_f32 v30, v30
  v_cvt_pk_bf16_f32 v109, v26, v27
  v_exp_f32 v31, v31
  v_cvt_pk_bf16_f32 v110, v28, v29
  v_cvt_pk_bf16_f32 v111, v30, v31
  v_mfma_f32_32x32x16_bf16 v[16:31], v[136:139], v[120:123], v[80:95]
  ds_read_b128 v[128:131], v172 offset:8192
  v_exp_f32 v0, v0
  v_exp_f32 v1, v1
  v_exp_f32 v2, v2
  v_mfma_f32_32x32x16_bf16 v[16:31], v[140:143], v[124:127], v[16:31]
  ds_read_b128 v[132:135], v172 offset:8704
  v_exp_f32 v3, v3
  v_exp_f32 v4, v4
  v_cvt_pk_bf16_f32 v96, v0, v1
  v_exp_f32 v5, v5
  v_mfma_f32_32x32x16_bf16 v[48:63], v[144:147], v[104:107], v[48:63]
  s_add_u32 m0, s63, 32768
  v_exp_f32 v6, v6
  v_cvt_pk_bf16_f32 v97, v2, v3
  v_exp_f32 v7, v7
  v_exp_f32 v8, v8
  v_cvt_pk_bf16_f32 v98, v4, v5
  v_mfma_f32_32x32x16_bf16 v[48:63], v[148:151], v[108:111], v[48:63]
  buffer_load_dwordx4 v232, s[20:23], s62 offen offset:0 lds
  v_exp_f32 v9, v9
  v_exp_f32 v10, v10
  v_cvt_pk_bf16_f32 v99, v6, v7
  v_exp_f32 v11, v11
  v_mfma_f32_16x16x32_bf16 v[164:167], v[168:171], v[104:107], v[164:167]
  buffer_load_dwordx4 v233, s[20:23], s62 offen offset:1024 lds
  v_exp_f32 v12, v12
  v_cvt_pk_bf16_f32 v100, v8, v9
  v_exp_f32 v13, v13
  v_mfma_f32_16x16x32_bf16 v[164:167], v[168:171], v[108:111], v[164:167]
  s_waitcnt lgkmcnt(0)
  buffer_load_dwordx4 v234, s[20:23], s62 offen offset:2048 lds
  v_exp_f32 v14, v14
  v_cvt_pk_bf16_f32 v101, v10, v11
  v_exp_f32 v15, v15
  v_cvt_pk_bf16_f32 v102, v12, v13
  v_cvt_pk_bf16_f32 v103, v14, v15
  s_waitcnt vmcnt(39) lgkmcnt(8)
  v_mfma_f32_16x16x32_bf16 v[200:203], a[0:3], a[160:163], v[200:203]
  ds_read_b64_tr_b16 a[32:33], v236 offset:57344
  v_mfma_f32_16x16x32_bf16 v[204:207], a[4:7], a[160:163], v[204:207]
  ds_read_b64_tr_b16 a[34:35], v236 offset:59392
  v_mfma_f32_16x16x32_bf16 v[208:211], a[8:11], a[160:163], v[208:211]
  ds_read_b64_tr_b16 a[36:37], v237 offset:57344
  buffer_load_dwordx4 a[120:123], v255, s[36:39], s60 offen offset:0 sc1
  v_mfma_f32_16x16x32_bf16 v[212:215], a[12:15], a[160:163], v[212:215]
  ds_read_b64_tr_b16 a[38:39], v237 offset:59392
  v_mfma_f32_16x16x32_bf16 v[228:231], a[12:15], a[164:167], v[228:231]
  ds_read_b64_tr_b16 a[40:41], v238 offset:57344
  v_mfma_f32_16x16x32_bf16 v[224:227], a[8:11], a[164:167], v[224:227]
  ds_read_b64_tr_b16 a[42:43], v238 offset:59392
  buffer_load_dwordx4 a[124:127], v255, s[36:39], s60 offen offset:1024 sc1
  v_mfma_f32_16x16x32_bf16 v[220:223], a[4:7], a[164:167], v[220:223]
  ds_read_b64_tr_b16 a[44:45], v239 offset:57344
  v_mfma_f32_16x16x32_bf16 v[216:219], a[0:3], a[164:167], v[216:219]
  ds_read_b64_tr_b16 a[46:47], v239 offset:59392
  s_add_u32 s60, s60, 8192
  s_waitcnt vmcnt(39) lgkmcnt(8)
  v_mfma_f32_16x16x32_bf16 v[200:203], a[16:19], a[168:171], v[200:203]
  ds_read_b64_tr_b16 a[0:1], v236 offset:61440
  v_mfma_f32_16x16x32_bf16 v[204:207], a[20:23], a[168:171], v[204:207]
  ds_read_b64_tr_b16 a[2:3], v236 offset:63488
  v_mfma_f32_16x16x32_bf16 v[208:211], a[24:27], a[168:171], v[208:211]
  ds_read_b64_tr_b16 a[4:5], v237 offset:61440
  buffer_load_dwordx4 a[128:131], v255, s[36:39], s60 offen offset:0 sc1
  v_mfma_f32_16x16x32_bf16 v[212:215], a[28:31], a[168:171], v[212:215]
  ds_read_b64_tr_b16 a[6:7], v237 offset:63488
  v_mfma_f32_16x16x32_bf16 v[228:231], a[28:31], a[172:175], v[228:231]
  ds_read_b64_tr_b16 a[8:9], v238 offset:61440
  v_mfma_f32_16x16x32_bf16 v[224:227], a[24:27], a[172:175], v[224:227]
  ds_read_b64_tr_b16 a[10:11], v238 offset:63488
  buffer_load_dwordx4 a[132:135], v255, s[36:39], s60 offen offset:1024 sc1
  v_mfma_f32_16x16x32_bf16 v[220:223], a[20:23], a[172:175], v[220:223]
  ds_read_b64_tr_b16 a[12:13], v239 offset:61440
  v_mfma_f32_16x16x32_bf16 v[216:219], a[16:19], a[172:175], v[216:219]
  ds_read_b64_tr_b16 a[14:15], v239 offset:63488
  s_add_u32 s60, s60, 8192
  s_waitcnt vmcnt(39) lgkmcnt(8)
  v_mfma_f32_16x16x32_bf16 v[200:203], a[32:35], a[176:179], v[200:203]
  ds_read_b64_tr_b16 a[16:17], v240 offset:0
  v_mfma_f32_16x16x32_bf16 v[204:207], a[36:39], a[176:179], v[204:207]
  ds_read_b64_tr_b16 a[18:19], v240 offset:2048
  v_mfma_f32_16x16x32_bf16 v[208:211], a[40:43], a[176:179], v[208:211]
  ds_read_b64_tr_b16 a[20:21], v241 offset:0
  buffer_load_dwordx4 a[136:139], v255, s[36:39], s60 offen offset:0 sc1
  v_mfma_f32_16x16x32_bf16 v[212:215], a[44:47], a[176:179], v[212:215]
  ds_read_b64_tr_b16 a[22:23], v241 offset:2048
  v_mfma_f32_16x16x32_bf16 v[228:231], a[44:47], a[180:183], v[228:231]
  ds_read_b64_tr_b16 a[24:25], v242 offset:0
  v_mfma_f32_16x16x32_bf16 v[224:227], a[40:43], a[180:183], v[224:227]
  ds_read_b64_tr_b16 a[26:27], v242 offset:2048
  buffer_load_dwordx4 a[140:143], v255, s[36:39], s60 offen offset:1024 sc1
  v_mfma_f32_16x16x32_bf16 v[220:223], a[36:39], a[180:183], v[220:223]
  ds_read_b64_tr_b16 a[28:29], v243 offset:0
  v_mfma_f32_16x16x32_bf16 v[216:219], a[32:35], a[180:183], v[216:219]
  ds_read_b64_tr_b16 a[30:31], v243 offset:2048
  s_add_u32 s60, s60, 8192
  s_waitcnt vmcnt(39) lgkmcnt(8)
  v_mfma_f32_16x16x32_bf16 v[200:203], a[0:3], a[184:187], v[200:203]
  ds_read_b64_tr_b16 a[32:33], v240 offset:4096
  v_mfma_f32_16x16x32_bf16 v[204:207], a[4:7], a[184:187], v[204:207]
  ds_read_b64_tr_b16 a[34:35], v240 offset:6144
  buffer_load_dwordx2 a[144:145], v249, s[36:39], s60 offen offset:0 sc1
  v_mfma_f32_16x16x32_bf16 v[208:211], a[8:11], a[184:187], v[208:211]
  ds_read_b64_tr_b16 a[36:37], v241 offset:4096
  v_mfma_f32_16x16x32_bf16 v[212:215], a[12:15], a[184:187], v[212:215]
  ds_read_b64_tr_b16 a[38:39], v241 offset:6144
  buffer_load_dwordx2 a[146:147], v249, s[36:39], s60 offen offset:512 sc1
  v_mfma_f32_16x16x32_bf16 v[228:231], a[12:15], a[188:191], v[228:231]
  ds_read_b64_tr_b16 a[40:41], v242 offset:4096
  v_mfma_f32_16x16x32_bf16 v[224:227], a[8:11], a[188:191], v[224:227]
  ds_read_b64_tr_b16 a[42:43], v242 offset:6144
  buffer_load_dwordx2 a[148:149], v249, s[36:39], s60 offen offset:1024 sc1
  v_mfma_f32_16x16x32_bf16 v[220:223], a[4:7], a[188:191], v[220:223]
  ds_read_b64_tr_b16 a[44:45], v243 offset:4096
  buffer_load_dwordx2 a[150:151], v249, s[36:39], s60 offen offset:1536 sc1
  v_mfma_f32_16x16x32_bf16 v[216:219], a[0:3], a[188:191], v[216:219]
  ds_read_b64_tr_b16 a[46:47], v243 offset:6144
  s_add_u32 s60, s60, 8192
  s_waitcnt lgkmcnt(0)
  v_mfma_f32_32x32x16_bf16 v[0:15], v[128:131], v[112:115], v[64:79]
  ds_read_b128 v[144:147], v172 offset:9216
  v_exp_f32 v16, v16
  v_exp_f32 v17, v17
  v_exp_f32 v18, v18
  v_mfma_f32_32x32x16_bf16 v[0:15], v[132:135], v[116:119], v[0:15]
  ds_read_b128 v[148:151], v172 offset:9728
  v_exp_f32 v19, v19
  v_exp_f32 v20, v20
  v_cvt_pk_bf16_f32 v104, v16, v17
  v_exp_f32 v21, v21
  v_mfma_f32_32x32x16_bf16 v[32:47], v[152:155], v[96:99], v[32:47]
  buffer_load_dwordx4 v235, s[20:23], s62 offen offset:3072 lds
  s_add_u32 s62, s62, 262144
  v_exp_f32 v22, v22
  v_cvt_pk_bf16_f32 v105, v18, v19
  v_exp_f32 v23, v23
  v_exp_f32 v24, v24
  v_cvt_pk_bf16_f32 v106, v20, v21
  v_mfma_f32_32x32x16_bf16 v[32:47], v[156:159], v[100:103], v[32:47]
  s_add_u32 m0, s63, 49152
  v_exp_f32 v25, v25
  v_exp_f32 v26, v26
  v_cvt_pk_bf16_f32 v107, v22, v23
  v_exp_f32 v27, v27
  v_mfma_f32_16x16x32_bf16 v[160:163], v[168:171], v[96:99], v[160:163]
  buffer_load_dwordx4 v232, s[20:23], s62 offen offset:0 lds
  v_exp_f32 v28, v28
  v_cvt_pk_bf16_f32 v108, v24, v25
  v_exp_f32 v29, v29
  v_mfma_f32_16x16x32_bf16 v[160:163], v[168:171], v[100:103], v[160:163]
  s_waitcnt lgkmcnt(0)
  buffer_load_dwordx4 v233, s[20:23], s62 offen offset:1024 lds
  v_exp_f32 v30, v30
  v_cvt_pk_bf16_f32 v109, v26, v27
  v_exp_f32 v31, v31
  v_cvt_pk_bf16_f32 v110, v28, v29
  v_cvt_pk_bf16_f32 v111, v30, v31
  s_waitcnt vmcnt(44) lgkmcnt(8)
  v_mfma_f32_16x16x32_bf16 v[200:203], a[16:19], a[192:195], v[200:203]
  ds_read_b64_tr_b16 a[0:1], v240 offset:8192
  v_mfma_f32_16x16x32_bf16 v[204:207], a[20:23], a[192:195], v[204:207]
  ds_read_b64_tr_b16 a[2:3], v240 offset:10240
  v_mfma_f32_16x16x32_bf16 v[208:211], a[24:27], a[192:195], v[208:211]
  ds_read_b64_tr_b16 a[4:5], v241 offset:8192
  buffer_load_dwordx4 a[152:155], v255, s[36:39], s60 offen offset:0 sc1
  v_mfma_f32_16x16x32_bf16 v[212:215], a[28:31], a[192:195], v[212:215]
  ds_read_b64_tr_b16 a[6:7], v241 offset:10240
  v_mfma_f32_16x16x32_bf16 v[228:231], a[28:31], a[196:199], v[228:231]
  ds_read_b64_tr_b16 a[8:9], v242 offset:8192
  v_mfma_f32_16x16x32_bf16 v[224:227], a[24:27], a[196:199], v[224:227]
  ds_read_b64_tr_b16 a[10:11], v242 offset:10240
  buffer_load_dwordx4 a[156:159], v255, s[36:39], s60 offen offset:1024 sc1
  v_mfma_f32_16x16x32_bf16 v[220:223], a[20:23], a[196:199], v[220:223]
  ds_read_b64_tr_b16 a[12:13], v243 offset:8192
  v_mfma_f32_16x16x32_bf16 v[216:219], a[16:19], a[196:199], v[216:219]
  ds_read_b64_tr_b16 a[14:15], v243 offset:10240
  s_add_u32 s60, s60, 8192
  s_waitcnt vmcnt(42) lgkmcnt(8)
  v_mfma_f32_16x16x32_bf16 v[200:203], a[32:35], a[200:203], v[200:203]
  ds_read_b64_tr_b16 a[16:17], v240 offset:12288
  v_mfma_f32_16x16x32_bf16 v[204:207], a[36:39], a[200:203], v[204:207]
  ds_read_b64_tr_b16 a[18:19], v240 offset:14336
  v_mfma_f32_16x16x32_bf16 v[208:211], a[40:43], a[200:203], v[208:211]
  ds_read_b64_tr_b16 a[20:21], v241 offset:12288
  buffer_load_dwordx4 a[160:163], v255, s[36:39], s60 offen offset:0 sc1
  v_mfma_f32_16x16x32_bf16 v[212:215], a[44:47], a[200:203], v[212:215]
  ds_read_b64_tr_b16 a[22:23], v241 offset:14336
  v_mfma_f32_16x16x32_bf16 v[228:231], a[44:47], a[204:207], v[228:231]
  ds_read_b64_tr_b16 a[24:25], v242 offset:12288
  v_mfma_f32_16x16x32_bf16 v[224:227], a[40:43], a[204:207], v[224:227]
  ds_read_b64_tr_b16 a[26:27], v242 offset:14336
  buffer_load_dwordx4 a[164:167], v255, s[36:39], s60 offen offset:1024 sc1
  v_mfma_f32_16x16x32_bf16 v[220:223], a[36:39], a[204:207], v[220:223]
  ds_read_b64_tr_b16 a[28:29], v243 offset:12288
  v_mfma_f32_16x16x32_bf16 v[216:219], a[32:35], a[204:207], v[216:219]
  ds_read_b64_tr_b16 a[30:31], v243 offset:14336
  s_add_u32 s60, s60, 8192
  s_waitcnt vmcnt(42) lgkmcnt(8)
  v_mfma_f32_16x16x32_bf16 v[200:203], a[0:3], a[208:211], v[200:203]
  ds_read_b64_tr_b16 a[32:33], v240 offset:16384
  v_mfma_f32_16x16x32_bf16 v[204:207], a[4:7], a[208:211], v[204:207]
  ds_read_b64_tr_b16 a[34:35], v240 offset:18432
  v_mfma_f32_16x16x32_bf16 v[208:211], a[8:11], a[208:211], v[208:211]
  ds_read_b64_tr_b16 a[36:37], v241 offset:16384
  buffer_load_dwordx4 a[168:171], v255, s[36:39], s60 offen offset:0 sc1
  v_mfma_f32_16x16x32_bf16 v[212:215], a[12:15], a[208:211], v[212:215]
  ds_read_b64_tr_b16 a[38:39], v241 offset:18432
  v_mfma_f32_16x16x32_bf16 v[228:231], a[12:15], a[212:215], v[228:231]
  ds_read_b64_tr_b16 a[40:41], v242 offset:16384
  v_mfma_f32_16x16x32_bf16 v[224:227], a[8:11], a[212:215], v[224:227]
  ds_read_b64_tr_b16 a[42:43], v242 offset:18432
  buffer_load_dwordx4 a[172:175], v255, s[36:39], s60 offen offset:1024 sc1
  v_mfma_f32_16x16x32_bf16 v[220:223], a[4:7], a[212:215], v[220:223]
  ds_read_b64_tr_b16 a[44:45], v243 offset:16384
  v_mfma_f32_16x16x32_bf16 v[216:219], a[0:3], a[212:215], v[216:219]
  ds_read_b64_tr_b16 a[46:47], v243 offset:18432
  s_add_u32 s60, s60, 8192
  s_waitcnt vmcnt(42) lgkmcnt(8)
  v_mfma_f32_16x16x32_bf16 v[200:203], a[16:19], a[216:219], v[200:203]
  ds_read_b64_tr_b16 a[0:1], v240 offset:20480
  v_mfma_f32_16x16x32_bf16 v[204:207], a[20:23], a[216:219], v[204:207]
  ds_read_b64_tr_b16 a[2:3], v240 offset:22528
  v_mfma_f32_16x16x32_bf16 v[208:211], a[24:27], a[216:219], v[208:211]
  ds_read_b64_tr_b16 a[4:5], v241 offset:20480
  buffer_load_dwordx4 a[176:179], v255, s[36:39], s60 offen offset:0 sc1
  v_mfma_f32_16x16x32_bf16 v[212:215], a[28:31], a[216:219], v[212:215]
  ds_read_b64_tr_b16 a[6:7], v241 offset:22528
  v_mfma_f32_16x16x32_bf16 v[228:231], a[28:31], a[220:223], v[228:231]
  ds_read_b64_tr_b16 a[8:9], v242 offset:20480
  v_mfma_f32_16x16x32_bf16 v[224:227], a[24:27], a[220:223], v[224:227]
  ds_read_b64_tr_b16 a[10:11], v242 offset:22528
  buffer_load_dwordx4 a[180:183], v255, s[36:39], s60 offen offset:1024 sc1
  v_mfma_f32_16x16x32_bf16 v[220:223], a[20:23], a[220:223], v[220:223]
  ds_read_b64_tr_b16 a[12:13], v243 offset:20480
  v_mfma_f32_16x16x32_bf16 v[216:219], a[16:19], a[220:223], v[216:219]
  ds_read_b64_tr_b16 a[14:15], v243 offset:22528
  s_add_u32 s60, s60, 8192
  s_waitcnt lgkmcnt(0)
  v_mfma_f32_32x32x16_bf16 v[16:31], v[128:131], v[120:123], v[80:95]
  ds_read_b128 v[136:139], v172 offset:12288
  v_exp_f32 v0, v0
  v_exp_f32 v1, v1
  v_exp_f32 v2, v2
  v_mfma_f32_32x32x16_bf16 v[16:31], v[132:135], v[124:127], v[16:31]
  ds_read_b128 v[140:143], v172 offset:12800
  v_exp_f32 v3, v3
  v_exp_f32 v4, v4
  v_cvt_pk_bf16_f32 v96, v0, v1
  v_exp_f32 v5, v5
  v_mfma_f32_32x32x16_bf16 v[48:63], v[152:155], v[104:107], v[48:63]
  buffer_load_dwordx4 v234, s[20:23], s62 offen offset:2048 lds
  v_exp_f32 v6, v6
  v_cvt_pk_bf16_f32 v97, v2, v3
  v_exp_f32 v7, v7
  v_exp_f32 v8, v8
  v_cvt_pk_bf16_f32 v98, v4, v5
  v_mfma_f32_32x32x16_bf16 v[48:63], v[156:159], v[108:111], v[48:63]
  buffer_load_dwordx4 v235, s[20:23], s62 offen offset:3072 lds
  s_add_u32 s62, s62, 262144
  v_exp_f32 v9, v9
  v_exp_f32 v10, v10
  v_cvt_pk_bf16_f32 v99, v6, v7
  v_exp_f32 v11, v11
  v_mfma_f32_16x16x32_bf16 v[164:167], v[168:171], v[104:107], v[164:167]
  s_add_u32 m0, s63, 65536
  v_exp_f32 v12, v12
  v_cvt_pk_bf16_f32 v100, v8, v9
  v_exp_f32 v13, v13
  v_mfma_f32_16x16x32_bf16 v[164:167], v[168:171], v[108:111], v[164:167]
  s_waitcnt lgkmcnt(0)
  buffer_load_dwordx4 v232, s[20:23], s62 offen offset:0 lds
  v_exp_f32 v14, v14
  v_cvt_pk_bf16_f32 v101, v10, v11
  v_exp_f32 v15, v15
  v_cvt_pk_bf16_f32 v102, v12, v13
  v_cvt_pk_bf16_f32 v103, v14, v15
  v_mfma_f32_32x32x16_bf16 v[0:15], v[136:139], v[112:115], v[64:79]
  ds_read_b128 v[152:155], v172 offset:13312
  v_exp_f32 v16, v16
  v_exp_f32 v17, v17
  v_exp_f32 v18, v18
  v_mfma_f32_32x32x16_bf16 v[0:15], v[140:143], v[116:119], v[0:15]
  ds_read_b128 v[156:159], v172 offset:13824
  v_exp_f32 v19, v19
  v_exp_f32 v20, v20
  v_cvt_pk_bf16_f32 v104, v16, v17
  v_exp_f32 v21, v21
  v_mfma_f32_32x32x16_bf16 v[32:47], v[144:147], v[96:99], v[32:47]
  buffer_load_dwordx4 v233, s[20:23], s62 offen offset:1024 lds
  v_exp_f32 v22, v22
  v_cvt_pk_bf16_f32 v105, v18, v19
  v_exp_f32 v23, v23
  v_exp_f32 v24, v24
  v_cvt_pk_bf16_f32 v106, v20, v21
  v_mfma_f32_32x32x16_bf16 v[32:47], v[148:151], v[100:103], v[32:47]
  buffer_load_dwordx4 v234, s[20:23], s62 offen offset:2048 lds
  v_exp_f32 v25, v25
  v_exp_f32 v26, v26
  v_cvt_pk_bf16_f32 v107, v22, v23
  v_exp_f32 v27, v27
  v_mfma_f32_16x16x32_bf16 v[160:163], v[168:171], v[96:99], v[160:163]
  buffer_load_dwordx4 v235, s[20:23], s62 offen offset:3072 lds
  s_add_u32 s62, s62, 262144
  v_exp_f32 v28, v28
  v_cvt_pk_bf16_f32 v108, v24, v25
  v_exp_f32 v29, v29
  v_mfma_f32_16x16x32_bf16 v[160:163], v[168:171], v[100:103], v[160:163]
  s_waitcnt vmcnt(16) lgkmcnt(0)
  s_barrier
  v_exp_f32 v30, v30
  v_cvt_pk_bf16_f32 v109, v26, v27
  v_exp_f32 v31, v31
  v_cvt_pk_bf16_f32 v110, v28, v29
  v_cvt_pk_bf16_f32 v111, v30, v31
  s_waitcnt vmcnt(46) lgkmcnt(8)
  v_mfma_f32_16x16x32_bf16 v[200:203], a[32:35], a[224:227], v[200:203]
  ds_read_b64_tr_b16 a[16:17], v240 offset:24576
  v_mfma_f32_16x16x32_bf16 v[204:207], a[36:39], a[224:227], v[204:207]
  ds_read_b64_tr_b16 a[18:19], v240 offset:26624
  v_mfma_f32_16x16x32_bf16 v[208:211], a[40:43], a[224:227], v[208:211]
  ds_read_b64_tr_b16 a[20:21], v241 offset:24576
  buffer_load_dwordx4 a[184:187], v255, s[36:39], s60 offen offset:0 sc1
  v_mfma_f32_16x16x32_bf16 v[212:215], a[44:47], a[224:227], v[212:215]
  ds_read_b64_tr_b16 a[22:23], v241 offset:26624
  v_mfma_f32_16x16x32_bf16 v[228:231], a[44:47], a[228:231], v[228:231]
  ds_read_b64_tr_b16 a[24:25], v242 offset:24576
  v_mfma_f32_16x16x32_bf16 v[224:227], a[40:43], a[228:231], v[224:227]
  ds_read_b64_tr_b16 a[26:27], v242 offset:26624
  buffer_load_dwordx4 a[188:191], v255, s[36:39], s60 offen offset:1024 sc1
  v_mfma_f32_16x16x32_bf16 v[220:223], a[36:39], a[228:231], v[220:223]
  ds_read_b64_tr_b16 a[28:29], v243 offset:24576
  v_mfma_f32_16x16x32_bf16 v[216:219], a[32:35], a[228:231], v[216:219]
  ds_read_b64_tr_b16 a[30:31], v243 offset:26624
  s_add_u32 s60, s60, 8192
  s_waitcnt vmcnt(46) lgkmcnt(8)
  v_mfma_f32_16x16x32_bf16 v[200:203], a[0:3], a[64:67], v[200:203]
  ds_read_b64_tr_b16 a[32:33], v240 offset:28672
  v_mfma_f32_16x16x32_bf16 v[204:207], a[4:7], a[64:67], v[204:207]
  ds_read_b64_tr_b16 a[34:35], v240 offset:30720
  v_mfma_f32_16x16x32_bf16 v[208:211], a[8:11], a[64:67], v[208:211]
  ds_read_b64_tr_b16 a[36:37], v241 offset:28672
  buffer_load_dwordx4 a[192:195], v255, s[36:39], s60 offen offset:0 sc1
  v_mfma_f32_16x16x32_bf16 v[212:215], a[12:15], a[64:67], v[212:215]
  ds_read_b64_tr_b16 a[38:39], v241 offset:30720
  v_mfma_f32_16x16x32_bf16 v[228:231], a[12:15], a[68:71], v[228:231]
  ds_read_b64_tr_b16 a[40:41], v242 offset:28672
  v_mfma_f32_16x16x32_bf16 v[224:227], a[8:11], a[68:71], v[224:227]
  ds_read_b64_tr_b16 a[42:43], v242 offset:30720
  buffer_load_dwordx4 a[196:199], v255, s[36:39], s60 offen offset:1024 sc1
  v_mfma_f32_16x16x32_bf16 v[220:223], a[4:7], a[68:71], v[220:223]
  ds_read_b64_tr_b16 a[44:45], v243 offset:28672
  v_mfma_f32_16x16x32_bf16 v[216:219], a[0:3], a[68:71], v[216:219]
  ds_read_b64_tr_b16 a[46:47], v243 offset:30720
  s_add_u32 s60, s60, 8192
  s_waitcnt vmcnt(46) lgkmcnt(8)
  v_mfma_f32_16x16x32_bf16 v[200:203], a[16:19], a[72:75], v[200:203]
  ds_read_b64_tr_b16 a[0:1], v240 offset:32768
  v_mfma_f32_16x16x32_bf16 v[204:207], a[20:23], a[72:75], v[204:207]
  ds_read_b64_tr_b16 a[2:3], v240 offset:34816
  buffer_load_dwordx2 a[200:201], v249, s[36:39], s60 offen offset:0 sc1
  v_mfma_f32_16x16x32_bf16 v[208:211], a[24:27], a[72:75], v[208:211]
  ds_read_b64_tr_b16 a[4:5], v241 offset:32768
  v_mfma_f32_16x16x32_bf16 v[212:215], a[28:31], a[72:75], v[212:215]
  ds_read_b64_tr_b16 a[6:7], v241 offset:34816
  buffer_load_dwordx2 a[202:203], v249, s[36:39], s60 offen offset:512 sc1
  v_mfma_f32_16x16x32_bf16 v[228:231], a[28:31], a[76:79], v[228:231]
  ds_read_b64_tr_b16 a[8:9], v242 offset:32768
  v_mfma_f32_16x16x32_bf16 v[224:227], a[24:27], a[76:79], v[224:227]
  ds_read_b64_tr_b16 a[10:11], v242 offset:34816
  buffer_load_dwordx2 a[204:205], v249, s[36:39], s60 offen offset:1024 sc1
  v_mfma_f32_16x16x32_bf16 v[220:223], a[20:23], a[76:79], v[220:223]
  ds_read_b64_tr_b16 a[12:13], v243 offset:32768
  buffer_load_dwordx2 a[206:207], v249, s[36:39], s60 offen offset:1536 sc1
  v_mfma_f32_16x16x32_bf16 v[216:219], a[16:19], a[76:79], v[216:219]
  ds_read_b64_tr_b16 a[14:15], v243 offset:34816
  s_add_u32 s60, s60, 8192
  s_waitcnt vmcnt(48) lgkmcnt(8)
  v_mfma_f32_16x16x32_bf16 v[200:203], a[32:35], a[80:83], v[200:203]
  ds_read_b64_tr_b16 a[16:17], v240 offset:36864
  v_mfma_f32_16x16x32_bf16 v[204:207], a[36:39], a[80:83], v[204:207]
  ds_read_b64_tr_b16 a[18:19], v240 offset:38912
  v_mfma_f32_16x16x32_bf16 v[208:211], a[40:43], a[80:83], v[208:211]
  ds_read_b64_tr_b16 a[20:21], v241 offset:36864
  buffer_load_dwordx4 a[208:211], v255, s[36:39], s60 offen offset:0 sc1
  v_mfma_f32_16x16x32_bf16 v[212:215], a[44:47], a[80:83], v[212:215]
  ds_read_b64_tr_b16 a[22:23], v241 offset:38912
  v_mfma_f32_16x16x32_bf16 v[228:231], a[44:47], a[84:87], v[228:231]
  ds_read_b64_tr_b16 a[24:25], v242 offset:36864
  v_mfma_f32_16x16x32_bf16 v[224:227], a[40:43], a[84:87], v[224:227]
  ds_read_b64_tr_b16 a[26:27], v242 offset:38912
  buffer_load_dwordx4 a[212:215], v255, s[36:39], s60 offen offset:1024 sc1
  v_mfma_f32_16x16x32_bf16 v[220:223], a[36:39], a[84:87], v[220:223]
  ds_read_b64_tr_b16 a[28:29], v243 offset:36864
  v_mfma_f32_16x16x32_bf16 v[216:219], a[32:35], a[84:87], v[216:219]
  ds_read_b64_tr_b16 a[30:31], v243 offset:38912
  s_add_u32 s60, s60, 8192
  s_waitcnt lgkmcnt(0)
  v_mfma_f32_32x32x16_bf16 v[16:31], v[136:139], v[120:123], v[80:95]
  ds_read_b128 v[128:131], v172 offset:16384
  v_exp_f32 v0, v0
  v_exp_f32 v1, v1
  v_exp_f32 v2, v2
  v_mfma_f32_32x32x16_bf16 v[16:31], v[140:143], v[124:127], v[16:31]
  ds_read_b128 v[132:135], v172 offset:16896
  v_exp_f32 v3, v3
  v_exp_f32 v4, v4
  v_cvt_pk_bf16_f32 v96, v0, v1
  v_exp_f32 v5, v5
  v_mfma_f32_32x32x16_bf16 v[48:63], v[144:147], v[104:107], v[48:63]
  s_add_u32 m0, s63, 81920
  v_exp_f32 v6, v6
  v_cvt_pk_bf16_f32 v97, v2, v3
  v_exp_f32 v7, v7
  v_exp_f32 v8, v8
  v_cvt_pk_bf16_f32 v98, v4, v5
  v_mfma_f32_32x32x16_bf16 v[48:63], v[148:151], v[108:111], v[48:63]
  buffer_load_dwordx4 v232, s[20:23], s62 offen offset:0 lds
  v_exp_f32 v9, v9
  v_exp_f32 v10, v10
  v_cvt_pk_bf16_f32 v99, v6, v7
  v_exp_f32 v11, v11
  v_mfma_f32_16x16x32_bf16 v[164:167], v[168:171], v[104:107], v[164:167]
  buffer_load_dwordx4 v233, s[20:23], s62 offen offset:1024 lds
  v_exp_f32 v12, v12
  v_cvt_pk_bf16_f32 v100, v8, v9
  v_exp_f32 v13, v13
  v_mfma_f32_16x16x32_bf16 v[164:167], v[168:171], v[108:111], v[164:167]
  s_waitcnt lgkmcnt(0)
  buffer_load_dwordx4 v234, s[20:23], s62 offen offset:2048 lds
  v_exp_f32 v14, v14
  v_cvt_pk_bf16_f32 v101, v10, v11
  v_exp_f32 v15, v15
  v_cvt_pk_bf16_f32 v102, v12, v13
  v_cvt_pk_bf16_f32 v103, v14, v15
  v_mfma_f32_32x32x16_bf16 v[0:15], v[128:131], v[112:115], v[64:79]
  ds_read_b128 v[144:147], v172 offset:17408
  v_exp_f32 v16, v16
  v_exp_f32 v17, v17
  v_exp_f32 v18, v18
  v_mfma_f32_32x32x16_bf16 v[0:15], v[132:135], v[116:119], v[0:15]
  ds_read_b128 v[148:151], v172 offset:17920
  v_exp_f32 v19, v19
  v_exp_f32 v20, v20
  v_cvt_pk_bf16_f32 v104, v16, v17
  v_exp_f32 v21, v21
  v_mfma_f32_32x32x16_bf16 v[32:47], v[152:155], v[96:99], v[32:47]
  buffer_load_dwordx4 v235, s[20:23], s62 offen offset:3072 lds
  s_add_u32 s62, s62, 262144
  v_exp_f32 v22, v22
  v_cvt_pk_bf16_f32 v105, v18, v19
  v_exp_f32 v23, v23
  v_exp_f32 v24, v24
  v_cvt_pk_bf16_f32 v106, v20, v21
  v_mfma_f32_32x32x16_bf16 v[32:47], v[156:159], v[100:103], v[32:47]
  s_add_u32 m0, s63, 98304
  v_exp_f32 v25, v25
  v_exp_f32 v26, v26
  v_cvt_pk_bf16_f32 v107, v22, v23
  v_exp_f32 v27, v27
  v_mfma_f32_16x16x32_bf16 v[160:163], v[168:171], v[96:99], v[160:163]
  buffer_load_dwordx4 v232, s[20:23], s62 offen offset:0 lds
  v_exp_f32 v28, v28
  v_cvt_pk_bf16_f32 v108, v24, v25
  v_exp_f32 v29, v29
  v_mfma_f32_16x16x32_bf16 v[160:163], v[168:171], v[100:103], v[160:163]
  s_waitcnt lgkmcnt(0)
  buffer_load_dwordx4 v233, s[20:23], s62 offen offset:1024 lds
  v_exp_f32 v30, v30
  v_cvt_pk_bf16_f32 v109, v26, v27
  v_exp_f32 v31, v31
  v_cvt_pk_bf16_f32 v110, v28, v29
  v_cvt_pk_bf16_f32 v111, v30, v31
  s_waitcnt vmcnt(52) lgkmcnt(8)
  v_mfma_f32_16x16x32_bf16 v[200:203], a[0:3], a[88:91], v[200:203]
  ds_read_b64_tr_b16 a[32:33], v240 offset:40960
  v_mfma_f32_16x16x32_bf16 v[204:207], a[4:7], a[88:91], v[204:207]
  ds_read_b64_tr_b16 a[34:35], v240 offset:43008
  v_mfma_f32_16x16x32_bf16 v[208:211], a[8:11], a[88:91], v[208:211]
  ds_read_b64_tr_b16 a[36:37], v241 offset:40960
  buffer_load_dwordx4 a[216:219], v255, s[36:39], s60 offen offset:0 sc1
  v_mfma_f32_16x16x32_bf16 v[212:215], a[12:15], a[88:91], v[212:215]
  ds_read_b64_tr_b16 a[38:39], v241 offset:43008
  v_mfma_f32_16x16x32_bf16 v[228:231], a[12:15], a[92:95], v[228:231]
  ds_read_b64_tr_b16 a[40:41], v242 offset:40960
  v_mfma_f32_16x16x32_bf16 v[224:227], a[8:11], a[92:95], v[224:227]
  ds_read_b64_tr_b16 a[42:43], v242 offset:43008
  buffer_load_dwordx4 a[220:223], v255, s[36:39], s60 offen offset:1024 sc1
  v_mfma_f32_16x16x32_bf16 v[220:223], a[4:7], a[92:95], v[220:223]
  ds_read_b64_tr_b16 a[44:45], v243 offset:40960
  v_mfma_f32_16x16x32_bf16 v[216:219], a[0:3], a[92:95], v[216:219]
  ds_read_b64_tr_b16 a[46:47], v243 offset:43008
  s_add_u32 s60, s60, 8192
  s_waitcnt vmcnt(52) lgkmcnt(8)
  v_mfma_f32_16x16x32_bf16 v[200:203], a[16:19], a[96:99], v[200:203]
  ds_read_b64_tr_b16 a[0:1], v240 offset:45056
  v_mfma_f32_16x16x32_bf16 v[204:207], a[20:23], a[96:99], v[204:207]
  ds_read_b64_tr_b16 a[2:3], v240 offset:47104
  v_mfma_f32_16x16x32_bf16 v[208:211], a[24:27], a[96:99], v[208:211]
  ds_read_b64_tr_b16 a[4:5], v241 offset:45056
  buffer_load_dwordx4 a[224:227], v255, s[36:39], s60 offen offset:0 sc1
  v_mfma_f32_16x16x32_bf16 v[212:215], a[28:31], a[96:99], v[212:215]
  ds_read_b64_tr_b16 a[6:7], v241 offset:47104
  v_mfma_f32_16x16x32_bf16 v[228:231], a[28:31], a[100:103], v[228:231]
  ds_read_b64_tr_b16 a[8:9], v242 offset:45056
  v_mfma_f32_16x16x32_bf16 v[224:227], a[24:27], a[100:103], v[224:227]
  ds_read_b64_tr_b16 a[10:11], v242 offset:47104
  buffer_load_dwordx4 a[228:231], v255, s[36:39], s60 offen offset:1024 sc1
  v_mfma_f32_16x16x32_bf16 v[220:223], a[20:23], a[100:103], v[220:223]
  ds_read_b64_tr_b16 a[12:13], v243 offset:45056
  v_mfma_f32_16x16x32_bf16 v[216:219], a[16:19], a[100:103], v[216:219]
  ds_read_b64_tr_b16 a[14:15], v243 offset:47104
  s_add_u32 s60, s60, 8192
  s_waitcnt vmcnt(52) lgkmcnt(8)
  v_mfma_f32_16x16x32_bf16 v[200:203], a[32:35], a[104:107], v[200:203]
  ds_read_b64_tr_b16 a[16:17], v240 offset:49152
  v_mfma_f32_16x16x32_bf16 v[204:207], a[36:39], a[104:107], v[204:207]
  ds_read_b64_tr_b16 a[18:19], v240 offset:51200
  v_mfma_f32_16x16x32_bf16 v[208:211], a[40:43], a[104:107], v[208:211]
  ds_read_b64_tr_b16 a[20:21], v241 offset:49152
  buffer_load_dwordx4 a[64:67], v255, s[36:39], s60 offen offset:0 sc1
  v_mfma_f32_16x16x32_bf16 v[212:215], a[44:47], a[104:107], v[212:215]
  ds_read_b64_tr_b16 a[22:23], v241 offset:51200
  v_mfma_f32_16x16x32_bf16 v[228:231], a[44:47], a[108:111], v[228:231]
  ds_read_b64_tr_b16 a[24:25], v242 offset:49152
  v_mfma_f32_16x16x32_bf16 v[224:227], a[40:43], a[108:111], v[224:227]
  ds_read_b64_tr_b16 a[26:27], v242 offset:51200
  buffer_load_dwordx4 a[68:71], v255, s[36:39], s60 offen offset:1024 sc1
  v_mfma_f32_16x16x32_bf16 v[220:223], a[36:39], a[108:111], v[220:223]
  ds_read_b64_tr_b16 a[28:29], v243 offset:49152
  v_mfma_f32_16x16x32_bf16 v[216:219], a[32:35], a[108:111], v[216:219]
  ds_read_b64_tr_b16 a[30:31], v243 offset:51200
  s_add_u32 s60, s60, 8192
  s_waitcnt vmcnt(52) lgkmcnt(8)
  v_mfma_f32_16x16x32_bf16 v[200:203], a[0:3], a[112:115], v[200:203]
  ds_read_b64_tr_b16 a[32:33], v240 offset:53248
  v_mfma_f32_16x16x32_bf16 v[204:207], a[4:7], a[112:115], v[204:207]
  ds_read_b64_tr_b16 a[34:35], v240 offset:55296
  v_mfma_f32_16x16x32_bf16 v[208:211], a[8:11], a[112:115], v[208:211]
  ds_read_b64_tr_b16 a[36:37], v241 offset:53248
  buffer_load_dwordx4 a[72:75], v255, s[36:39], s60 offen offset:0 sc1
  v_mfma_f32_16x16x32_bf16 v[212:215], a[12:15], a[112:115], v[212:215]
  ds_read_b64_tr_b16 a[38:39], v241 offset:55296
  v_mfma_f32_16x16x32_bf16 v[228:231], a[12:15], a[116:119], v[228:231]
  ds_read_b64_tr_b16 a[40:41], v242 offset:53248
  v_mfma_f32_16x16x32_bf16 v[224:227], a[8:11], a[116:119], v[224:227]
  ds_read_b64_tr_b16 a[42:43], v242 offset:55296
  buffer_load_dwordx4 a[76:79], v255, s[36:39], s60 offen offset:1024 sc1
  v_mfma_f32_16x16x32_bf16 v[220:223], a[4:7], a[116:119], v[220:223]
  ds_read_b64_tr_b16 a[44:45], v243 offset:53248
  v_mfma_f32_16x16x32_bf16 v[216:219], a[0:3], a[116:119], v[216:219]
  ds_read_b64_tr_b16 a[46:47], v243 offset:55296
  s_add_u32 s60, s60, 8192
  s_waitcnt lgkmcnt(0)
  v_mfma_f32_32x32x16_bf16 v[16:31], v[128:131], v[120:123], v[80:95]
  ds_read_b128 v[136:139], v172 offset:20480
  v_exp_f32 v0, v0
  v_exp_f32 v1, v1
  v_exp_f32 v2, v2
  v_mfma_f32_32x32x16_bf16 v[16:31], v[132:135], v[124:127], v[16:31]
  ds_read_b128 v[140:143], v172 offset:20992
  v_exp_f32 v3, v3
  v_exp_f32 v4, v4
  v_cvt_pk_bf16_f32 v96, v0, v1
  v_exp_f32 v5, v5
  v_mfma_f32_32x32x16_bf16 v[48:63], v[152:155], v[104:107], v[48:63]
  buffer_load_dwordx4 v234, s[20:23], s62 offen offset:2048 lds
  v_exp_f32 v6, v6
  v_cvt_pk_bf16_f32 v97, v2, v3
  v_exp_f32 v7, v7
  v_exp_f32 v8, v8
  v_cvt_pk_bf16_f32 v98, v4, v5
  v_mfma_f32_32x32x16_bf16 v[48:63], v[156:159], v[108:111], v[48:63]
  buffer_load_dwordx4 v235, s[20:23], s62 offen offset:3072 lds
  s_add_u32 s62, s62, 262144
  v_exp_f32 v9, v9
  v_exp_f32 v10, v10
  v_cvt_pk_bf16_f32 v99, v6, v7
  v_exp_f32 v11, v11
  v_mfma_f32_16x16x32_bf16 v[164:167], v[168:171], v[104:107], v[164:167]
  v_exp_f32 v12, v12
  v_cvt_pk_bf16_f32 v100, v8, v9
  v_exp_f32 v13, v13
  v_mfma_f32_16x16x32_bf16 v[164:167], v[168:171], v[108:111], v[164:167]
  s_waitcnt lgkmcnt(0)
  v_exp_f32 v14, v14
  v_cvt_pk_bf16_f32 v101, v10, v11
  v_exp_f32 v15, v15
  v_cvt_pk_bf16_f32 v102, v12, v13
  v_cvt_pk_bf16_f32 v103, v14, v15
  s_waitcnt vmcnt(51) lgkmcnt(8)
  v_mfma_f32_16x16x32_bf16 v[200:203], a[16:19], a[120:123], v[200:203]
  ds_read_b64_tr_b16 a[0:1], v240 offset:57344
  v_mfma_f32_16x16x32_bf16 v[204:207], a[20:23], a[120:123], v[204:207]
  ds_read_b64_tr_b16 a[2:3], v240 offset:59392
  v_mfma_f32_16x16x32_bf16 v[208:211], a[24:27], a[120:123], v[208:211]
  ds_read_b64_tr_b16 a[4:5], v241 offset:57344
  buffer_load_dwordx4 a[80:83], v255, s[36:39], s60 offen offset:0 sc1
  v_mfma_f32_16x16x32_bf16 v[212:215], a[28:31], a[120:123], v[212:215]
  ds_read_b64_tr_b16 a[6:7], v241 offset:59392
  v_mfma_f32_16x16x32_bf16 v[228:231], a[28:31], a[124:127], v[228:231]
  ds_read_b64_tr_b16 a[8:9], v242 offset:57344
  v_mfma_f32_16x16x32_bf16 v[224:227], a[24:27], a[124:127], v[224:227]
  ds_read_b64_tr_b16 a[10:11], v242 offset:59392
  buffer_load_dwordx4 a[84:87], v255, s[36:39], s60 offen offset:1024 sc1
  v_mfma_f32_16x16x32_bf16 v[220:223], a[20:23], a[124:127], v[220:223]
  ds_read_b64_tr_b16 a[12:13], v243 offset:57344
  v_mfma_f32_16x16x32_bf16 v[216:219], a[16:19], a[124:127], v[216:219]
  ds_read_b64_tr_b16 a[14:15], v243 offset:59392
  s_add_u32 s60, s60, 8192
  s_waitcnt vmcnt(51) lgkmcnt(8)
  v_mfma_f32_16x16x32_bf16 v[200:203], a[32:35], a[128:131], v[200:203]
  ds_read_b64_tr_b16 a[16:17], v240 offset:61440
  v_mfma_f32_16x16x32_bf16 v[204:207], a[36:39], a[128:131], v[204:207]
  ds_read_b64_tr_b16 a[18:19], v240 offset:63488
  buffer_load_dwordx2 a[88:89], v249, s[36:39], s60 offen offset:0 sc1
  v_mfma_f32_16x16x32_bf16 v[208:211], a[40:43], a[128:131], v[208:211]
  ds_read_b64_tr_b16 a[20:21], v241 offset:61440
  v_mfma_f32_16x16x32_bf16 v[212:215], a[44:47], a[128:131], v[212:215]
  ds_read_b64_tr_b16 a[22:23], v241 offset:63488
  buffer_load_dwordx2 a[90:91], v249, s[36:39], s60 offen offset:512 sc1
  v_mfma_f32_16x16x32_bf16 v[228:231], a[44:47], a[132:135], v[228:231]
  ds_read_b64_tr_b16 a[24:25], v242 offset:61440
  v_mfma_f32_16x16x32_bf16 v[224:227], a[40:43], a[132:135], v[224:227]
  ds_read_b64_tr_b16 a[26:27], v242 offset:63488
  buffer_load_dwordx2 a[92:93], v249, s[36:39], s60 offen offset:1024 sc1
  v_mfma_f32_16x16x32_bf16 v[220:223], a[36:39], a[132:135], v[220:223]
  ds_read_b64_tr_b16 a[28:29], v243 offset:61440
  buffer_load_dwordx2 a[94:95], v249, s[36:39], s60 offen offset:1536 sc1
  v_mfma_f32_16x16x32_bf16 v[216:219], a[32:35], a[132:135], v[216:219]
  ds_read_b64_tr_b16 a[30:31], v243 offset:63488
  s_add_u32 s60, s60, 8192
  s_waitcnt vmcnt(53) lgkmcnt(8)
  v_mfma_f32_16x16x32_bf16 v[200:203], a[0:3], a[136:139], v[200:203]
  ds_read_b64_tr_b16 a[32:33], v236 offset:0
  v_mfma_f32_16x16x32_bf16 v[204:207], a[4:7], a[136:139], v[204:207]
  ds_read_b64_tr_b16 a[34:35], v236 offset:2048
  v_mfma_f32_16x16x32_bf16 v[208:211], a[8:11], a[136:139], v[208:211]
  ds_read_b64_tr_b16 a[36:37], v237 offset:0
  buffer_load_dwordx4 a[96:99], v255, s[36:39], s60 offen offset:0 sc1
  v_mfma_f32_16x16x32_bf16 v[212:215], a[12:15], a[136:139], v[212:215]
  ds_read_b64_tr_b16 a[38:39], v237 offset:2048
  v_mfma_f32_16x16x32_bf16 v[228:231], a[12:15], a[140:143], v[228:231]
  ds_read_b64_tr_b16 a[40:41], v238 offset:0
  v_mfma_f32_16x16x32_bf16 v[224:227], a[8:11], a[140:143], v[224:227]
  ds_read_b64_tr_b16 a[42:43], v238 offset:2048
  buffer_load_dwordx4 a[100:103], v255, s[36:39], s60 offen offset:1024 sc1
  v_mfma_f32_16x16x32_bf16 v[220:223], a[4:7], a[140:143], v[220:223]
  ds_read_b64_tr_b16 a[44:45], v239 offset:0
  v_mfma_f32_16x16x32_bf16 v[216:219], a[0:3], a[140:143], v[216:219]
  ds_read_b64_tr_b16 a[46:47], v239 offset:2048
  s_add_u32 s60, s60, 8192
  s_waitcnt vmcnt(51) lgkmcnt(8)
  v_mfma_f32_16x16x32_bf16 v[200:203], a[16:19], a[144:147], v[200:203]
  ds_read_b64_tr_b16 a[0:1], v236 offset:4096
  v_mfma_f32_16x16x32_bf16 v[204:207], a[20:23], a[144:147], v[204:207]
  ds_read_b64_tr_b16 a[2:3], v236 offset:6144
  v_mfma_f32_16x16x32_bf16 v[208:211], a[24:27], a[144:147], v[208:211]
  ds_read_b64_tr_b16 a[4:5], v237 offset:4096
  buffer_load_dwordx4 a[104:107], v255, s[36:39], s60 offen offset:0 sc1
  v_mfma_f32_16x16x32_bf16 v[212:215], a[28:31], a[144:147], v[212:215]
  ds_read_b64_tr_b16 a[6:7], v237 offset:6144
  v_mfma_f32_16x16x32_bf16 v[228:231], a[28:31], a[148:151], v[228:231]
  ds_read_b64_tr_b16 a[8:9], v238 offset:4096
  v_mfma_f32_16x16x32_bf16 v[224:227], a[24:27], a[148:151], v[224:227]
  ds_read_b64_tr_b16 a[10:11], v238 offset:6144
  buffer_load_dwordx4 a[108:111], v255, s[36:39], s60 offen offset:1024 sc1
  v_mfma_f32_16x16x32_bf16 v[220:223], a[20:23], a[148:151], v[220:223]
  ds_read_b64_tr_b16 a[12:13], v239 offset:4096
  v_mfma_f32_16x16x32_bf16 v[216:219], a[16:19], a[148:151], v[216:219]
  ds_read_b64_tr_b16 a[14:15], v239 offset:6144
  s_add_u32 s60, s60, 8192
  s_waitcnt lgkmcnt(0)
  v_mfma_f32_32x32x16_bf16 v[0:15], v[136:139], v[112:115], v[64:79]
  ds_read_b128 v[152:155], v172 offset:21504
  v_exp_f32 v16, v16
  v_exp_f32 v17, v17
  v_exp_f32 v18, v18
  v_mfma_f32_32x32x16_bf16 v[0:15], v[140:143], v[116:119], v[0:15]
  ds_read_b128 v[156:159], v172 offset:22016
  v_exp_f32 v19, v19
  v_exp_f32 v20, v20
  v_cvt_pk_bf16_f32 v104, v16, v17
  v_exp_f32 v21, v21
  v_mfma_f32_32x32x16_bf16 v[32:47], v[144:147], v[96:99], v[32:47]
  v_exp_f32 v22, v22
  v_cvt_pk_bf16_f32 v105, v18, v19
  v_exp_f32 v23, v23
  v_exp_f32 v24, v24
  v_cvt_pk_bf16_f32 v106, v20, v21
  v_mfma_f32_32x32x16_bf16 v[32:47], v[148:151], v[100:103], v[32:47]
  v_exp_f32 v25, v25
  v_exp_f32 v26, v26
  v_cvt_pk_bf16_f32 v107, v22, v23
  v_exp_f32 v27, v27
  v_mfma_f32_16x16x32_bf16 v[160:163], v[168:171], v[96:99], v[160:163]
  v_exp_f32 v28, v28
  v_cvt_pk_bf16_f32 v108, v24, v25
  v_exp_f32 v29, v29
  v_mfma_f32_16x16x32_bf16 v[160:163], v[168:171], v[100:103], v[160:163]
  s_waitcnt vmcnt(36) lgkmcnt(0)
  s_barrier
  v_exp_f32 v30, v30
  v_cvt_pk_bf16_f32 v109, v26, v27
  v_exp_f32 v31, v31
  v_cvt_pk_bf16_f32 v110, v28, v29
  v_cvt_pk_bf16_f32 v111, v30, v31
  v_mfma_f32_32x32x16_bf16 v[16:31], v[136:139], v[120:123], v[80:95]
  ds_read_b128 v[128:131], v172 offset:24576
  v_exp_f32 v0, v0
  v_exp_f32 v1, v1
  v_exp_f32 v2, v2
  v_mfma_f32_32x32x16_bf16 v[16:31], v[140:143], v[124:127], v[16:31]
  ds_read_b128 v[132:135], v172 offset:25088
  v_exp_f32 v3, v3
  v_exp_f32 v4, v4
  v_cvt_pk_bf16_f32 v96, v0, v1
  v_exp_f32 v5, v5
  v_mfma_f32_32x32x16_bf16 v[48:63], v[144:147], v[104:107], v[48:63]
  s_add_u32 m0, s63, 114688
  v_exp_f32 v6, v6
  v_cvt_pk_bf16_f32 v97, v2, v3
  v_exp_f32 v7, v7
  v_exp_f32 v8, v8
  v_cvt_pk_bf16_f32 v98, v4, v5
  v_mfma_f32_32x32x16_bf16 v[48:63], v[148:151], v[108:111], v[48:63]
  buffer_load_dwordx4 v232, s[20:23], s62 offen offset:0 lds
  v_exp_f32 v9, v9
  v_exp_f32 v10, v10
  v_cvt_pk_bf16_f32 v99, v6, v7
  v_exp_f32 v11, v11
  v_mfma_f32_16x16x32_bf16 v[164:167], v[168:171], v[104:107], v[164:167]
  buffer_load_dwordx4 v233, s[20:23], s62 offen offset:1024 lds
  v_exp_f32 v12, v12
  v_cvt_pk_bf16_f32 v100, v8, v9
  v_exp_f32 v13, v13
  v_mfma_f32_16x16x32_bf16 v[164:167], v[168:171], v[108:111], v[164:167]
  s_waitcnt lgkmcnt(0)
  buffer_load_dwordx4 v234, s[20:23], s62 offen offset:2048 lds
  v_exp_f32 v14, v14
  v_cvt_pk_bf16_f32 v101, v10, v11
  v_exp_f32 v15, v15
  v_cvt_pk_bf16_f32 v102, v12, v13
  v_cvt_pk_bf16_f32 v103, v14, v15
  s_waitcnt vmcnt(51) lgkmcnt(8)
  v_mfma_f32_16x16x32_bf16 v[200:203], a[32:35], a[152:155], v[200:203]
  ds_read_b64_tr_b16 a[16:17], v236 offset:8192
  v_mfma_f32_16x16x32_bf16 v[204:207], a[36:39], a[152:155], v[204:207]
  ds_read_b64_tr_b16 a[18:19], v236 offset:10240
  v_mfma_f32_16x16x32_bf16 v[208:211], a[40:43], a[152:155], v[208:211]
  ds_read_b64_tr_b16 a[20:21], v237 offset:8192
  buffer_load_dwordx4 a[112:115], v255, s[36:39], s60 offen offset:0 sc1
  v_mfma_f32_16x16x32_bf16 v[212:215], a[44:47], a[152:155], v[212:215]
  ds_read_b64_tr_b16 a[22:23], v237 offset:10240
  v_mfma_f32_16x16x32_bf16 v[228:231], a[44:47], a[156:159], v[228:231]
  ds_read_b64_tr_b16 a[24:25], v238 offset:8192
  v_mfma_f32_16x16x32_bf16 v[224:227], a[40:43], a[156:159], v[224:227]
  ds_read_b64_tr_b16 a[26:27], v238 offset:10240
  buffer_load_dwordx4 a[116:119], v255, s[36:39], s60 offen offset:1024 sc1
  v_mfma_f32_16x16x32_bf16 v[220:223], a[36:39], a[156:159], v[220:223]
  ds_read_b64_tr_b16 a[28:29], v239 offset:8192
  v_mfma_f32_16x16x32_bf16 v[216:219], a[32:35], a[156:159], v[216:219]
  ds_read_b64_tr_b16 a[30:31], v239 offset:10240
  s_add_u32 s60, s60, 8192
  s_waitcnt vmcnt(51) lgkmcnt(8)
  v_mfma_f32_16x16x32_bf16 v[200:203], a[0:3], a[160:163], v[200:203]
  ds_read_b64_tr_b16 a[32:33], v236 offset:12288
  v_mfma_f32_16x16x32_bf16 v[204:207], a[4:7], a[160:163], v[204:207]
  ds_read_b64_tr_b16 a[34:35], v236 offset:14336
  v_mfma_f32_16x16x32_bf16 v[208:211], a[8:11], a[160:163], v[208:211]
  ds_read_b64_tr_b16 a[36:37], v237 offset:12288
  buffer_load_dwordx4 a[120:123], v255, s[36:39], s60 offen offset:0 sc1
  v_mfma_f32_16x16x32_bf16 v[212:215], a[12:15], a[160:163], v[212:215]
  ds_read_b64_tr_b16 a[38:39], v237 offset:14336
  v_mfma_f32_16x16x32_bf16 v[228:231], a[12:15], a[164:167], v[228:231]
  ds_read_b64_tr_b16 a[40:41], v238 offset:12288
  v_mfma_f32_16x16x32_bf16 v[224:227], a[8:11], a[164:167], v[224:227]
  ds_read_b64_tr_b16 a[42:43], v238 offset:14336
  buffer_load_dwordx4 a[124:127], v255, s[36:39], s60 offen offset:1024 sc1
  v_mfma_f32_16x16x32_bf16 v[220:223], a[4:7], a[164:167], v[220:223]
  ds_read_b64_tr_b16 a[44:45], v239 offset:12288
  v_mfma_f32_16x16x32_bf16 v[216:219], a[0:3], a[164:167], v[216:219]
  ds_read_b64_tr_b16 a[46:47], v239 offset:14336
  s_add_u32 s60, s60, 8192
  s_waitcnt vmcnt(51) lgkmcnt(8)
  v_mfma_f32_16x16x32_bf16 v[200:203], a[16:19], a[168:171], v[200:203]
  ds_read_b64_tr_b16 a[0:1], v236 offset:16384
  v_mfma_f32_16x16x32_bf16 v[204:207], a[20:23], a[168:171], v[204:207]
  ds_read_b64_tr_b16 a[2:3], v236 offset:18432
  v_mfma_f32_16x16x32_bf16 v[208:211], a[24:27], a[168:171], v[208:211]
  ds_read_b64_tr_b16 a[4:5], v237 offset:16384
  buffer_load_dwordx4 a[128:131], v255, s[36:39], s60 offen offset:0 sc1
  v_mfma_f32_16x16x32_bf16 v[212:215], a[28:31], a[168:171], v[212:215]
  ds_read_b64_tr_b16 a[6:7], v237 offset:18432
  v_mfma_f32_16x16x32_bf16 v[228:231], a[28:31], a[172:175], v[228:231]
  ds_read_b64_tr_b16 a[8:9], v238 offset:16384
  v_mfma_f32_16x16x32_bf16 v[224:227], a[24:27], a[172:175], v[224:227]
  ds_read_b64_tr_b16 a[10:11], v238 offset:18432
  buffer_load_dwordx4 a[132:135], v255, s[36:39], s60 offen offset:1024 sc1
  v_mfma_f32_16x16x32_bf16 v[220:223], a[20:23], a[172:175], v[220:223]
  ds_read_b64_tr_b16 a[12:13], v239 offset:16384
  v_mfma_f32_16x16x32_bf16 v[216:219], a[16:19], a[172:175], v[216:219]
  ds_read_b64_tr_b16 a[14:15], v239 offset:18432
  s_add_u32 s60, s60, 8192
  s_waitcnt vmcnt(51) lgkmcnt(8)
  v_mfma_f32_16x16x32_bf16 v[200:203], a[32:35], a[176:179], v[200:203]
  ds_read_b64_tr_b16 a[16:17], v236 offset:20480
  v_mfma_f32_16x16x32_bf16 v[204:207], a[36:39], a[176:179], v[204:207]
  ds_read_b64_tr_b16 a[18:19], v236 offset:22528
  v_mfma_f32_16x16x32_bf16 v[208:211], a[40:43], a[176:179], v[208:211]
  ds_read_b64_tr_b16 a[20:21], v237 offset:20480
  buffer_load_dwordx4 a[136:139], v255, s[36:39], s60 offen offset:0 sc1
  v_mfma_f32_16x16x32_bf16 v[212:215], a[44:47], a[176:179], v[212:215]
  ds_read_b64_tr_b16 a[22:23], v237 offset:22528
  v_mfma_f32_16x16x32_bf16 v[228:231], a[44:47], a[180:183], v[228:231]
  ds_read_b64_tr_b16 a[24:25], v238 offset:20480
  v_mfma_f32_16x16x32_bf16 v[224:227], a[40:43], a[180:183], v[224:227]
  ds_read_b64_tr_b16 a[26:27], v238 offset:22528
  buffer_load_dwordx4 a[140:143], v255, s[36:39], s60 offen offset:1024 sc1
  v_mfma_f32_16x16x32_bf16 v[220:223], a[36:39], a[180:183], v[220:223]
  ds_read_b64_tr_b16 a[28:29], v239 offset:20480
  v_mfma_f32_16x16x32_bf16 v[216:219], a[32:35], a[180:183], v[216:219]
  ds_read_b64_tr_b16 a[30:31], v239 offset:22528
  s_add_u32 s60, s60, 8192
  s_waitcnt lgkmcnt(0)
  v_mfma_f32_32x32x16_bf16 v[0:15], v[128:131], v[112:115], v[64:79]
  ds_read_b128 v[144:147], v172 offset:25600
  v_exp_f32 v16, v16
  v_exp_f32 v17, v17
  v_exp_f32 v18, v18
  v_mfma_f32_32x32x16_bf16 v[0:15], v[132:135], v[116:119], v[0:15]
  ds_read_b128 v[148:151], v172 offset:26112
  v_exp_f32 v19, v19
  v_exp_f32 v20, v20
  v_cvt_pk_bf16_f32 v104, v16, v17
  v_exp_f32 v21, v21
  v_mfma_f32_32x32x16_bf16 v[32:47], v[152:155], v[96:99], v[32:47]
  buffer_load_dwordx4 v235, s[20:23], s62 offen offset:3072 lds
  s_sub_u32 s62, s62, 3407872
  v_exp_f32 v22, v22
  v_cvt_pk_bf16_f32 v105, v18, v19
  v_exp_f32 v23, v23
  v_exp_f32 v24, v24
  v_cvt_pk_bf16_f32 v106, v20, v21
  v_mfma_f32_32x32x16_bf16 v[32:47], v[156:159], v[100:103], v[32:47]
  s_add_u32 m0, s63, 131072
  v_exp_f32 v25, v25
  v_exp_f32 v26, v26
  v_cvt_pk_bf16_f32 v107, v22, v23
  v_exp_f32 v27, v27
  v_mfma_f32_16x16x32_bf16 v[160:163], v[168:171], v[96:99], v[160:163]
  buffer_load_dwordx4 v232, s[24:27], s62 offen offset:0 lds
  v_exp_f32 v28, v28
  v_cvt_pk_bf16_f32 v108, v24, v25
  v_exp_f32 v29, v29
  v_mfma_f32_16x16x32_bf16 v[160:163], v[168:171], v[100:103], v[160:163]
  s_waitcnt lgkmcnt(0)
  buffer_load_dwordx4 v233, s[24:27], s62 offen offset:1024 lds
  v_exp_f32 v30, v30
  v_cvt_pk_bf16_f32 v109, v26, v27
  v_exp_f32 v31, v31
  v_cvt_pk_bf16_f32 v110, v28, v29
  v_cvt_pk_bf16_f32 v111, v30, v31
  v_mfma_f32_32x32x16_bf16 v[16:31], v[128:131], v[120:123], v[80:95]
  ds_read_b128 v[136:139], v172 offset:28672
  v_exp_f32 v0, v0
  v_exp_f32 v1, v1
  v_exp_f32 v2, v2
  v_mfma_f32_32x32x16_bf16 v[16:31], v[132:135], v[124:127], v[16:31]
  ds_read_b128 v[140:143], v172 offset:29184
  v_exp_f32 v3, v3
  v_exp_f32 v4, v4
  v_cvt_pk_bf16_f32 v96, v0, v1
  v_exp_f32 v5, v5
  v_mfma_f32_32x32x16_bf16 v[48:63], v[152:155], v[104:107], v[48:63]
  buffer_load_dwordx4 v234, s[24:27], s62 offen offset:2048 lds
  v_exp_f32 v6, v6
  v_cvt_pk_bf16_f32 v97, v2, v3
  v_exp_f32 v7, v7
  v_exp_f32 v8, v8
  v_cvt_pk_bf16_f32 v98, v4, v5
  v_mfma_f32_32x32x16_bf16 v[48:63], v[156:159], v[108:111], v[48:63]
  buffer_load_dwordx4 v235, s[24:27], s62 offen offset:3072 lds
  s_add_u32 s62, s62, 262144
  v_exp_f32 v9, v9
  v_exp_f32 v10, v10
  v_cvt_pk_bf16_f32 v99, v6, v7
  v_exp_f32 v11, v11
  v_mfma_f32_16x16x32_bf16 v[164:167], v[168:171], v[104:107], v[164:167]
  s_add_u32 m0, s63, 147456
  v_exp_f32 v12, v12
  v_cvt_pk_bf16_f32 v100, v8, v9
  v_exp_f32 v13, v13
  v_mfma_f32_16x16x32_bf16 v[164:167], v[168:171], v[108:111], v[164:167]
  s_waitcnt lgkmcnt(0)
  buffer_load_dwordx4 v232, s[24:27], s62 offen offset:0 lds
  v_exp_f32 v14, v14
  v_cvt_pk_bf16_f32 v101, v10, v11
  v_exp_f32 v15, v15
  v_cvt_pk_bf16_f32 v102, v12, v13
  v_cvt_pk_bf16_f32 v103, v14, v15
  s_waitcnt vmcnt(51) lgkmcnt(8)
  v_mfma_f32_16x16x32_bf16 v[200:203], a[0:3], a[184:187], v[200:203]
  ds_read_b64_tr_b16 a[32:33], v236 offset:24576
  v_mfma_f32_16x16x32_bf16 v[204:207], a[4:7], a[184:187], v[204:207]
  ds_read_b64_tr_b16 a[34:35], v236 offset:26624
  buffer_load_dwordx2 a[144:145], v249, s[36:39], s60 offen offset:0 sc1
  v_mfma_f32_16x16x32_bf16 v[208:211], a[8:11], a[184:187], v[208:211]
  ds_read_b64_tr_b16 a[36:37], v237 offset:24576
  v_mfma_f32_16x16x32_bf16 v[212:215], a[12:15], a[184:187], v[212:215]
  ds_read_b64_tr_b16 a[38:39], v237 offset:26624
  buffer_load_dwordx2 a[146:147], v249, s[36:39], s60 offen offset:512 sc1
  v_mfma_f32_16x16x32_bf16 v[228:231], a[12:15], a[188:191], v[228:231]
  ds_read_b64_tr_b16 a[40:41], v238 offset:24576
  v_mfma_f32_16x16x32_bf16 v[224:227], a[8:11], a[188:191], v[224:227]
  ds_read_b64_tr_b16 a[42:43], v238 offset:26624
  buffer_load_dwordx2 a[148:149], v249, s[36:39], s60 offen offset:1024 sc1
  v_mfma_f32_16x16x32_bf16 v[220:223], a[4:7], a[188:191], v[220:223]
  ds_read_b64_tr_b16 a[44:45], v239 offset:24576
  buffer_load_dwordx2 a[150:151], v249, s[36:39], s60 offen offset:1536 sc1
  v_mfma_f32_16x16x32_bf16 v[216:219], a[0:3], a[188:191], v[216:219]
  ds_read_b64_tr_b16 a[46:47], v239 offset:26624
  s_add_u32 s60, s60, 8192
  s_waitcnt vmcnt(53) lgkmcnt(8)
  v_mfma_f32_16x16x32_bf16 v[200:203], a[16:19], a[192:195], v[200:203]
  ds_read_b64_tr_b16 a[0:1], v236 offset:28672
  v_mfma_f32_16x16x32_bf16 v[204:207], a[20:23], a[192:195], v[204:207]
  ds_read_b64_tr_b16 a[2:3], v236 offset:30720
  v_mfma_f32_16x16x32_bf16 v[208:211], a[24:27], a[192:195], v[208:211]
  ds_read_b64_tr_b16 a[4:5], v237 offset:28672
  buffer_load_dwordx4 a[152:155], v255, s[36:39], s60 offen offset:0 sc1
  v_mfma_f32_16x16x32_bf16 v[212:215], a[28:31], a[192:195], v[212:215]
  ds_read_b64_tr_b16 a[6:7], v237 offset:30720
  v_mfma_f32_16x16x32_bf16 v[228:231], a[28:31], a[196:199], v[228:231]
  ds_read_b64_tr_b16 a[8:9], v238 offset:28672
  v_mfma_f32_16x16x32_bf16 v[224:227], a[24:27], a[196:199], v[224:227]
  ds_read_b64_tr_b16 a[10:11], v238 offset:30720
  buffer_load_dwordx4 a[156:159], v255, s[36:39], s60 offen offset:1024 sc1
  v_mfma_f32_16x16x32_bf16 v[220:223], a[20:23], a[196:199], v[220:223]
  ds_read_b64_tr_b16 a[12:13], v239 offset:28672
  v_mfma_f32_16x16x32_bf16 v[216:219], a[16:19], a[196:199], v[216:219]
  ds_read_b64_tr_b16 a[14:15], v239 offset:30720
  s_add_u32 s60, s60, 8192
  s_waitcnt vmcnt(51) lgkmcnt(8)
  v_mfma_f32_16x16x32_bf16 v[200:203], a[32:35], a[200:203], v[200:203]
  ds_read_b64_tr_b16 a[16:17], v236 offset:32768
  v_mfma_f32_16x16x32_bf16 v[204:207], a[36:39], a[200:203], v[204:207]
  ds_read_b64_tr_b16 a[18:19], v236 offset:34816
  v_mfma_f32_16x16x32_bf16 v[208:211], a[40:43], a[200:203], v[208:211]
  ds_read_b64_tr_b16 a[20:21], v237 offset:32768
  buffer_load_dwordx4 a[160:163], v255, s[36:39], s60 offen offset:0 sc1
  v_mfma_f32_16x16x32_bf16 v[212:215], a[44:47], a[200:203], v[212:215]
  ds_read_b64_tr_b16 a[22:23], v237 offset:34816
  v_mfma_f32_16x16x32_bf16 v[228:231], a[44:47], a[204:207], v[228:231]
  ds_read_b64_tr_b16 a[24:25], v238 offset:32768
  v_mfma_f32_16x16x32_bf16 v[224:227], a[40:43], a[204:207], v[224:227]
  ds_read_b64_tr_b16 a[26:27], v238 offset:34816
  buffer_load_dwordx4 a[164:167], v255, s[36:39], s60 offen offset:1024 sc1
  v_mfma_f32_16x16x32_bf16 v[220:223], a[36:39], a[204:207], v[220:223]
  ds_read_b64_tr_b16 a[28:29], v239 offset:32768
  v_mfma_f32_16x16x32_bf16 v[216:219], a[32:35], a[204:207], v[216:219]
  ds_read_b64_tr_b16 a[30:31], v239 offset:34816
  s_add_u32 s60, s60, 8192
  s_waitcnt vmcnt(51) lgkmcnt(8)
  v_mfma_f32_16x16x32_bf16 v[200:203], a[0:3], a[208:211], v[200:203]
  ds_read_b64_tr_b16 a[32:33], v236 offset:36864
  v_mfma_f32_16x16x32_bf16 v[204:207], a[4:7], a[208:211], v[204:207]
  ds_read_b64_tr_b16 a[34:35], v236 offset:38912
  v_mfma_f32_16x16x32_bf16 v[208:211], a[8:11], a[208:211], v[208:211]
  ds_read_b64_tr_b16 a[36:37], v237 offset:36864
  buffer_load_dwordx4 a[168:171], v255, s[36:39], s60 offen offset:0 sc1
  v_mfma_f32_16x16x32_bf16 v[212:215], a[12:15], a[208:211], v[212:215]
  ds_read_b64_tr_b16 a[38:39], v237 offset:38912
  v_mfma_f32_16x16x32_bf16 v[228:231], a[12:15], a[212:215], v[228:231]
  ds_read_b64_tr_b16 a[40:41], v238 offset:36864
  v_mfma_f32_16x16x32_bf16 v[224:227], a[8:11], a[212:215], v[224:227]
  ds_read_b64_tr_b16 a[42:43], v238 offset:38912
  buffer_load_dwordx4 a[172:175], v255, s[36:39], s60 offen offset:1024 sc1
  v_mfma_f32_16x16x32_bf16 v[220:223], a[4:7], a[212:215], v[220:223]
  ds_read_b64_tr_b16 a[44:45], v239 offset:36864
  v_mfma_f32_16x16x32_bf16 v[216:219], a[0:3], a[212:215], v[216:219]
  ds_read_b64_tr_b16 a[46:47], v239 offset:38912
  s_sub_u32 s60, s60, 712704
  s_waitcnt lgkmcnt(0)
  v_mfma_f32_32x32x16_bf16 v[0:15], v[136:139], v[112:115], v[64:79]
  ds_read_b128 v[152:155], v172 offset:29696
  v_exp_f32 v16, v16
  v_exp_f32 v17, v17
  v_exp_f32 v18, v18
  v_mfma_f32_32x32x16_bf16 v[0:15], v[140:143], v[116:119], v[0:15]
  ds_read_b128 v[156:159], v172 offset:30208
  v_exp_f32 v19, v19
  v_exp_f32 v20, v20
  v_cvt_pk_bf16_f32 v104, v16, v17
  v_exp_f32 v21, v21
  v_mfma_f32_32x32x16_bf16 v[32:47], v[144:147], v[96:99], v[32:47]
  buffer_load_dwordx4 v233, s[24:27], s62 offen offset:1024 lds
  v_exp_f32 v22, v22
  v_cvt_pk_bf16_f32 v105, v18, v19
  v_exp_f32 v23, v23
  v_exp_f32 v24, v24
  v_cvt_pk_bf16_f32 v106, v20, v21
  v_mfma_f32_32x32x16_bf16 v[32:47], v[148:151], v[100:103], v[32:47]
  buffer_load_dwordx4 v234, s[24:27], s62 offen offset:2048 lds
  v_exp_f32 v25, v25
  v_exp_f32 v26, v26
  v_cvt_pk_bf16_f32 v107, v22, v23
  v_exp_f32 v27, v27
  v_mfma_f32_16x16x32_bf16 v[160:163], v[168:171], v[96:99], v[160:163]
  buffer_load_dwordx4 v235, s[24:27], s62 offen offset:3072 lds
  s_add_u32 s62, s62, 262144
  v_exp_f32 v28, v28
  v_cvt_pk_bf16_f32 v108, v24, v25
  v_exp_f32 v29, v29
  v_mfma_f32_16x16x32_bf16 v[160:163], v[168:171], v[100:103], v[160:163]
  s_waitcnt lgkmcnt(0)
  v_exp_f32 v30, v30
  v_cvt_pk_bf16_f32 v109, v26, v27
  v_exp_f32 v31, v31
  v_cvt_pk_bf16_f32 v110, v28, v29
  v_cvt_pk_bf16_f32 v111, v30, v31
  v_mfma_f32_32x32x16_bf16 v[16:31], v[136:139], v[120:123], v[80:95]
  v_exp_f32 v0, v0
  v_exp_f32 v1, v1
  v_exp_f32 v2, v2
  v_mfma_f32_32x32x16_bf16 v[16:31], v[140:143], v[124:127], v[16:31]
  v_exp_f32 v3, v3
  v_exp_f32 v4, v4
  v_cvt_pk_bf16_f32 v96, v0, v1
  v_exp_f32 v5, v5
  v_mfma_f32_32x32x16_bf16 v[48:63], v[144:147], v[104:107], v[48:63]
  v_exp_f32 v6, v6
  v_cvt_pk_bf16_f32 v97, v2, v3
  v_exp_f32 v7, v7
  v_exp_f32 v8, v8
  v_cvt_pk_bf16_f32 v98, v4, v5
  v_mfma_f32_32x32x16_bf16 v[48:63], v[148:151], v[108:111], v[48:63]
  v_exp_f32 v9, v9
  v_exp_f32 v10, v10
  v_cvt_pk_bf16_f32 v99, v6, v7
  v_exp_f32 v11, v11
  v_mfma_f32_16x16x32_bf16 v[164:167], v[168:171], v[104:107], v[164:167]
  v_exp_f32 v12, v12
  v_cvt_pk_bf16_f32 v100, v8, v9
  v_exp_f32 v13, v13
  v_mfma_f32_16x16x32_bf16 v[164:167], v[168:171], v[108:111], v[164:167]
  s_waitcnt lgkmcnt(0)
  v_exp_f32 v14, v14
  v_cvt_pk_bf16_f32 v101, v10, v11
  v_exp_f32 v15, v15
  v_cvt_pk_bf16_f32 v102, v12, v13
  v_cvt_pk_bf16_f32 v103, v14, v15
  v_exp_f32 v16, v16
  v_exp_f32 v17, v17
  v_exp_f32 v18, v18
  v_exp_f32 v19, v19
  v_exp_f32 v20, v20
  v_cvt_pk_bf16_f32 v104, v16, v17
  v_exp_f32 v21, v21
  v_mfma_f32_32x32x16_bf16 v[32:47], v[152:155], v[96:99], v[32:47]
  v_exp_f32 v22, v22
  v_cvt_pk_bf16_f32 v105, v18, v19
  v_exp_f32 v23, v23
  v_exp_f32 v24, v24
  v_cvt_pk_bf16_f32 v106, v20, v21
  v_mfma_f32_32x32x16_bf16 v[32:47], v[156:159], v[100:103], v[32:47]
  v_exp_f32 v25, v25
  v_exp_f32 v26, v26
  v_cvt_pk_bf16_f32 v107, v22, v23
  v_exp_f32 v27, v27
  v_mfma_f32_16x16x32_bf16 v[160:163], v[168:171], v[96:99], v[160:163]
  v_exp_f32 v28, v28
  v_cvt_pk_bf16_f32 v108, v24, v25
  v_exp_f32 v29, v29
  v_mfma_f32_16x16x32_bf16 v[160:163], v[168:171], v[100:103], v[160:163]
  s_waitcnt lgkmcnt(0)
  v_exp_f32 v30, v30
  v_cvt_pk_bf16_f32 v109, v26, v27
  v_exp_f32 v31, v31
  v_cvt_pk_bf16_f32 v110, v28, v29
  v_cvt_pk_bf16_f32 v111, v30, v31
  s_nop 1
  v_mfma_f32_32x32x16_bf16 v[48:63], v[152:155], v[104:107], v[48:63]
  v_mfma_f32_32x32x16_bf16 v[48:63], v[156:159], v[108:111], v[48:63]
  v_mfma_f32_16x16x32_bf16 v[164:167], v[168:171], v[104:107], v[164:167]
  v_mfma_f32_16x16x32_bf16 v[164:167], v[168:171], v[108:111], v[164:167]
  s_lshl_b32 s64, s46, 1
  s_lshr_b32 s65, s44, 1
  s_add_u32 s64, s64, s65
  s_lshl_b32 s51, s64, 8
  s_lshl_b32 s66, s45, 3
  s_add_u32 s51, s51, s66
  s_and_b32 s65, s44, 1
  s_lshl_b32 s66, s65, 2
  s_add_u32 s51, s51, s66
  s_add_u32 s51, s51, 44048384
  s_add_u32 s52, s52, 4096
  s_mul_i32 s64, s64, 88
  s_add_u32 s64, s64, s45
  s_lshl_b32 s64, s64, 13
  s_lshl_b32 s65, s65, 12
  s_add_u32 s64, s64, s65
  s_add_u32 s64, s64, 29360128
  v_cmp_eq_u32 vcc, 1, v176
  s_nop 5
  v_cndmask_b32 v184, v160, v161, vcc
  v_cndmask_b32 v185, v164, v165, vcc
  v_mov_b32 v187, 0x5d800000
  v_cmp_nle_f32 vcc, v184, v187
  v_cmp_nle_f32 s[66:67], v185, v187
  s_nop 3
  s_or_b64 vcc, vcc, s[66:67]
  s_cbranch_scc1 gated_mix__mha_block__mixer_gmlp__prompt_kernel_slow
gated_mix__mha_block__mixer_gmlp__prompt_kernel_afin:
  v_rcp_f32 v186, v184
  v_rcp_f32 v187, v185
  s_nop 0
  v_mul_f32 v186, v186, v174
  v_mul_f32 v187, v187, v175
  v_mul_f32 v32, v32, v186
  v_mul_f32 v33, v33, v186
  v_mul_f32 v34, v34, v186
  v_mul_f32 v35, v35, v186
  v_mul_f32 v36, v36, v186
  v_mul_f32 v37, v37, v186
  v_mul_f32 v38, v38, v186
  v_mul_f32 v39, v39, v186
  v_mul_f32 v40, v40, v186
  v_mul_f32 v41, v41, v186
  v_mul_f32 v42, v42, v186
  v_mul_f32 v43, v43, v186
  v_mul_f32 v44, v44, v186
  v_mul_f32 v45, v45, v186
  v_mul_f32 v46, v46, v186
  v_mul_f32 v47, v47, v186
  v_cvt_pk_bf16_f32 v96, v32, v33
  v_cvt_pk_bf16_f32 v97, v34, v35
  v_cvt_pk_bf16_f32 v98, v36, v37
  v_cvt_pk_bf16_f32 v99, v38, v39
  v_cvt_pk_bf16_f32 v100, v40, v41
  v_cvt_pk_bf16_f32 v101, v42, v43
  v_cvt_pk_bf16_f32 v102, v44, v45
  v_cvt_pk_bf16_f32 v103, v46, v47
  buffer_store_dwordx4 v[96:99], v179, s[4:7], s64 offen offset:0 sc1
  buffer_store_dwordx4 v[100:103], v179, s[4:7], s64 offen offset:512 sc1
  v_mul_f32 v48, v48, v187
  v_mul_f32 v49, v49, v187
  v_mul_f32 v50, v50, v187
  v_mul_f32 v51, v51, v187
  v_mul_f32 v52, v52, v187
  v_mul_f32 v53, v53, v187
  v_mul_f32 v54, v54, v187
  v_mul_f32 v55, v55, v187
  v_mul_f32 v56, v56, v187
  v_mul_f32 v57, v57, v187
  v_mul_f32 v58, v58, v187
  v_mul_f32 v59, v59, v187
  v_mul_f32 v60, v60, v187
  v_mul_f32 v61, v61, v187
  v_mul_f32 v62, v62, v187
  v_mul_f32 v63, v63, v187
  v_cvt_pk_bf16_f32 v104, v48, v49
  v_cvt_pk_bf16_f32 v105, v50, v51
  v_cvt_pk_bf16_f32 v106, v52, v53
  v_cvt_pk_bf16_f32 v107, v54, v55
  v_cvt_pk_bf16_f32 v108, v56, v57
  v_cvt_pk_bf16_f32 v109, v58, v59
  v_cvt_pk_bf16_f32 v110, v60, v61
  v_cvt_pk_bf16_f32 v111, v62, v63
  buffer_store_dwordx4 v[104:107], v179, s[4:7], s64 offen offset:2048 sc1
  buffer_store_dwordx4 v[108:111], v179, s[4:7], s64 offen offset:2560 sc1
  s_waitcnt lgkmcnt(0)
  s_waitcnt vmcnt(56)
  s_barrier
  s_waitcnt vmcnt(52) lgkmcnt(8)
  v_mfma_f32_16x16x32_bf16 v[200:203], a[16:19], a[216:219], v[200:203]
  ds_read_b64_tr_b16 a[0:1], v236 offset:40960
  v_mfma_f32_16x16x32_bf16 v[204:207], a[20:23], a[216:219], v[204:207]
  ds_read_b64_tr_b16 a[2:3], v236 offset:43008
  v_mfma_f32_16x16x32_bf16 v[208:211], a[24:27], a[216:219], v[208:211]
  ds_read_b64_tr_b16 a[4:5], v237 offset:40960
  v_mfma_f32_16x16x32_bf16 v[212:215], a[28:31], a[216:219], v[212:215]
  ds_read_b64_tr_b16 a[6:7], v237 offset:43008
  v_mfma_f32_16x16x32_bf16 v[228:231], a[28:31], a[220:223], v[228:231]
  ds_read_b64_tr_b16 a[8:9], v238 offset:40960
  v_mfma_f32_16x16x32_bf16 v[224:227], a[24:27], a[220:223], v[224:227]
  ds_read_b64_tr_b16 a[10:11], v238 offset:43008
  v_mfma_f32_16x16x32_bf16 v[220:223], a[20:23], a[220:223], v[220:223]
  ds_read_b64_tr_b16 a[12:13], v239 offset:40960
  v_mfma_f32_16x16x32_bf16 v[216:219], a[16:19], a[220:223], v[216:219]
  ds_read_b64_tr_b16 a[14:15], v239 offset:43008
  s_add_u32 m0, s63, 32768
  s_waitcnt vmcnt(50) lgkmcnt(8)
  v_mfma_f32_16x16x32_bf16 v[200:203], a[32:35], a[224:227], v[200:203]
  ds_read_b64_tr_b16 a[16:17], v236 offset:45056
  v_mfma_f32_16x16x32_bf16 v[204:207], a[36:39], a[224:227], v[204:207]
  ds_read_b64_tr_b16 a[18:19], v236 offset:47104
  v_mfma_f32_16x16x32_bf16 v[208:211], a[40:43], a[224:227], v[208:211]
  ds_read_b64_tr_b16 a[20:21], v237 offset:45056
  v_mfma_f32_16x16x32_bf16 v[212:215], a[44:47], a[224:227], v[212:215]
  ds_read_b64_tr_b16 a[22:23], v237 offset:47104
  v_mfma_f32_16x16x32_bf16 v[228:231], a[44:47], a[228:231], v[228:231]
  ds_read_b64_tr_b16 a[24:25], v238 offset:45056
  v_mfma_f32_16x16x32_bf16 v[224:227], a[40:43], a[228:231], v[224:227]
  ds_read_b64_tr_b16 a[26:27], v238 offset:47104
  v_mfma_f32_16x16x32_bf16 v[220:223], a[36:39], a[228:231], v[220:223]
  ds_read_b64_tr_b16 a[28:29], v239 offset:45056
  v_mfma_f32_16x16x32_bf16 v[216:219], a[32:35], a[228:231], v[216:219]
  ds_read_b64_tr_b16 a[30:31], v239 offset:47104
  buffer_load_dwordx4 v232, s[24:27], s62 offen offset:0 lds
  s_waitcnt vmcnt(49) lgkmcnt(8)
  v_mfma_f32_16x16x32_bf16 v[200:203], a[0:3], a[64:67], v[200:203]
  ds_read_b64_tr_b16 a[32:33], v236 offset:49152
  v_mfma_f32_16x16x32_bf16 v[204:207], a[4:7], a[64:67], v[204:207]
  ds_read_b64_tr_b16 a[34:35], v236 offset:51200
  v_mfma_f32_16x16x32_bf16 v[208:211], a[8:11], a[64:67], v[208:211]
  ds_read_b64_tr_b16 a[36:37], v237 offset:49152
  v_mfma_f32_16x16x32_bf16 v[212:215], a[12:15], a[64:67], v[212:215]
  ds_read_b64_tr_b16 a[38:39], v237 offset:51200
  v_mfma_f32_16x16x32_bf16 v[228:231], a[12:15], a[68:71], v[228:231]
  ds_read_b64_tr_b16 a[40:41], v238 offset:49152
  v_mfma_f32_16x16x32_bf16 v[224:227], a[8:11], a[68:71], v[224:227]
  ds_read_b64_tr_b16 a[42:43], v238 offset:51200
  v_mfma_f32_16x16x32_bf16 v[220:223], a[4:7], a[68:71], v[220:223]
  ds_read_b64_tr_b16 a[44:45], v239 offset:49152
  v_mfma_f32_16x16x32_bf16 v[216:219], a[0:3], a[68:71], v[216:219]
  ds_read_b64_tr_b16 a[46:47], v239 offset:51200
  buffer_load_dwordx4 v233, s[24:27], s62 offen offset:1024 lds
  s_waitcnt vmcnt(48) lgkmcnt(8)
  v_mfma_f32_16x16x32_bf16 v[200:203], a[16:19], a[72:75], v[200:203]
  ds_read_b64_tr_b16 a[0:1], v236 offset:53248
  v_mfma_f32_16x16x32_bf16 v[204:207], a[20:23], a[72:75], v[204:207]
  ds_read_b64_tr_b16 a[2:3], v236 offset:55296
  v_mfma_f32_16x16x32_bf16 v[208:211], a[24:27], a[72:75], v[208:211]
  ds_read_b64_tr_b16 a[4:5], v237 offset:53248
  v_mfma_f32_16x16x32_bf16 v[212:215], a[28:31], a[72:75], v[212:215]
  ds_read_b64_tr_b16 a[6:7], v237 offset:55296
  v_mfma_f32_16x16x32_bf16 v[228:231], a[28:31], a[76:79], v[228:231]
  ds_read_b64_tr_b16 a[8:9], v238 offset:53248
  v_mfma_f32_16x16x32_bf16 v[224:227], a[24:27], a[76:79], v[224:227]
  ds_read_b64_tr_b16 a[10:11], v238 offset:55296
  v_mfma_f32_16x16x32_bf16 v[220:223], a[20:23], a[76:79], v[220:223]
  ds_read_b64_tr_b16 a[12:13], v239 offset:53248
  v_mfma_f32_16x16x32_bf16 v[216:219], a[16:19], a[76:79], v[216:219]
  ds_read_b64_tr_b16 a[14:15], v239 offset:55296
  buffer_load_dwordx4 v234, s[24:27], s62 offen offset:2048 lds
  buffer_load_dwordx4 v235, s[24:27], s62 offen offset:3072 lds
  s_add_u32 s62, s62, 262144
  s_add_u32 m0, s63, 49152
  s_nop 0
  buffer_load_dwordx4 v232, s[24:27], s62 offen offset:0 lds
  buffer_load_dwordx4 v233, s[24:27], s62 offen offset:1024 lds
  buffer_load_dwordx4 v234, s[24:27], s62 offen offset:2048 lds
  buffer_load_dwordx4 v235, s[24:27], s62 offen offset:3072 lds
  s_add_u32 s62, s62, 262144
  s_waitcnt vmcnt(8)
  buffer_store_dword v252, v251, s[4:7], s51 offen sc1
  s_waitcnt lgkmcnt(0)
  s_waitcnt vmcnt(52)
  s_barrier
  s_waitcnt vmcnt(50) lgkmcnt(8)
  v_mfma_f32_16x16x32_bf16 v[200:203], a[32:35], a[80:83], v[200:203]
  ds_read_b64_tr_b16 a[16:17], v236 offset:57344
  v_mfma_f32_16x16x32_bf16 v[204:207], a[36:39], a[80:83], v[204:207]
  ds_read_b64_tr_b16 a[18:19], v236 offset:59392
  v_mfma_f32_16x16x32_bf16 v[208:211], a[40:43], a[80:83], v[208:211]
  ds_read_b64_tr_b16 a[20:21], v237 offset:57344
  v_mfma_f32_16x16x32_bf16 v[212:215], a[44:47], a[80:83], v[212:215]
  ds_read_b64_tr_b16 a[22:23], v237 offset:59392
  v_mfma_f32_16x16x32_bf16 v[228:231], a[44:47], a[84:87], v[228:231]
  ds_read_b64_tr_b16 a[24:25], v238 offset:57344
  v_mfma_f32_16x16x32_bf16 v[224:227], a[40:43], a[84:87], v[224:227]
  ds_read_b64_tr_b16 a[26:27], v238 offset:59392
  v_mfma_f32_16x16x32_bf16 v[220:223], a[36:39], a[84:87], v[220:223]
  ds_read_b64_tr_b16 a[28:29], v239 offset:57344
  v_mfma_f32_16x16x32_bf16 v[216:219], a[32:35], a[84:87], v[216:219]
  ds_read_b64_tr_b16 a[30:31], v239 offset:59392
  s_add_u32 m0, s63, 65536
  s_waitcnt vmcnt(46) lgkmcnt(8)
  v_mfma_f32_16x16x32_bf16 v[200:203], a[0:3], a[88:91], v[200:203]
  ds_read_b64_tr_b16 a[32:33], v236 offset:61440
  v_mfma_f32_16x16x32_bf16 v[204:207], a[4:7], a[88:91], v[204:207]
  ds_read_b64_tr_b16 a[34:35], v236 offset:63488
  v_mfma_f32_16x16x32_bf16 v[208:211], a[8:11], a[88:91], v[208:211]
  ds_read_b64_tr_b16 a[36:37], v237 offset:61440
  v_mfma_f32_16x16x32_bf16 v[212:215], a[12:15], a[88:91], v[212:215]
  ds_read_b64_tr_b16 a[38:39], v237 offset:63488
  v_mfma_f32_16x16x32_bf16 v[228:231], a[12:15], a[92:95], v[228:231]
  ds_read_b64_tr_b16 a[40:41], v238 offset:61440
  v_mfma_f32_16x16x32_bf16 v[224:227], a[8:11], a[92:95], v[224:227]
  ds_read_b64_tr_b16 a[42:43], v238 offset:63488
  v_mfma_f32_16x16x32_bf16 v[220:223], a[4:7], a[92:95], v[220:223]
  ds_read_b64_tr_b16 a[44:45], v239 offset:61440
  v_mfma_f32_16x16x32_bf16 v[216:219], a[0:3], a[92:95], v[216:219]
  ds_read_b64_tr_b16 a[46:47], v239 offset:63488
  buffer_load_dwordx4 v232, s[24:27], s62 offen offset:0 lds
  s_waitcnt vmcnt(45) lgkmcnt(8)
  v_mfma_f32_16x16x32_bf16 v[200:203], a[16:19], a[96:99], v[200:203]
  ds_read_b64_tr_b16 a[0:1], v240 offset:0
  v_mfma_f32_16x16x32_bf16 v[204:207], a[20:23], a[96:99], v[204:207]
  ds_read_b64_tr_b16 a[2:3], v240 offset:2048
  v_mfma_f32_16x16x32_bf16 v[208:211], a[24:27], a[96:99], v[208:211]
  ds_read_b64_tr_b16 a[4:5], v241 offset:0
  v_mfma_f32_16x16x32_bf16 v[212:215], a[28:31], a[96:99], v[212:215]
  ds_read_b64_tr_b16 a[6:7], v241 offset:2048
  v_mfma_f32_16x16x32_bf16 v[228:231], a[28:31], a[100:103], v[228:231]
  ds_read_b64_tr_b16 a[8:9], v242 offset:0
  v_mfma_f32_16x16x32_bf16 v[224:227], a[24:27], a[100:103], v[224:227]
  ds_read_b64_tr_b16 a[10:11], v242 offset:2048
  v_mfma_f32_16x16x32_bf16 v[220:223], a[20:23], a[100:103], v[220:223]
  ds_read_b64_tr_b16 a[12:13], v243 offset:0
  v_mfma_f32_16x16x32_bf16 v[216:219], a[16:19], a[100:103], v[216:219]
  ds_read_b64_tr_b16 a[14:15], v243 offset:2048
  buffer_load_dwordx4 v233, s[24:27], s62 offen offset:1024 lds
  s_waitcnt vmcnt(44) lgkmcnt(8)
  v_mfma_f32_16x16x32_bf16 v[200:203], a[32:35], a[104:107], v[200:203]
  ds_read_b64_tr_b16 a[16:17], v240 offset:4096
  v_mfma_f32_16x16x32_bf16 v[204:207], a[36:39], a[104:107], v[204:207]
  ds_read_b64_tr_b16 a[18:19], v240 offset:6144
  v_mfma_f32_16x16x32_bf16 v[208:211], a[40:43], a[104:107], v[208:211]
  ds_read_b64_tr_b16 a[20:21], v241 offset:4096
  v_mfma_f32_16x16x32_bf16 v[212:215], a[44:47], a[104:107], v[212:215]
  ds_read_b64_tr_b16 a[22:23], v241 offset:6144
  v_mfma_f32_16x16x32_bf16 v[228:231], a[44:47], a[108:111], v[228:231]
  ds_read_b64_tr_b16 a[24:25], v242 offset:4096
  v_mfma_f32_16x16x32_bf16 v[224:227], a[40:43], a[108:111], v[224:227]
  ds_read_b64_tr_b16 a[26:27], v242 offset:6144
  v_mfma_f32_16x16x32_bf16 v[220:223], a[36:39], a[108:111], v[220:223]
  ds_read_b64_tr_b16 a[28:29], v243 offset:4096
  v_mfma_f32_16x16x32_bf16 v[216:219], a[32:35], a[108:111], v[216:219]
  ds_read_b64_tr_b16 a[30:31], v243 offset:6144
  buffer_load_dwordx4 v234, s[24:27], s62 offen offset:2048 lds
  buffer_load_dwordx4 v235, s[24:27], s62 offen offset:3072 lds
  s_add_u32 s62, s62, 262144
  buffer_load_dword v250, v253, s[4:7], s52 offen sc1
  s_waitcnt lgkmcnt(0)
  s_waitcnt vmcnt(35)
  s_barrier
  s_waitcnt vmcnt(42) lgkmcnt(8)
  v_mfma_f32_16x16x32_bf16 v[200:203], a[0:3], a[112:115], v[200:203]
  ds_read_b64_tr_b16 a[32:33], v240 offset:8192
  v_mfma_f32_16x16x32_bf16 v[204:207], a[4:7], a[112:115], v[204:207]
  ds_read_b64_tr_b16 a[34:35], v240 offset:10240
  v_mfma_f32_16x16x32_bf16 v[208:211], a[8:11], a[112:115], v[208:211]
  ds_read_b64_tr_b16 a[36:37], v241 offset:8192
  v_mfma_f32_16x16x32_bf16 v[212:215], a[12:15], a[112:115], v[212:215]
  ds_read_b64_tr_b16 a[38:39], v241 offset:10240
  v_mfma_f32_16x16x32_bf16 v[228:231], a[12:15], a[116:119], v[228:231]
  ds_read_b64_tr_b16 a[40:41], v242 offset:8192
  v_mfma_f32_16x16x32_bf16 v[224:227], a[8:11], a[116:119], v[224:227]
  ds_read_b64_tr_b16 a[42:43], v242 offset:10240
  v_mfma_f32_16x16x32_bf16 v[220:223], a[4:7], a[116:119], v[220:223]
  ds_read_b64_tr_b16 a[44:45], v243 offset:8192
  v_mfma_f32_16x16x32_bf16 v[216:219], a[0:3], a[116:119], v[216:219]
  ds_read_b64_tr_b16 a[46:47], v243 offset:10240
  s_add_u32 m0, s63, 81920
  s_waitcnt vmcnt(40) lgkmcnt(8)
  v_mfma_f32_16x16x32_bf16 v[200:203], a[16:19], a[120:123], v[200:203]
  ds_read_b64_tr_b16 a[0:1], v240 offset:12288
  v_mfma_f32_16x16x32_bf16 v[204:207], a[20:23], a[120:123], v[204:207]
  ds_read_b64_tr_b16 a[2:3], v240 offset:14336
  v_mfma_f32_16x16x32_bf16 v[208:211], a[24:27], a[120:123], v[208:211]
  ds_read_b64_tr_b16 a[4:5], v241 offset:12288
  v_mfma_f32_16x16x32_bf16 v[212:215], a[28:31], a[120:123], v[212:215]
  ds_read_b64_tr_b16 a[6:7], v241 offset:14336
  v_mfma_f32_16x16x32_bf16 v[228:231], a[28:31], a[124:127], v[228:231]
  ds_read_b64_tr_b16 a[8:9], v242 offset:12288
  v_mfma_f32_16x16x32_bf16 v[224:227], a[24:27], a[124:127], v[224:227]
  ds_read_b64_tr_b16 a[10:11], v242 offset:14336
  v_mfma_f32_16x16x32_bf16 v[220:223], a[20:23], a[124:127], v[220:223]
  ds_read_b64_tr_b16 a[12:13], v243 offset:12288
  v_mfma_f32_16x16x32_bf16 v[216:219], a[16:19], a[124:127], v[216:219]
  ds_read_b64_tr_b16 a[14:15], v243 offset:14336
  buffer_load_dwordx4 v232, s[24:27], s62 offen offset:0 lds
  s_waitcnt vmcnt(39) lgkmcnt(8)
  v_mfma_f32_16x16x32_bf16 v[200:203], a[32:35], a[128:131], v[200:203]
  ds_read_b64_tr_b16 a[16:17], v240 offset:16384
  v_mfma_f32_16x16x32_bf16 v[204:207], a[36:39], a[128:131], v[204:207]
  ds_read_b64_tr_b16 a[18:19], v240 offset:18432
  v_mfma_f32_16x16x32_bf16 v[208:211], a[40:43], a[128:131], v[208:211]
  ds_read_b64_tr_b16 a[20:21], v241 offset:16384
  v_mfma_f32_16x16x32_bf16 v[212:215], a[44:47], a[128:131], v[212:215]
  ds_read_b64_tr_b16 a[22:23], v241 offset:18432
  v_mfma_f32_16x16x32_bf16 v[228:231], a[44:47], a[132:135], v[228:231]
  ds_read_b64_tr_b16 a[24:25], v242 offset:16384
  v_mfma_f32_16x16x32_bf16 v[224:227], a[40:43], a[132:135], v[224:227]
  ds_read_b64_tr_b16 a[26:27], v242 offset:18432
  v_mfma_f32_16x16x32_bf16 v[220:223], a[36:39], a[132:135], v[220:223]
  ds_read_b64_tr_b16 a[28:29], v243 offset:16384
  v_mfma_f32_16x16x32_bf16 v[216:219], a[32:35], a[132:135], v[216:219]
  ds_read_b64_tr_b16 a[30:31], v243 offset:18432
  buffer_load_dwordx4 v233, s[24:27], s62 offen offset:1024 lds
  s_waitcnt vmcnt(38) lgkmcnt(8)
  v_mfma_f32_16x16x32_bf16 v[200:203], a[0:3], a[136:139], v[200:203]
  ds_read_b64_tr_b16 a[32:33], v240 offset:20480
  v_mfma_f32_16x16x32_bf16 v[204:207], a[4:7], a[136:139], v[204:207]
  ds_read_b64_tr_b16 a[34:35], v240 offset:22528
  v_mfma_f32_16x16x32_bf16 v[208:211], a[8:11], a[136:139], v[208:211]
  ds_read_b64_tr_b16 a[36:37], v241 offset:20480
  v_mfma_f32_16x16x32_bf16 v[212:215], a[12:15], a[136:139], v[212:215]
  ds_read_b64_tr_b16 a[38:39], v241 offset:22528
  v_mfma_f32_16x16x32_bf16 v[228:231], a[12:15], a[140:143], v[228:231]
  ds_read_b64_tr_b16 a[40:41], v242 offset:20480
  v_mfma_f32_16x16x32_bf16 v[224:227], a[8:11], a[140:143], v[224:227]
  ds_read_b64_tr_b16 a[42:43], v242 offset:22528
  v_mfma_f32_16x16x32_bf16 v[220:223], a[4:7], a[140:143], v[220:223]
  ds_read_b64_tr_b16 a[44:45], v243 offset:20480
  v_mfma_f32_16x16x32_bf16 v[216:219], a[0:3], a[140:143], v[216:219]
  ds_read_b64_tr_b16 a[46:47], v243 offset:22528
  buffer_load_dwordx4 v234, s[24:27], s62 offen offset:2048 lds
  buffer_load_dwordx4 v235, s[24:27], s62 offen offset:3072 lds
  s_add_u32 s62, s62, 262144
  s_waitcnt vmcnt(4)
  s_cmp_lg_u32 s44, 0
  s_cbranch_scc1 gated_mix__mha_block__mixer_gmlp__prompt_kernel_c2_ok
  s_mov_b32 s53, 0x8000
gated_mix__mha_block__mixer_gmlp__prompt_kernel_c2:
  v_cmp_eq_u32 vcc, 0, v250
  s_nop 3
  s_cmp_eq_u64 vcc, 0
  s_cbranch_scc1 gated_mix__mha_block__mixer_gmlp__prompt_kernel_c2_ok
  s_sleep 8
  buffer_load_dword v250, v253, s[4:7], s52 offen sc1
  s_waitcnt vmcnt(0)
  s_sub_u32 s53, s53, 1
  s_cmp_lg_u32 s53, 0
  s_cbranch_scc1 gated_mix__mha_block__mixer_gmlp__prompt_kernel_c2
gated_mix__mha_block__mixer_gmlp__prompt_kernel_c2_ok:
  s_barrier
  buffer_load_dwordx4 a[176:179], v255, s[36:39], s60 offen offset:0 sc1
  buffer_load_dwordx4 a[180:183], v255, s[36:39], s60 offen offset:1024 sc1
  s_add_u32 s60, s60, 8192
  buffer_load_dwordx4 a[184:187], v255, s[36:39], s60 offen offset:0 sc1
  buffer_load_dwordx4 a[188:191], v255, s[36:39], s60 offen offset:1024 sc1
  s_add_u32 s60, s60, 8192
  buffer_load_dwordx4 a[192:195], v255, s[36:39], s60 offen offset:0 sc1
  buffer_load_dwordx4 a[196:199], v255, s[36:39], s60 offen offset:1024 sc1
  s_add_u32 s60, s60, 8192
  buffer_load_dwordx4 a[200:203], v255, s[36:39], s60 offen offset:0 sc1
  buffer_load_dwordx4 a[204:207], v255, s[36:39], s60 offen offset:1024 sc1
  s_add_u32 s60, s60, 8192
  s_waitcnt lgkmcnt(0)
  s_waitcnt vmcnt(43)
  s_barrier
  s_waitcnt vmcnt(38) lgkmcnt(8)
  v_mfma_f32_16x16x32_bf16 v[200:203], a[16:19], a[144:147], v[200:203]
  ds_read_b64_tr_b16 a[0:1], v240 offset:24576
  v_mfma_f32_16x16x32_bf16 v[204:207], a[20:23], a[144:147], v[204:207]
  ds_read_b64_tr_b16 a[2:3], v240 offset:26624
  v_mfma_f32_16x16x32_bf16 v[208:211], a[24:27], a[144:147], v[208:211]
  ds_read_b64_tr_b16 a[4:5], v241 offset:24576
  buffer_load_dwordx4 a[208:211], v255, s[36:39], s60 offen offset:0 sc1
  v_mfma_f32_16x16x32_bf16 v[212:215], a[28:31], a[144:147], v[212:215]
  ds_read_b64_tr_b16 a[6:7], v241 offset:26624
  v_mfma_f32_16x16x32_bf16 v[228:231], a[28:31], a[148:151], v[228:231]
  ds_read_b64_tr_b16 a[8:9], v242 offset:24576
  v_mfma_f32_16x16x32_bf16 v[224:227], a[24:27], a[148:151], v[224:227]
  ds_read_b64_tr_b16 a[10:11], v242 offset:26624
  buffer_load_dwordx4 a[212:215], v255, s[36:39], s60 offen offset:1024 sc1
  v_mfma_f32_16x16x32_bf16 v[220:223], a[20:23], a[148:151], v[220:223]
  ds_read_b64_tr_b16 a[12:13], v243 offset:24576
  v_mfma_f32_16x16x32_bf16 v[216:219], a[16:19], a[148:151], v[216:219]
  ds_read_b64_tr_b16 a[14:15], v243 offset:26624
  s_add_u32 m0, s63, 98304
  s_add_u32 s60, s60, 8192
  s_waitcnt vmcnt(38) lgkmcnt(8)
  v_mfma_f32_16x16x32_bf16 v[200:203], a[32:35], a[152:155], v[200:203]
  ds_read_b64_tr_b16 a[16:17], v240 offset:28672
  v_mfma_f32_16x16x32_bf16 v[204:207], a[36:39], a[152:155], v[204:207]
  ds_read_b64_tr_b16 a[18:19], v240 offset:30720
  v_mfma_f32_16x16x32_bf16 v[208:211], a[40:43], a[152:155], v[208:211]
  ds_read_b64_tr_b16 a[20:21], v241 offset:28672
  buffer_load_dwordx4 a[216:219], v255, s[36:39], s60 offen offset:0 sc1
  v_mfma_f32_16x16x32_bf16 v[212:215], a[44:47], a[152:155], v[212:215]
  ds_read_b64_tr_b16 a[22:23], v241 offset:30720
  v_mfma_f32_16x16x32_bf16 v[228:231], a[44:47], a[156:159], v[228:231]
  ds_read_b64_tr_b16 a[24:25], v242 offset:28672
  v_mfma_f32_16x16x32_bf16 v[224:227], a[40:43], a[156:159], v[224:227]
  ds_read_b64_tr_b16 a[26:27], v242 offset:30720
  buffer_load_dwordx4 a[220:223], v255, s[36:39], s60 offen offset:1024 sc1
  v_mfma_f32_16x16x32_bf16 v[220:223], a[36:39], a[156:159], v[220:223]
  ds_read_b64_tr_b16 a[28:29], v243 offset:28672
  v_mfma_f32_16x16x32_bf16 v[216:219], a[32:35], a[156:159], v[216:219]
  ds_read_b64_tr_b16 a[30:31], v243 offset:30720
  buffer_load_dwordx4 v232, s[24:27], s62 offen offset:0 lds
  s_add_u32 s60, s60, 8192
  s_waitcnt vmcnt(39) lgkmcnt(8)
  v_mfma_f32_16x16x32_bf16 v[200:203], a[0:3], a[160:163], v[200:203]
  ds_read_b64_tr_b16 a[32:33], v240 offset:32768
  v_mfma_f32_16x16x32_bf16 v[204:207], a[4:7], a[160:163], v[204:207]
  ds_read_b64_tr_b16 a[34:35], v240 offset:34816
  v_mfma_f32_16x16x32_bf16 v[208:211], a[8:11], a[160:163], v[208:211]
  ds_read_b64_tr_b16 a[36:37], v241 offset:32768
  buffer_load_dwordx4 a[224:227], v255, s[36:39], s60 offen offset:0 sc1
  v_mfma_f32_16x16x32_bf16 v[212:215], a[12:15], a[160:163], v[212:215]
  ds_read_b64_tr_b16 a[38:39], v241 offset:34816
  v_mfma_f32_16x16x32_bf16 v[228:231], a[12:15], a[164:167], v[228:231]
  ds_read_b64_tr_b16 a[40:41], v242 offset:32768
  v_mfma_f32_16x16x32_bf16 v[224:227], a[8:11], a[164:167], v[224:227]
  ds_read_b64_tr_b16 a[42:43], v242 offset:34816
  buffer_load_dwordx4 a[228:231], v255, s[36:39], s60 offen offset:1024 sc1
  v_mfma_f32_16x16x32_bf16 v[220:223], a[4:7], a[164:167], v[220:223]
  ds_read_b64_tr_b16 a[44:45], v243 offset:32768
  v_mfma_f32_16x16x32_bf16 v[216:219], a[0:3], a[164:167], v[216:219]
  ds_read_b64_tr_b16 a[46:47], v243 offset:34816
  buffer_load_dwordx4 v233, s[24:27], s62 offen offset:1024 lds
  s_add_u32 s60, s60, 8192
  s_waitcnt vmcnt(40) lgkmcnt(8)
  v_mfma_f32_16x16x32_bf16 v[200:203], a[16:19], a[168:171], v[200:203]
  ds_read_b64_tr_b16 a[0:1], v240 offset:36864
  v_mfma_f32_16x16x32_bf16 v[204:207], a[20:23], a[168:171], v[204:207]
  ds_read_b64_tr_b16 a[2:3], v240 offset:38912
  v_mfma_f32_16x16x32_bf16 v[208:211], a[24:27], a[168:171], v[208:211]
  ds_read_b64_tr_b16 a[4:5], v241 offset:36864
  buffer_load_dwordx4 a[64:67], v255, s[36:39], s60 offen offset:0 sc1
  v_mfma_f32_16x16x32_bf16 v[212:215], a[28:31], a[168:171], v[212:215]
  ds_read_b64_tr_b16 a[6:7], v241 offset:38912
  v_mfma_f32_16x16x32_bf16 v[228:231], a[28:31], a[172:175], v[228:231]
  ds_read_b64_tr_b16 a[8:9], v242 offset:36864
  v_mfma_f32_16x16x32_bf16 v[224:227], a[24:27], a[172:175], v[224:227]
  ds_read_b64_tr_b16 a[10:11], v242 offset:38912
  buffer_load_dwordx4 a[68:71], v255, s[36:39], s60 offen offset:1024 sc1
  v_mfma_f32_16x16x32_bf16 v[220:223], a[20:23], a[172:175], v[220:223]
  ds_read_b64_tr_b16 a[12:13], v243 offset:36864
  v_mfma_f32_16x16x32_bf16 v[216:219], a[16:19], a[172:175], v[216:219]
  ds_read_b64_tr_b16 a[14:15], v243 offset:38912
  buffer_load_dwordx4 v234, s[24:27], s62 offen offset:2048 lds
  s_add_u32 s60, s60, 8192
  buffer_load_dwordx4 v235, s[24:27], s62 offen offset:3072 lds
  s_add_u32 s62, s62, 262144
  s_nop 7
  v_mul_f32 v200, v200, v198
  v_mul_f32 v201, v201, v198
  v_mul_f32 v202, v202, v198
  v_mul_f32 v203, v203, v198
  v_mul_f32 v204, v204, v198
  v_mul_f32 v205, v205, v198
  v_mul_f32 v206, v206, v198
  v_mul_f32 v207, v207, v198
  v_mul_f32 v208, v208, v198
  v_mul_f32 v209, v209, v198
  v_mul_f32 v210, v210, v198
  v_mul_f32 v211, v211, v198
  v_mul_f32 v212, v212, v198
  v_mul_f32 v213, v213, v198
  v_mul_f32 v214, v214, v198
  v_mul_f32 v215, v215, v198
  v_mul_f32 v216, v216, v199
  v_mul_f32 v217, v217, v199
  v_mul_f32 v218, v218, v199
  v_mul_f32 v219, v219, v199
  v_mul_f32 v220, v220, v199
  v_mul_f32 v221, v221, v199
  v_mul_f32 v222, v222, v199
  v_mul_f32 v223, v223, v199
  v_mul_f32 v224, v224, v199
  v_mul_f32 v225, v225, v199
  v_mul_f32 v226, v226, v199
  v_mul_f32 v227, v227, v199
  v_mul_f32 v228, v228, v199
  v_mul_f32 v229, v229, v199
  v_mul_f32 v230, v230, v199
  v_mul_f32 v231, v231, v199
  s_nop 1
  s_waitcnt lgkmcnt(0)
  s_waitcnt vmcnt(41)
  s_barrier
  s_waitcnt vmcnt(18) lgkmcnt(8)
  v_mfma_f32_16x16x32_bf16 v[200:203], a[32:35], a[176:179], v[200:203]
  ds_read_b64_tr_b16 a[16:17], v240 offset:40960
  v_mfma_f32_16x16x32_bf16 v[204:207], a[36:39], a[176:179], v[204:207]
  ds_read_b64_tr_b16 a[18:19], v240 offset:43008
  v_mfma_f32_16x16x32_bf16 v[208:211], a[40:43], a[176:179], v[208:211]
  ds_read_b64_tr_b16 a[20:21], v241 offset:40960
  buffer_load_dwordx4 a[72:75], v255, s[36:39], s60 offen offset:0 sc1
  v_mfma_f32_16x16x32_bf16 v[212:215], a[44:47], a[176:179], v[212:215]
  ds_read_b64_tr_b16 a[22:23], v241 offset:43008
  v_mfma_f32_16x16x32_bf16 v[228:231], a[44:47], a[180:183], v[228:231]
  ds_read_b64_tr_b16 a[24:25], v242 offset:40960
  v_mfma_f32_16x16x32_bf16 v[224:227], a[40:43], a[180:183], v[224:227]
  ds_read_b64_tr_b16 a[26:27], v242 offset:43008
  buffer_load_dwordx4 a[76:79], v255, s[36:39], s60 offen offset:1024 sc1
  v_mfma_f32_16x16x32_bf16 v[220:223], a[36:39], a[180:183], v[220:223]
  ds_read_b64_tr_b16 a[28:29], v243 offset:40960
  v_mfma_f32_16x16x32_bf16 v[216:219], a[32:35], a[180:183], v[216:219]
  ds_read_b64_tr_b16 a[30:31], v243 offset:43008
  s_add_u32 m0, s63, 114688
  s_add_u32 s60, s60, 8192
  s_waitcnt vmcnt(18) lgkmcnt(8)
  v_mfma_f32_16x16x32_bf16 v[200:203], a[0:3], a[184:187], v[200:203]
  ds_read_b64_tr_b16 a[32:33], v240 offset:45056
  v_mfma_f32_16x16x32_bf16 v[204:207], a[4:7], a[184:187], v[204:207]
  ds_read_b64_tr_b16 a[34:35], v240 offset:47104
  v_mfma_f32_16x16x32_bf16 v[208:211], a[8:11], a[184:187], v[208:211]
  ds_read_b64_tr_b16 a[36:37], v241 offset:45056
  buffer_load_dwordx4 a[80:83], v255, s[36:39], s60 offen offset:0 sc1
  v_mfma_f32_16x16x32_bf16 v[212:215], a[12:15], a[184:187], v[212:215]
  ds_read_b64_tr_b16 a[38:39], v241 offset:47104
  v_mfma_f32_16x16x32_bf16 v[228:231], a[12:15], a[188:191], v[228:231]
  ds_read_b64_tr_b16 a[40:41], v242 offset:45056
  v_mfma_f32_16x16x32_bf16 v[224:227], a[8:11], a[188:191], v[224:227]
  ds_read_b64_tr_b16 a[42:43], v242 offset:47104
  buffer_load_dwordx4 a[84:87], v255, s[36:39], s60 offen offset:1024 sc1
  v_mfma_f32_16x16x32_bf16 v[220:223], a[4:7], a[188:191], v[220:223]
  ds_read_b64_tr_b16 a[44:45], v243 offset:45056
  v_mfma_f32_16x16x32_bf16 v[216:219], a[0:3], a[188:191], v[216:219]
  ds_read_b64_tr_b16 a[46:47], v243 offset:47104
  buffer_load_dwordx4 v232, s[24:27], s62 offen offset:0 lds
  s_add_u32 s60, s60, 8192
  s_waitcnt vmcnt(19) lgkmcnt(8)
  v_mfma_f32_16x16x32_bf16 v[200:203], a[16:19], a[192:195], v[200:203]
  ds_read_b64_tr_b16 a[0:1], v240 offset:49152
  v_mfma_f32_16x16x32_bf16 v[204:207], a[20:23], a[192:195], v[204:207]
  ds_read_b64_tr_b16 a[2:3], v240 offset:51200
  v_mfma_f32_16x16x32_bf16 v[208:211], a[24:27], a[192:195], v[208:211]
  ds_read_b64_tr_b16 a[4:5], v241 offset:49152
  buffer_load_dwordx4 a[88:91], v255, s[36:39], s60 offen offset:0 sc1
  v_mfma_f32_16x16x32_bf16 v[212:215], a[28:31], a[192:195], v[212:215]
  ds_read_b64_tr_b16 a[6:7], v241 offset:51200
  v_mfma_f32_16x16x32_bf16 v[228:231], a[28:31], a[196:199], v[228:231]
  ds_read_b64_tr_b16 a[8:9], v242 offset:49152
  v_mfma_f32_16x16x32_bf16 v[224:227], a[24:27], a[196:199], v[224:227]
  ds_read_b64_tr_b16 a[10:11], v242 offset:51200
  buffer_load_dwordx4 a[92:95], v255, s[36:39], s60 offen offset:1024 sc1
  v_mfma_f32_16x16x32_bf16 v[220:223], a[20:23], a[196:199], v[220:223]
  ds_read_b64_tr_b16 a[12:13], v243 offset:49152
  v_mfma_f32_16x16x32_bf16 v[216:219], a[16:19], a[196:199], v[216:219]
  ds_read_b64_tr_b16 a[14:15], v243 offset:51200
  buffer_load_dwordx4 v233, s[24:27], s62 offen offset:1024 lds
  s_add_u32 s60, s60, 8192
  s_waitcnt vmcnt(20) lgkmcnt(8)
  v_mfma_f32_16x16x32_bf16 v[200:203], a[32:35], a[200:203], v[200:203]
  ds_read_b64_tr_b16 a[16:17], v240 offset:53248
  v_mfma_f32_16x16x32_bf16 v[204:207], a[36:39], a[200:203], v[204:207]
  ds_read_b64_tr_b16 a[18:19], v240 offset:55296
  v_mfma_f32_16x16x32_bf16 v[208:211], a[40:43], a[200:203], v[208:211]
  ds_read_b64_tr_b16 a[20:21], v241 offset:53248
  buffer_load_dwordx4 a[96:99], v255, s[36:39], s60 offen offset:0 sc1
  v_mfma_f32_16x16x32_bf16 v[212:215], a[44:47], a[200:203], v[212:215]
  ds_read_b64_tr_b16 a[22:23], v241 offset:55296
  v_mfma_f32_16x16x32_bf16 v[228:231], a[44:47], a[204:207], v[228:231]
  ds_read_b64_tr_b16 a[24:25], v242 offset:53248
  v_mfma_f32_16x16x32_bf16 v[224:227], a[40:43], a[204:207], v[224:227]
  ds_read_b64_tr_b16 a[26:27], v242 offset:55296
  buffer_load_dwordx4 a[100:103], v255, s[36:39], s60 offen offset:1024 sc1
  v_mfma_f32_16x16x32_bf16 v[220:223], a[36:39], a[204:207], v[220:223]
  ds_read_b64_tr_b16 a[28:29], v243 offset:53248
  v_mfma_f32_16x16x32_bf16 v[216:219], a[32:35], a[204:207], v[216:219]
  ds_read_b64_tr_b16 a[30:31], v243 offset:55296
  buffer_load_dwordx4 v234, s[24:27], s62 offen offset:2048 lds
  s_add_u32 s60, s60, 8192
  buffer_load_dwordx4 v235, s[24:27], s62 offen offset:3072 lds
  s_add_u32 s62, s62, 262144
  s_waitcnt lgkmcnt(0)
  s_waitcnt vmcnt(45)
  s_barrier
  s_waitcnt vmcnt(22) lgkmcnt(8)
  v_mfma_f32_16x16x32_bf16 v[200:203], a[0:3], a[208:211], v[200:203]
  ds_read_b64_tr_b16 a[32:33], v240 offset:57344
  v_mfma_f32_16x16x32_bf16 v[204:207], a[4:7], a[208:211], v[204:207]
  ds_read_b64_tr_b16 a[34:35], v240 offset:59392
  v_mfma_f32_16x16x32_bf16 v[208:211], a[8:11], a[208:211], v[208:211]
  ds_read_b64_tr_b16 a[36:37], v241 offset:57344
  buffer_load_dwordx4 a[104:107], v255, s[36:39], s60 offen offset:0 sc1
  v_mfma_f32_16x16x32_bf16 v[212:215], a[12:15], a[208:211], v[212:215]
  ds_read_b64_tr_b16 a[38:39], v241 offset:59392
  v_mfma_f32_16x16x32_bf16 v[228:231], a[12:15], a[212:215], v[228:231]
  ds_read_b64_tr_b16 a[40:41], v242 offset:57344
  v_mfma_f32_16x16x32_bf16 v[224:227], a[8:11], a[212:215], v[224:227]
  ds_read_b64_tr_b16 a[42:43], v242 offset:59392
  buffer_load_dwordx4 a[108:111], v255, s[36:39], s60 offen offset:1024 sc1
  v_mfma_f32_16x16x32_bf16 v[220:223], a[4:7], a[212:215], v[220:223]
  ds_read_b64_tr_b16 a[44:45], v243 offset:57344
  v_mfma_f32_16x16x32_bf16 v[216:219], a[0:3], a[212:215], v[216:219]
  ds_read_b64_tr_b16 a[46:47], v243 offset:59392
  s_add_u32 s60, s60, 8192
  s_waitcnt vmcnt(22) lgkmcnt(8)
  v_mfma_f32_16x16x32_bf16 v[200:203], a[16:19], a[216:219], v[200:203]
  ds_read_b64_tr_b16 a[0:1], v240 offset:61440
  v_mfma_f32_16x16x32_bf16 v[204:207], a[20:23], a[216:219], v[204:207]
  ds_read_b64_tr_b16 a[2:3], v240 offset:63488
  v_mfma_f32_16x16x32_bf16 v[208:211], a[24:27], a[216:219], v[208:211]
  ds_read_b64_tr_b16 a[4:5], v241 offset:61440
  buffer_load_dwordx4 a[112:115], v255, s[36:39], s60 offen offset:0 sc1
  v_mfma_f32_16x16x32_bf16 v[212:215], a[28:31], a[216:219], v[212:215]
  ds_read_b64_tr_b16 a[6:7], v241 offset:63488
  v_mfma_f32_16x16x32_bf16 v[228:231], a[28:31], a[220:223], v[228:231]
  ds_read_b64_tr_b16 a[8:9], v242 offset:61440
  v_mfma_f32_16x16x32_bf16 v[224:227], a[24:27], a[220:223], v[224:227]
  ds_read_b64_tr_b16 a[10:11], v242 offset:63488
  buffer_load_dwordx4 a[116:119], v255, s[36:39], s60 offen offset:1024 sc1
  v_mfma_f32_16x16x32_bf16 v[220:223], a[20:23], a[220:223], v[220:223]
  ds_read_b64_tr_b16 a[12:13], v243 offset:61440
  v_mfma_f32_16x16x32_bf16 v[216:219], a[16:19], a[220:223], v[216:219]
  ds_read_b64_tr_b16 a[14:15], v243 offset:63488
  s_add_u32 s60, s60, 8192
  s_waitcnt vmcnt(21) lgkmcnt(8)
  v_mfma_f32_16x16x32_bf16 v[200:203], a[32:35], a[224:227], v[200:203]
  ds_read_b64_tr_b16 a[16:17], v236 offset:0
  v_mfma_f32_16x16x32_bf16 v[204:207], a[36:39], a[224:227], v[204:207]
  ds_read_b64_tr_b16 a[18:19], v236 offset:2048
  v_mfma_f32_16x16x32_bf16 v[208:211], a[40:43], a[224:227], v[208:211]
  ds_read_b64_tr_b16 a[20:21], v237 offset:0
  buffer_load_dwordx4 a[120:123], v255, s[36:39], s60 offen offset:0 sc1
  v_mfma_f32_16x16x32_bf16 v[212:215], a[44:47], a[224:227], v[212:215]
  ds_read_b64_tr_b16 a[22:23], v237 offset:2048
  v_mfma_f32_16x16x32_bf16 v[228:231], a[44:47], a[228:231], v[228:231]
  ds_read_b64_tr_b16 a[24:25], v238 offset:0
  v_mfma_f32_16x16x32_bf16 v[224:227], a[40:43], a[228:231], v[224:227]
  ds_read_b64_tr_b16 a[26:27], v238 offset:2048
  buffer_load_dwordx4 a[124:127], v255, s[36:39], s60 offen offset:1024 sc1
  v_mfma_f32_16x16x32_bf16 v[220:223], a[36:39], a[228:231], v[220:223]
  ds_read_b64_tr_b16 a[28:29], v239 offset:0
  v_mfma_f32_16x16x32_bf16 v[216:219], a[32:35], a[228:231], v[216:219]
  ds_read_b64_tr_b16 a[30:31], v239 offset:2048
  s_add_u32 s60, s60, 8192
  s_waitcnt vmcnt(20) lgkmcnt(8)
  v_mfma_f32_16x16x32_bf16 v[200:203], a[0:3], a[64:67], v[200:203]
  ds_read_b64_tr_b16 a[32:33], v236 offset:4096
  v_mfma_f32_16x16x32_bf16 v[204:207], a[4:7], a[64:67], v[204:207]
  ds_read_b64_tr_b16 a[34:35], v236 offset:6144
  v_mfma_f32_16x16x32_bf16 v[208:211], a[8:11], a[64:67], v[208:211]
  ds_read_b64_tr_b16 a[36:37], v237 offset:4096
  buffer_load_dwordx4 a[128:131], v255, s[36:39], s60 offen offset:0 sc1
  v_mfma_f32_16x16x32_bf16 v[212:215], a[12:15], a[64:67], v[212:215]
  ds_read_b64_tr_b16 a[38:39], v237 offset:6144
  v_mfma_f32_16x16x32_bf16 v[228:231], a[12:15], a[68:71], v[228:231]
  ds_read_b64_tr_b16 a[40:41], v238 offset:4096
  v_mfma_f32_16x16x32_bf16 v[224:227], a[8:11], a[68:71], v[224:227]
  ds_read_b64_tr_b16 a[42:43], v238 offset:6144
  buffer_load_dwordx4 a[132:135], v255, s[36:39], s60 offen offset:1024 sc1
  v_mfma_f32_16x16x32_bf16 v[220:223], a[4:7], a[68:71], v[220:223]
  ds_read_b64_tr_b16 a[44:45], v239 offset:4096
  v_mfma_f32_16x16x32_bf16 v[216:219], a[0:3], a[68:71], v[216:219]
  ds_read_b64_tr_b16 a[46:47], v239 offset:6144
  s_add_u32 s60, s60, 8192
  s_waitcnt lgkmcnt(0)
  s_waitcnt vmcnt(49)
  s_barrier
  s_waitcnt vmcnt(18) lgkmcnt(8)
  v_mfma_f32_16x16x32_bf16 v[200:203], a[16:19], a[72:75], v[200:203]
  ds_read_b64_tr_b16 a[0:1], v236 offset:8192
  v_mfma_f32_16x16x32_bf16 v[204:207], a[20:23], a[72:75], v[204:207]
  ds_read_b64_tr_b16 a[2:3], v236 offset:10240
  v_mfma_f32_16x16x32_bf16 v[208:211], a[24:27], a[72:75], v[208:211]
  ds_read_b64_tr_b16 a[4:5], v237 offset:8192
  buffer_load_dwordx4 a[136:139], v255, s[36:39], s60 offen offset:0 sc1
  v_mfma_f32_16x16x32_bf16 v[212:215], a[28:31], a[72:75], v[212:215]
  ds_read_b64_tr_b16 a[6:7], v237 offset:10240
  v_mfma_f32_16x16x32_bf16 v[228:231], a[28:31], a[76:79], v[228:231]
  ds_read_b64_tr_b16 a[8:9], v238 offset:8192
  v_mfma_f32_16x16x32_bf16 v[224:227], a[24:27], a[76:79], v[224:227]
  ds_read_b64_tr_b16 a[10:11], v238 offset:10240
  buffer_load_dwordx4 a[140:143], v255, s[36:39], s60 offen offset:1024 sc1
  v_mfma_f32_16x16x32_bf16 v[220:223], a[20:23], a[76:79], v[220:223]
  ds_read_b64_tr_b16 a[12:13], v239 offset:8192
  v_mfma_f32_16x16x32_bf16 v[216:219], a[16:19], a[76:79], v[216:219]
  ds_read_b64_tr_b16 a[14:15], v239 offset:10240
  s_add_u32 s60, s60, 8192
  s_waitcnt vmcnt(18) lgkmcnt(8)
  v_mfma_f32_16x16x32_bf16 v[200:203], a[32:35], a[80:83], v[200:203]
  ds_read_b64_tr_b16 a[16:17], v236 offset:12288
  v_mfma_f32_16x16x32_bf16 v[204:207], a[36:39], a[80:83], v[204:207]
  ds_read_b64_tr_b16 a[18:19], v236 offset:14336
  v_mfma_f32_16x16x32_bf16 v[208:211], a[40:43], a[80:83], v[208:211]
  ds_read_b64_tr_b16 a[20:21], v237 offset:12288
  buffer_load_dwordx4 a[144:147], v255, s[36:39], s60 offen offset:0 sc1
  v_mfma_f32_16x16x32_bf16 v[212:215], a[44:47], a[80:83], v[212:215]
  ds_read_b64_tr_b16 a[22:23], v237 offset:14336
  v_mfma_f32_16x16x32_bf16 v[228:231], a[44:47], a[84:87], v[228:231]
  ds_read_b64_tr_b16 a[24:25], v238 offset:12288
  v_mfma_f32_16x16x32_bf16 v[224:227], a[40:43], a[84:87], v[224:227]
  ds_read_b64_tr_b16 a[26:27], v238 offset:14336
  buffer_load_dwordx4 a[148:151], v255, s[36:39], s60 offen offset:1024 sc1
  v_mfma_f32_16x16x32_bf16 v[220:223], a[36:39], a[84:87], v[220:223]
  ds_read_b64_tr_b16 a[28:29], v239 offset:12288
  v_mfma_f32_16x16x32_bf16 v[216:219], a[32:35], a[84:87], v[216:219]
  ds_read_b64_tr_b16 a[30:31], v239 offset:14336
  s_add_u32 s60, s60, 8192
  s_waitcnt vmcnt(17) lgkmcnt(8)
  v_mfma_f32_16x16x32_bf16 v[200:203], a[0:3], a[88:91], v[200:203]
  ds_read_b64_tr_b16 a[32:33], v236 offset:16384
  v_mfma_f32_16x16x32_bf16 v[204:207], a[4:7], a[88:91], v[204:207]
  ds_read_b64_tr_b16 a[34:35], v236 offset:18432
  v_mfma_f32_16x16x32_bf16 v[208:211], a[8:11], a[88:91], v[208:211]
  ds_read_b64_tr_b16 a[36:37], v237 offset:16384
  buffer_load_dwordx4 a[152:155], v255, s[36:39], s60 offen offset:0 sc1
  v_mfma_f32_16x16x32_bf16 v[212:215], a[12:15], a[88:91], v[212:215]
  ds_read_b64_tr_b16 a[38:39], v237 offset:18432
  v_mfma_f32_16x16x32_bf16 v[228:231], a[12:15], a[92:95], v[228:231]
  ds_read_b64_tr_b16 a[40:41], v238 offset:16384
  v_mfma_f32_16x16x32_bf16 v[224:227], a[8:11], a[92:95], v[224:227]
  ds_read_b64_tr_b16 a[42:43], v238 offset:18432
  buffer_load_dwordx4 a[156:159], v255, s[36:39], s60 offen offset:1024 sc1
  v_mfma_f32_16x16x32_bf16 v[220:223], a[4:7], a[92:95], v[220:223]
  ds_read_b64_tr_b16 a[44:45], v239 offset:16384
  v_mfma_f32_16x16x32_bf16 v[216:219], a[0:3], a[92:95], v[216:219]
  ds_read_b64_tr_b16 a[46:47], v239 offset:18432
  s_add_u32 s60, s60, 8192
  s_waitcnt vmcnt(16) lgkmcnt(8)
  v_mfma_f32_16x16x32_bf16 v[200:203], a[16:19], a[96:99], v[200:203]
  ds_read_b64_tr_b16 a[0:1], v236 offset:20480
  v_mfma_f32_16x16x32_bf16 v[204:207], a[20:23], a[96:99], v[204:207]
  ds_read_b64_tr_b16 a[2:3], v236 offset:22528
  v_mfma_f32_16x16x32_bf16 v[208:211], a[24:27], a[96:99], v[208:211]
  ds_read_b64_tr_b16 a[4:5], v237 offset:20480
  buffer_load_dwordx4 a[160:163], v255, s[36:39], s60 offen offset:0 sc1
  v_mfma_f32_16x16x32_bf16 v[212:215], a[28:31], a[96:99], v[212:215]
  ds_read_b64_tr_b16 a[6:7], v237 offset:22528
  v_mfma_f32_16x16x32_bf16 v[228:231], a[28:31], a[100:103], v[228:231]
  ds_read_b64_tr_b16 a[8:9], v238 offset:20480
  v_mfma_f32_16x16x32_bf16 v[224:227], a[24:27], a[100:103], v[224:227]
  ds_read_b64_tr_b16 a[10:11], v238 offset:22528
  buffer_load_dwordx4 a[164:167], v255, s[36:39], s60 offen offset:1024 sc1
  v_mfma_f32_16x16x32_bf16 v[220:223], a[20:23], a[100:103], v[220:223]
  ds_read_b64_tr_b16 a[12:13], v239 offset:20480
  v_mfma_f32_16x16x32_bf16 v[216:219], a[16:19], a[100:103], v[216:219]
  ds_read_b64_tr_b16 a[14:15], v239 offset:22528
  s_add_u32 s60, s60, 8192
  s_waitcnt lgkmcnt(0)
  s_waitcnt vmcnt(53)
  s_barrier
  s_waitcnt vmcnt(14) lgkmcnt(8)
  v_mfma_f32_16x16x32_bf16 v[200:203], a[32:35], a[104:107], v[200:203]
  ds_read_b64_tr_b16 a[16:17], v236 offset:24576
  v_mfma_f32_16x16x32_bf16 v[204:207], a[36:39], a[104:107], v[204:207]
  ds_read_b64_tr_b16 a[18:19], v236 offset:26624
  v_mfma_f32_16x16x32_bf16 v[208:211], a[40:43], a[104:107], v[208:211]
  ds_read_b64_tr_b16 a[20:21], v237 offset:24576
  buffer_load_dwordx4 a[168:171], v255, s[36:39], s60 offen offset:0 sc1
  v_mfma_f32_16x16x32_bf16 v[212:215], a[44:47], a[104:107], v[212:215]
  ds_read_b64_tr_b16 a[22:23], v237 offset:26624
  v_mfma_f32_16x16x32_bf16 v[228:231], a[44:47], a[108:111], v[228:231]
  ds_read_b64_tr_b16 a[24:25], v238 offset:24576
  v_mfma_f32_16x16x32_bf16 v[224:227], a[40:43], a[108:111], v[224:227]
  ds_read_b64_tr_b16 a[26:27], v238 offset:26624
  buffer_load_dwordx4 a[172:175], v255, s[36:39], s60 offen offset:1024 sc1
  v_mfma_f32_16x16x32_bf16 v[220:223], a[36:39], a[108:111], v[220:223]
  ds_read_b64_tr_b16 a[28:29], v239 offset:24576
  v_mfma_f32_16x16x32_bf16 v[216:219], a[32:35], a[108:111], v[216:219]
  ds_read_b64_tr_b16 a[30:31], v239 offset:26624
  s_add_u32 s60, s60, 8192
  s_waitcnt vmcnt(14) lgkmcnt(8)
  v_mfma_f32_16x16x32_bf16 v[200:203], a[0:3], a[112:115], v[200:203]
  ds_read_b64_tr_b16 a[32:33], v236 offset:28672
  v_mfma_f32_16x16x32_bf16 v[204:207], a[4:7], a[112:115], v[204:207]
  ds_read_b64_tr_b16 a[34:35], v236 offset:30720
  v_mfma_f32_16x16x32_bf16 v[208:211], a[8:11], a[112:115], v[208:211]
  ds_read_b64_tr_b16 a[36:37], v237 offset:28672
  buffer_load_dwordx4 a[176:179], v255, s[36:39], s60 offen offset:0 sc1
  v_mfma_f32_16x16x32_bf16 v[212:215], a[12:15], a[112:115], v[212:215]
  ds_read_b64_tr_b16 a[38:39], v237 offset:30720
  v_mfma_f32_16x16x32_bf16 v[228:231], a[12:15], a[116:119], v[228:231]
  ds_read_b64_tr_b16 a[40:41], v238 offset:28672
  v_mfma_f32_16x16x32_bf16 v[224:227], a[8:11], a[116:119], v[224:227]
  ds_read_b64_tr_b16 a[42:43], v238 offset:30720
  buffer_load_dwordx4 a[180:183], v255, s[36:39], s60 offen offset:1024 sc1
  v_mfma_f32_16x16x32_bf16 v[220:223], a[4:7], a[116:119], v[220:223]
  ds_read_b64_tr_b16 a[44:45], v239 offset:28672
  v_mfma_f32_16x16x32_bf16 v[216:219], a[0:3], a[116:119], v[216:219]
  ds_read_b64_tr_b16 a[46:47], v239 offset:30720
  s_add_u32 s60, s60, 8192
  s_waitcnt vmcnt(14) lgkmcnt(8)
  v_mfma_f32_16x16x32_bf16 v[200:203], a[16:19], a[120:123], v[200:203]
  ds_read_b64_tr_b16 a[0:1], v236 offset:32768
  v_mfma_f32_16x16x32_bf16 v[204:207], a[20:23], a[120:123], v[204:207]
  ds_read_b64_tr_b16 a[2:3], v236 offset:34816
  v_mfma_f32_16x16x32_bf16 v[208:211], a[24:27], a[120:123], v[208:211]
  ds_read_b64_tr_b16 a[4:5], v237 offset:32768
  buffer_load_dwordx4 a[184:187], v255, s[36:39], s60 offen offset:0 sc1
  v_mfma_f32_16x16x32_bf16 v[212:215], a[28:31], a[120:123], v[212:215]
  ds_read_b64_tr_b16 a[6:7], v237 offset:34816
  v_mfma_f32_16x16x32_bf16 v[228:231], a[28:31], a[124:127], v[228:231]
  ds_read_b64_tr_b16 a[8:9], v238 offset:32768
  v_mfma_f32_16x16x32_bf16 v[224:227], a[24:27], a[124:127], v[224:227]
  ds_read_b64_tr_b16 a[10:11], v238 offset:34816
  buffer_load_dwordx4 a[188:191], v255, s[36:39], s60 offen offset:1024 sc1
  v_mfma_f32_16x16x32_bf16 v[220:223], a[20:23], a[124:127], v[220:223]
  ds_read_b64_tr_b16 a[12:13], v239 offset:32768
  v_mfma_f32_16x16x32_bf16 v[216:219], a[16:19], a[124:127], v[216:219]
  ds_read_b64_tr_b16 a[14:15], v239 offset:34816
  s_add_u32 s60, s60, 8192
  s_waitcnt vmcnt(14) lgkmcnt(8)
  v_mfma_f32_16x16x32_bf16 v[200:203], a[32:35], a[128:131], v[200:203]
  ds_read_b64_tr_b16 a[16:17], v236 offset:36864
  v_mfma_f32_16x16x32_bf16 v[204:207], a[36:39], a[128:131], v[204:207]
  ds_read_b64_tr_b16 a[18:19], v236 offset:38912
  v_mfma_f32_16x16x32_bf16 v[208:211], a[40:43], a[128:131], v[208:211]
  ds_read_b64_tr_b16 a[20:21], v237 offset:36864
  buffer_load_dwordx4 a[192:195], v255, s[36:39], s60 offen offset:0 sc1
  v_mfma_f32_16x16x32_bf16 v[212:215], a[44:47], a[128:131], v[212:215]
  ds_read_b64_tr_b16 a[22:23], v237 offset:38912
  v_mfma_f32_16x16x32_bf16 v[228:231], a[44:47], a[132:135], v[228:231]
  ds_read_b64_tr_b16 a[24:25], v238 offset:36864
  v_mfma_f32_16x16x32_bf16 v[224:227], a[40:43], a[132:135], v[224:227]
  ds_read_b64_tr_b16 a[26:27], v238 offset:38912
  buffer_load_dwordx4 a[196:199], v255, s[36:39], s60 offen offset:1024 sc1
  v_mfma_f32_16x16x32_bf16 v[220:223], a[36:39], a[132:135], v[220:223]
  ds_read_b64_tr_b16 a[28:29], v239 offset:36864
  v_mfma_f32_16x16x32_bf16 v[216:219], a[32:35], a[132:135], v[216:219]
  ds_read_b64_tr_b16 a[30:31], v239 offset:38912
  s_add_u32 s60, s60, 8192
  s_waitcnt lgkmcnt(0)
  s_waitcnt vmcnt(56)
  s_barrier
  s_waitcnt vmcnt(14) lgkmcnt(8)
  v_mfma_f32_16x16x32_bf16 v[200:203], a[0:3], a[136:139], v[200:203]
  ds_read_b64_tr_b16 a[32:33], v236 offset:40960
  v_mfma_f32_16x16x32_bf16 v[204:207], a[4:7], a[136:139], v[204:207]
  ds_read_b64_tr_b16 a[34:35], v236 offset:43008
  v_mfma_f32_16x16x32_bf16 v[208:211], a[8:11], a[136:139], v[208:211]
  ds_read_b64_tr_b16 a[36:37], v237 offset:40960
  buffer_load_dwordx4 a[200:203], v255, s[36:39], s60 offen offset:0 sc1
  v_mfma_f32_16x16x32_bf16 v[212:215], a[12:15], a[136:139], v[212:215]
  ds_read_b64_tr_b16 a[38:39], v237 offset:43008
  v_mfma_f32_16x16x32_bf16 v[228:231], a[12:15], a[140:143], v[228:231]
  ds_read_b64_tr_b16 a[40:41], v238 offset:40960
  v_mfma_f32_16x16x32_bf16 v[224:227], a[8:11], a[140:143], v[224:227]
  ds_read_b64_tr_b16 a[42:43], v238 offset:43008
  buffer_load_dwordx4 a[204:207], v255, s[36:39], s60 offen offset:1024 sc1
  v_mfma_f32_16x16x32_bf16 v[220:223], a[4:7], a[140:143], v[220:223]
  ds_read_b64_tr_b16 a[44:45], v239 offset:40960
  v_mfma_f32_16x16x32_bf16 v[216:219], a[0:3], a[140:143], v[216:219]
  ds_read_b64_tr_b16 a[46:47], v239 offset:43008
  s_add_u32 s60, s60, 8192
  s_waitcnt vmcnt(14) lgkmcnt(8)
  v_mfma_f32_16x16x32_bf16 v[200:203], a[16:19], a[144:147], v[200:203]
  ds_read_b64_tr_b16 a[0:1], v236 offset:45056
  v_mfma_f32_16x16x32_bf16 v[204:207], a[20:23], a[144:147], v[204:207]
  ds_read_b64_tr_b16 a[2:3], v236 offset:47104
  v_mfma_f32_16x16x32_bf16 v[208:211], a[24:27], a[144:147], v[208:211]
  ds_read_b64_tr_b16 a[4:5], v237 offset:45056
  buffer_load_dwordx4 a[208:211], v255, s[36:39], s60 offen offset:0 sc1
  v_mfma_f32_16x16x32_bf16 v[212:215], a[28:31], a[144:147], v[212:215]
  ds_read_b64_tr_b16 a[6:7], v237 offset:47104
  v_mfma_f32_16x16x32_bf16 v[228:231], a[28:31], a[148:151], v[228:231]
  ds_read_b64_tr_b16 a[8:9], v238 offset:45056
  v_mfma_f32_16x16x32_bf16 v[224:227], a[24:27], a[148:151], v[224:227]
  ds_read_b64_tr_b16 a[10:11], v238 offset:47104
  buffer_load_dwordx4 a[212:215], v255, s[36:39], s60 offen offset:1024 sc1
  v_mfma_f32_16x16x32_bf16 v[220:223], a[20:23], a[148:151], v[220:223]
  ds_read_b64_tr_b16 a[12:13], v239 offset:45056
  v_mfma_f32_16x16x32_bf16 v[216:219], a[16:19], a[148:151], v[216:219]
  ds_read_b64_tr_b16 a[14:15], v239 offset:47104
  s_add_u32 s60, s60, 8192
  s_waitcnt vmcnt(14) lgkmcnt(8)
  v_mfma_f32_16x16x32_bf16 v[200:203], a[32:35], a[152:155], v[200:203]
  ds_read_b64_tr_b16 a[16:17], v236 offset:49152
  v_mfma_f32_16x16x32_bf16 v[204:207], a[36:39], a[152:155], v[204:207]
  ds_read_b64_tr_b16 a[18:19], v236 offset:51200
  v_mfma_f32_16x16x32_bf16 v[208:211], a[40:43], a[152:155], v[208:211]
  ds_read_b64_tr_b16 a[20:21], v237 offset:49152
  buffer_load_dwordx4 a[216:219], v255, s[36:39], s60 offen offset:0 sc1
  v_mfma_f32_16x16x32_bf16 v[212:215], a[44:47], a[152:155], v[212:215]
  ds_read_b64_tr_b16 a[22:23], v237 offset:51200
  v_mfma_f32_16x16x32_bf16 v[228:231], a[44:47], a[156:159], v[228:231]
  ds_read_b64_tr_b16 a[24:25], v238 offset:49152
  v_mfma_f32_16x16x32_bf16 v[224:227], a[40:43], a[156:159], v[224:227]
  ds_read_b64_tr_b16 a[26:27], v238 offset:51200
  buffer_load_dwordx4 a[220:223], v255, s[36:39], s60 offen offset:1024 sc1
  v_mfma_f32_16x16x32_bf16 v[220:223], a[36:39], a[156:159], v[220:223]
  ds_read_b64_tr_b16 a[28:29], v239 offset:49152
  v_mfma_f32_16x16x32_bf16 v[216:219], a[32:35], a[156:159], v[216:219]
  ds_read_b64_tr_b16 a[30:31], v239 offset:51200
  s_add_u32 s60, s60, 8192
  s_waitcnt vmcnt(14) lgkmcnt(8)
  v_mfma_f32_16x16x32_bf16 v[200:203], a[0:3], a[160:163], v[200:203]
  ds_read_b64_tr_b16 a[32:33], v236 offset:53248
  v_mfma_f32_16x16x32_bf16 v[204:207], a[4:7], a[160:163], v[204:207]
  ds_read_b64_tr_b16 a[34:35], v236 offset:55296
  v_mfma_f32_16x16x32_bf16 v[208:211], a[8:11], a[160:163], v[208:211]
  ds_read_b64_tr_b16 a[36:37], v237 offset:53248
  buffer_load_dwordx4 a[224:227], v255, s[36:39], s60 offen offset:0 sc1
  v_mfma_f32_16x16x32_bf16 v[212:215], a[12:15], a[160:163], v[212:215]
  ds_read_b64_tr_b16 a[38:39], v237 offset:55296
  v_mfma_f32_16x16x32_bf16 v[228:231], a[12:15], a[164:167], v[228:231]
  ds_read_b64_tr_b16 a[40:41], v238 offset:53248
  v_mfma_f32_16x16x32_bf16 v[224:227], a[8:11], a[164:167], v[224:227]
  ds_read_b64_tr_b16 a[42:43], v238 offset:55296
  buffer_load_dwordx4 a[228:231], v255, s[36:39], s60 offen offset:1024 sc1
  v_mfma_f32_16x16x32_bf16 v[220:223], a[4:7], a[164:167], v[220:223]
  ds_read_b64_tr_b16 a[44:45], v239 offset:53248
  v_mfma_f32_16x16x32_bf16 v[216:219], a[0:3], a[164:167], v[216:219]
  ds_read_b64_tr_b16 a[46:47], v239 offset:55296
  s_add_u32 s60, s60, 8192
  s_waitcnt lgkmcnt(0)
  s_waitcnt vmcnt(44)
  s_barrier
  s_waitcnt vmcnt(14) lgkmcnt(8)
  v_mfma_f32_16x16x32_bf16 v[200:203], a[16:19], a[168:171], v[200:203]
  ds_read_b64_tr_b16 a[0:1], v236 offset:57344
  v_mfma_f32_16x16x32_bf16 v[204:207], a[20:23], a[168:171], v[204:207]
  ds_read_b64_tr_b16 a[2:3], v236 offset:59392
  v_mfma_f32_16x16x32_bf16 v[208:211], a[24:27], a[168:171], v[208:211]
  ds_read_b64_tr_b16 a[4:5], v237 offset:57344
  buffer_load_dwordx4 a[64:67], v255, s[36:39], s60 offen offset:0 sc1
  v_mfma_f32_16x16x32_bf16 v[212:215], a[28:31], a[168:171], v[212:215]
  ds_read_b64_tr_b16 a[6:7], v237 offset:59392
  v_mfma_f32_16x16x32_bf16 v[228:231], a[28:31], a[172:175], v[228:231]
  ds_read_b64_tr_b16 a[8:9], v238 offset:57344
  v_mfma_f32_16x16x32_bf16 v[224:227], a[24:27], a[172:175], v[224:227]
  ds_read_b64_tr_b16 a[10:11], v238 offset:59392
  buffer_load_dwordx4 a[68:71], v255, s[36:39], s60 offen offset:1024 sc1
  v_mfma_f32_16x16x32_bf16 v[220:223], a[20:23], a[172:175], v[220:223]
  ds_read_b64_tr_b16 a[12:13], v239 offset:57344
  v_mfma_f32_16x16x32_bf16 v[216:219], a[16:19], a[172:175], v[216:219]
  ds_read_b64_tr_b16 a[14:15], v239 offset:59392
  s_add_u32 s60, s60, 8192
  s_waitcnt vmcnt(14) lgkmcnt(8)
  v_mfma_f32_16x16x32_bf16 v[200:203], a[32:35], a[176:179], v[200:203]
  ds_read_b64_tr_b16 a[16:17], v236 offset:61440
  v_mfma_f32_16x16x32_bf16 v[204:207], a[36:39], a[176:179], v[204:207]
  ds_read_b64_tr_b16 a[18:19], v236 offset:63488
  v_mfma_f32_16x16x32_bf16 v[208:211], a[40:43], a[176:179], v[208:211]
  ds_read_b64_tr_b16 a[20:21], v237 offset:61440
  buffer_load_dwordx4 a[72:75], v255, s[36:39], s60 offen offset:0 sc1
  v_mfma_f32_16x16x32_bf16 v[212:215], a[44:47], a[176:179], v[212:215]
  ds_read_b64_tr_b16 a[22:23], v237 offset:63488
  v_mfma_f32_16x16x32_bf16 v[228:231], a[44:47], a[180:183], v[228:231]
  ds_read_b64_tr_b16 a[24:25], v238 offset:61440
  v_mfma_f32_16x16x32_bf16 v[224:227], a[40:43], a[180:183], v[224:227]
  ds_read_b64_tr_b16 a[26:27], v238 offset:63488
  buffer_load_dwordx4 a[76:79], v255, s[36:39], s60 offen offset:1024 sc1
  v_mfma_f32_16x16x32_bf16 v[220:223], a[36:39], a[180:183], v[220:223]
  ds_read_b64_tr_b16 a[28:29], v239 offset:61440
  v_mfma_f32_16x16x32_bf16 v[216:219], a[32:35], a[180:183], v[216:219]
  ds_read_b64_tr_b16 a[30:31], v239 offset:63488
  s_add_u32 s60, s60, 8192
  s_waitcnt vmcnt(14) lgkmcnt(8)
  v_mfma_f32_16x16x32_bf16 v[200:203], a[0:3], a[184:187], v[200:203]
  ds_read_b64_tr_b16 a[32:33], v240 offset:0
  v_mfma_f32_16x16x32_bf16 v[204:207], a[4:7], a[184:187], v[204:207]
  ds_read_b64_tr_b16 a[34:35], v240 offset:2048
  v_mfma_f32_16x16x32_bf16 v[208:211], a[8:11], a[184:187], v[208:211]
  ds_read_b64_tr_b16 a[36:37], v241 offset:0
  buffer_load_dwordx4 a[80:83], v255, s[36:39], s60 offen offset:0 sc1
  v_mfma_f32_16x16x32_bf16 v[212:215], a[12:15], a[184:187], v[212:215]
  ds_read_b64_tr_b16 a[38:39], v241 offset:2048
  v_mfma_f32_16x16x32_bf16 v[228:231], a[12:15], a[188:191], v[228:231]
  ds_read_b64_tr_b16 a[40:41], v242 offset:0
  v_mfma_f32_16x16x32_bf16 v[224:227], a[8:11], a[188:191], v[224:227]
  ds_read_b64_tr_b16 a[42:43], v242 offset:2048
  buffer_load_dwordx4 a[84:87], v255, s[36:39], s60 offen offset:1024 sc1
  v_mfma_f32_16x16x32_bf16 v[220:223], a[4:7], a[188:191], v[220:223]
  ds_read_b64_tr_b16 a[44:45], v243 offset:0
  v_mfma_f32_16x16x32_bf16 v[216:219], a[0:3], a[188:191], v[216:219]
  ds_read_b64_tr_b16 a[46:47], v243 offset:2048
  s_add_u32 s60, s60, 8192
  s_waitcnt vmcnt(14) lgkmcnt(8)
  v_mfma_f32_16x16x32_bf16 v[200:203], a[16:19], a[192:195], v[200:203]
  ds_read_b64_tr_b16 a[0:1], v240 offset:4096
  v_mfma_f32_16x16x32_bf16 v[204:207], a[20:23], a[192:195], v[204:207]
  ds_read_b64_tr_b16 a[2:3], v240 offset:6144
  v_mfma_f32_16x16x32_bf16 v[208:211], a[24:27], a[192:195], v[208:211]
  ds_read_b64_tr_b16 a[4:5], v241 offset:4096
  buffer_load_dwordx4 a[88:91], v255, s[36:39], s60 offen offset:0 sc1
  v_mfma_f32_16x16x32_bf16 v[212:215], a[28:31], a[192:195], v[212:215]
  ds_read_b64_tr_b16 a[6:7], v241 offset:6144
  v_mfma_f32_16x16x32_bf16 v[228:231], a[28:31], a[196:199], v[228:231]
  ds_read_b64_tr_b16 a[8:9], v242 offset:4096
  v_mfma_f32_16x16x32_bf16 v[224:227], a[24:27], a[196:199], v[224:227]
  ds_read_b64_tr_b16 a[10:11], v242 offset:6144
  buffer_load_dwordx4 a[92:95], v255, s[36:39], s60 offen offset:1024 sc1
  v_mfma_f32_16x16x32_bf16 v[220:223], a[20:23], a[196:199], v[220:223]
  ds_read_b64_tr_b16 a[12:13], v243 offset:4096
  v_mfma_f32_16x16x32_bf16 v[216:219], a[16:19], a[196:199], v[216:219]
  ds_read_b64_tr_b16 a[14:15], v243 offset:6144
  s_add_u32 s60, s60, 8192
  s_waitcnt lgkmcnt(0)
  s_waitcnt vmcnt(40)
  s_barrier
  s_waitcnt vmcnt(14) lgkmcnt(8)
  v_mfma_f32_16x16x32_bf16 v[200:203], a[32:35], a[200:203], v[200:203]
  ds_read_b64_tr_b16 a[16:17], v240 offset:8192
  v_mfma_f32_16x16x32_bf16 v[204:207], a[36:39], a[200:203], v[204:207]
  ds_read_b64_tr_b16 a[18:19], v240 offset:10240
  v_mfma_f32_16x16x32_bf16 v[208:211], a[40:43], a[200:203], v[208:211]
  ds_read_b64_tr_b16 a[20:21], v241 offset:8192
  v_mfma_f32_16x16x32_bf16 v[212:215], a[44:47], a[200:203], v[212:215]
  ds_read_b64_tr_b16 a[22:23], v241 offset:10240
  v_mfma_f32_16x16x32_bf16 v[228:231], a[44:47], a[204:207], v[228:231]
  ds_read_b64_tr_b16 a[24:25], v242 offset:8192
  v_mfma_f32_16x16x32_bf16 v[224:227], a[40:43], a[204:207], v[224:227]
  ds_read_b64_tr_b16 a[26:27], v242 offset:10240
  v_mfma_f32_16x16x32_bf16 v[220:223], a[36:39], a[204:207], v[220:223]
  ds_read_b64_tr_b16 a[28:29], v243 offset:8192
  v_mfma_f32_16x16x32_bf16 v[216:219], a[32:35], a[204:207], v[216:219]
  ds_read_b64_tr_b16 a[30:31], v243 offset:10240
  s_waitcnt vmcnt(12) lgkmcnt(8)
  v_mfma_f32_16x16x32_bf16 v[200:203], a[0:3], a[208:211], v[200:203]
  ds_read_b64_tr_b16 a[32:33], v240 offset:12288
  v_mfma_f32_16x16x32_bf16 v[204:207], a[4:7], a[208:211], v[204:207]
  ds_read_b64_tr_b16 a[34:35], v240 offset:14336
  v_mfma_f32_16x16x32_bf16 v[208:211], a[8:11], a[208:211], v[208:211]
  ds_read_b64_tr_b16 a[36:37], v241 offset:12288
  v_mfma_f32_16x16x32_bf16 v[212:215], a[12:15], a[208:211], v[212:215]
  ds_read_b64_tr_b16 a[38:39], v241 offset:14336
  v_mfma_f32_16x16x32_bf16 v[228:231], a[12:15], a[212:215], v[228:231]
  ds_read_b64_tr_b16 a[40:41], v242 offset:12288
  v_mfma_f32_16x16x32_bf16 v[224:227], a[8:11], a[212:215], v[224:227]
  ds_read_b64_tr_b16 a[42:43], v242 offset:14336
  v_mfma_f32_16x16x32_bf16 v[220:223], a[4:7], a[212:215], v[220:223]
  ds_read_b64_tr_b16 a[44:45], v243 offset:12288
  v_mfma_f32_16x16x32_bf16 v[216:219], a[0:3], a[212:215], v[216:219]
  ds_read_b64_tr_b16 a[46:47], v243 offset:14336
  s_waitcnt vmcnt(10) lgkmcnt(8)
  v_mfma_f32_16x16x32_bf16 v[200:203], a[16:19], a[216:219], v[200:203]
  ds_read_b64_tr_b16 a[0:1], v240 offset:16384
  v_mfma_f32_16x16x32_bf16 v[204:207], a[20:23], a[216:219], v[204:207]
  ds_read_b64_tr_b16 a[2:3], v240 offset:18432
  v_mfma_f32_16x16x32_bf16 v[208:211], a[24:27], a[216:219], v[208:211]
  ds_read_b64_tr_b16 a[4:5], v241 offset:16384
  v_mfma_f32_16x16x32_bf16 v[212:215], a[28:31], a[216:219], v[212:215]
  ds_read_b64_tr_b16 a[6:7], v241 offset:18432
  v_mfma_f32_16x16x32_bf16 v[228:231], a[28:31], a[220:223], v[228:231]
  ds_read_b64_tr_b16 a[8:9], v242 offset:16384
  v_mfma_f32_16x16x32_bf16 v[224:227], a[24:27], a[220:223], v[224:227]
  ds_read_b64_tr_b16 a[10:11], v242 offset:18432
  v_mfma_f32_16x16x32_bf16 v[220:223], a[20:23], a[220:223], v[220:223]
  ds_read_b64_tr_b16 a[12:13], v243 offset:16384
  v_mfma_f32_16x16x32_bf16 v[216:219], a[16:19], a[220:223], v[216:219]
  ds_read_b64_tr_b16 a[14:15], v243 offset:18432
  s_waitcnt vmcnt(8) lgkmcnt(8)
  v_mfma_f32_16x16x32_bf16 v[200:203], a[32:35], a[224:227], v[200:203]
  ds_read_b64_tr_b16 a[16:17], v240 offset:20480
  v_mfma_f32_16x16x32_bf16 v[204:207], a[36:39], a[224:227], v[204:207]
  ds_read_b64_tr_b16 a[18:19], v240 offset:22528
  v_mfma_f32_16x16x32_bf16 v[208:211], a[40:43], a[224:227], v[208:211]
  ds_read_b64_tr_b16 a[20:21], v241 offset:20480
  v_mfma_f32_16x16x32_bf16 v[212:215], a[44:47], a[224:227], v[212:215]
  ds_read_b64_tr_b16 a[22:23], v241 offset:22528
  v_mfma_f32_16x16x32_bf16 v[228:231], a[44:47], a[228:231], v[228:231]
  ds_read_b64_tr_b16 a[24:25], v242 offset:20480
  v_mfma_f32_16x16x32_bf16 v[224:227], a[40:43], a[228:231], v[224:227]
  ds_read_b64_tr_b16 a[26:27], v242 offset:22528
  v_mfma_f32_16x16x32_bf16 v[220:223], a[36:39], a[228:231], v[220:223]
  ds_read_b64_tr_b16 a[28:29], v243 offset:20480
  v_mfma_f32_16x16x32_bf16 v[216:219], a[32:35], a[228:231], v[216:219]
  ds_read_b64_tr_b16 a[30:31], v243 offset:22528
  s_waitcnt vmcnt(6) lgkmcnt(8)
  v_mfma_f32_16x16x32_bf16 v[200:203], a[0:3], a[64:67], v[200:203]
  ds_read_b64_tr_b16 a[32:33], v240 offset:24576
  v_mfma_f32_16x16x32_bf16 v[204:207], a[4:7], a[64:67], v[204:207]
  ds_read_b64_tr_b16 a[34:35], v240 offset:26624
  v_mfma_f32_16x16x32_bf16 v[208:211], a[8:11], a[64:67], v[208:211]
  ds_read_b64_tr_b16 a[36:37], v241 offset:24576
  v_mfma_f32_16x16x32_bf16 v[212:215], a[12:15], a[64:67], v[212:215]
  ds_read_b64_tr_b16 a[38:39], v241 offset:26624
  v_mfma_f32_16x16x32_bf16 v[228:231], a[12:15], a[68:71], v[228:231]
  ds_read_b64_tr_b16 a[40:41], v242 offset:24576
  v_mfma_f32_16x16x32_bf16 v[224:227], a[8:11], a[68:71], v[224:227]
  ds_read_b64_tr_b16 a[42:43], v242 offset:26624
  v_mfma_f32_16x16x32_bf16 v[220:223], a[4:7], a[68:71], v[220:223]
  ds_read_b64_tr_b16 a[44:45], v243 offset:24576
  v_mfma_f32_16x16x32_bf16 v[216:219], a[0:3], a[68:71], v[216:219]
  ds_read_b64_tr_b16 a[46:47], v243 offset:26624
  s_waitcnt vmcnt(4) lgkmcnt(8)
  v_mfma_f32_16x16x32_bf16 v[200:203], a[16:19], a[72:75], v[200:203]
  ds_read_b64_tr_b16 a[0:1], v240 offset:28672
  v_mfma_f32_16x16x32_bf16 v[204:207], a[20:23], a[72:75], v[204:207]
  ds_read_b64_tr_b16 a[2:3], v240 offset:30720
  v_mfma_f32_16x16x32_bf16 v[208:211], a[24:27], a[72:75], v[208:211]
  ds_read_b64_tr_b16 a[4:5], v241 offset:28672
  v_mfma_f32_16x16x32_bf16 v[212:215], a[28:31], a[72:75], v[212:215]
  ds_read_b64_tr_b16 a[6:7], v241 offset:30720
  v_mfma_f32_16x16x32_bf16 v[228:231], a[28:31], a[76:79], v[228:231]
  ds_read_b64_tr_b16 a[8:9], v242 offset:28672
  v_mfma_f32_16x16x32_bf16 v[224:227], a[24:27], a[76:79], v[224:227]
  ds_read_b64_tr_b16 a[10:11], v242 offset:30720
  v_mfma_f32_16x16x32_bf16 v[220:223], a[20:23], a[76:79], v[220:223]
  ds_read_b64_tr_b16 a[12:13], v243 offset:28672
  v_mfma_f32_16x16x32_bf16 v[216:219], a[16:19], a[76:79], v[216:219]
  ds_read_b64_tr_b16 a[14:15], v243 offset:30720
  s_waitcnt vmcnt(2) lgkmcnt(8)
  v_mfma_f32_16x16x32_bf16 v[200:203], a[32:35], a[80:83], v[200:203]
  v_mfma_f32_16x16x32_bf16 v[204:207], a[36:39], a[80:83], v[204:207]
  v_mfma_f32_16x16x32_bf16 v[208:211], a[40:43], a[80:83], v[208:211]
  v_mfma_f32_16x16x32_bf16 v[212:215], a[44:47], a[80:83], v[212:215]
  v_mfma_f32_16x16x32_bf16 v[228:231], a[44:47], a[84:87], v[228:231]
  v_mfma_f32_16x16x32_bf16 v[224:227], a[40:43], a[84:87], v[224:227]
  v_mfma_f32_16x16x32_bf16 v[220:223], a[36:39], a[84:87], v[220:223]
  v_mfma_f32_16x16x32_bf16 v[216:219], a[32:35], a[84:87], v[216:219]
  s_waitcnt vmcnt(0) lgkmcnt(0)
  v_mfma_f32_16x16x32_bf16 v[200:203], a[0:3], a[88:91], v[200:203]
  v_mfma_f32_16x16x32_bf16 v[204:207], a[4:7], a[88:91], v[204:207]
  v_mfma_f32_16x16x32_bf16 v[208:211], a[8:11], a[88:91], v[208:211]
  v_mfma_f32_16x16x32_bf16 v[212:215], a[12:15], a[88:91], v[212:215]
  v_mfma_f32_16x16x32_bf16 v[228:231], a[12:15], a[92:95], v[228:231]
  v_mfma_f32_16x16x32_bf16 v[224:227], a[8:11], a[92:95], v[224:227]
  v_mfma_f32_16x16x32_bf16 v[220:223], a[4:7], a[92:95], v[220:223]
  v_mfma_f32_16x16x32_bf16 v[216:219], a[0:3], a[92:95], v[216:219]
  v_and_b32 v192, 15, v254
  v_lshrrev_b32 v193, 2, v192
  v_lshlrev_b32 v193, 3, v193
  v_and_b32 v192, 3, v192
  v_add_u32 v192, v192, v193
  v_lshlrev_b32 v192, 11, v192
  v_bfe_u32 v193, v254, 4, 1
  v_lshl_add_u32 v192, v193, 5, v192
  v_lshrrev_b32 v193, 5, v254
  v_lshl_add_u32 v192, v193, 4, v192
  s_lshl_b32 s64, s47, 2
  s_add_u32 s64, s64, s44
  s_lshl_b32 s64, s64, 16
  s_lshl_b32 s65, s48, 7
  s_add_u32 s64, s64, s65
  s_add_u32 s65, s64, 8192
  v_cvt_pk_bf16_f32 v128, v200, v201
  v_cvt_pk_bf16_f32 v129, v202, v203
  v_cvt_pk_bf16_f32 v130, v204, v205
  v_cvt_pk_bf16_f32 v131, v206, v207
  v_cvt_pk_bf16_f32 v132, v208, v209
  v_cvt_pk_bf16_f32 v133, v210, v211
  v_cvt_pk_bf16_f32 v134, v212, v213
  v_cvt_pk_bf16_f32 v135, v214, v215
  v_cvt_pk_bf16_f32 v136, v216, v217
  v_cvt_pk_bf16_f32 v137, v218, v219
  v_cvt_pk_bf16_f32 v138, v220, v221
  v_cvt_pk_bf16_f32 v139, v222, v223
  v_cvt_pk_bf16_f32 v140, v224, v225
  v_cvt_pk_bf16_f32 v141, v226, v227
  v_cvt_pk_bf16_f32 v142, v228, v229
  v_cvt_pk_bf16_f32 v143, v230, v231
  s_nop 1
  v_permlane16_swap_b32 v128, v130
  v_permlane16_swap_b32 v129, v131
  v_permlane16_swap_b32 v132, v134
  v_permlane16_swap_b32 v133, v135
  v_permlane16_swap_b32 v136, v138
  v_permlane16_swap_b32 v137, v139
  v_permlane16_swap_b32 v140, v142
  v_permlane16_swap_b32 v141, v143
  buffer_store_dwordx4 v[128:131], v192, s[40:43], s64 offen offset:0 sc1
  buffer_store_dwordx4 v[132:135], v192, s[40:43], s64 offen offset:64 sc1
  buffer_store_dwordx4 v[136:139], v192, s[40:43], s65 offen offset:0 sc1
  buffer_store_dwordx4 v[140:143], v192, s[40:43], s65 offen offset:64 sc1
  s_endpgm
gated_mix__mha_block__mixer_gmlp__prompt_kernel_slow:
  v_and_b32 v21, 2048, v172
  v_lshrrev_b32 v21, 1, v21
  v_sub_u32 v21, v172, v21
  v_mov_b32 v16, 0xff800000
  v_mov_b32 v17, 0
  v_mov_b32 v32, 0
  v_mov_b32 v33, 0
  v_mov_b32 v34, 0
  v_mov_b32 v35, 0
  v_mov_b32 v36, 0
  v_mov_b32 v37, 0
  v_mov_b32 v38, 0
  v_mov_b32 v39, 0
  v_mov_b32 v40, 0
  v_mov_b32 v41, 0
  v_mov_b32 v42, 0
  v_mov_b32 v43, 0
  v_mov_b32 v44, 0
  v_mov_b32 v45, 0
  v_mov_b32 v46, 0
  v_mov_b32 v47, 0
  s_mov_b32 s66, 0
gated_mix__mha_block__mixer_gmlp__prompt_kernel_slow0:
  buffer_load_dwordx4 v[128:131], v21, s[8:11], s66 offen offset:0 sc1
  buffer_load_dwordx4 v[144:147], v21, s[12:15], s66 offen offset:1024 sc1
  buffer_load_dwordx4 v[132:135], v21, s[8:11], s66 offen offset:512 sc1
  buffer_load_dwordx4 v[148:151], v21, s[12:15], s66 offen offset:1536 sc1
  s_waitcnt vmcnt(0)
  v_mfma_f32_32x32x16_bf16 v[0:15], v[128:131], v[112:115], 0
  v_mfma_f32_32x32x16_bf16 v[0:15], v[132:135], v[116:119], v[0:15]
  s_nop 15
  v_max3_f32 v18, v0, v1, v2
  v_max3_f32 v18, v18, v3, v4
  v_max3_f32 v18, v18, v5, v6
  v_max3_f32 v18, v18, v7, v8
  v_max3_f32 v18, v18, v9, v10
  v_max3_f32 v18, v18, v11, v12
  v_max3_f32 v18, v18, v13, v14
  v_max3_f32 v18, v18, v15, v16
  v_mov_b32 v19, v18
  s_nop 1
  v_permlane32_swap_b32 v18, v19
  s_nop 1
  v_max_f32 v18, v18, v19
  v_sub_f32 v20, v16, v18
  v_exp_f32 v20, v20
  v_mov_b32 v16, v18
  v_sub_f32 v0, v0, v18
  v_sub_f32 v1, v1, v18
  v_sub_f32 v2, v2, v18
  v_sub_f32 v3, v3, v18
  v_sub_f32 v4, v4, v18
  v_sub_f32 v5, v5, v18
  v_sub_f32 v6, v6, v18
  v_sub_f32 v7, v7, v18
  v_sub_f32 v8, v8, v18
  v_sub_f32 v9, v9, v18
  v_sub_f32 v10, v10, v18
  v_sub_f32 v11, v11, v18
  v_sub_f32 v12, v12, v18
  v_sub_f32 v13, v13, v18
  v_sub_f32 v14, v14, v18
  v_sub_f32 v15, v15, v18
  v_exp_f32 v0, v0
  v_exp_f32 v1, v1
  v_exp_f32 v2, v2
  v_exp_f32 v3, v3
  v_exp_f32 v4, v4
  v_exp_f32 v5, v5
  v_exp_f32 v6, v6
  v_exp_f32 v7, v7
  v_exp_f32 v8, v8
  v_exp_f32 v9, v9
  v_exp_f32 v10, v10
  v_exp_f32 v11, v11
  v_exp_f32 v12, v12
  v_exp_f32 v13, v13
  v_exp_f32 v14, v14
  v_exp_f32 v15, v15
  v_mul_f32 v17, v17, v20
  v_mul_f32 v32, v32, v20
  v_mul_f32 v33, v33, v20
  v_mul_f32 v34, v34, v20
  v_mul_f32 v35, v35, v20
  v_mul_f32 v36, v36, v20
  v_mul_f32 v37, v37, v20
  v_mul_f32 v38, v38, v20
  v_mul_f32 v39, v39, v20
  v_mul_f32 v40, v40, v20
  v_mul_f32 v41, v41, v20
  v_mul_f32 v42, v42, v20
  v_mul_f32 v43, v43, v20
  v_mul_f32 v44, v44, v20
  v_mul_f32 v45, v45, v20
  v_mul_f32 v46, v46, v20
  v_mul_f32 v47, v47, v20
  v_add_f32 v17, v17, v0
  v_add_f32 v17, v17, v1
  v_add_f32 v17, v17, v2
  v_add_f32 v17, v17, v3
  v_add_f32 v17, v17, v4
  v_add_f32 v17, v17, v5
  v_add_f32 v17, v17, v6
  v_add_f32 v17, v17, v7
  v_add_f32 v17, v17, v8
  v_add_f32 v17, v17, v9
  v_add_f32 v17, v17, v10
  v_add_f32 v17, v17, v11
  v_add_f32 v17, v17, v12
  v_add_f32 v17, v17, v13
  v_add_f32 v17, v17, v14
  v_add_f32 v17, v17, v15
  v_cvt_pk_bf16_f32 v96, v0, v1
  v_cvt_pk_bf16_f32 v97, v2, v3
  v_cvt_pk_bf16_f32 v98, v4, v5
  v_cvt_pk_bf16_f32 v99, v6, v7
  v_cvt_pk_bf16_f32 v100, v8, v9
  v_cvt_pk_bf16_f32 v101, v10, v11
  v_cvt_pk_bf16_f32 v102, v12, v13
  v_cvt_pk_bf16_f32 v103, v14, v15
  s_nop 1
  v_mfma_f32_32x32x16_bf16 v[32:47], v[144:147], v[96:99], v[32:47]
  v_mfma_f32_32x32x16_bf16 v[32:47], v[148:151], v[100:103], v[32:47]
  s_add_u32 s66, s66, 2048
  s_cmp_lt_u32 s66, 131072
  s_nop 15
  s_cbranch_scc1 gated_mix__mha_block__mixer_gmlp__prompt_kernel_slow0
  v_mov_b32 v18, v17
  s_nop 1
  v_permlane32_swap_b32 v17, v18
  s_nop 1
  v_add_f32 v184, v17, v18
  v_mov_b32 v16, 0xff800000
  v_mov_b32 v17, 0
  v_mov_b32 v48, 0
  v_mov_b32 v49, 0
  v_mov_b32 v50, 0
  v_mov_b32 v51, 0
  v_mov_b32 v52, 0
  v_mov_b32 v53, 0
  v_mov_b32 v54, 0
  v_mov_b32 v55, 0
  v_mov_b32 v56, 0
  v_mov_b32 v57, 0
  v_mov_b32 v58, 0
  v_mov_b32 v59, 0
  v_mov_b32 v60, 0
  v_mov_b32 v61, 0
  v_mov_b32 v62, 0
  v_mov_b32 v63, 0
  s_mov_b32 s66, 0
gated_mix__mha_block__mixer_gmlp__prompt_kernel_slow1:
  buffer_load_dwordx4 v[128:131], v21, s[8:11], s66 offen offset:0 sc1
  buffer_load_dwordx4 v[144:147], v21, s[12:15], s66 offen offset:1024 sc1
  buffer_load_dwordx4 v[132:135], v21, s[8:11], s66 offen offset:512 sc1
  buffer_load_dwordx4 v[148:151], v21, s[12:15], s66 offen offset:1536 sc1
  s_waitcnt vmcnt(0)
  v_mfma_f32_32x32x16_bf16 v[0:15], v[128:131], v[120:123], 0
  v_mfma_f32_32x32x16_bf16 v[0:15], v[132:135], v[124:127], v[0:15]
  s_nop 15
  v_max3_f32 v18, v0, v1, v2
  v_max3_f32 v18, v18, v3, v4
  v_max3_f32 v18, v18, v5, v6
  v_max3_f32 v18, v18, v7, v8
  v_max3_f32 v18, v18, v9, v10
  v_max3_f32 v18, v18, v11, v12
  v_max3_f32 v18, v18, v13, v14
  v_max3_f32 v18, v18, v15, v16
  v_mov_b32 v19, v18
  s_nop 1
  v_permlane32_swap_b32 v18, v19
  s_nop 1
  v_max_f32 v18, v18, v19
  v_sub_f32 v20, v16, v18
  v_exp_f32 v20, v20
  v_mov_b32 v16, v18
  v_sub_f32 v0, v0, v18
  v_sub_f32 v1, v1, v18
  v_sub_f32 v2, v2, v18
  v_sub_f32 v3, v3, v18
  v_sub_f32 v4, v4, v18
  v_sub_f32 v5, v5, v18
  v_sub_f32 v6, v6, v18
  v_sub_f32 v7, v7, v18
  v_sub_f32 v8, v8, v18
  v_sub_f32 v9, v9, v18
  v_sub_f32 v10, v10, v18
  v_sub_f32 v11, v11, v18
  v_sub_f32 v12, v12, v18
  v_sub_f32 v13, v13, v18
  v_sub_f32 v14, v14, v18
  v_sub_f32 v15, v15, v18
  v_exp_f32 v0, v0
  v_exp_f32 v1, v1
  v_exp_f32 v2, v2
  v_exp_f32 v3, v3
  v_exp_f32 v4, v4
  v_exp_f32 v5, v5
  v_exp_f32 v6, v6
  v_exp_f32 v7, v7
  v_exp_f32 v8, v8
  v_exp_f32 v9, v9
  v_exp_f32 v10, v10
  v_exp_f32 v11, v11
  v_exp_f32 v12, v12
  v_exp_f32 v13, v13
  v_exp_f32 v14, v14
  v_exp_f32 v15, v15
  v_mul_f32 v17, v17, v20
  v_mul_f32 v48, v48, v20
  v_mul_f32 v49, v49, v20
  v_mul_f32 v50, v50, v20
  v_mul_f32 v51, v51, v20
  v_mul_f32 v52, v52, v20
  v_mul_f32 v53, v53, v20
  v_mul_f32 v54, v54, v20
  v_mul_f32 v55, v55, v20
  v_mul_f32 v56, v56, v20
  v_mul_f32 v57, v57, v20
  v_mul_f32 v58, v58, v20
  v_mul_f32 v59, v59, v20
  v_mul_f32 v60, v60, v20
  v_mul_f32 v61, v61, v20
  v_mul_f32 v62, v62, v20
  v_mul_f32 v63, v63, v20
  v_add_f32 v17, v17, v0
  v_add_f32 v17, v17, v1
  v_add_f32 v17, v17, v2
  v_add_f32 v17, v17, v3
  v_add_f32 v17, v17, v4
  v_add_f32 v17, v17, v5
  v_add_f32 v17, v17, v6
  v_add_f32 v17, v17, v7
  v_add_f32 v17, v17, v8
  v_add_f32 v17, v17, v9
  v_add_f32 v17, v17, v10
  v_add_f32 v17, v17, v11
  v_add_f32 v17, v17, v12
  v_add_f32 v17, v17, v13
  v_add_f32 v17, v17, v14
  v_add_f32 v17, v17, v15
  v_cvt_pk_bf16_f32 v96, v0, v1
  v_cvt_pk_bf16_f32 v97, v2, v3
  v_cvt_pk_bf16_f32 v98, v4, v5
  v_cvt_pk_bf16_f32 v99, v6, v7
  v_cvt_pk_bf16_f32 v100, v8, v9
  v_cvt_pk_bf16_f32 v101, v10, v11
  v_cvt_pk_bf16_f32 v102, v12, v13
  v_cvt_pk_bf16_f32 v103, v14, v15
  s_nop 1
  v_mfma_f32_32x32x16_bf16 v[48:63], v[144:147], v[96:99], v[48:63]
  v_mfma_f32_32x32x16_bf16 v[48:63], v[148:151], v[100:103], v[48:63]
  s_add_u32 s66, s66, 2048
  s_cmp_lt_u32 s66, 131072
  s_nop 15
  s_cbranch_scc1 gated_mix__mha_block__mixer_gmlp__prompt_kernel_slow1
  v_mov_b32 v18, v17
  s_nop 1
  v_permlane32_swap_b32 v17, v18
  s_nop 1
  v_add_f32 v185, v17, v18
  s_branch gated_mix__mha_block__mixer_gmlp__prompt_kernel_afin
gated_mix__mha_block__mixer_gmlp__prompt_kernel_end:
  s_endpgm
.p2align 6
code_end:
  s_endpgm
.section .rodata,"a"
.p2align 6
.amdhsa_kernel gated_mix__mha_block__mixer_gmlp__prompt_kernel
  .amdhsa_next_free_vgpr 512
  .amdhsa_next_free_sgpr 102
  .amdhsa_accum_offset 256
  .amdhsa_group_segment_fixed_size 0
  .amdhsa_kernarg_size 96
  .amdhsa_user_sgpr_count 2
  .amdhsa_user_sgpr_kernarg_segment_ptr 1
  .amdhsa_system_sgpr_workgroup_id_x 1
  .amdhsa_float_denorm_mode_32 3
.end_amdhsa_kernel
```
